```python
import torch

def _softmax(x, axis=-1):
    return torch.softmax(x, dim=axis)
def _gelu(x):
    return torch.nn.functional.gelu(x, approximate="tanh")
def _silu(x):
    return torch.nn.functional.silu(x)
def _sigmoid(x):
    return torch.sigmoid(x)
def _layernorm(x, axis=-1, eps=1e-5):
    m = x.mean(dim=axis, keepdim=True)
    v = x.var(dim=axis, keepdim=True, unbiased=False)
    return (x - m) / torch.sqrt(v + eps)
def _scatter_add(tgt, idx, src, axis=0):
    return tgt.clone().index_add_(axis, idx, src)
def _segment_sum(src, seg, n):
    out = torch.zeros((n,) + src.shape[1:], dtype=src.dtype)
    return out.index_add_(0, seg, src)
def _pad(x, pw):
    flat = tuple(v for pair in reversed(pw) for v in pair)
    return torch.nn.functional.pad(x, flat)

kernel_name = 'concat_heads__mha_block_cached__gqa_block_cached__near_ridge'

def setup_inputs():

    _w = (lambda a: (lambda t: t.to(torch.bfloat16) if t.is_floating_point() else t)(torch.as_tensor(a)))
    def _A_setup():
        B, Sq, D = 16, 144, 512
        H, Sk, Dh = 32, 512, 128
        return {
            "x": _w((lambda *s: torch.randn(*s, dtype=torch.bfloat16) * 0.8)(B, Sq, D)),
            "k_cache": _w((lambda *s: torch.randn(*s, dtype=torch.bfloat16) * 0.8)(B, H, Sk, Dh)),
            "v_cache": _w((lambda *s: torch.randn(*s, dtype=torch.bfloat16) * 0.05)(B, H, Sk, Dh)),
            "wq": _w((lambda *s: torch.randn(*s, dtype=torch.bfloat16) * 0.8)(D, H * Dh) * (D ** -0.5)),
            "wo": _w((lambda *s: torch.randn(*s, dtype=torch.bfloat16) * 0.05)(H * Dh, D) * ((H * Dh) ** -0.5)),
        }
    _A_in = _A_setup()

    def _B_setup():
        B, Sq, D = 16, 144, 512
        Hq, Hkv, Sk, Dh = 32, 32, 512, 128
        assert Hq % Hkv == 0, (Hq, Hkv)
        return {
            "x": _w((lambda *s: torch.randn(*s, dtype=torch.bfloat16) * 0.8)(B, Sq, D)),
            "k_cache": _w((lambda *s: torch.randn(*s, dtype=torch.bfloat16) * 0.8)(B, Hkv, Sk, Dh)),
            "v_cache": _w((lambda *s: torch.randn(*s, dtype=torch.bfloat16) * 0.05)(B, Hkv, Sk, Dh)),
            "wq": _w((lambda *s: torch.randn(*s, dtype=torch.bfloat16) * 0.8)(D, Hq * Dh) * (D ** -0.5)),
            "wo": _w((lambda *s: torch.randn(*s, dtype=torch.bfloat16) * 0.05)(Hq * Dh, D) * ((Hq * Dh) ** -0.5)),
        }
    _B_in = _B_setup()

    return {
        "A_x": _A_in["x"],
        "A_k_cache": _A_in["k_cache"],
        "A_v_cache": _A_in["v_cache"],
        "A_wq": _A_in["wq"],
        "A_wo": _A_in["wo"],
        "B_x": _B_in["x"],
        "B_k_cache": _B_in["k_cache"],
        "B_v_cache": _B_in["v_cache"],
        "B_wq": _B_in["wq"],
        "B_wo": _B_in["wo"],
    }

def reference(A_x, A_k_cache, A_v_cache, A_wq, A_wo, B_x, B_k_cache, B_v_cache, B_wq, B_wo):
    def _A_ref(x, k_cache, v_cache, wq, wo):
        B, Sq, D = x.shape
        H, Dh = 32, 128
        q = (lambda x, *d: x.permute(*d))((x @ wq).reshape(B, Sq, H, Dh), 0, 2, 1, 3)
        scores = torch.einsum("bhqd,bhkd->bhqk", q, k_cache) * (Dh ** -0.5)
        p = _softmax(scores, axis=-1)
        o = torch.einsum("bhqk,bhkd->bhqd", p, v_cache)
        return (lambda x, *d: x.permute(*d))(o, 0, 2, 1, 3).reshape(B, Sq, H * Dh) @ wo

    def _B_ref(x, k_cache, v_cache, wq, wo):
        B, Sq, D = x.shape
        Hq, Dh = 32, 128
        Hkv = k_cache.shape[1]
        rep = Hq // Hkv
        q = (lambda x, *d: x.permute(*d))((x @ wq).reshape(B, Sq, Hq, Dh), 0, 2, 1, 3)
        k = (lambda x, n, axis: torch.repeat_interleave(x, n, dim=axis))(k_cache, rep, axis=1)
        v = (lambda x, n, axis: torch.repeat_interleave(x, n, dim=axis))(v_cache, rep, axis=1)
        scores = torch.einsum("bhqd,bhkd->bhqk", q, k) * (Dh ** -0.5)
        p = _softmax(scores, axis=-1)
        o = torch.einsum("bhqk,bhkd->bhqd", p, v)
        return (lambda x, *d: x.permute(*d))(o, 0, 2, 1, 3).reshape(B, Sq, Hq * Dh) @ wo

    a = _A_ref(A_x, A_k_cache, A_v_cache, A_wq, A_wo)
    b = _B_ref(B_x, B_k_cache, B_v_cache, B_wq, B_wo)
    return torch.concatenate([a, b], axis=-1)
```

```asm
; @launch grid=(256,1,1) block=(512,1,1) lds=163840
.amdgcn_target "amdgcn-amd-amdhsa--gfx950"
.text
.globl concat_heads__mha_block_cached__gqa_block_cached__near_ridge_kernel
.p2align 8
.type concat_heads__mha_block_cached__gqa_block_cached__near_ridge_kernel,@function
concat_heads__mha_block_cached__gqa_block_cached__near_ridge_kernel:
    s_cmp_ge_u32 s2, 256
    s_cbranch_scc1 L_end
    s_and_b32 s41, s2, 7
    s_lshr_b32 s42, s2, 3
    s_lshr_b32 s43, s41, 2
    s_mul_i32 s44, s43, 40
    s_add_u32 s98, s0, s44
    s_addc_u32 s99, s1, 0
    s_load_dwordx2 s[12:13], s[98:99], 0
    s_load_dwordx2 s[16:17], s[98:99], 24
    s_load_dwordx2 s[4:5], s[98:99], 8
    s_load_dwordx2 s[8:9], s[98:99], 16
    s_load_dwordx2 s[20:21], s[98:99], 32
    s_load_dwordx2 s[24:25], s[0:1], 80
    s_load_dwordx2 s[32:33], s[0:1], 88
    s_load_dwordx2 s[28:29], s[0:1], 96
    s_getpc_b64 s[96:97]
L_pc0:
    s_sub_u32 s96, s96, L_pc0-concat_heads__mha_block_cached__gqa_block_cached__near_ridge_kernel
    s_subb_u32 s97, s97, 0
    s_lshl_b32 s44, s42, 7
    v_lshlrev_b32 v2, 12, v0
    v_add_u32 v2, s44, v2
    v_min_u32 v2, L_end-concat_heads__mha_block_cached__gqa_block_cached__near_ridge_kernel, v2
    v_mov_b32 v3, s97
    v_add_co_u32 v2, vcc, s96, v2
    s_nop 1
    v_addc_co_u32 v3, vcc, 0, v3, vcc
    global_load_dword v255, v[2:3], off
    v_lshrrev_b32 v1, 6, v0
    v_and_b32 v0, 63, v0
    v_readfirstlane_b32 s37, v1
    s_and_b32 s41, s41, 3
    s_and_b32 s62, s41, 0
    s_lshr_b32 s63, s41, 0
    s_mul_i32 s62, s62, 16
    s_mul_i32 s63, s63, 2
    s_and_b32 s3, s42, 15
    s_add_u32 s62, s62, s3
    s_lshr_b32 s42, s42, 4
    s_add_u32 s39, s63, s42
    s_and_b32 s44, s3, 7
    s_add_u32 s94, s39, s44
    s_and_b32 s94, s94, 7
    s_sub_u32 s96, s39, s44
    s_lshl_b32 s44, s44, 2
    s_add_u32 s44, s44, 4
    s_mov_b32 s100, 1985229328
    s_mov_b32 s101, 1985229328
    s_lshr_b64 s[100:101], s[100:101], s44
    s_mov_b32 s101, s96
    s_lshr_b32 s95, s39, 0
    s_and_b32 s95, s95, 1
    s_lshl_b32 s95, s95, 9
    s_and_b32 s95, s95, 0x3ff
    s_lshl_b32 s40, s43, 4
    s_add_u32 s40, s40, s62
    s_and_b32 s36, s37, 3
    s_lshr_b32 s37, s37, 2
    s_lshl_b32 s47, s36, 10
    s_mov_b32 s49, 0
    s_lshl_b32 s48, s36, 13
    s_lshl_b32 s46, s36, 11
    s_add_u32 s46, s46, 65536
    s_and_b32 s41, s36, 1
    s_and_b32 s42, s36, 2
    s_lshl_b32 s42, s42, 1
    s_add_u32 s41, s41, s42
    s_lshl_b32 s45, s41, 10
    s_mov_b32 s14, 147456
    s_mov_b32 s15, 0x20000
    s_mov_b32 s6, 4194304
    s_mov_b32 s7, 0x20000
    s_mov_b32 s10, 4194304
    s_mov_b32 s11, 0x20000
    s_mov_b32 s18, 4194304
    s_mov_b32 s19, 0x20000
    s_mov_b32 s22, 4194304
    s_mov_b32 s23, 0x20000
    s_mov_b32 s26, 294912
    s_mov_b32 s27, 0x20000
    s_mov_b32 s30, 289931264
    s_mov_b32 s31, 0x20000
    s_mov_b32 s34, 256
    s_mov_b32 s35, 0x20000
    s_mul_i32 s50, s62, 147456
    s_lshl_b32 s52, s62, 22
    s_lshl_b32 s88, s39, 19
    s_add_u32 s89, s88, 0x40000
    s_mul_i32 s53, s62, 294912
L_role:
    s_cmp_eq_u32 s37, 1
    s_cbranch_scc1 L_B
L_A:
    v_and_b32 v180, 15, v0
    v_lshrrev_b32 v181, 4, v0
    s_and_b32 s41, s36, 1
    s_lshr_b32 s42, s36, 1
    s_lshl_b32 s43, s41, 3
    v_lshlrev_b32 v182, 1, v181
    v_add_u32 v182, s43, v182
    v_xor_b32 v182, v182, v180
    v_lshlrev_b32 v182, 4, v182
    v_lshl_add_u32 v177, v181, 13, v182
    s_lshl_b32 s43, s36, 16
    v_add_u32 v177, s43, v177
    v_lshl_add_u32 v176, v181, 8, v182
    v_add_u32 v176, s45, v176
    v_lshrrev_b32 v182, 3, v0
    v_and_b32 v183, 7, v0
    v_and_b32 v178, 6, v182
    v_xor_b32 v178, v178, v183
    v_lshlrev_b32 v178, 4, v178
    v_lshl_add_u32 v178, v182, 10, v178
    s_lshl_b32 s43, s36, 15
    v_add_u32 v178, s43, v178
    v_xor_b32 v179, v181, v183
    v_lshlrev_b32 v179, 4, v179
    v_lshl_add_u32 v179, v182, 10, v179
    s_lshl_b32 s43, s41, 13
    s_lshl_b32 s44, s42, 7
    s_add_u32 s43, s43, s44
    s_add_u32 s43, s43, 131072
    v_add_u32 v179, s43, v179
    s_lshr_b32 s60, s88, 9
    s_lshl_b32 s62, s36, 12
    s_lshl_b32 s41, s36, 6
    v_add_u32 v244, s41, v0
    v_cmp_gt_u32 vcc, 64, v244
    v_and_b32 v245, 1, v244
    v_lshrrev_b32 v244, 1, v244
    v_lshlrev_b32 v244, 17, v244
    v_lshl_add_u32 v244, v245, 7, v244
    v_mov_b32 v245, 0x40000000
    s_lshl_b32 s42, s3, 13
    s_add_u32 s42, s42, s60
    v_cndmask_b32 v244, v245, v244, vcc
    v_add_u32 v244, s42, v244
    s_lshl_b32 s41, s95, 12
    s_add_u32 s60, s60, s41
    s_waitcnt lgkmcnt(0)
    s_add_u32 s12, s12, s50
    s_addc_u32 s13, s13, 0
    s_add_u32 s4, s4, s52
    s_addc_u32 s5, s5, 0
    s_add_u32 s8, s8, s52
    s_addc_u32 s9, s9, 0
    s_add_u32 s24, s24, s53
    s_addc_u32 s25, s25, 0
    s_add_u32 m0, s62, 0
    s_add_u32 s41, s95, 0
    s_and_b32 s41, s41, 0x3ff
    buffer_load_dwordx4 v178, s[12:15], s41 offen  lds
    s_add_u32 s41, s41, 7168
    buffer_load_dwordx4 v178, s[12:15], s41 offen offset:1024  lds
    s_add_u32 s41, s41, 7168
    buffer_load_dwordx4 v178, s[12:15], s41 offen offset:2048  lds
    s_add_u32 s41, s41, 7168
    buffer_load_dwordx4 v178, s[12:15], s41 offen offset:3072  lds
    s_add_u32 m0, s47, 151552
    s_add_u32 s41, s95, 0
    s_and_b32 s41, s41, 0x3ff
    buffer_load_dwordx4 v179, s[12:15], s41 offen  lds
    s_add_u32 m0, s46, 0
    s_add_u32 s41, s60, 0
    s_and_b32 s41, s41, 0x3fffff
    buffer_load_dwordx4 v177, s[16:19], s41 offen  lds
    s_add_u32 s41, s41, 31744
    buffer_load_dwordx4 v177, s[16:19], s41 offen offset:1024  lds
    s_add_u32 m0, s46, 8192
    s_add_u32 s41, s60, 262144
    s_and_b32 s41, s41, 0x3fffff
    buffer_load_dwordx4 v177, s[16:19], s41 offen  lds
    s_add_u32 s41, s41, 31744
    buffer_load_dwordx4 v177, s[16:19], s41 offen offset:1024  lds
    s_add_u32 m0, s62, 16384
    s_add_u32 s41, s95, 128
    s_and_b32 s41, s41, 0x3ff
    buffer_load_dwordx4 v178, s[12:15], s41 offen  lds
    s_add_u32 s41, s41, 7168
    buffer_load_dwordx4 v178, s[12:15], s41 offen offset:1024  lds
    s_add_u32 s41, s41, 7168
    buffer_load_dwordx4 v178, s[12:15], s41 offen offset:2048  lds
    s_add_u32 s41, s41, 7168
    buffer_load_dwordx4 v178, s[12:15], s41 offen offset:3072  lds
    buffer_load_dword v246, v244, s[16:19], 0 offen
    s_or_b32 s41, s36, s49
    s_cselect_b32 s42, 0x40000000, 0
    s_lshl_b32 s41, s40, 3
    s_add_u32 s41, s41, s39
    s_lshl_b32 s41, s41, 7
    s_add_u32 s41, s41, s42
    v_and_b32 v180, 31, v0
    v_lshlrev_b32 v180, 2, v180
    v_mov_b32 v181, 0
    buffer_store_dword v181, v180, s[28:31], s41 offen sc1
    v_and_b32 v180, 15, v0
    v_lshrrev_b32 v181, 4, v0
    v_and_b32 v182, 6, v0
    v_xor_b32 v182, v182, v181
    v_lshlrev_b32 v182, 4, v182
    v_lshl_add_u32 v182, v180, 7, v182
    v_add_u32 v168, s62, v182
    v_xor_b32 v169, 64, v168
    v_bfe_u32 v182, v0, 2, 3
    v_lshlrev_b32 v182, 5, v182
    v_lshl_add_u32 v182, v181, 11, v182
    v_bfe_u32 v183, v0, 2, 2
    v_lshl_add_u32 v182, v183, 8, v182
    v_and_b32 v183, 3, v0
    v_lshl_add_u32 v182, v183, 3, v182
    v_add_u32 v182, 65536, v182
    s_mov_b32 s96, 0x3e0293ee
    v_xor_b32 v160, 0, v182
    v_xor_b32 v161, 32, v182
    v_xor_b32 v162, 64, v182
    v_xor_b32 v163, 96, v182
    v_xor_b32 v164, 128, v182
    v_xor_b32 v165, 160, v182
    v_xor_b32 v166, 192, v182
    v_xor_b32 v167, 224, v182
    v_and_b32 v1, 15, v0
    v_lshrrev_b32 v2, 4, v0
    v_and_b32 v3, 7, v0
    v_lshlrev_b32 v3, 1, v3
    v_xor_b32 v3, v3, v2
    v_lshlrev_b32 v3, 4, v3
    v_lshl_add_u32 v3, v1, 8, v3
    s_lshl_b32 s41, s36, 12
    v_xor_b32 v212, 0, v3
    v_add_u32 v216, s41, v212
    v_xor_b32 v213, 64, v3
    v_add_u32 v217, s41, v213
    v_xor_b32 v214, 128, v3
    v_add_u32 v218, s41, v214
    v_xor_b32 v215, 192, v3
    v_add_u32 v219, s41, v215
    v_lshrrev_b32 v3, 2, v0
    v_and_b32 v238, 7, v3
    v_lshlrev_b32 v238, 5, v238
    v_lshl_add_u32 v3, v3, 8, v238
    v_and_b32 v238, 3, v0
    v_lshl_add_u32 v3, v238, 3, v3
    v_add_u32 v3, 16384, v3
    s_lshl_b32 s41, s36, 1
    s_xor_b32 s41, s41, 6
    s_lshl_b32 s41, s41, 5
    v_xor_b32 v3, s41, v3
    v_xor_b32 v220, 0, v3
    v_xor_b32 v221, 32, v3
    v_xor_b32 v222, 64, v3
    v_xor_b32 v223, 96, v3
    v_xor_b32 v224, 128, v3
    v_xor_b32 v225, 160, v3
    v_xor_b32 v226, 192, v3
    v_xor_b32 v227, 224, v3
    v_lshlrev_b32 v229, 4, v0
    v_add_u32 v229, 114688, v229
    v_add_u32 v228, s48, v229
    s_lshr_b32 s41, s36, 1
    s_lshl_b32 s41, s41, 10
    s_and_b32 s42, s36, 1
    s_lshl_b32 s42, s42, 3
    s_add_u32 s41, s41, s42
    v_add_u32 v230, s41, v229
    s_lshl_b32 s41, s36, 8
    s_add_u32 s41, s41, 161792
    v_lshlrev_b32 v1, 4, v1
    v_lshl_add_u32 v1, v2, 2, v1
    v_add_u32 v231, s41, v1
    s_mov_b32 s54, 0x30800000
    s_mov_b32 s55, 0x4e800000
    s_mov_b64 s[58:59], 0
    s_mov_b32 s38, 0
    s_xor_b32 s50, s47, 3072
    s_xor_b32 s51, s47, 2048
    s_xor_b32 s52, s47, 1024
    s_xor_b32 s53, s47, 0
    s_cmp_lg_u32 s49, 0
    s_cselect_b64 vcc, -1, 0
    s_waitcnt vmcnt(6) lgkmcnt(0)
    s_barrier
    ds_read_b128 v[140:143], v168 offset:0
    ds_read_b128 v[144:147], v168 offset:2048
    ds_read_b64_tr_b16 v[176:177], v160 offset:0
    ds_read_b64_tr_b16 v[178:179], v160 offset:1024
    ds_read_b64_tr_b16 v[180:181], v161 offset:0
    ds_read_b64_tr_b16 v[182:183], v161 offset:1024
    ds_read_b64_tr_b16 v[184:185], v162 offset:0
    ds_read_b64_tr_b16 v[186:187], v162 offset:1024
    ds_read_b64_tr_b16 v[188:189], v163 offset:0
    ds_read_b64_tr_b16 v[190:191], v163 offset:1024
    ds_read_b64_tr_b16 v[192:193], v164 offset:0
    ds_read_b64_tr_b16 v[194:195], v164 offset:1024
    ds_read_b64_tr_b16 v[196:197], v165 offset:0
    ds_read_b64_tr_b16 v[198:199], v165 offset:1024
    ds_read_b64_tr_b16 v[200:201], v166 offset:0
    s_waitcnt lgkmcnt(11)
    v_mfma_f32_16x16x32_bf16 v[4:7], v[176:179], v[140:143], 0
    ds_read_b64_tr_b16 v[202:203], v166 offset:1024
    v_mfma_f32_16x16x32_bf16 v[36:39], v[176:179], v[144:147], 0
    s_waitcnt lgkmcnt(10)
    ds_read_b64_tr_b16 v[204:205], v167 offset:0
    v_mfma_f32_16x16x32_bf16 v[8:11], v[180:183], v[140:143], 0
    ds_read_b64_tr_b16 v[206:207], v167 offset:1024
    v_mfma_f32_16x16x32_bf16 v[40:43], v[180:183], v[144:147], 0
    s_waitcnt lgkmcnt(10)
    ds_read_b128 v[148:151], v169 offset:0
    ds_read_b128 v[152:155], v169 offset:2048
    v_mfma_f32_16x16x32_bf16 v[12:15], v[184:187], v[140:143], 0
    ds_read_b64_tr_b16 v[176:177], v160 offset:8192
    v_mfma_f32_16x16x32_bf16 v[44:47], v[184:187], v[144:147], 0
    s_waitcnt lgkmcnt(11)
    ds_read_b64_tr_b16 v[178:179], v160 offset:9216
    v_mfma_f32_16x16x32_bf16 v[16:19], v[188:191], v[140:143], 0
    ds_read_b64_tr_b16 v[180:181], v161 offset:8192
    v_mfma_f32_16x16x32_bf16 v[48:51], v[188:191], v[144:147], 0
    s_waitcnt lgkmcnt(10)
    ds_read_b64_tr_b16 v[182:183], v161 offset:9216
    ds_read_b64_tr_b16 v[184:185], v162 offset:8192
    v_mfma_f32_16x16x32_bf16 v[20:23], v[192:195], v[140:143], 0
    ds_read_b64_tr_b16 v[186:187], v162 offset:9216
    v_mfma_f32_16x16x32_bf16 v[52:55], v[192:195], v[144:147], 0
    s_waitcnt lgkmcnt(10)
    ds_read_b64_tr_b16 v[188:189], v163 offset:8192
    v_mfma_f32_16x16x32_bf16 v[24:27], v[196:199], v[140:143], 0
    ds_read_b64_tr_b16 v[190:191], v163 offset:9216
    v_mfma_f32_16x16x32_bf16 v[56:59], v[196:199], v[144:147], 0
    ds_read_b64_tr_b16 v[192:193], v164 offset:8192
    ds_read_b64_tr_b16 v[194:195], v164 offset:9216
    v_mfma_f32_16x16x32_bf16 v[28:31], v[200:203], v[140:143], 0
    ds_read_b64_tr_b16 v[196:197], v165 offset:8192
    v_mfma_f32_16x16x32_bf16 v[60:63], v[200:203], v[144:147], 0
    s_waitcnt lgkmcnt(11)
    ds_read_b64_tr_b16 v[198:199], v165 offset:9216
    v_mfma_f32_16x16x32_bf16 v[32:35], v[204:207], v[140:143], 0
    ds_read_b64_tr_b16 v[200:201], v166 offset:8192
    v_mfma_f32_16x16x32_bf16 v[64:67], v[204:207], v[144:147], 0
    s_waitcnt lgkmcnt(10)
    ds_read_b64_tr_b16 v[202:203], v166 offset:9216
    ds_read_b64_tr_b16 v[204:205], v167 offset:8192
    v_mfma_f32_16x16x32_bf16 v[4:7], v[176:179], v[148:151], v[4:7]
    ds_read_b64_tr_b16 v[206:207], v167 offset:9216
    v_mfma_f32_16x16x32_bf16 v[36:39], v[176:179], v[152:155], v[36:39]
    s_waitcnt lgkmcnt(11)
    v_mfma_f32_16x16x32_bf16 v[8:11], v[180:183], v[148:151], v[8:11]
    v_mfma_f32_16x16x32_bf16 v[40:43], v[180:183], v[152:155], v[40:43]
    s_waitcnt lgkmcnt(10)
    v_mfma_f32_16x16x32_bf16 v[12:15], v[184:187], v[148:151], v[12:15]
    v_mfma_f32_16x16x32_bf16 v[44:47], v[184:187], v[152:155], v[44:47]
    s_waitcnt lgkmcnt(8)
    v_mfma_f32_16x16x32_bf16 v[16:19], v[188:191], v[148:151], v[16:19]
    v_mfma_f32_16x16x32_bf16 v[48:51], v[188:191], v[152:155], v[48:51]
    s_waitcnt vmcnt(2) lgkmcnt(0)
    s_barrier
    ds_read_b128 v[140:143], v168 offset:16384
    ds_read_b128 v[144:147], v168 offset:18432
    v_mfma_f32_16x16x32_bf16 v[20:23], v[192:195], v[148:151], v[20:23]
    ds_read_b64_tr_b16 v[176:177], v160 offset:16384
    ds_read_b64_tr_b16 v[178:179], v160 offset:17408
    v_mfma_f32_16x16x32_bf16 v[52:55], v[192:195], v[152:155], v[52:55]
    ds_read_b64_tr_b16 v[180:181], v161 offset:16384
    ds_read_b64_tr_b16 v[182:183], v161 offset:17408
    v_mfma_f32_16x16x32_bf16 v[24:27], v[196:199], v[148:151], v[24:27]
    ds_read_b64_tr_b16 v[184:185], v162 offset:16384
    ds_read_b64_tr_b16 v[186:187], v162 offset:17408
    v_mfma_f32_16x16x32_bf16 v[56:59], v[196:199], v[152:155], v[56:59]
    ds_read_b64_tr_b16 v[188:189], v163 offset:16384
    ds_read_b64_tr_b16 v[190:191], v163 offset:17408
    v_mfma_f32_16x16x32_bf16 v[28:31], v[200:203], v[148:151], v[28:31]
    ds_read_b64_tr_b16 v[192:193], v164 offset:16384
    v_mfma_f32_16x16x32_bf16 v[60:63], v[200:203], v[152:155], v[60:63]
    ds_read_b64_tr_b16 v[194:195], v164 offset:17408
    v_mfma_f32_16x16x32_bf16 v[32:35], v[204:207], v[148:151], v[32:35]
    ds_read_b64_tr_b16 v[196:197], v165 offset:16384
    v_mfma_f32_16x16x32_bf16 v[64:67], v[204:207], v[152:155], v[64:67]
    s_waitcnt lgkmcnt(9)
    ds_read_b64_tr_b16 v[198:199], v165 offset:17408
    ds_read_b64_tr_b16 v[200:201], v166 offset:16384
    v_mfma_f32_16x16x32_bf16 v[4:7], v[176:179], v[140:143], v[4:7]
    ds_read_b64_tr_b16 v[202:203], v166 offset:17408
    v_mfma_f32_16x16x32_bf16 v[36:39], v[176:179], v[144:147], v[36:39]
    s_waitcnt lgkmcnt(10)
    ds_read_b64_tr_b16 v[204:205], v167 offset:16384
    v_mfma_f32_16x16x32_bf16 v[8:11], v[180:183], v[140:143], v[8:11]
    ds_read_b64_tr_b16 v[206:207], v167 offset:17408
    v_mfma_f32_16x16x32_bf16 v[40:43], v[180:183], v[144:147], v[40:43]
    s_waitcnt lgkmcnt(10)
    ds_read_b128 v[148:151], v169 offset:16384
    ds_read_b128 v[152:155], v169 offset:18432
    v_mfma_f32_16x16x32_bf16 v[12:15], v[184:187], v[140:143], v[12:15]
    ds_read_b64_tr_b16 v[176:177], v160 offset:24576
    v_mfma_f32_16x16x32_bf16 v[44:47], v[184:187], v[144:147], v[44:47]
    s_waitcnt lgkmcnt(11)
    ds_read_b64_tr_b16 v[178:179], v160 offset:25600
    v_mfma_f32_16x16x32_bf16 v[16:19], v[188:191], v[140:143], v[16:19]
    ds_read_b64_tr_b16 v[180:181], v161 offset:24576
    v_mfma_f32_16x16x32_bf16 v[48:51], v[188:191], v[144:147], v[48:51]
    s_waitcnt lgkmcnt(10)
    ds_read_b64_tr_b16 v[182:183], v161 offset:25600
    ds_read_b64_tr_b16 v[184:185], v162 offset:24576
    v_mfma_f32_16x16x32_bf16 v[20:23], v[192:195], v[140:143], v[20:23]
    ds_read_b64_tr_b16 v[186:187], v162 offset:25600
    v_mfma_f32_16x16x32_bf16 v[52:55], v[192:195], v[144:147], v[52:55]
    s_waitcnt lgkmcnt(10)
    ds_read_b64_tr_b16 v[188:189], v163 offset:24576
    v_mfma_f32_16x16x32_bf16 v[24:27], v[196:199], v[140:143], v[24:27]
    ds_read_b64_tr_b16 v[190:191], v163 offset:25600
    v_mfma_f32_16x16x32_bf16 v[56:59], v[196:199], v[144:147], v[56:59]
    ds_read_b64_tr_b16 v[192:193], v164 offset:24576
    ds_read_b64_tr_b16 v[194:195], v164 offset:25600
    v_mfma_f32_16x16x32_bf16 v[28:31], v[200:203], v[140:143], v[28:31]
    ds_read_b64_tr_b16 v[196:197], v165 offset:24576
    v_mfma_f32_16x16x32_bf16 v[60:63], v[200:203], v[144:147], v[60:63]
    s_waitcnt lgkmcnt(11)
    ds_read_b64_tr_b16 v[198:199], v165 offset:25600
    v_mfma_f32_16x16x32_bf16 v[32:35], v[204:207], v[140:143], v[32:35]
    ds_read_b64_tr_b16 v[200:201], v166 offset:24576
    v_mfma_f32_16x16x32_bf16 v[64:67], v[204:207], v[144:147], v[64:67]
    s_waitcnt lgkmcnt(10)
    ds_read_b64_tr_b16 v[202:203], v166 offset:25600
    ds_read_b64_tr_b16 v[204:205], v167 offset:24576
    v_mfma_f32_16x16x32_bf16 v[4:7], v[176:179], v[148:151], v[4:7]
    ds_read_b64_tr_b16 v[206:207], v167 offset:25600
    v_mfma_f32_16x16x32_bf16 v[36:39], v[176:179], v[152:155], v[36:39]
    s_waitcnt lgkmcnt(11)
    v_mfma_f32_16x16x32_bf16 v[8:11], v[180:183], v[148:151], v[8:11]
    v_mfma_f32_16x16x32_bf16 v[40:43], v[180:183], v[152:155], v[40:43]
    s_waitcnt lgkmcnt(10)
    v_mfma_f32_16x16x32_bf16 v[12:15], v[184:187], v[148:151], v[12:15]
    v_mfma_f32_16x16x32_bf16 v[44:47], v[184:187], v[152:155], v[44:47]
    s_waitcnt lgkmcnt(8)
    v_mfma_f32_16x16x32_bf16 v[16:19], v[188:191], v[148:151], v[16:19]
    v_mfma_f32_16x16x32_bf16 v[48:51], v[188:191], v[152:155], v[48:51]
    s_waitcnt lgkmcnt(0)
    s_barrier
    ds_read_b128 v[140:143], v168 offset:32768
    ds_read_b128 v[144:147], v168 offset:34816
    v_mfma_f32_16x16x32_bf16 v[20:23], v[192:195], v[148:151], v[20:23]
    ds_read_b64_tr_b16 v[176:177], v160 offset:49152
    ds_read_b64_tr_b16 v[178:179], v160 offset:50176
    v_mfma_f32_16x16x32_bf16 v[52:55], v[192:195], v[152:155], v[52:55]
    ds_read_b64_tr_b16 v[180:181], v161 offset:49152
    ds_read_b64_tr_b16 v[182:183], v161 offset:50176
    v_mfma_f32_16x16x32_bf16 v[24:27], v[196:199], v[148:151], v[24:27]
    ds_read_b64_tr_b16 v[184:185], v162 offset:49152
    ds_read_b64_tr_b16 v[186:187], v162 offset:50176
    v_mfma_f32_16x16x32_bf16 v[56:59], v[196:199], v[152:155], v[56:59]
    ds_read_b64_tr_b16 v[188:189], v163 offset:49152
    ds_read_b64_tr_b16 v[190:191], v163 offset:50176
    v_mfma_f32_16x16x32_bf16 v[28:31], v[200:203], v[148:151], v[28:31]
    ds_read_b64_tr_b16 v[192:193], v164 offset:49152
    v_mfma_f32_16x16x32_bf16 v[60:63], v[200:203], v[152:155], v[60:63]
    ds_read_b64_tr_b16 v[194:195], v164 offset:50176
    v_mfma_f32_16x16x32_bf16 v[32:35], v[204:207], v[148:151], v[32:35]
    ds_read_b64_tr_b16 v[196:197], v165 offset:49152
    v_mfma_f32_16x16x32_bf16 v[64:67], v[204:207], v[152:155], v[64:67]
    s_waitcnt lgkmcnt(9)
    ds_read_b64_tr_b16 v[198:199], v165 offset:50176
    ds_read_b64_tr_b16 v[200:201], v166 offset:49152
    v_mfma_f32_16x16x32_bf16 v[4:7], v[176:179], v[140:143], v[4:7]
    ds_read_b64_tr_b16 v[202:203], v166 offset:50176
    v_mfma_f32_16x16x32_bf16 v[36:39], v[176:179], v[144:147], v[36:39]
    s_waitcnt lgkmcnt(10)
    ds_read_b64_tr_b16 v[204:205], v167 offset:49152
    v_mfma_f32_16x16x32_bf16 v[8:11], v[180:183], v[140:143], v[8:11]
    ds_read_b64_tr_b16 v[206:207], v167 offset:50176
    v_mfma_f32_16x16x32_bf16 v[40:43], v[180:183], v[144:147], v[40:43]
    s_waitcnt lgkmcnt(10)
    ds_read_b128 v[148:151], v169 offset:32768
    ds_read_b128 v[152:155], v169 offset:34816
    v_mfma_f32_16x16x32_bf16 v[12:15], v[184:187], v[140:143], v[12:15]
    ds_read_b64_tr_b16 v[176:177], v160 offset:57344
    v_mfma_f32_16x16x32_bf16 v[44:47], v[184:187], v[144:147], v[44:47]
    s_waitcnt lgkmcnt(11)
    ds_read_b64_tr_b16 v[178:179], v160 offset:58368
    v_mfma_f32_16x16x32_bf16 v[16:19], v[188:191], v[140:143], v[16:19]
    ds_read_b64_tr_b16 v[180:181], v161 offset:57344
    v_mfma_f32_16x16x32_bf16 v[48:51], v[188:191], v[144:147], v[48:51]
    s_waitcnt lgkmcnt(10)
    ds_read_b64_tr_b16 v[182:183], v161 offset:58368
    ds_read_b64_tr_b16 v[184:185], v162 offset:57344
    v_mfma_f32_16x16x32_bf16 v[20:23], v[192:195], v[140:143], v[20:23]
    ds_read_b64_tr_b16 v[186:187], v162 offset:58368
    v_mfma_f32_16x16x32_bf16 v[52:55], v[192:195], v[144:147], v[52:55]
    s_waitcnt lgkmcnt(10)
    ds_read_b64_tr_b16 v[188:189], v163 offset:57344
    v_mfma_f32_16x16x32_bf16 v[24:27], v[196:199], v[140:143], v[24:27]
    ds_read_b64_tr_b16 v[190:191], v163 offset:58368
    v_mfma_f32_16x16x32_bf16 v[56:59], v[196:199], v[144:147], v[56:59]
    ds_read_b64_tr_b16 v[192:193], v164 offset:57344
    ds_read_b64_tr_b16 v[194:195], v164 offset:58368
    v_mfma_f32_16x16x32_bf16 v[28:31], v[200:203], v[140:143], v[28:31]
    ds_read_b64_tr_b16 v[196:197], v165 offset:57344
    v_mfma_f32_16x16x32_bf16 v[60:63], v[200:203], v[144:147], v[60:63]
    s_waitcnt lgkmcnt(11)
    ds_read_b64_tr_b16 v[198:199], v165 offset:58368
    v_mfma_f32_16x16x32_bf16 v[32:35], v[204:207], v[140:143], v[32:35]
    ds_read_b64_tr_b16 v[200:201], v166 offset:57344
    v_mfma_f32_16x16x32_bf16 v[64:67], v[204:207], v[144:147], v[64:67]
    s_waitcnt lgkmcnt(10)
    ds_read_b64_tr_b16 v[202:203], v166 offset:58368
    ds_read_b64_tr_b16 v[204:205], v167 offset:57344
    v_mfma_f32_16x16x32_bf16 v[4:7], v[176:179], v[148:151], v[4:7]
    ds_read_b64_tr_b16 v[206:207], v167 offset:58368
    v_mfma_f32_16x16x32_bf16 v[36:39], v[176:179], v[152:155], v[36:39]
    s_waitcnt lgkmcnt(11)
    v_mfma_f32_16x16x32_bf16 v[8:11], v[180:183], v[148:151], v[8:11]
    v_mfma_f32_16x16x32_bf16 v[40:43], v[180:183], v[152:155], v[40:43]
    s_waitcnt lgkmcnt(10)
    v_mfma_f32_16x16x32_bf16 v[12:15], v[184:187], v[148:151], v[12:15]
    v_mfma_f32_16x16x32_bf16 v[44:47], v[184:187], v[152:155], v[44:47]
    s_waitcnt lgkmcnt(8)
    v_mfma_f32_16x16x32_bf16 v[16:19], v[188:191], v[148:151], v[16:19]
    v_mfma_f32_16x16x32_bf16 v[48:51], v[188:191], v[152:155], v[48:51]
    s_waitcnt vmcnt(0) lgkmcnt(0)
    s_barrier
    ds_read_b128 v[140:143], v168 offset:49152
    ds_read_b128 v[144:147], v168 offset:51200
    v_mfma_f32_16x16x32_bf16 v[20:23], v[192:195], v[148:151], v[20:23]
    ds_read_b64_tr_b16 v[176:177], v160 offset:32768
    ds_read_b64_tr_b16 v[178:179], v160 offset:33792
    v_mfma_f32_16x16x32_bf16 v[52:55], v[192:195], v[152:155], v[52:55]
    ds_read_b64_tr_b16 v[180:181], v161 offset:32768
    ds_read_b64_tr_b16 v[182:183], v161 offset:33792
    v_mfma_f32_16x16x32_bf16 v[24:27], v[196:199], v[148:151], v[24:27]
    ds_read_b64_tr_b16 v[184:185], v162 offset:32768
    ds_read_b64_tr_b16 v[186:187], v162 offset:33792
    v_mfma_f32_16x16x32_bf16 v[56:59], v[196:199], v[152:155], v[56:59]
    ds_read_b64_tr_b16 v[188:189], v163 offset:32768
    ds_read_b64_tr_b16 v[190:191], v163 offset:33792
    v_mfma_f32_16x16x32_bf16 v[28:31], v[200:203], v[148:151], v[28:31]
    ds_read_b64_tr_b16 v[192:193], v164 offset:32768
    v_mfma_f32_16x16x32_bf16 v[60:63], v[200:203], v[152:155], v[60:63]
    ds_read_b64_tr_b16 v[194:195], v164 offset:33792
    v_mfma_f32_16x16x32_bf16 v[32:35], v[204:207], v[148:151], v[32:35]
    ds_read_b64_tr_b16 v[196:197], v165 offset:32768
    v_mfma_f32_16x16x32_bf16 v[64:67], v[204:207], v[152:155], v[64:67]
    s_waitcnt lgkmcnt(9)
    ds_read_b64_tr_b16 v[198:199], v165 offset:33792
    ds_read_b64_tr_b16 v[200:201], v166 offset:32768
    v_mfma_f32_16x16x32_bf16 v[4:7], v[176:179], v[140:143], v[4:7]
    ds_read_b64_tr_b16 v[202:203], v166 offset:33792
    v_mfma_f32_16x16x32_bf16 v[36:39], v[176:179], v[144:147], v[36:39]
    s_waitcnt lgkmcnt(10)
    ds_read_b64_tr_b16 v[204:205], v167 offset:32768
    v_mfma_f32_16x16x32_bf16 v[8:11], v[180:183], v[140:143], v[8:11]
    ds_read_b64_tr_b16 v[206:207], v167 offset:33792
    v_mfma_f32_16x16x32_bf16 v[40:43], v[180:183], v[144:147], v[40:43]
    s_waitcnt lgkmcnt(10)
    ds_read_b128 v[148:151], v169 offset:49152
    ds_read_b128 v[152:155], v169 offset:51200
    v_mfma_f32_16x16x32_bf16 v[12:15], v[184:187], v[140:143], v[12:15]
    ds_read_b64_tr_b16 v[176:177], v160 offset:40960
    v_mfma_f32_16x16x32_bf16 v[44:47], v[184:187], v[144:147], v[44:47]
    s_waitcnt lgkmcnt(11)
    ds_read_b64_tr_b16 v[178:179], v160 offset:41984
    v_mfma_f32_16x16x32_bf16 v[16:19], v[188:191], v[140:143], v[16:19]
    ds_read_b64_tr_b16 v[180:181], v161 offset:40960
    v_mfma_f32_16x16x32_bf16 v[48:51], v[188:191], v[144:147], v[48:51]
    s_waitcnt lgkmcnt(10)
    ds_read_b64_tr_b16 v[182:183], v161 offset:41984
    ds_read_b64_tr_b16 v[184:185], v162 offset:40960
    v_mfma_f32_16x16x32_bf16 v[20:23], v[192:195], v[140:143], v[20:23]
    ds_read_b64_tr_b16 v[186:187], v162 offset:41984
    v_mfma_f32_16x16x32_bf16 v[52:55], v[192:195], v[144:147], v[52:55]
    s_waitcnt lgkmcnt(10)
    ds_read_b64_tr_b16 v[188:189], v163 offset:40960
    v_mfma_f32_16x16x32_bf16 v[24:27], v[196:199], v[140:143], v[24:27]
    ds_read_b64_tr_b16 v[190:191], v163 offset:41984
    v_mfma_f32_16x16x32_bf16 v[56:59], v[196:199], v[144:147], v[56:59]
    ds_read_b64_tr_b16 v[192:193], v164 offset:40960
    ds_read_b64_tr_b16 v[194:195], v164 offset:41984
    v_mfma_f32_16x16x32_bf16 v[28:31], v[200:203], v[140:143], v[28:31]
    ds_read_b64_tr_b16 v[196:197], v165 offset:40960
    v_mfma_f32_16x16x32_bf16 v[60:63], v[200:203], v[144:147], v[60:63]
    s_waitcnt lgkmcnt(11)
    ds_read_b64_tr_b16 v[198:199], v165 offset:41984
    v_mfma_f32_16x16x32_bf16 v[32:35], v[204:207], v[140:143], v[32:35]
    ds_read_b64_tr_b16 v[200:201], v166 offset:40960
    v_mfma_f32_16x16x32_bf16 v[64:67], v[204:207], v[144:147], v[64:67]
    s_waitcnt lgkmcnt(10)
    ds_read_b64_tr_b16 v[202:203], v166 offset:41984
    ds_read_b64_tr_b16 v[204:205], v167 offset:40960
    v_mfma_f32_16x16x32_bf16 v[4:7], v[176:179], v[148:151], v[4:7]
    ds_read_b64_tr_b16 v[206:207], v167 offset:41984
    v_mfma_f32_16x16x32_bf16 v[36:39], v[176:179], v[152:155], v[36:39]
    s_waitcnt lgkmcnt(11)
    v_mfma_f32_16x16x32_bf16 v[8:11], v[180:183], v[148:151], v[8:11]
    v_mfma_f32_16x16x32_bf16 v[40:43], v[180:183], v[152:155], v[40:43]
    s_waitcnt lgkmcnt(10)
    v_mfma_f32_16x16x32_bf16 v[12:15], v[184:187], v[148:151], v[12:15]
    v_mfma_f32_16x16x32_bf16 v[44:47], v[184:187], v[152:155], v[44:47]
    s_waitcnt lgkmcnt(8)
    v_mfma_f32_16x16x32_bf16 v[16:19], v[188:191], v[148:151], v[16:19]
    v_mfma_f32_16x16x32_bf16 v[48:51], v[188:191], v[152:155], v[48:51]
    s_or_b32 s41, s36, s49
    s_cbranch_scc1 L_Bnoadd
    v_lshlrev_b32 v2, 8, v0
    v_mov_b32 v3, 1
    s_lshl_b32 s41, s40, 2
    buffer_atomic_add v3, v2, s[32:35], s41 offen offset:128 sc1
L_Bnoadd:
    s_waitcnt lgkmcnt(0)
    s_barrier
    ds_read_b128 v[140:143], v168 offset:0
    ds_read_b128 v[144:147], v168 offset:2048
    v_mfma_f32_16x16x32_bf16 v[20:23], v[192:195], v[148:151], v[20:23]
    ds_read_b64_tr_b16 v[176:177], v160 offset:0
    ds_read_b64_tr_b16 v[178:179], v160 offset:1024
    v_mfma_f32_16x16x32_bf16 v[52:55], v[192:195], v[152:155], v[52:55]
    ds_read_b64_tr_b16 v[180:181], v161 offset:0
    ds_read_b64_tr_b16 v[182:183], v161 offset:1024
    v_mfma_f32_16x16x32_bf16 v[24:27], v[196:199], v[148:151], v[24:27]
    ds_read_b64_tr_b16 v[184:185], v162 offset:0
    ds_read_b64_tr_b16 v[186:187], v162 offset:1024
    v_mfma_f32_16x16x32_bf16 v[56:59], v[196:199], v[152:155], v[56:59]
    ds_read_b64_tr_b16 v[188:189], v163 offset:0
    ds_read_b64_tr_b16 v[190:191], v163 offset:1024
    v_mfma_f32_16x16x32_bf16 v[28:31], v[200:203], v[148:151], v[28:31]
    ds_read_b64_tr_b16 v[192:193], v164 offset:0
    v_mfma_f32_16x16x32_bf16 v[60:63], v[200:203], v[152:155], v[60:63]
    ds_read_b64_tr_b16 v[194:195], v164 offset:1024
    v_mfma_f32_16x16x32_bf16 v[32:35], v[204:207], v[148:151], v[32:35]
    ds_read_b64_tr_b16 v[196:197], v165 offset:0
    v_mfma_f32_16x16x32_bf16 v[64:67], v[204:207], v[152:155], v[64:67]
    s_waitcnt lgkmcnt(9)
    ds_read_b64_tr_b16 v[198:199], v165 offset:1024
    ds_read_b64_tr_b16 v[200:201], v166 offset:0
    v_mfma_f32_16x16x32_bf16 v[4:7], v[176:179], v[140:143], v[4:7]
    ds_read_b64_tr_b16 v[202:203], v166 offset:1024
    v_mfma_f32_16x16x32_bf16 v[36:39], v[176:179], v[144:147], v[36:39]
    s_waitcnt lgkmcnt(10)
    ds_read_b64_tr_b16 v[204:205], v167 offset:0
    v_mfma_f32_16x16x32_bf16 v[8:11], v[180:183], v[140:143], v[8:11]
    ds_read_b64_tr_b16 v[206:207], v167 offset:1024
    v_mfma_f32_16x16x32_bf16 v[40:43], v[180:183], v[144:147], v[40:43]
    s_waitcnt lgkmcnt(10)
    ds_read_b128 v[148:151], v169 offset:0
    ds_read_b128 v[152:155], v169 offset:2048
    v_mfma_f32_16x16x32_bf16 v[12:15], v[184:187], v[140:143], v[12:15]
    ds_read_b64_tr_b16 v[176:177], v160 offset:8192
    v_mfma_f32_16x16x32_bf16 v[44:47], v[184:187], v[144:147], v[44:47]
    s_waitcnt lgkmcnt(11)
    ds_read_b64_tr_b16 v[178:179], v160 offset:9216
    v_mfma_f32_16x16x32_bf16 v[16:19], v[188:191], v[140:143], v[16:19]
    ds_read_b64_tr_b16 v[180:181], v161 offset:8192
    v_mfma_f32_16x16x32_bf16 v[48:51], v[188:191], v[144:147], v[48:51]
    s_waitcnt lgkmcnt(10)
    ds_read_b64_tr_b16 v[182:183], v161 offset:9216
    ds_read_b64_tr_b16 v[184:185], v162 offset:8192
    v_mfma_f32_16x16x32_bf16 v[20:23], v[192:195], v[140:143], v[20:23]
    ds_read_b64_tr_b16 v[186:187], v162 offset:9216
    v_mfma_f32_16x16x32_bf16 v[52:55], v[192:195], v[144:147], v[52:55]
    s_waitcnt lgkmcnt(10)
    ds_read_b64_tr_b16 v[188:189], v163 offset:8192
    v_mfma_f32_16x16x32_bf16 v[24:27], v[196:199], v[140:143], v[24:27]
    ds_read_b64_tr_b16 v[190:191], v163 offset:9216
    v_mfma_f32_16x16x32_bf16 v[56:59], v[196:199], v[144:147], v[56:59]
    ds_read_b64_tr_b16 v[192:193], v164 offset:8192
    ds_read_b64_tr_b16 v[194:195], v164 offset:9216
    v_mfma_f32_16x16x32_bf16 v[28:31], v[200:203], v[140:143], v[28:31]
    ds_read_b64_tr_b16 v[196:197], v165 offset:8192
    v_mfma_f32_16x16x32_bf16 v[60:63], v[200:203], v[144:147], v[60:63]
    s_waitcnt lgkmcnt(11)
    ds_read_b64_tr_b16 v[198:199], v165 offset:9216
    v_mfma_f32_16x16x32_bf16 v[32:35], v[204:207], v[140:143], v[32:35]
    ds_read_b64_tr_b16 v[200:201], v166 offset:8192
    v_mfma_f32_16x16x32_bf16 v[64:67], v[204:207], v[144:147], v[64:67]
    s_waitcnt lgkmcnt(10)
    ds_read_b64_tr_b16 v[202:203], v166 offset:9216
    ds_read_b64_tr_b16 v[204:205], v167 offset:8192
    v_mfma_f32_16x16x32_bf16 v[4:7], v[176:179], v[148:151], v[4:7]
    ds_read_b64_tr_b16 v[206:207], v167 offset:9216
    v_mfma_f32_16x16x32_bf16 v[36:39], v[176:179], v[152:155], v[36:39]
    s_waitcnt lgkmcnt(11)
    v_mfma_f32_16x16x32_bf16 v[8:11], v[180:183], v[148:151], v[8:11]
    v_mfma_f32_16x16x32_bf16 v[40:43], v[180:183], v[152:155], v[40:43]
    s_waitcnt lgkmcnt(10)
    v_mfma_f32_16x16x32_bf16 v[12:15], v[184:187], v[148:151], v[12:15]
    v_mfma_f32_16x16x32_bf16 v[44:47], v[184:187], v[152:155], v[44:47]
    s_waitcnt lgkmcnt(8)
    v_mfma_f32_16x16x32_bf16 v[16:19], v[188:191], v[148:151], v[16:19]
    v_mfma_f32_16x16x32_bf16 v[48:51], v[188:191], v[152:155], v[48:51]
    s_waitcnt lgkmcnt(0)
    s_barrier
    ds_read_b128 v[140:143], v168 offset:16384
    ds_read_b128 v[144:147], v168 offset:18432
    v_mfma_f32_16x16x32_bf16 v[20:23], v[192:195], v[148:151], v[20:23]
    ds_read_b64_tr_b16 v[176:177], v160 offset:16384
    ds_read_b64_tr_b16 v[178:179], v160 offset:17408
    v_mfma_f32_16x16x32_bf16 v[52:55], v[192:195], v[152:155], v[52:55]
    ds_read_b64_tr_b16 v[180:181], v161 offset:16384
    ds_read_b64_tr_b16 v[182:183], v161 offset:17408
    v_mfma_f32_16x16x32_bf16 v[24:27], v[196:199], v[148:151], v[24:27]
    ds_read_b64_tr_b16 v[184:185], v162 offset:16384
    ds_read_b64_tr_b16 v[186:187], v162 offset:17408
    v_mfma_f32_16x16x32_bf16 v[56:59], v[196:199], v[152:155], v[56:59]
    ds_read_b64_tr_b16 v[188:189], v163 offset:16384
    ds_read_b64_tr_b16 v[190:191], v163 offset:17408
    v_mfma_f32_16x16x32_bf16 v[28:31], v[200:203], v[148:151], v[28:31]
    ds_read_b64_tr_b16 v[192:193], v164 offset:16384
    v_mfma_f32_16x16x32_bf16 v[60:63], v[200:203], v[152:155], v[60:63]
    ds_read_b64_tr_b16 v[194:195], v164 offset:17408
    v_mfma_f32_16x16x32_bf16 v[32:35], v[204:207], v[148:151], v[32:35]
    ds_read_b64_tr_b16 v[196:197], v165 offset:16384
    v_mfma_f32_16x16x32_bf16 v[64:67], v[204:207], v[152:155], v[64:67]
    s_waitcnt lgkmcnt(9)
    ds_read_b64_tr_b16 v[198:199], v165 offset:17408
    ds_read_b64_tr_b16 v[200:201], v166 offset:16384
    v_mfma_f32_16x16x32_bf16 v[4:7], v[176:179], v[140:143], v[4:7]
    ds_read_b64_tr_b16 v[202:203], v166 offset:17408
    v_mfma_f32_16x16x32_bf16 v[36:39], v[176:179], v[144:147], v[36:39]
    s_waitcnt lgkmcnt(10)
    ds_read_b64_tr_b16 v[204:205], v167 offset:16384
    v_mfma_f32_16x16x32_bf16 v[8:11], v[180:183], v[140:143], v[8:11]
    ds_read_b64_tr_b16 v[206:207], v167 offset:17408
    v_mfma_f32_16x16x32_bf16 v[40:43], v[180:183], v[144:147], v[40:43]
    s_waitcnt lgkmcnt(10)
    ds_read_b128 v[148:151], v169 offset:16384
    ds_read_b128 v[152:155], v169 offset:18432
    v_mfma_f32_16x16x32_bf16 v[12:15], v[184:187], v[140:143], v[12:15]
    ds_read_b64_tr_b16 v[176:177], v160 offset:24576
    v_mfma_f32_16x16x32_bf16 v[44:47], v[184:187], v[144:147], v[44:47]
    s_waitcnt lgkmcnt(11)
    ds_read_b64_tr_b16 v[178:179], v160 offset:25600
    v_mfma_f32_16x16x32_bf16 v[16:19], v[188:191], v[140:143], v[16:19]
    ds_read_b64_tr_b16 v[180:181], v161 offset:24576
    v_mfma_f32_16x16x32_bf16 v[48:51], v[188:191], v[144:147], v[48:51]
    s_waitcnt lgkmcnt(10)
    ds_read_b64_tr_b16 v[182:183], v161 offset:25600
    ds_read_b64_tr_b16 v[184:185], v162 offset:24576
    v_mfma_f32_16x16x32_bf16 v[20:23], v[192:195], v[140:143], v[20:23]
    ds_read_b64_tr_b16 v[186:187], v162 offset:25600
    v_mfma_f32_16x16x32_bf16 v[52:55], v[192:195], v[144:147], v[52:55]
    s_waitcnt lgkmcnt(10)
    ds_read_b64_tr_b16 v[188:189], v163 offset:24576
    v_mfma_f32_16x16x32_bf16 v[24:27], v[196:199], v[140:143], v[24:27]
    ds_read_b64_tr_b16 v[190:191], v163 offset:25600
    v_mfma_f32_16x16x32_bf16 v[56:59], v[196:199], v[144:147], v[56:59]
    ds_read_b64_tr_b16 v[192:193], v164 offset:24576
    ds_read_b64_tr_b16 v[194:195], v164 offset:25600
    v_mfma_f32_16x16x32_bf16 v[28:31], v[200:203], v[140:143], v[28:31]
    ds_read_b64_tr_b16 v[196:197], v165 offset:24576
    v_mfma_f32_16x16x32_bf16 v[60:63], v[200:203], v[144:147], v[60:63]
    s_waitcnt lgkmcnt(11)
    ds_read_b64_tr_b16 v[198:199], v165 offset:25600
    v_mfma_f32_16x16x32_bf16 v[32:35], v[204:207], v[140:143], v[32:35]
    ds_read_b64_tr_b16 v[200:201], v166 offset:24576
    v_mfma_f32_16x16x32_bf16 v[64:67], v[204:207], v[144:147], v[64:67]
    s_waitcnt lgkmcnt(10)
    ds_read_b64_tr_b16 v[202:203], v166 offset:25600
    ds_read_b64_tr_b16 v[204:205], v167 offset:24576
    v_mfma_f32_16x16x32_bf16 v[4:7], v[176:179], v[148:151], v[4:7]
    ds_read_b64_tr_b16 v[206:207], v167 offset:25600
    v_mfma_f32_16x16x32_bf16 v[36:39], v[176:179], v[152:155], v[36:39]
    s_waitcnt lgkmcnt(11)
    v_mfma_f32_16x16x32_bf16 v[8:11], v[180:183], v[148:151], v[8:11]
    v_mfma_f32_16x16x32_bf16 v[40:43], v[180:183], v[152:155], v[40:43]
    s_waitcnt lgkmcnt(10)
    v_mfma_f32_16x16x32_bf16 v[12:15], v[184:187], v[148:151], v[12:15]
    v_mfma_f32_16x16x32_bf16 v[44:47], v[184:187], v[152:155], v[44:47]
    s_waitcnt lgkmcnt(8)
    v_mfma_f32_16x16x32_bf16 v[16:19], v[188:191], v[148:151], v[16:19]
    v_mfma_f32_16x16x32_bf16 v[48:51], v[188:191], v[152:155], v[48:51]
    s_waitcnt lgkmcnt(0)
    s_barrier
    ds_read_b128 v[140:143], v168 offset:32768
    ds_read_b128 v[144:147], v168 offset:34816
    v_mfma_f32_16x16x32_bf16 v[20:23], v[192:195], v[148:151], v[20:23]
    ds_read_b64_tr_b16 v[176:177], v160 offset:49152
    ds_read_b64_tr_b16 v[178:179], v160 offset:50176
    v_mfma_f32_16x16x32_bf16 v[52:55], v[192:195], v[152:155], v[52:55]
    ds_read_b64_tr_b16 v[180:181], v161 offset:49152
    ds_read_b64_tr_b16 v[182:183], v161 offset:50176
    v_mfma_f32_16x16x32_bf16 v[24:27], v[196:199], v[148:151], v[24:27]
    ds_read_b64_tr_b16 v[184:185], v162 offset:49152
    ds_read_b64_tr_b16 v[186:187], v162 offset:50176
    v_mfma_f32_16x16x32_bf16 v[56:59], v[196:199], v[152:155], v[56:59]
    ds_read_b64_tr_b16 v[188:189], v163 offset:49152
    ds_read_b64_tr_b16 v[190:191], v163 offset:50176
    v_mfma_f32_16x16x32_bf16 v[28:31], v[200:203], v[148:151], v[28:31]
    ds_read_b64_tr_b16 v[192:193], v164 offset:49152
    v_mfma_f32_16x16x32_bf16 v[60:63], v[200:203], v[152:155], v[60:63]
    ds_read_b64_tr_b16 v[194:195], v164 offset:50176
    v_mfma_f32_16x16x32_bf16 v[32:35], v[204:207], v[148:151], v[32:35]
    ds_read_b64_tr_b16 v[196:197], v165 offset:49152
    v_mfma_f32_16x16x32_bf16 v[64:67], v[204:207], v[152:155], v[64:67]
    s_waitcnt lgkmcnt(9)
    ds_read_b64_tr_b16 v[198:199], v165 offset:50176
    ds_read_b64_tr_b16 v[200:201], v166 offset:49152
    v_mfma_f32_16x16x32_bf16 v[4:7], v[176:179], v[140:143], v[4:7]
    ds_read_b64_tr_b16 v[202:203], v166 offset:50176
    v_mfma_f32_16x16x32_bf16 v[36:39], v[176:179], v[144:147], v[36:39]
    s_waitcnt lgkmcnt(10)
    ds_read_b64_tr_b16 v[204:205], v167 offset:49152
    v_mfma_f32_16x16x32_bf16 v[8:11], v[180:183], v[140:143], v[8:11]
    ds_read_b64_tr_b16 v[206:207], v167 offset:50176
    v_mfma_f32_16x16x32_bf16 v[40:43], v[180:183], v[144:147], v[40:43]
    s_waitcnt lgkmcnt(10)
    ds_read_b128 v[148:151], v169 offset:32768
    ds_read_b128 v[152:155], v169 offset:34816
    v_mfma_f32_16x16x32_bf16 v[12:15], v[184:187], v[140:143], v[12:15]
    ds_read_b64_tr_b16 v[176:177], v160 offset:57344
    v_mfma_f32_16x16x32_bf16 v[44:47], v[184:187], v[144:147], v[44:47]
    s_waitcnt lgkmcnt(11)
    ds_read_b64_tr_b16 v[178:179], v160 offset:58368
    v_mfma_f32_16x16x32_bf16 v[16:19], v[188:191], v[140:143], v[16:19]
    ds_read_b64_tr_b16 v[180:181], v161 offset:57344
    v_mfma_f32_16x16x32_bf16 v[48:51], v[188:191], v[144:147], v[48:51]
    s_waitcnt lgkmcnt(10)
    ds_read_b64_tr_b16 v[182:183], v161 offset:58368
    ds_read_b64_tr_b16 v[184:185], v162 offset:57344
    v_mfma_f32_16x16x32_bf16 v[20:23], v[192:195], v[140:143], v[20:23]
    ds_read_b64_tr_b16 v[186:187], v162 offset:58368
    v_mfma_f32_16x16x32_bf16 v[52:55], v[192:195], v[144:147], v[52:55]
    s_waitcnt lgkmcnt(10)
    ds_read_b64_tr_b16 v[188:189], v163 offset:57344
    v_mfma_f32_16x16x32_bf16 v[24:27], v[196:199], v[140:143], v[24:27]
    ds_read_b64_tr_b16 v[190:191], v163 offset:58368
    v_mfma_f32_16x16x32_bf16 v[56:59], v[196:199], v[144:147], v[56:59]
    ds_read_b64_tr_b16 v[192:193], v164 offset:57344
    ds_read_b64_tr_b16 v[194:195], v164 offset:58368
    v_mfma_f32_16x16x32_bf16 v[28:31], v[200:203], v[140:143], v[28:31]
    ds_read_b64_tr_b16 v[196:197], v165 offset:57344
    v_mfma_f32_16x16x32_bf16 v[60:63], v[200:203], v[144:147], v[60:63]
    s_waitcnt lgkmcnt(11)
    ds_read_b64_tr_b16 v[198:199], v165 offset:58368
    v_mfma_f32_16x16x32_bf16 v[32:35], v[204:207], v[140:143], v[32:35]
    ds_read_b64_tr_b16 v[200:201], v166 offset:57344
    v_mfma_f32_16x16x32_bf16 v[64:67], v[204:207], v[144:147], v[64:67]
    s_waitcnt lgkmcnt(10)
    ds_read_b64_tr_b16 v[202:203], v166 offset:58368
    ds_read_b64_tr_b16 v[204:205], v167 offset:57344
    v_mfma_f32_16x16x32_bf16 v[4:7], v[176:179], v[148:151], v[4:7]
    ds_read_b64_tr_b16 v[206:207], v167 offset:58368
    v_mfma_f32_16x16x32_bf16 v[36:39], v[176:179], v[152:155], v[36:39]
    s_waitcnt lgkmcnt(11)
    v_mfma_f32_16x16x32_bf16 v[8:11], v[180:183], v[148:151], v[8:11]
    v_mfma_f32_16x16x32_bf16 v[40:43], v[180:183], v[152:155], v[40:43]
    s_waitcnt lgkmcnt(10)
    v_mfma_f32_16x16x32_bf16 v[12:15], v[184:187], v[148:151], v[12:15]
    v_mfma_f32_16x16x32_bf16 v[44:47], v[184:187], v[152:155], v[44:47]
    s_waitcnt lgkmcnt(8)
    v_mfma_f32_16x16x32_bf16 v[16:19], v[188:191], v[148:151], v[16:19]
    v_mfma_f32_16x16x32_bf16 v[48:51], v[188:191], v[152:155], v[48:51]
    s_waitcnt lgkmcnt(0)
    s_barrier
    ds_read_b128 v[140:143], v168 offset:49152
    ds_read_b128 v[144:147], v168 offset:51200
    v_mfma_f32_16x16x32_bf16 v[20:23], v[192:195], v[148:151], v[20:23]
    ds_read_b64_tr_b16 v[176:177], v160 offset:32768
    ds_read_b64_tr_b16 v[178:179], v160 offset:33792
    v_mfma_f32_16x16x32_bf16 v[52:55], v[192:195], v[152:155], v[52:55]
    ds_read_b64_tr_b16 v[180:181], v161 offset:32768
    ds_read_b64_tr_b16 v[182:183], v161 offset:33792
    v_mfma_f32_16x16x32_bf16 v[24:27], v[196:199], v[148:151], v[24:27]
    ds_read_b64_tr_b16 v[184:185], v162 offset:32768
    ds_read_b64_tr_b16 v[186:187], v162 offset:33792
    v_mfma_f32_16x16x32_bf16 v[56:59], v[196:199], v[152:155], v[56:59]
    ds_read_b64_tr_b16 v[188:189], v163 offset:32768
    ds_read_b64_tr_b16 v[190:191], v163 offset:33792
    v_mfma_f32_16x16x32_bf16 v[28:31], v[200:203], v[148:151], v[28:31]
    ds_read_b64_tr_b16 v[192:193], v164 offset:32768
    v_mfma_f32_16x16x32_bf16 v[60:63], v[200:203], v[152:155], v[60:63]
    ds_read_b64_tr_b16 v[194:195], v164 offset:33792
    v_mfma_f32_16x16x32_bf16 v[32:35], v[204:207], v[148:151], v[32:35]
    ds_read_b64_tr_b16 v[196:197], v165 offset:32768
    v_mfma_f32_16x16x32_bf16 v[64:67], v[204:207], v[152:155], v[64:67]
    s_waitcnt lgkmcnt(9)
    ds_read_b64_tr_b16 v[198:199], v165 offset:33792
    ds_read_b64_tr_b16 v[200:201], v166 offset:32768
    v_mfma_f32_16x16x32_bf16 v[4:7], v[176:179], v[140:143], v[4:7]
    ds_read_b64_tr_b16 v[202:203], v166 offset:33792
    v_mfma_f32_16x16x32_bf16 v[36:39], v[176:179], v[144:147], v[36:39]
    s_waitcnt lgkmcnt(10)
    ds_read_b64_tr_b16 v[204:205], v167 offset:32768
    v_mfma_f32_16x16x32_bf16 v[8:11], v[180:183], v[140:143], v[8:11]
    ds_read_b64_tr_b16 v[206:207], v167 offset:33792
    v_mfma_f32_16x16x32_bf16 v[40:43], v[180:183], v[144:147], v[40:43]
    s_waitcnt lgkmcnt(10)
    ds_read_b128 v[148:151], v169 offset:49152
    ds_read_b128 v[152:155], v169 offset:51200
    v_mfma_f32_16x16x32_bf16 v[12:15], v[184:187], v[140:143], v[12:15]
    ds_read_b64_tr_b16 v[176:177], v160 offset:40960
    v_mfma_f32_16x16x32_bf16 v[44:47], v[184:187], v[144:147], v[44:47]
    s_waitcnt lgkmcnt(11)
    ds_read_b64_tr_b16 v[178:179], v160 offset:41984
    v_mfma_f32_16x16x32_bf16 v[16:19], v[188:191], v[140:143], v[16:19]
    ds_read_b64_tr_b16 v[180:181], v161 offset:40960
    v_mfma_f32_16x16x32_bf16 v[48:51], v[188:191], v[144:147], v[48:51]
    s_waitcnt lgkmcnt(10)
    ds_read_b64_tr_b16 v[182:183], v161 offset:41984
    ds_read_b64_tr_b16 v[184:185], v162 offset:40960
    v_mfma_f32_16x16x32_bf16 v[20:23], v[192:195], v[140:143], v[20:23]
    ds_read_b64_tr_b16 v[186:187], v162 offset:41984
    v_mfma_f32_16x16x32_bf16 v[52:55], v[192:195], v[144:147], v[52:55]
    s_waitcnt lgkmcnt(10)
    ds_read_b64_tr_b16 v[188:189], v163 offset:40960
    v_mfma_f32_16x16x32_bf16 v[24:27], v[196:199], v[140:143], v[24:27]
    ds_read_b64_tr_b16 v[190:191], v163 offset:41984
    v_mfma_f32_16x16x32_bf16 v[56:59], v[196:199], v[144:147], v[56:59]
    ds_read_b64_tr_b16 v[192:193], v164 offset:40960
    ds_read_b64_tr_b16 v[194:195], v164 offset:41984
    v_mfma_f32_16x16x32_bf16 v[28:31], v[200:203], v[140:143], v[28:31]
    ds_read_b64_tr_b16 v[196:197], v165 offset:40960
    v_mfma_f32_16x16x32_bf16 v[60:63], v[200:203], v[144:147], v[60:63]
    s_waitcnt lgkmcnt(11)
    ds_read_b64_tr_b16 v[198:199], v165 offset:41984
    v_mfma_f32_16x16x32_bf16 v[32:35], v[204:207], v[140:143], v[32:35]
    ds_read_b64_tr_b16 v[200:201], v166 offset:40960
    v_mfma_f32_16x16x32_bf16 v[64:67], v[204:207], v[144:147], v[64:67]
    s_waitcnt lgkmcnt(10)
    ds_read_b64_tr_b16 v[202:203], v166 offset:41984
    ds_read_b64_tr_b16 v[204:205], v167 offset:40960
    v_mfma_f32_16x16x32_bf16 v[4:7], v[176:179], v[148:151], v[4:7]
    ds_read_b64_tr_b16 v[206:207], v167 offset:41984
    v_mfma_f32_16x16x32_bf16 v[36:39], v[176:179], v[152:155], v[36:39]
    s_waitcnt lgkmcnt(11)
    v_mfma_f32_16x16x32_bf16 v[8:11], v[180:183], v[148:151], v[8:11]
    v_mfma_f32_16x16x32_bf16 v[40:43], v[180:183], v[152:155], v[40:43]
    s_waitcnt lgkmcnt(10)
    v_mfma_f32_16x16x32_bf16 v[12:15], v[184:187], v[148:151], v[12:15]
    v_mfma_f32_16x16x32_bf16 v[44:47], v[184:187], v[152:155], v[44:47]
    s_waitcnt lgkmcnt(8)
    v_mfma_f32_16x16x32_bf16 v[16:19], v[188:191], v[148:151], v[16:19]
    v_mfma_f32_16x16x32_bf16 v[48:51], v[188:191], v[152:155], v[48:51]
    s_waitcnt lgkmcnt(6)
    v_mul_f32 v4, s96, v4
    v_mul_f32 v5, s96, v5
    v_mfma_f32_16x16x32_bf16 v[20:23], v[192:195], v[148:151], v[20:23]
    v_mul_f32 v6, s96, v6
    v_mul_f32 v7, s96, v7
    v_mfma_f32_16x16x32_bf16 v[52:55], v[192:195], v[152:155], v[52:55]
    s_waitcnt lgkmcnt(3)
    v_mul_f32 v8, s96, v8
    v_mul_f32 v9, s96, v9
    v_mfma_f32_16x16x32_bf16 v[24:27], v[196:199], v[148:151], v[24:27]
    v_mul_f32 v10, s96, v10
    v_mul_f32 v11, s96, v11
    v_mfma_f32_16x16x32_bf16 v[56:59], v[196:199], v[152:155], v[56:59]
    s_waitcnt lgkmcnt(0)
    v_cvt_pk_bf16_f32 v76, v4, v5
    v_cvt_pk_bf16_f32 v77, v6, v7
    v_mfma_f32_16x16x32_bf16 v[28:31], v[200:203], v[148:151], v[28:31]
    v_cvt_pk_bf16_f32 v78, v8, v9
    v_cvt_pk_bf16_f32 v79, v10, v11
    v_mfma_f32_16x16x32_bf16 v[60:63], v[200:203], v[152:155], v[60:63]
    v_mul_f32 v36, s96, v36
    v_mul_f32 v37, s96, v37
    v_mfma_f32_16x16x32_bf16 v[32:35], v[204:207], v[148:151], v[32:35]
    v_mul_f32 v38, s96, v38
    v_mul_f32 v39, s96, v39
    v_mfma_f32_16x16x32_bf16 v[64:67], v[204:207], v[152:155], v[64:67]
    v_mul_f32 v40, s96, v40
    v_mul_f32 v41, s96, v41
    v_mul_f32 v42, s96, v42
    v_mul_f32 v43, s96, v43
    v_cvt_pk_bf16_f32 v92, v36, v37
    v_cvt_pk_bf16_f32 v93, v38, v39
    v_cvt_pk_bf16_f32 v94, v40, v41
    v_cvt_pk_bf16_f32 v95, v42, v43
    v_mul_f32 v12, s96, v12
    v_mul_f32 v13, s96, v13
    v_mul_f32 v14, s96, v14
    v_mul_f32 v15, s96, v15
    v_mul_f32 v16, s96, v16
    v_mul_f32 v17, s96, v17
    v_mul_f32 v18, s96, v18
    v_mul_f32 v19, s96, v19
    v_cvt_pk_bf16_f32 v80, v12, v13
    v_cvt_pk_bf16_f32 v81, v14, v15
    v_cvt_pk_bf16_f32 v82, v16, v17
    v_cvt_pk_bf16_f32 v83, v18, v19
    v_mul_f32 v44, s96, v44
    v_mul_f32 v45, s96, v45
    v_mul_f32 v46, s96, v46
    v_mul_f32 v47, s96, v47
    v_mul_f32 v48, s96, v48
    v_mul_f32 v49, s96, v49
    v_mul_f32 v50, s96, v50
    v_mul_f32 v51, s96, v51
    v_cvt_pk_bf16_f32 v96, v44, v45
    v_cvt_pk_bf16_f32 v97, v46, v47
    v_cvt_pk_bf16_f32 v98, v48, v49
    v_cvt_pk_bf16_f32 v99, v50, v51
    v_permlane32_swap_b32 v76, v78
    v_permlane32_swap_b32 v77, v79
    v_permlane32_swap_b32 v92, v94
    v_permlane32_swap_b32 v93, v95
    v_permlane16_swap_b32 v76, v78
    v_permlane16_swap_b32 v77, v79
    v_permlane16_swap_b32 v92, v94
    v_permlane16_swap_b32 v93, v95
    v_mul_f32 v20, s96, v20
    v_mul_f32 v21, s96, v21
    v_mul_f32 v22, s96, v22
    v_mul_f32 v23, s96, v23
    v_mul_f32 v24, s96, v24
    v_mul_f32 v25, s96, v25
    v_mul_f32 v26, s96, v26
    v_mul_f32 v27, s96, v27
    v_cvt_pk_bf16_f32 v84, v20, v21
    v_cvt_pk_bf16_f32 v85, v22, v23
    v_cvt_pk_bf16_f32 v86, v24, v25
    v_cvt_pk_bf16_f32 v87, v26, v27
    v_mul_f32 v52, s96, v52
    v_mul_f32 v53, s96, v53
    v_mul_f32 v54, s96, v54
    v_mul_f32 v55, s96, v55
    v_mul_f32 v56, s96, v56
    v_mul_f32 v57, s96, v57
    v_mul_f32 v58, s96, v58
    v_mul_f32 v59, s96, v59
    v_cvt_pk_bf16_f32 v100, v52, v53
    v_cvt_pk_bf16_f32 v101, v54, v55
    v_cvt_pk_bf16_f32 v102, v56, v57
    v_cvt_pk_bf16_f32 v103, v58, v59
    v_permlane32_swap_b32 v80, v82
    v_permlane32_swap_b32 v81, v83
    v_permlane32_swap_b32 v96, v98
    v_permlane32_swap_b32 v97, v99
    v_permlane16_swap_b32 v80, v82
    v_permlane16_swap_b32 v81, v83
    v_permlane16_swap_b32 v96, v98
    v_permlane16_swap_b32 v97, v99
    v_mul_f32 v28, s96, v28
    v_mul_f32 v29, s96, v29
    v_mul_f32 v30, s96, v30
    v_mul_f32 v31, s96, v31
    v_mul_f32 v32, s96, v32
    v_mul_f32 v33, s96, v33
    v_mul_f32 v34, s96, v34
    v_mul_f32 v35, s96, v35
    v_cvt_pk_bf16_f32 v88, v28, v29
    v_cvt_pk_bf16_f32 v89, v30, v31
    v_cvt_pk_bf16_f32 v90, v32, v33
    v_cvt_pk_bf16_f32 v91, v34, v35
    v_mul_f32 v60, s96, v60
    v_mul_f32 v61, s96, v61
    v_mul_f32 v62, s96, v62
    v_mul_f32 v63, s96, v63
    v_mul_f32 v64, s96, v64
    v_mul_f32 v65, s96, v65
    v_mul_f32 v66, s96, v66
    v_mul_f32 v67, s96, v67
    v_cvt_pk_bf16_f32 v104, v60, v61
    v_cvt_pk_bf16_f32 v105, v62, v63
    v_cvt_pk_bf16_f32 v106, v64, v65
    v_cvt_pk_bf16_f32 v107, v66, v67
    v_permlane32_swap_b32 v84, v86
    v_permlane32_swap_b32 v85, v87
    v_permlane32_swap_b32 v100, v102
    v_permlane32_swap_b32 v101, v103
    v_permlane16_swap_b32 v84, v86
    v_permlane16_swap_b32 v85, v87
    v_permlane16_swap_b32 v100, v102
    v_permlane16_swap_b32 v101, v103
    v_permlane32_swap_b32 v88, v90
    v_permlane32_swap_b32 v89, v91
    v_permlane32_swap_b32 v104, v106
    v_permlane32_swap_b32 v105, v107
    v_permlane16_swap_b32 v88, v90
    v_permlane16_swap_b32 v89, v91
    v_permlane16_swap_b32 v104, v106
    v_permlane16_swap_b32 v105, v107
    s_waitcnt lgkmcnt(0)
L_Amain:
    s_barrier
    ds_read_b128 v[108:111], v229 offset:32768
    ds_read_b128 v[192:195], v216 offset:0
    ds_read_b128 v[112:115], v229 offset:33792
    ds_read_b128 v[196:199], v217 offset:0
    ds_read_b128 v[116:119], v229 offset:34816
    ds_read_b128 v[200:203], v218 offset:0
    ds_read_b128 v[120:123], v229 offset:35840
    ds_read_b128 v[204:207], v219 offset:0
    ds_read_b128 v[176:179], v212 offset:0
    ds_read_b128 v[180:183], v213 offset:0
    ds_read_b128 v[184:187], v214 offset:0
    ds_read_b128 v[188:191], v215 offset:0
    s_waitcnt lgkmcnt(10)
    v_mfma_f32_16x16x32_bf16 v[156:159], v[192:195], v[108:111], -4.0
    s_waitcnt lgkmcnt(8)
    ds_read_b128 v[192:195], v212 offset:4096
    v_mfma_f32_16x16x32_bf16 v[156:159], v[196:199], v[112:115], v[156:159]
    s_waitcnt lgkmcnt(7)
    ds_read_b128 v[196:199], v213 offset:4096
    v_mfma_f32_16x16x32_bf16 v[156:159], v[200:203], v[116:119], v[156:159]
    s_waitcnt lgkmcnt(6)
    ds_read_b128 v[200:203], v214 offset:4096
    v_mfma_f32_16x16x32_bf16 v[156:159], v[204:207], v[120:123], v[156:159]
    s_waitcnt lgkmcnt(6)
    ds_read_b128 v[204:207], v215 offset:4096
    v_mfma_f32_16x16x32_bf16 v[124:127], v[176:179], v[76:79], -4.0
    s_waitcnt lgkmcnt(6)
    v_mfma_f32_16x16x32_bf16 v[124:127], v[180:183], v[80:83], v[124:127]
    s_waitcnt lgkmcnt(5)
    v_mfma_f32_16x16x32_bf16 v[124:127], v[184:187], v[84:87], v[124:127]
    s_waitcnt lgkmcnt(4)
    v_mfma_f32_16x16x32_bf16 v[124:127], v[188:191], v[88:91], v[124:127]
    v_mfma_f32_16x16x32_bf16 v[128:131], v[176:179], v[92:95], -4.0
    v_mfma_f32_16x16x32_bf16 v[128:131], v[180:183], v[96:99], v[128:131]
    v_mfma_f32_16x16x32_bf16 v[128:131], v[184:187], v[100:103], v[128:131]
    s_cbranch_vccnz L_hkx15pre
L_hrx15pre:
    v_exp_f32 v156, v156
    v_mfma_f32_16x16x32_bf16 v[128:131], v[188:191], v[104:107], v[128:131]
    s_waitcnt lgkmcnt(3)
    v_exp_f32 v157, v157
    v_mfma_f32_16x16x32_bf16 v[132:135], v[192:195], v[76:79], -4.0
    s_waitcnt lgkmcnt(2)
    v_exp_f32 v158, v158
    v_mfma_f32_16x16x32_bf16 v[132:135], v[196:199], v[80:83], v[132:135]
    s_waitcnt lgkmcnt(1)
    v_exp_f32 v159, v159
    v_mfma_f32_16x16x32_bf16 v[132:135], v[200:203], v[84:87], v[132:135]
    s_waitcnt lgkmcnt(0)
    v_add_f32 v237, v156, v157
    v_mfma_f32_16x16x32_bf16 v[132:135], v[204:207], v[88:91], v[132:135]
    v_add_f32 v237, v237, v158
    v_mfma_f32_16x16x32_bf16 v[136:139], v[192:195], v[92:95], -4.0
    v_add_f32 v237, v237, v159
    v_mfma_f32_16x16x32_bf16 v[136:139], v[196:199], v[96:99], v[136:139]
    v_cvt_pk_bf16_f32 v156, v156, v157
    v_mfma_f32_16x16x32_bf16 v[136:139], v[200:203], v[100:103], v[136:139]
    v_cvt_pk_bf16_f32 v157, v158, v159
    v_mfma_f32_16x16x32_bf16 v[136:139], v[204:207], v[104:107], v[136:139]
    ds_write_b64 v230, v[156:157] offset:45056
    s_cbranch_vccnz L_hkm15pre
L_hrm15pre:
    v_exp_f32 v124, v124
    v_exp_f32 v125, v125
    v_exp_f32 v126, v126
    v_exp_f32 v127, v127
    v_exp_f32 v128, v128
    v_exp_f32 v129, v129
    v_exp_f32 v130, v130
    v_exp_f32 v131, v131
    s_waitcnt lgkmcnt(0)
    s_barrier
    ds_read_b128 v[176:179], v212 offset:8192
    ds_read_b128 v[180:183], v213 offset:8192
    ds_read_b128 v[184:187], v214 offset:8192
    ds_read_b128 v[188:191], v215 offset:8192
    ds_read_b128 v[192:195], v212 offset:12288
    ds_read_b128 v[196:199], v213 offset:12288
    ds_read_b128 v[200:203], v214 offset:12288
    ds_read_b128 v[204:207], v215 offset:12288
    v_exp_f32 v132, v132
    v_exp_f32 v133, v133
    v_exp_f32 v134, v134
    v_exp_f32 v135, v135
    v_exp_f32 v136, v136
    v_exp_f32 v137, v137
    v_exp_f32 v138, v138
    v_exp_f32 v139, v139
    s_waitcnt lgkmcnt(7)
    v_mfma_f32_16x16x32_bf16 v[140:143], v[176:179], v[76:79], -4.0
    s_waitcnt lgkmcnt(6)
    v_add_f32 v233, v124, v125
    v_cvt_pk_bf16_f32 v160, v124, v125
    v_mfma_f32_16x16x32_bf16 v[140:143], v[180:183], v[80:83], v[140:143]
    s_waitcnt lgkmcnt(5)
    ds_read_b128 v[168:171], v229 offset:45056
    v_add_f32 v235, v128, v129
    v_mfma_f32_16x16x32_bf16 v[140:143], v[184:187], v[84:87], v[140:143]
    s_waitcnt lgkmcnt(5)
    v_cvt_pk_bf16_f32 v164, v128, v129
    v_add_f32 v233, v233, v126
    v_mfma_f32_16x16x32_bf16 v[140:143], v[188:191], v[88:91], v[140:143]
    ds_read_b128 v[172:175], v229 offset:46080
    v_add_f32 v233, v233, v127
    v_mfma_f32_16x16x32_bf16 v[144:147], v[176:179], v[92:95], -4.0
    ds_read_b64_tr_b16 v[176:177], v220 offset:0
    v_cvt_pk_bf16_f32 v161, v126, v127
    v_add_f32 v235, v235, v130
    v_mfma_f32_16x16x32_bf16 v[144:147], v[180:183], v[96:99], v[144:147]
    ds_read_b64_tr_b16 v[178:179], v220 offset:4096
    v_add_f32 v235, v235, v131
    v_mfma_f32_16x16x32_bf16 v[144:147], v[184:187], v[100:103], v[144:147]
    ds_read_b64_tr_b16 v[180:181], v221 offset:0
    v_cvt_pk_bf16_f32 v165, v130, v131
    v_add_f32 v233, v233, v132
    v_mfma_f32_16x16x32_bf16 v[144:147], v[188:191], v[104:107], v[144:147]
    s_waitcnt lgkmcnt(5)
    ds_read_b64_tr_b16 v[182:183], v221 offset:4096
    v_add_f32 v233, v233, v133
    v_mfma_f32_16x16x32_bf16 v[148:151], v[192:195], v[76:79], -4.0
    ds_read_b64_tr_b16 v[184:185], v222 offset:0
    v_cvt_pk_bf16_f32 v162, v132, v133
    v_add_f32 v235, v235, v136
    v_mfma_f32_16x16x32_bf16 v[148:151], v[196:199], v[80:83], v[148:151]
    ds_read_b64_tr_b16 v[186:187], v222 offset:4096
    v_add_f32 v235, v235, v137
    v_mfma_f32_16x16x32_bf16 v[148:151], v[200:203], v[84:87], v[148:151]
    ds_read_b64_tr_b16 v[188:189], v223 offset:0
    v_cvt_pk_bf16_f32 v166, v136, v137
    v_add_f32 v233, v233, v134
    v_mfma_f32_16x16x32_bf16 v[148:151], v[204:207], v[88:91], v[148:151]
    ds_read_b64_tr_b16 v[190:191], v223 offset:4096
    v_add_f32 v233, v233, v135
    v_mfma_f32_16x16x32_bf16 v[152:155], v[192:195], v[92:95], -4.0
    ds_read_b64_tr_b16 v[192:193], v224 offset:0
    v_cvt_pk_bf16_f32 v163, v134, v135
    v_add_f32 v235, v235, v138
    v_mfma_f32_16x16x32_bf16 v[152:155], v[196:199], v[96:99], v[152:155]
    ds_read_b64_tr_b16 v[194:195], v224 offset:4096
    v_add_f32 v235, v235, v139
    v_mfma_f32_16x16x32_bf16 v[152:155], v[200:203], v[100:103], v[152:155]
    ds_read_b64_tr_b16 v[196:197], v225 offset:0
    v_cvt_pk_bf16_f32 v167, v138, v139
    v_mfma_f32_16x16x32_bf16 v[152:155], v[204:207], v[104:107], v[152:155]
    s_waitcnt lgkmcnt(8)
    ds_read_b64_tr_b16 v[198:199], v225 offset:4096
    v_mfma_f32_16x16x32_bf16 v[4:7], v[176:179], v[160:163], 0
    ds_read_b64_tr_b16 v[200:201], v226 offset:0
    ds_read_b64_tr_b16 v[202:203], v226 offset:4096
    s_cbranch_vccnz L_hkm0first
L_hrm0first:
    v_exp_f32 v140, v140
    v_mfma_f32_16x16x32_bf16 v[36:39], v[176:179], v[164:167], 0
    s_waitcnt lgkmcnt(9)
    ds_read_b64_tr_b16 v[204:205], v227 offset:0
    ds_read_b64_tr_b16 v[206:207], v227 offset:4096
    v_exp_f32 v141, v141
    v_mfma_f32_16x16x32_bf16 v[8:11], v[180:183], v[160:163], 0
    v_exp_f32 v142, v142
    v_mfma_f32_16x16x32_bf16 v[40:43], v[180:183], v[164:167], 0
    s_waitcnt lgkmcnt(9)
    v_exp_f32 v143, v143
    v_mfma_f32_16x16x32_bf16 v[12:15], v[184:187], v[160:163], 0
    v_exp_f32 v144, v144
    v_mfma_f32_16x16x32_bf16 v[44:47], v[184:187], v[164:167], 0
    s_waitcnt lgkmcnt(8)
    v_exp_f32 v145, v145
    v_mfma_f32_16x16x32_bf16 v[16:19], v[188:191], v[160:163], 0
    v_exp_f32 v146, v146
    v_mfma_f32_16x16x32_bf16 v[48:51], v[188:191], v[164:167], 0
    v_exp_f32 v147, v147
    s_waitcnt lgkmcnt(0)
    s_branch L_A1
    .p2align 6
L_Aloop:
    s_barrier
    v_mfma_f32_16x16x32_bf16 v[20:23], v[176:179], v[160:163], v[20:23]
    s_lshl_b32 s41, s36, 12
    ds_read_b128 v[192:195], v216 offset:0
    ds_read_b128 v[196:199], v217 offset:0
    v_mfma_f32_16x16x32_bf16 v[52:55], v[176:179], v[164:167], v[52:55]
    s_sub_u32 s41, 4294950912, s41
    ds_read_b128 v[200:203], v218 offset:0
    ds_read_b128 v[204:207], v219 offset:0
    ds_read_b128 v[108:111], v229 offset:32768
    ds_read_b128 v[112:115], v229 offset:33792
    v_exp_f32 v148, v148
    v_mfma_f32_16x16x32_bf16 v[24:27], v[180:183], v[160:163], v[24:27]
    s_cmp_eq_u32 s38, 0
    v_exp_f32 v149, v149
    v_mfma_f32_16x16x32_bf16 v[56:59], v[180:183], v[164:167], v[56:59]
    s_cselect_b32 s56, s41, 4096
    ds_read_b128 v[176:179], v212 offset:0
    ds_read_b128 v[180:183], v213 offset:0
    ds_read_b128 v[116:119], v229 offset:34816
    ds_read_b128 v[120:123], v229 offset:35840
    v_exp_f32 v150, v150
    v_mfma_f32_16x16x32_bf16 v[28:31], v[184:187], v[160:163], v[28:31]
    s_lshl_b32 s41, s38, 12
    v_exp_f32 v151, v151
    v_mfma_f32_16x16x32_bf16 v[60:63], v[184:187], v[164:167], v[60:63]
    s_add_u32 s41, s41, 4294950912
    v_exp_f32 v152, v152
    v_mfma_f32_16x16x32_bf16 v[68:71], v[184:187], v[168:171], v[68:71]
    s_cmp_ge_u32 s38, 2
    ds_read_b128 v[184:187], v214 offset:0
    ds_read_b128 v[76:79], v228 offset:0
    ds_read_b128 v[80:83], v228 offset:1024
    ds_read_b128 v[84:87], v228 offset:2048
    ds_read_b128 v[88:91], v228 offset:3072
    v_exp_f32 v153, v153
    v_add_f32 v233, v233, v140
    v_mfma_f32_16x16x32_bf16 v[32:35], v[188:191], v[160:163], v[32:35]
    s_cselect_b32 s41, s41, 32768
    v_exp_f32 v154, v154
    v_mfma_f32_16x16x32_bf16 v[64:67], v[188:191], v[164:167], v[64:67]
    s_add_u32 s57, s41, s47
    v_exp_f32 v155, v155
    v_mfma_f32_16x16x32_bf16 v[72:75], v[188:191], v[168:171], v[72:75]
    s_waitcnt lgkmcnt(5)
    ds_read_b128 v[188:191], v215 offset:0
    ds_read_b128 v[92:95], v228 offset:4096
    ds_read_b128 v[96:99], v228 offset:5120
    ds_read_b128 v[100:103], v228 offset:6144
    ds_read_b128 v[104:107], v228 offset:7168
    v_add_f32 v235, v235, v144
    v_add_f32 v233, v233, v141
    v_mfma_f32_16x16x32_bf16 v[156:159], v[192:195], v[108:111], -4.0
    s_add_u32 s38, s38, 1
    ds_read_b128 v[192:195], v212 offset:4096
    v_cvt_pk_bf16_f32 v160, v140, v141
    v_mfma_f32_16x16x32_bf16 v[156:159], v[196:199], v[112:115], v[156:159]
    ds_read_b128 v[196:199], v213 offset:4096
    v_add_f32 v235, v235, v145
    v_mfma_f32_16x16x32_bf16 v[156:159], v[200:203], v[116:119], v[156:159]
    ds_read_b128 v[200:203], v214 offset:4096
    v_cvt_pk_bf16_f32 v164, v144, v145
    v_mfma_f32_16x16x32_bf16 v[156:159], v[204:207], v[120:123], v[156:159]
    s_waitcnt lgkmcnt(8)
    ds_read_b128 v[204:207], v215 offset:4096
    ds_read_b128 v[208:211], v229 offset:47104
    v_mfma_f32_16x16x32_bf16 v[124:127], v[176:179], v[76:79], -4.0
    v_add_f32 v233, v233, v142
    v_cvt_pk_bf16_f32 v161, v142, v143
    v_mfma_f32_16x16x32_bf16 v[124:127], v[180:183], v[80:83], v[124:127]
    s_waitcnt lgkmcnt(9)
    v_add_f32 v235, v235, v146
    v_cvt_pk_bf16_f32 v165, v146, v147
    v_mfma_f32_16x16x32_bf16 v[124:127], v[184:187], v[84:87], v[124:127]
    s_cbranch_vccnz L_hkx15
L_hrx15:
    v_exp_f32 v156, v156
    v_mfma_f32_16x16x32_bf16 v[124:127], v[188:191], v[88:91], v[124:127]
    s_waitcnt lgkmcnt(5)
    v_exp_f32 v157, v157
    v_exp_f32 v158, v158
    v_mfma_f32_16x16x32_bf16 v[128:131], v[176:179], v[92:95], -4.0
    ds_read_b64_tr_b16 v[176:177], v220 offset:40960
    v_add_f32 v233, v233, v143
    v_mfma_f32_16x16x32_bf16 v[128:131], v[180:183], v[96:99], v[128:131]
    ds_read_b64_tr_b16 v[178:179], v220 offset:45056
    v_cvt_pk_bf16_f32 v162, v148, v149
    v_mfma_f32_16x16x32_bf16 v[128:131], v[184:187], v[100:103], v[128:131]
    ds_read_b64_tr_b16 v[180:181], v221 offset:40960
    v_add_f32 v235, v235, v147
    v_mfma_f32_16x16x32_bf16 v[128:131], v[188:191], v[104:107], v[128:131]
    s_waitcnt lgkmcnt(4)
    ds_read_b64_tr_b16 v[182:183], v221 offset:45056
    v_exp_f32 v159, v159
    v_mfma_f32_16x16x32_bf16 v[132:135], v[192:195], v[76:79], -4.0
    ds_read_b64_tr_b16 v[184:185], v222 offset:40960
    v_cvt_pk_bf16_f32 v166, v152, v153
    v_mfma_f32_16x16x32_bf16 v[132:135], v[196:199], v[80:83], v[132:135]
    ds_read_b64_tr_b16 v[186:187], v222 offset:45056
    v_add_f32 v233, v233, v148
    v_mfma_f32_16x16x32_bf16 v[132:135], v[200:203], v[84:87], v[132:135]
    ds_read_b64_tr_b16 v[188:189], v223 offset:40960
    v_cvt_pk_bf16_f32 v163, v150, v151
    v_mfma_f32_16x16x32_bf16 v[132:135], v[204:207], v[88:91], v[132:135]
    ds_read_b64_tr_b16 v[190:191], v223 offset:45056
    v_add_f32 v235, v235, v152
    s_waitcnt lgkmcnt(8)
    v_add_f32 v208, v208, v209
    v_add_f32 v210, v210, v211
    v_mfma_f32_16x16x32_bf16 v[136:139], v[192:195], v[92:95], -4.0
    ds_read_b64_tr_b16 v[192:193], v224 offset:40960
    v_cvt_pk_bf16_f32 v167, v154, v155
    v_mfma_f32_16x16x32_bf16 v[136:139], v[196:199], v[96:99], v[136:139]
    ds_read_b64_tr_b16 v[194:195], v224 offset:45056
    v_add_f32 v233, v233, v149
    v_mfma_f32_16x16x32_bf16 v[136:139], v[200:203], v[100:103], v[136:139]
    ds_read_b64_tr_b16 v[196:197], v225 offset:40960
    v_cvt_pk_bf16_f32 v250, v156, v157
    v_mfma_f32_16x16x32_bf16 v[136:139], v[204:207], v[104:107], v[136:139]
    s_waitcnt lgkmcnt(7)
    ds_read_b64_tr_b16 v[198:199], v225 offset:45056
    v_cvt_pk_bf16_f32 v251, v158, v159
    v_add_f32 v235, v235, v153
    v_add_f32 v233, v233, v150
    v_add_f32 v235, v235, v154
    v_add_f32 v233, v233, v151
    v_add_f32 v235, v235, v155
    v_add_f32 v208, v208, v210
    v_mfma_f32_16x16x32_bf16 v[4:7], v[176:179], v[160:163], v[4:7]
    s_cbranch_vccnz L_hkm15
L_hrm15:
    v_exp_f32 v124, v124
    v_mfma_f32_16x16x32_bf16 v[36:39], v[176:179], v[164:167], v[36:39]
    ds_read_b64_tr_b16 v[200:201], v226 offset:40960
    ds_read_b64_tr_b16 v[202:203], v226 offset:45056
    ds_read_b64_tr_b16 v[204:205], v227 offset:40960
    ds_read_b64_tr_b16 v[206:207], v227 offset:45056
    v_exp_f32 v125, v125
    v_mov_b32 v1, v233
    v_mov_b32 v2, v235
    v_mov_b32 v3, v208
    v_permlane32_swap_b32 v1, v233
    v_permlane32_swap_b32 v2, v235
    v_permlane32_swap_b32 v3, v208
    v_add_f32 v233, v233, v1
    v_add_f32 v235, v235, v2
    v_add_f32 v208, v208, v3
    v_mfma_f32_16x16x32_bf16 v[8:11], v[180:183], v[160:163], v[8:11]
    v_exp_f32 v126, v126
    v_mfma_f32_16x16x32_bf16 v[40:43], v[180:183], v[164:167], v[40:43]
    s_waitcnt lgkmcnt(8)
    ds_write_b64 v230, v[250:251] offset:45056
    v_exp_f32 v127, v127
    v_mov_b32 v1, v233
    v_mov_b32 v2, v235
    v_mov_b32 v3, v208
    v_permlane16_swap_b32 v1, v233
    v_permlane16_swap_b32 v2, v235
    v_permlane16_swap_b32 v3, v208
    v_add_f32 v233, v233, v1
    v_add_f32 v235, v235, v2
    v_add_f32 v208, v208, v3
    v_mfma_f32_16x16x32_bf16 v[12:15], v[184:187], v[160:163], v[12:15]
    v_exp_f32 v128, v128
    v_mfma_f32_16x16x32_bf16 v[44:47], v[184:187], v[164:167], v[44:47]
    v_exp_f32 v129, v129
    v_rcp_f32 v232, v233
    v_rcp_f32 v234, v235
    v_rcp_f32 v236, v208
    v_min3_f32 v1, v233, v235, v208
    v_max3_f32 v2, v233, v235, v208
    v_cmp_nle_f32 s[60:61], s54, v1
    v_cmp_nge_f32 s[62:63], s55, v2
    v_add_f32 v237, v156, v157
    v_add_f32 v237, v237, v158
    v_add_f32 v237, v237, v159
    v_mfma_f32_16x16x32_bf16 v[16:19], v[188:191], v[160:163], v[16:19]
    v_exp_f32 v130, v130
    v_mfma_f32_16x16x32_bf16 v[48:51], v[188:191], v[164:167], v[48:51]
    v_exp_f32 v131, v131
    s_or_b64 s[58:59], s[58:59], s[60:61]
    s_or_b64 s[58:59], s[58:59], s[62:63]
    s_waitcnt lgkmcnt(0)
    s_barrier
    v_mfma_f32_16x16x32_bf16 v[20:23], v[192:195], v[160:163], v[20:23]
    ds_read_b128 v[176:179], v212 offset:8192
    ds_read_b128 v[180:183], v213 offset:8192
    v_mfma_f32_16x16x32_bf16 v[52:55], v[192:195], v[164:167], v[52:55]
    ds_read_b128 v[184:187], v214 offset:8192
    ds_read_b128 v[188:191], v215 offset:8192
    v_exp_f32 v132, v132
    v_mul_f32 v4, v232, v4
    v_mul_f32 v5, v232, v5
    v_mul_f32 v6, v232, v6
    v_mul_f32 v7, v232, v7
    v_mul_f32 v8, v232, v8
    v_mul_f32 v9, v232, v9
    v_mul_f32 v10, v232, v10
    v_mul_f32 v11, v232, v11
    v_cvt_pk_bf16_f32 v4, v4, v5
    v_cvt_pk_bf16_f32 v5, v6, v7
    v_cvt_pk_bf16_f32 v6, v8, v9
    v_cvt_pk_bf16_f32 v7, v10, v11
    v_add_u32 v238, s50, v228
    v_mfma_f32_16x16x32_bf16 v[24:27], v[196:199], v[160:163], v[24:27]
    v_exp_f32 v133, v133
    v_mfma_f32_16x16x32_bf16 v[56:59], v[196:199], v[164:167], v[56:59]
    ds_write_b128 v238, v[4:7]
    ds_read_b128 v[192:195], v212 offset:12288
    ds_read_b128 v[196:199], v213 offset:12288
    v_exp_f32 v134, v134
    v_mul_f32 v36, v234, v36
    v_mul_f32 v37, v234, v37
    v_mul_f32 v38, v234, v38
    v_mul_f32 v39, v234, v39
    v_mul_f32 v40, v234, v40
    v_mul_f32 v41, v234, v41
    v_mul_f32 v42, v234, v42
    v_mul_f32 v43, v234, v43
    v_cvt_pk_bf16_f32 v36, v36, v37
    v_cvt_pk_bf16_f32 v37, v38, v39
    v_cvt_pk_bf16_f32 v38, v40, v41
    v_cvt_pk_bf16_f32 v39, v42, v43
    v_add_u32 v238, s56, v238
    v_mfma_f32_16x16x32_bf16 v[28:31], v[200:203], v[160:163], v[28:31]
    v_exp_f32 v135, v135
    v_mfma_f32_16x16x32_bf16 v[60:63], v[200:203], v[164:167], v[60:63]
    v_exp_f32 v136, v136
    v_mfma_f32_16x16x32_bf16 v[68:71], v[200:203], v[172:175], v[68:71]
    ds_write_b128 v238, v[36:39]
    ds_read_b128 v[200:203], v214 offset:12288
    v_exp_f32 v137, v137
    v_add_f32 v233, v124, v125
    v_mul_f32 v12, v232, v12
    v_mul_f32 v13, v232, v13
    v_mul_f32 v14, v232, v14
    v_mul_f32 v15, v232, v15
    v_mul_f32 v16, v232, v16
    v_mul_f32 v17, v232, v17
    v_mul_f32 v18, v232, v18
    v_mul_f32 v19, v232, v19
    v_cvt_pk_bf16_f32 v12, v12, v13
    v_cvt_pk_bf16_f32 v13, v14, v15
    v_cvt_pk_bf16_f32 v14, v16, v17
    v_cvt_pk_bf16_f32 v15, v18, v19
    v_add_u32 v238, s51, v228
    v_mfma_f32_16x16x32_bf16 v[32:35], v[204:207], v[160:163], v[32:35]
    v_exp_f32 v138, v138
    v_mfma_f32_16x16x32_bf16 v[64:67], v[204:207], v[164:167], v[64:67]
    v_exp_f32 v139, v139
    v_mfma_f32_16x16x32_bf16 v[72:75], v[204:207], v[172:175], v[72:75]
    s_waitcnt lgkmcnt(5)
    ds_write_b128 v238, v[12:15]
    ds_read_b128 v[204:207], v215 offset:12288
    v_add_f32 v235, v128, v129
    v_add_f32 v233, v233, v126
    v_mul_f32 v44, v234, v44
    v_mul_f32 v45, v234, v45
    v_mul_f32 v46, v234, v46
    v_mul_f32 v47, v234, v47
    v_mul_f32 v48, v234, v48
    v_mul_f32 v49, v234, v49
    v_mul_f32 v50, v234, v50
    v_mul_f32 v51, v234, v51
    v_cvt_pk_bf16_f32 v44, v44, v45
    v_cvt_pk_bf16_f32 v45, v46, v47
    v_cvt_pk_bf16_f32 v46, v48, v49
    v_cvt_pk_bf16_f32 v47, v50, v51
    v_add_u32 v238, s56, v238
    v_mfma_f32_16x16x32_bf16 v[140:143], v[176:179], v[76:79], -4.0
    ds_read_b128 v[168:171], v229 offset:45056
    v_cvt_pk_bf16_f32 v160, v124, v125
    v_mfma_f32_16x16x32_bf16 v[140:143], v[180:183], v[80:83], v[140:143]
    ds_read_b128 v[172:175], v229 offset:46080
    v_add_f32 v235, v235, v130
    v_mfma_f32_16x16x32_bf16 v[140:143], v[184:187], v[84:87], v[140:143]
    v_cvt_pk_bf16_f32 v164, v128, v129
    v_add_f32 v233, v233, v127
    v_mfma_f32_16x16x32_bf16 v[140:143], v[188:191], v[88:91], v[140:143]
    ds_write_b128 v238, v[44:47]
    v_cvt_pk_bf16_f32 v161, v126, v127
    v_add_f32 v235, v235, v131
    v_mul_f32 v20, v232, v20
    v_mul_f32 v21, v232, v21
    v_mul_f32 v22, v232, v22
    v_mul_f32 v23, v232, v23
    v_mul_f32 v24, v232, v24
    v_mul_f32 v25, v232, v25
    v_mul_f32 v26, v232, v26
    v_mul_f32 v27, v232, v27
    v_cvt_pk_bf16_f32 v20, v20, v21
    v_cvt_pk_bf16_f32 v21, v22, v23
    v_cvt_pk_bf16_f32 v22, v24, v25
    v_cvt_pk_bf16_f32 v23, v26, v27
    v_add_u32 v238, s52, v228
    v_mfma_f32_16x16x32_bf16 v[144:147], v[176:179], v[92:95], -4.0
    ds_read_b64_tr_b16 v[176:177], v220 offset:0
    v_cvt_pk_bf16_f32 v165, v130, v131
    v_mfma_f32_16x16x32_bf16 v[144:147], v[180:183], v[96:99], v[144:147]
    ds_read_b64_tr_b16 v[178:179], v220 offset:4096
    v_add_f32 v233, v233, v132
    v_mfma_f32_16x16x32_bf16 v[144:147], v[184:187], v[100:103], v[144:147]
    ds_read_b64_tr_b16 v[180:181], v221 offset:0
    v_cvt_pk_bf16_f32 v162, v132, v133
    v_mfma_f32_16x16x32_bf16 v[144:147], v[188:191], v[104:107], v[144:147]
    s_waitcnt lgkmcnt(6)
    ds_write_b128 v238, v[20:23]
    ds_read_b64_tr_b16 v[182:183], v221 offset:4096
    v_add_f32 v235, v235, v136
    v_mul_f32 v52, v234, v52
    v_mul_f32 v53, v234, v53
    v_mul_f32 v54, v234, v54
    v_mul_f32 v55, v234, v55
    v_mul_f32 v56, v234, v56
    v_mul_f32 v57, v234, v57
    v_mul_f32 v58, v234, v58
    v_mul_f32 v59, v234, v59
    v_cvt_pk_bf16_f32 v52, v52, v53
    v_cvt_pk_bf16_f32 v53, v54, v55
    v_cvt_pk_bf16_f32 v54, v56, v57
    v_cvt_pk_bf16_f32 v55, v58, v59
    v_add_u32 v238, s56, v238
    v_mfma_f32_16x16x32_bf16 v[148:151], v[192:195], v[76:79], -4.0
    ds_read_b64_tr_b16 v[184:185], v222 offset:0
    v_cvt_pk_bf16_f32 v166, v136, v137
    v_mfma_f32_16x16x32_bf16 v[148:151], v[196:199], v[80:83], v[148:151]
    ds_read_b64_tr_b16 v[186:187], v222 offset:4096
    v_add_f32 v233, v233, v133
    v_mfma_f32_16x16x32_bf16 v[148:151], v[200:203], v[84:87], v[148:151]
    ds_read_b64_tr_b16 v[188:189], v223 offset:0
    v_cvt_pk_bf16_f32 v163, v134, v135
    v_mfma_f32_16x16x32_bf16 v[148:151], v[204:207], v[88:91], v[148:151]
    ds_write_b128 v238, v[52:55]
    ds_read_b64_tr_b16 v[190:191], v223 offset:4096
    v_add_f32 v235, v235, v137
    v_mul_f32 v28, v232, v28
    v_mul_f32 v29, v232, v29
    v_mul_f32 v30, v232, v30
    v_mul_f32 v31, v232, v31
    v_mul_f32 v32, v232, v32
    v_mul_f32 v33, v232, v33
    v_mul_f32 v34, v232, v34
    v_mul_f32 v35, v232, v35
    v_cvt_pk_bf16_f32 v28, v28, v29
    v_cvt_pk_bf16_f32 v29, v30, v31
    v_cvt_pk_bf16_f32 v30, v32, v33
    v_cvt_pk_bf16_f32 v31, v34, v35
    v_add_u32 v238, s53, v228
    v_mfma_f32_16x16x32_bf16 v[152:155], v[192:195], v[92:95], -4.0
    ds_read_b64_tr_b16 v[192:193], v224 offset:0
    v_cvt_pk_bf16_f32 v167, v138, v139
    v_mfma_f32_16x16x32_bf16 v[152:155], v[196:199], v[96:99], v[152:155]
    ds_read_b64_tr_b16 v[194:195], v224 offset:4096
    v_add_f32 v233, v233, v134
    v_mfma_f32_16x16x32_bf16 v[152:155], v[200:203], v[100:103], v[152:155]
    ds_read_b64_tr_b16 v[196:197], v225 offset:0
    v_add_f32 v235, v235, v138
    v_mfma_f32_16x16x32_bf16 v[152:155], v[204:207], v[104:107], v[152:155]
    s_waitcnt lgkmcnt(8)
    ds_write_b128 v238, v[28:31]
    ds_read_b64_tr_b16 v[198:199], v225 offset:4096
    v_add_f32 v233, v233, v135
    v_mul_f32 v60, v234, v60
    v_mul_f32 v61, v234, v61
    v_mul_f32 v62, v234, v62
    v_mul_f32 v63, v234, v63
    v_mul_f32 v64, v234, v64
    v_mul_f32 v65, v234, v65
    v_mul_f32 v66, v234, v66
    v_mul_f32 v67, v234, v67
    v_cvt_pk_bf16_f32 v60, v60, v61
    v_cvt_pk_bf16_f32 v61, v62, v63
    v_cvt_pk_bf16_f32 v62, v64, v65
    v_cvt_pk_bf16_f32 v63, v66, v67
    v_add_u32 v238, s56, v238
    v_mfma_f32_16x16x32_bf16 v[4:7], v[176:179], v[160:163], 0
    s_cbranch_vccnz L_hkm0
L_hrm0:
    v_exp_f32 v140, v140
    v_mfma_f32_16x16x32_bf16 v[36:39], v[176:179], v[164:167], 0
    ds_read_b64_tr_b16 v[200:201], v226 offset:0
    ds_read_b64_tr_b16 v[202:203], v226 offset:4096
    ds_read_b64_tr_b16 v[204:205], v227 offset:0
    ds_read_b64_tr_b16 v[206:207], v227 offset:4096
    v_exp_f32 v141, v141
    v_mfma_f32_16x16x32_bf16 v[8:11], v[180:183], v[160:163], 0
    v_exp_f32 v142, v142
    v_mfma_f32_16x16x32_bf16 v[40:43], v[180:183], v[164:167], 0
    s_waitcnt lgkmcnt(9)
    ds_write_b128 v238, v[60:63]
    v_exp_f32 v143, v143
    v_mul_f32 v68, v236, v68
    v_mul_f32 v69, v236, v69
    v_mul_f32 v70, v236, v70
    v_mul_f32 v71, v236, v71
    v_mul_f32 v72, v236, v72
    v_mul_f32 v73, v236, v73
    v_mul_f32 v74, v236, v74
    v_mul_f32 v75, v236, v75
    v_cvt_pk_bf16_f32 v68, v68, v69
    v_cvt_pk_bf16_f32 v69, v70, v71
    v_cvt_pk_bf16_f32 v70, v72, v73
    v_cvt_pk_bf16_f32 v71, v74, v75
    v_add_u32 v238, s57, v229
    v_mfma_f32_16x16x32_bf16 v[12:15], v[184:187], v[160:163], 0
    v_exp_f32 v144, v144
    v_mfma_f32_16x16x32_bf16 v[44:47], v[184:187], v[164:167], 0
    ds_write_b128 v238, v[68:71]
    v_exp_f32 v145, v145
    v_add_f32 v235, v235, v139
    v_mfma_f32_16x16x32_bf16 v[16:19], v[188:191], v[160:163], 0
    v_exp_f32 v146, v146
    v_mfma_f32_16x16x32_bf16 v[48:51], v[188:191], v[164:167], 0
    v_exp_f32 v147, v147
    s_waitcnt lgkmcnt(0)
L_A1:
    s_barrier
    v_mfma_f32_16x16x32_bf16 v[20:23], v[192:195], v[160:163], 0
    ds_read_b128 v[176:179], v216 offset:32768
    ds_read_b128 v[180:183], v217 offset:32768
    v_mfma_f32_16x16x32_bf16 v[52:55], v[192:195], v[164:167], 0
    ds_read_b128 v[184:187], v218 offset:32768
    ds_read_b128 v[188:191], v219 offset:32768
    v_exp_f32 v148, v148
    v_mfma_f32_16x16x32_bf16 v[24:27], v[196:199], v[160:163], 0
    v_exp_f32 v149, v149
    v_mfma_f32_16x16x32_bf16 v[56:59], v[196:199], v[164:167], 0
    ds_read_b128 v[192:195], v212 offset:32768
    ds_read_b128 v[196:199], v213 offset:32768
    v_exp_f32 v150, v150
    v_mfma_f32_16x16x32_bf16 v[28:31], v[200:203], v[160:163], 0
    v_exp_f32 v151, v151
    v_mfma_f32_16x16x32_bf16 v[60:63], v[200:203], v[164:167], 0
    v_exp_f32 v152, v152
    v_mfma_f32_16x16x32_bf16 v[68:71], v[200:203], v[168:171], 0
    ds_read_b128 v[200:203], v214 offset:32768
    v_exp_f32 v153, v153
    v_add_f32 v233, v233, v140
    v_mfma_f32_16x16x32_bf16 v[32:35], v[204:207], v[160:163], 0
    v_exp_f32 v154, v154
    v_mfma_f32_16x16x32_bf16 v[64:67], v[204:207], v[164:167], 0
    v_exp_f32 v155, v155
    v_mfma_f32_16x16x32_bf16 v[72:75], v[204:207], v[168:171], 0
    s_waitcnt lgkmcnt(3)
    ds_read_b128 v[204:207], v215 offset:32768
    v_add_f32 v235, v235, v144
    v_add_f32 v233, v233, v141
    v_mfma_f32_16x16x32_bf16 v[156:159], v[176:179], v[108:111], -4.0
    ds_read_b128 v[176:179], v212 offset:36864
    v_cvt_pk_bf16_f32 v160, v140, v141
    v_mfma_f32_16x16x32_bf16 v[156:159], v[180:183], v[112:115], v[156:159]
    ds_read_b128 v[180:183], v213 offset:36864
    v_add_f32 v235, v235, v145
    v_mfma_f32_16x16x32_bf16 v[156:159], v[184:187], v[116:119], v[156:159]
    ds_read_b128 v[184:187], v214 offset:36864
    v_cvt_pk_bf16_f32 v164, v144, v145
    v_mfma_f32_16x16x32_bf16 v[156:159], v[188:191], v[120:123], v[156:159]
    s_waitcnt lgkmcnt(4)
    ds_read_b128 v[188:191], v215 offset:36864
    v_add_f32 v233, v233, v142
    v_mfma_f32_16x16x32_bf16 v[124:127], v[192:195], v[76:79], -4.0
    v_cvt_pk_bf16_f32 v161, v142, v143
    v_add_f32 v235, v235, v146
    v_mfma_f32_16x16x32_bf16 v[124:127], v[196:199], v[80:83], v[124:127]
    s_waitcnt lgkmcnt(4)
    v_cvt_pk_bf16_f32 v165, v146, v147
    v_add_f32 v233, v233, v143
    v_mfma_f32_16x16x32_bf16 v[124:127], v[200:203], v[84:87], v[124:127]
    s_cbranch_vccnz L_hkx1
L_hrx1:
    v_exp_f32 v156, v156
    v_mfma_f32_16x16x32_bf16 v[124:127], v[204:207], v[88:91], v[124:127]
    v_exp_f32 v157, v157
    v_exp_f32 v158, v158
    v_mfma_f32_16x16x32_bf16 v[128:131], v[192:195], v[92:95], -4.0
    ds_read_b64_tr_b16 v[192:193], v220 offset:8192
    v_cvt_pk_bf16_f32 v162, v148, v149
    v_mfma_f32_16x16x32_bf16 v[128:131], v[196:199], v[96:99], v[128:131]
    ds_read_b64_tr_b16 v[194:195], v220 offset:12288
    v_add_f32 v235, v235, v147
    v_mfma_f32_16x16x32_bf16 v[128:131], v[200:203], v[100:103], v[128:131]
    ds_read_b64_tr_b16 v[196:197], v221 offset:8192
    v_cvt_pk_bf16_f32 v166, v152, v153
    v_mfma_f32_16x16x32_bf16 v[128:131], v[204:207], v[104:107], v[128:131]
    s_waitcnt lgkmcnt(3)
    ds_read_b64_tr_b16 v[198:199], v221 offset:12288
    v_exp_f32 v159, v159
    v_mfma_f32_16x16x32_bf16 v[132:135], v[176:179], v[76:79], -4.0
    ds_read_b64_tr_b16 v[200:201], v222 offset:8192
    v_add_f32 v233, v233, v148
    v_mfma_f32_16x16x32_bf16 v[132:135], v[180:183], v[80:83], v[132:135]
    ds_read_b64_tr_b16 v[202:203], v222 offset:12288
    v_cvt_pk_bf16_f32 v163, v150, v151
    v_mfma_f32_16x16x32_bf16 v[132:135], v[184:187], v[84:87], v[132:135]
    ds_read_b64_tr_b16 v[204:205], v223 offset:8192
    v_add_f32 v235, v235, v152
    v_mfma_f32_16x16x32_bf16 v[132:135], v[188:191], v[88:91], v[132:135]
    ds_read_b64_tr_b16 v[206:207], v223 offset:12288
    v_cvt_pk_bf16_f32 v167, v154, v155
    v_mfma_f32_16x16x32_bf16 v[136:139], v[176:179], v[92:95], -4.0
    ds_read_b64_tr_b16 v[176:177], v224 offset:8192
    v_add_f32 v233, v233, v149
    v_mfma_f32_16x16x32_bf16 v[136:139], v[180:183], v[96:99], v[136:139]
    ds_read_b64_tr_b16 v[178:179], v224 offset:12288
    v_cvt_pk_bf16_f32 v250, v156, v157
    v_mfma_f32_16x16x32_bf16 v[136:139], v[184:187], v[100:103], v[136:139]
    ds_read_b64_tr_b16 v[180:181], v225 offset:8192
    v_cvt_pk_bf16_f32 v251, v158, v159
    v_mfma_f32_16x16x32_bf16 v[136:139], v[188:191], v[104:107], v[136:139]
    s_waitcnt lgkmcnt(7)
    ds_read_b64_tr_b16 v[182:183], v225 offset:12288
    v_add_f32 v235, v235, v153
    v_mfma_f32_16x16x32_bf16 v[4:7], v[192:195], v[160:163], v[4:7]
    s_cbranch_vccnz L_hkm1
L_hrm1:
    v_exp_f32 v124, v124
    v_mfma_f32_16x16x32_bf16 v[36:39], v[192:195], v[164:167], v[36:39]
    ds_read_b64_tr_b16 v[184:185], v226 offset:8192
    ds_read_b64_tr_b16 v[186:187], v226 offset:12288
    ds_read_b64_tr_b16 v[188:189], v227 offset:8192
    ds_read_b64_tr_b16 v[190:191], v227 offset:12288
    v_exp_f32 v125, v125
    v_mfma_f32_16x16x32_bf16 v[8:11], v[196:199], v[160:163], v[8:11]
    v_exp_f32 v126, v126
    v_mfma_f32_16x16x32_bf16 v[40:43], v[196:199], v[164:167], v[40:43]
    s_waitcnt lgkmcnt(8)
    ds_write_b64 v230, v[250:251] offset:45056
    v_exp_f32 v127, v127
    v_mfma_f32_16x16x32_bf16 v[12:15], v[200:203], v[160:163], v[12:15]
    v_exp_f32 v128, v128
    v_mfma_f32_16x16x32_bf16 v[44:47], v[200:203], v[164:167], v[44:47]
    v_exp_f32 v129, v129
    v_add_f32 v237, v237, v156
    v_add_f32 v233, v233, v150
    v_add_f32 v237, v237, v157
    v_add_f32 v235, v235, v154
    v_mfma_f32_16x16x32_bf16 v[16:19], v[204:207], v[160:163], v[16:19]
    v_exp_f32 v130, v130
    v_mfma_f32_16x16x32_bf16 v[48:51], v[204:207], v[164:167], v[48:51]
    v_exp_f32 v131, v131
    v_add_f32 v237, v237, v158
    v_add_f32 v233, v233, v151
    v_add_f32 v237, v237, v159
    v_add_f32 v235, v235, v155
    s_waitcnt lgkmcnt(0)
    s_barrier
    v_mfma_f32_16x16x32_bf16 v[20:23], v[176:179], v[160:163], v[20:23]
    ds_read_b128 v[192:195], v212 offset:40960
    ds_read_b128 v[196:199], v213 offset:40960
    v_mfma_f32_16x16x32_bf16 v[52:55], v[176:179], v[164:167], v[52:55]
    ds_read_b128 v[200:203], v214 offset:40960
    ds_read_b128 v[204:207], v215 offset:40960
    v_exp_f32 v132, v132
    v_mfma_f32_16x16x32_bf16 v[24:27], v[180:183], v[160:163], v[24:27]
    v_exp_f32 v133, v133
    v_mfma_f32_16x16x32_bf16 v[56:59], v[180:183], v[164:167], v[56:59]
    ds_read_b128 v[176:179], v212 offset:45056
    ds_read_b128 v[180:183], v213 offset:45056
    v_exp_f32 v134, v134
    v_mfma_f32_16x16x32_bf16 v[28:31], v[184:187], v[160:163], v[28:31]
    v_exp_f32 v135, v135
    v_mfma_f32_16x16x32_bf16 v[60:63], v[184:187], v[164:167], v[60:63]
    v_exp_f32 v136, v136
    v_mfma_f32_16x16x32_bf16 v[68:71], v[184:187], v[172:175], v[68:71]
    ds_read_b128 v[184:187], v214 offset:45056
    v_exp_f32 v137, v137
    v_add_f32 v233, v233, v124
    v_mfma_f32_16x16x32_bf16 v[32:35], v[188:191], v[160:163], v[32:35]
    v_exp_f32 v138, v138
    v_mfma_f32_16x16x32_bf16 v[64:67], v[188:191], v[164:167], v[64:67]
    v_exp_f32 v139, v139
    v_mfma_f32_16x16x32_bf16 v[72:75], v[188:191], v[172:175], v[72:75]
    s_waitcnt lgkmcnt(3)
    ds_read_b128 v[188:191], v215 offset:45056
    v_add_f32 v235, v235, v128
    v_add_f32 v233, v233, v125
    v_mfma_f32_16x16x32_bf16 v[140:143], v[192:195], v[76:79], -4.0
    ds_read_b128 v[168:171], v229 offset:45056
    v_cvt_pk_bf16_f32 v160, v124, v125
    v_mfma_f32_16x16x32_bf16 v[140:143], v[196:199], v[80:83], v[140:143]
    ds_read_b128 v[172:175], v229 offset:46080
    v_add_f32 v235, v235, v129
    v_mfma_f32_16x16x32_bf16 v[140:143], v[200:203], v[84:87], v[140:143]
    v_cvt_pk_bf16_f32 v164, v128, v129
    v_add_f32 v233, v233, v126
    v_mfma_f32_16x16x32_bf16 v[140:143], v[204:207], v[88:91], v[140:143]
    v_cvt_pk_bf16_f32 v161, v126, v127
    v_add_f32 v235, v235, v130
    v_mfma_f32_16x16x32_bf16 v[144:147], v[192:195], v[92:95], -4.0
    ds_read_b64_tr_b16 v[192:193], v220 offset:32768
    v_cvt_pk_bf16_f32 v165, v130, v131
    v_mfma_f32_16x16x32_bf16 v[144:147], v[196:199], v[96:99], v[144:147]
    ds_read_b64_tr_b16 v[194:195], v220 offset:36864
    v_add_f32 v233, v233, v127
    v_mfma_f32_16x16x32_bf16 v[144:147], v[200:203], v[100:103], v[144:147]
    ds_read_b64_tr_b16 v[196:197], v221 offset:32768
    v_cvt_pk_bf16_f32 v162, v132, v133
    v_mfma_f32_16x16x32_bf16 v[144:147], v[204:207], v[104:107], v[144:147]
    s_waitcnt lgkmcnt(5)
    ds_read_b64_tr_b16 v[198:199], v221 offset:36864
    v_add_f32 v235, v235, v131
    v_mfma_f32_16x16x32_bf16 v[148:151], v[176:179], v[76:79], -4.0
    ds_read_b64_tr_b16 v[200:201], v222 offset:32768
    v_cvt_pk_bf16_f32 v166, v136, v137
    v_mfma_f32_16x16x32_bf16 v[148:151], v[180:183], v[80:83], v[148:151]
    ds_read_b64_tr_b16 v[202:203], v222 offset:36864
    v_add_f32 v233, v233, v132
    v_mfma_f32_16x16x32_bf16 v[148:151], v[184:187], v[84:87], v[148:151]
    ds_read_b64_tr_b16 v[204:205], v223 offset:32768
    v_cvt_pk_bf16_f32 v163, v134, v135
    v_mfma_f32_16x16x32_bf16 v[148:151], v[188:191], v[88:91], v[148:151]
    ds_read_b64_tr_b16 v[206:207], v223 offset:36864
    v_add_f32 v235, v235, v136
    v_mfma_f32_16x16x32_bf16 v[152:155], v[176:179], v[92:95], -4.0
    ds_read_b64_tr_b16 v[176:177], v224 offset:32768
    v_cvt_pk_bf16_f32 v167, v138, v139
    v_mfma_f32_16x16x32_bf16 v[152:155], v[180:183], v[96:99], v[152:155]
    ds_read_b64_tr_b16 v[178:179], v224 offset:36864
    v_add_f32 v233, v233, v133
    v_mfma_f32_16x16x32_bf16 v[152:155], v[184:187], v[100:103], v[152:155]
    ds_read_b64_tr_b16 v[180:181], v225 offset:32768
    v_add_f32 v235, v235, v137
    v_mfma_f32_16x16x32_bf16 v[152:155], v[188:191], v[104:107], v[152:155]
    s_waitcnt lgkmcnt(7)
    ds_read_b64_tr_b16 v[182:183], v225 offset:36864
    v_add_f32 v233, v233, v134
    v_mfma_f32_16x16x32_bf16 v[4:7], v[192:195], v[160:163], v[4:7]
    s_cbranch_vccnz L_hkm2
L_hrm2:
    v_exp_f32 v140, v140
    v_mfma_f32_16x16x32_bf16 v[36:39], v[192:195], v[164:167], v[36:39]
    ds_read_b64_tr_b16 v[184:185], v226 offset:32768
    ds_read_b64_tr_b16 v[186:187], v226 offset:36864
    ds_read_b64_tr_b16 v[188:189], v227 offset:32768
    ds_read_b64_tr_b16 v[190:191], v227 offset:36864
    v_exp_f32 v141, v141
    v_mfma_f32_16x16x32_bf16 v[8:11], v[196:199], v[160:163], v[8:11]
    v_exp_f32 v142, v142
    v_mfma_f32_16x16x32_bf16 v[40:43], v[196:199], v[164:167], v[40:43]
    s_waitcnt lgkmcnt(8)
    v_exp_f32 v143, v143
    v_mfma_f32_16x16x32_bf16 v[12:15], v[200:203], v[160:163], v[12:15]
    v_exp_f32 v144, v144
    v_mfma_f32_16x16x32_bf16 v[44:47], v[200:203], v[164:167], v[44:47]
    v_exp_f32 v145, v145
    v_add_f32 v235, v235, v138
    v_add_f32 v233, v233, v135
    v_mfma_f32_16x16x32_bf16 v[16:19], v[204:207], v[160:163], v[16:19]
    v_exp_f32 v146, v146
    v_mfma_f32_16x16x32_bf16 v[48:51], v[204:207], v[164:167], v[48:51]
    v_exp_f32 v147, v147
    v_add_f32 v235, v235, v139
    s_waitcnt lgkmcnt(0)
    s_barrier
    v_mfma_f32_16x16x32_bf16 v[20:23], v[176:179], v[160:163], v[20:23]
    ds_read_b128 v[192:195], v216 offset:0
    ds_read_b128 v[196:199], v217 offset:0
    v_mfma_f32_16x16x32_bf16 v[52:55], v[176:179], v[164:167], v[52:55]
    ds_read_b128 v[200:203], v218 offset:0
    ds_read_b128 v[204:207], v219 offset:0
    v_exp_f32 v148, v148
    v_mfma_f32_16x16x32_bf16 v[24:27], v[180:183], v[160:163], v[24:27]
    v_exp_f32 v149, v149
    v_mfma_f32_16x16x32_bf16 v[56:59], v[180:183], v[164:167], v[56:59]
    ds_read_b128 v[176:179], v212 offset:0
    ds_read_b128 v[180:183], v213 offset:0
    v_exp_f32 v150, v150
    v_mfma_f32_16x16x32_bf16 v[28:31], v[184:187], v[160:163], v[28:31]
    v_exp_f32 v151, v151
    v_mfma_f32_16x16x32_bf16 v[60:63], v[184:187], v[164:167], v[60:63]
    v_exp_f32 v152, v152
    v_mfma_f32_16x16x32_bf16 v[68:71], v[184:187], v[168:171], v[68:71]
    ds_read_b128 v[184:187], v214 offset:0
    v_exp_f32 v153, v153
    v_add_f32 v233, v233, v140
    v_mfma_f32_16x16x32_bf16 v[32:35], v[188:191], v[160:163], v[32:35]
    v_exp_f32 v154, v154
    v_mfma_f32_16x16x32_bf16 v[64:67], v[188:191], v[164:167], v[64:67]
    v_exp_f32 v155, v155
    v_mfma_f32_16x16x32_bf16 v[72:75], v[188:191], v[168:171], v[72:75]
    s_waitcnt lgkmcnt(3)
    ds_read_b128 v[188:191], v215 offset:0
    v_add_f32 v235, v235, v144
    v_add_f32 v233, v233, v141
    v_mfma_f32_16x16x32_bf16 v[156:159], v[192:195], v[108:111], -4.0
    ds_read_b128 v[192:195], v212 offset:4096
    v_cvt_pk_bf16_f32 v160, v140, v141
    v_mfma_f32_16x16x32_bf16 v[156:159], v[196:199], v[112:115], v[156:159]
    ds_read_b128 v[196:199], v213 offset:4096
    v_add_f32 v235, v235, v145
    v_mfma_f32_16x16x32_bf16 v[156:159], v[200:203], v[116:119], v[156:159]
    ds_read_b128 v[200:203], v214 offset:4096
    v_cvt_pk_bf16_f32 v164, v144, v145
    v_mfma_f32_16x16x32_bf16 v[156:159], v[204:207], v[120:123], v[156:159]
    s_waitcnt lgkmcnt(4)
    ds_read_b128 v[204:207], v215 offset:4096
    v_add_f32 v233, v233, v142
    v_mfma_f32_16x16x32_bf16 v[124:127], v[176:179], v[76:79], -4.0
    v_cvt_pk_bf16_f32 v161, v142, v143
    v_add_f32 v235, v235, v146
    v_mfma_f32_16x16x32_bf16 v[124:127], v[180:183], v[80:83], v[124:127]
    s_waitcnt lgkmcnt(4)
    v_cvt_pk_bf16_f32 v165, v146, v147
    v_add_f32 v233, v233, v143
    v_mfma_f32_16x16x32_bf16 v[124:127], v[184:187], v[84:87], v[124:127]
    s_cbranch_vccnz L_hkx3
L_hrx3:
    v_exp_f32 v156, v156
    v_mfma_f32_16x16x32_bf16 v[124:127], v[188:191], v[88:91], v[124:127]
    v_exp_f32 v157, v157
    v_exp_f32 v158, v158
    v_mfma_f32_16x16x32_bf16 v[128:131], v[176:179], v[92:95], -4.0
    ds_read_b64_tr_b16 v[176:177], v220 offset:40960
    v_cvt_pk_bf16_f32 v162, v148, v149
    v_mfma_f32_16x16x32_bf16 v[128:131], v[180:183], v[96:99], v[128:131]
    ds_read_b64_tr_b16 v[178:179], v220 offset:45056
    v_add_f32 v235, v235, v147
    v_mfma_f32_16x16x32_bf16 v[128:131], v[184:187], v[100:103], v[128:131]
    ds_read_b64_tr_b16 v[180:181], v221 offset:40960
    v_cvt_pk_bf16_f32 v166, v152, v153
    v_mfma_f32_16x16x32_bf16 v[128:131], v[188:191], v[104:107], v[128:131]
    s_waitcnt lgkmcnt(3)
    ds_read_b64_tr_b16 v[182:183], v221 offset:45056
    v_exp_f32 v159, v159
    v_mfma_f32_16x16x32_bf16 v[132:135], v[192:195], v[76:79], -4.0
    ds_read_b64_tr_b16 v[184:185], v222 offset:40960
    v_add_f32 v233, v233, v148
    v_mfma_f32_16x16x32_bf16 v[132:135], v[196:199], v[80:83], v[132:135]
    ds_read_b64_tr_b16 v[186:187], v222 offset:45056
    v_cvt_pk_bf16_f32 v163, v150, v151
    v_mfma_f32_16x16x32_bf16 v[132:135], v[200:203], v[84:87], v[132:135]
    ds_read_b64_tr_b16 v[188:189], v223 offset:40960
    v_add_f32 v235, v235, v152
    v_mfma_f32_16x16x32_bf16 v[132:135], v[204:207], v[88:91], v[132:135]
    ds_read_b64_tr_b16 v[190:191], v223 offset:45056
    v_cvt_pk_bf16_f32 v167, v154, v155
    v_mfma_f32_16x16x32_bf16 v[136:139], v[192:195], v[92:95], -4.0
    ds_read_b64_tr_b16 v[192:193], v224 offset:40960
    v_add_f32 v233, v233, v149
    v_mfma_f32_16x16x32_bf16 v[136:139], v[196:199], v[96:99], v[136:139]
    ds_read_b64_tr_b16 v[194:195], v224 offset:45056
    v_cvt_pk_bf16_f32 v250, v156, v157
    v_mfma_f32_16x16x32_bf16 v[136:139], v[200:203], v[100:103], v[136:139]
    ds_read_b64_tr_b16 v[196:197], v225 offset:40960
    v_cvt_pk_bf16_f32 v251, v158, v159
    v_mfma_f32_16x16x32_bf16 v[136:139], v[204:207], v[104:107], v[136:139]
    s_waitcnt lgkmcnt(7)
    ds_read_b64_tr_b16 v[198:199], v225 offset:45056
    v_add_f32 v235, v235, v153
    v_mfma_f32_16x16x32_bf16 v[4:7], v[176:179], v[160:163], v[4:7]
    s_cbranch_vccnz L_hkm3
L_hrm3:
    v_exp_f32 v124, v124
    v_mfma_f32_16x16x32_bf16 v[36:39], v[176:179], v[164:167], v[36:39]
    ds_read_b64_tr_b16 v[200:201], v226 offset:40960
    ds_read_b64_tr_b16 v[202:203], v226 offset:45056
    ds_read_b64_tr_b16 v[204:205], v227 offset:40960
    ds_read_b64_tr_b16 v[206:207], v227 offset:45056
    v_exp_f32 v125, v125
    v_mfma_f32_16x16x32_bf16 v[8:11], v[180:183], v[160:163], v[8:11]
    v_exp_f32 v126, v126
    v_mfma_f32_16x16x32_bf16 v[40:43], v[180:183], v[164:167], v[40:43]
    s_waitcnt lgkmcnt(8)
    ds_write_b64 v230, v[250:251] offset:45056
    v_exp_f32 v127, v127
    v_mfma_f32_16x16x32_bf16 v[12:15], v[184:187], v[160:163], v[12:15]
    v_exp_f32 v128, v128
    v_mfma_f32_16x16x32_bf16 v[44:47], v[184:187], v[164:167], v[44:47]
    v_exp_f32 v129, v129
    v_add_f32 v237, v237, v156
    v_add_f32 v233, v233, v150
    v_add_f32 v237, v237, v157
    v_add_f32 v235, v235, v154
    v_mfma_f32_16x16x32_bf16 v[16:19], v[188:191], v[160:163], v[16:19]
    v_exp_f32 v130, v130
    v_mfma_f32_16x16x32_bf16 v[48:51], v[188:191], v[164:167], v[48:51]
    v_exp_f32 v131, v131
    v_add_f32 v237, v237, v158
    v_add_f32 v233, v233, v151
    v_add_f32 v237, v237, v159
    v_add_f32 v235, v235, v155
    s_waitcnt lgkmcnt(0)
    s_barrier
    v_mfma_f32_16x16x32_bf16 v[20:23], v[192:195], v[160:163], v[20:23]
    ds_read_b128 v[176:179], v212 offset:8192
    ds_read_b128 v[180:183], v213 offset:8192
    v_mfma_f32_16x16x32_bf16 v[52:55], v[192:195], v[164:167], v[52:55]
    ds_read_b128 v[184:187], v214 offset:8192
    ds_read_b128 v[188:191], v215 offset:8192
    v_exp_f32 v132, v132
    v_mfma_f32_16x16x32_bf16 v[24:27], v[196:199], v[160:163], v[24:27]
    v_exp_f32 v133, v133
    v_mfma_f32_16x16x32_bf16 v[56:59], v[196:199], v[164:167], v[56:59]
    ds_read_b128 v[192:195], v212 offset:12288
    ds_read_b128 v[196:199], v213 offset:12288
    v_exp_f32 v134, v134
    v_mfma_f32_16x16x32_bf16 v[28:31], v[200:203], v[160:163], v[28:31]
    v_exp_f32 v135, v135
    v_mfma_f32_16x16x32_bf16 v[60:63], v[200:203], v[164:167], v[60:63]
    v_exp_f32 v136, v136
    v_mfma_f32_16x16x32_bf16 v[68:71], v[200:203], v[172:175], v[68:71]
    ds_read_b128 v[200:203], v214 offset:12288
    v_exp_f32 v137, v137
    v_add_f32 v233, v233, v124
    v_mfma_f32_16x16x32_bf16 v[32:35], v[204:207], v[160:163], v[32:35]
    v_exp_f32 v138, v138
    v_mfma_f32_16x16x32_bf16 v[64:67], v[204:207], v[164:167], v[64:67]
    v_exp_f32 v139, v139
    v_mfma_f32_16x16x32_bf16 v[72:75], v[204:207], v[172:175], v[72:75]
    s_waitcnt lgkmcnt(3)
    ds_read_b128 v[204:207], v215 offset:12288
    v_add_f32 v235, v235, v128
    v_add_f32 v233, v233, v125
    v_mfma_f32_16x16x32_bf16 v[140:143], v[176:179], v[76:79], -4.0
    ds_read_b128 v[168:171], v229 offset:45056
    v_cvt_pk_bf16_f32 v160, v124, v125
    v_mfma_f32_16x16x32_bf16 v[140:143], v[180:183], v[80:83], v[140:143]
    ds_read_b128 v[172:175], v229 offset:46080
    v_add_f32 v235, v235, v129
    v_mfma_f32_16x16x32_bf16 v[140:143], v[184:187], v[84:87], v[140:143]
    v_cvt_pk_bf16_f32 v164, v128, v129
    v_add_f32 v233, v233, v126
    v_mfma_f32_16x16x32_bf16 v[140:143], v[188:191], v[88:91], v[140:143]
    v_cvt_pk_bf16_f32 v161, v126, v127
    v_add_f32 v235, v235, v130
    v_mfma_f32_16x16x32_bf16 v[144:147], v[176:179], v[92:95], -4.0
    ds_read_b64_tr_b16 v[176:177], v220 offset:0
    v_cvt_pk_bf16_f32 v165, v130, v131
    v_mfma_f32_16x16x32_bf16 v[144:147], v[180:183], v[96:99], v[144:147]
    ds_read_b64_tr_b16 v[178:179], v220 offset:4096
    v_add_f32 v233, v233, v127
    v_mfma_f32_16x16x32_bf16 v[144:147], v[184:187], v[100:103], v[144:147]
    ds_read_b64_tr_b16 v[180:181], v221 offset:0
    v_cvt_pk_bf16_f32 v162, v132, v133
    v_mfma_f32_16x16x32_bf16 v[144:147], v[188:191], v[104:107], v[144:147]
    s_waitcnt lgkmcnt(5)
    ds_read_b64_tr_b16 v[182:183], v221 offset:4096
    v_add_f32 v235, v235, v131
    v_mfma_f32_16x16x32_bf16 v[148:151], v[192:195], v[76:79], -4.0
    ds_read_b64_tr_b16 v[184:185], v222 offset:0
    v_cvt_pk_bf16_f32 v166, v136, v137
    v_mfma_f32_16x16x32_bf16 v[148:151], v[196:199], v[80:83], v[148:151]
    ds_read_b64_tr_b16 v[186:187], v222 offset:4096
    v_add_f32 v233, v233, v132
    v_mfma_f32_16x16x32_bf16 v[148:151], v[200:203], v[84:87], v[148:151]
    ds_read_b64_tr_b16 v[188:189], v223 offset:0
    v_cvt_pk_bf16_f32 v163, v134, v135
    v_mfma_f32_16x16x32_bf16 v[148:151], v[204:207], v[88:91], v[148:151]
    ds_read_b64_tr_b16 v[190:191], v223 offset:4096
    v_add_f32 v235, v235, v136
    v_mfma_f32_16x16x32_bf16 v[152:155], v[192:195], v[92:95], -4.0
    ds_read_b64_tr_b16 v[192:193], v224 offset:0
    v_cvt_pk_bf16_f32 v167, v138, v139
    v_mfma_f32_16x16x32_bf16 v[152:155], v[196:199], v[96:99], v[152:155]
    ds_read_b64_tr_b16 v[194:195], v224 offset:4096
    v_add_f32 v233, v233, v133
    v_mfma_f32_16x16x32_bf16 v[152:155], v[200:203], v[100:103], v[152:155]
    ds_read_b64_tr_b16 v[196:197], v225 offset:0
    v_add_f32 v235, v235, v137
    v_mfma_f32_16x16x32_bf16 v[152:155], v[204:207], v[104:107], v[152:155]
    s_waitcnt lgkmcnt(7)
    ds_read_b64_tr_b16 v[198:199], v225 offset:4096
    v_add_f32 v233, v233, v134
    v_mfma_f32_16x16x32_bf16 v[4:7], v[176:179], v[160:163], v[4:7]
    s_cbranch_vccnz L_hkm4
L_hrm4:
    v_exp_f32 v140, v140
    v_mfma_f32_16x16x32_bf16 v[36:39], v[176:179], v[164:167], v[36:39]
    ds_read_b64_tr_b16 v[200:201], v226 offset:0
    ds_read_b64_tr_b16 v[202:203], v226 offset:4096
    ds_read_b64_tr_b16 v[204:205], v227 offset:0
    ds_read_b64_tr_b16 v[206:207], v227 offset:4096
    v_exp_f32 v141, v141
    v_mfma_f32_16x16x32_bf16 v[8:11], v[180:183], v[160:163], v[8:11]
    v_exp_f32 v142, v142
    v_mfma_f32_16x16x32_bf16 v[40:43], v[180:183], v[164:167], v[40:43]
    s_waitcnt lgkmcnt(8)
    v_exp_f32 v143, v143
    v_mfma_f32_16x16x32_bf16 v[12:15], v[184:187], v[160:163], v[12:15]
    v_exp_f32 v144, v144
    v_mfma_f32_16x16x32_bf16 v[44:47], v[184:187], v[164:167], v[44:47]
    v_exp_f32 v145, v145
    v_add_f32 v235, v235, v138
    v_add_f32 v233, v233, v135
    v_mfma_f32_16x16x32_bf16 v[16:19], v[188:191], v[160:163], v[16:19]
    v_exp_f32 v146, v146
    v_mfma_f32_16x16x32_bf16 v[48:51], v[188:191], v[164:167], v[48:51]
    v_exp_f32 v147, v147
    v_add_f32 v235, v235, v139
    s_waitcnt lgkmcnt(0)
    s_barrier
    v_mfma_f32_16x16x32_bf16 v[20:23], v[192:195], v[160:163], v[20:23]
    ds_read_b128 v[176:179], v216 offset:32768
    ds_read_b128 v[180:183], v217 offset:32768
    v_mfma_f32_16x16x32_bf16 v[52:55], v[192:195], v[164:167], v[52:55]
    ds_read_b128 v[184:187], v218 offset:32768
    ds_read_b128 v[188:191], v219 offset:32768
    v_exp_f32 v148, v148
    v_mfma_f32_16x16x32_bf16 v[24:27], v[196:199], v[160:163], v[24:27]
    v_exp_f32 v149, v149
    v_mfma_f32_16x16x32_bf16 v[56:59], v[196:199], v[164:167], v[56:59]
    ds_read_b128 v[192:195], v212 offset:32768
    ds_read_b128 v[196:199], v213 offset:32768
    v_exp_f32 v150, v150
    v_mfma_f32_16x16x32_bf16 v[28:31], v[200:203], v[160:163], v[28:31]
    v_exp_f32 v151, v151
    v_mfma_f32_16x16x32_bf16 v[60:63], v[200:203], v[164:167], v[60:63]
    v_exp_f32 v152, v152
    v_mfma_f32_16x16x32_bf16 v[68:71], v[200:203], v[168:171], v[68:71]
    ds_read_b128 v[200:203], v214 offset:32768
    v_exp_f32 v153, v153
    v_add_f32 v233, v233, v140
    v_mfma_f32_16x16x32_bf16 v[32:35], v[204:207], v[160:163], v[32:35]
    v_exp_f32 v154, v154
    v_mfma_f32_16x16x32_bf16 v[64:67], v[204:207], v[164:167], v[64:67]
    v_exp_f32 v155, v155
    v_mfma_f32_16x16x32_bf16 v[72:75], v[204:207], v[168:171], v[72:75]
    s_waitcnt lgkmcnt(3)
    ds_read_b128 v[204:207], v215 offset:32768
    v_add_f32 v235, v235, v144
    v_add_f32 v233, v233, v141
    v_mfma_f32_16x16x32_bf16 v[156:159], v[176:179], v[108:111], -4.0
    ds_read_b128 v[176:179], v212 offset:36864
    v_cvt_pk_bf16_f32 v160, v140, v141
    v_mfma_f32_16x16x32_bf16 v[156:159], v[180:183], v[112:115], v[156:159]
    ds_read_b128 v[180:183], v213 offset:36864
    v_add_f32 v235, v235, v145
    v_mfma_f32_16x16x32_bf16 v[156:159], v[184:187], v[116:119], v[156:159]
    ds_read_b128 v[184:187], v214 offset:36864
    v_cvt_pk_bf16_f32 v164, v144, v145
    v_mfma_f32_16x16x32_bf16 v[156:159], v[188:191], v[120:123], v[156:159]
    s_waitcnt lgkmcnt(4)
    ds_read_b128 v[188:191], v215 offset:36864
    v_add_f32 v233, v233, v142
    v_mfma_f32_16x16x32_bf16 v[124:127], v[192:195], v[76:79], -4.0
    v_cvt_pk_bf16_f32 v161, v142, v143
    v_add_f32 v235, v235, v146
    v_mfma_f32_16x16x32_bf16 v[124:127], v[196:199], v[80:83], v[124:127]
    s_waitcnt lgkmcnt(4)
    v_cvt_pk_bf16_f32 v165, v146, v147
    v_add_f32 v233, v233, v143
    v_mfma_f32_16x16x32_bf16 v[124:127], v[200:203], v[84:87], v[124:127]
    s_cbranch_vccnz L_hkx5
L_hrx5:
    v_exp_f32 v156, v156
    v_mfma_f32_16x16x32_bf16 v[124:127], v[204:207], v[88:91], v[124:127]
    v_exp_f32 v157, v157
    v_exp_f32 v158, v158
    v_mfma_f32_16x16x32_bf16 v[128:131], v[192:195], v[92:95], -4.0
    ds_read_b64_tr_b16 v[192:193], v220 offset:8192
    v_cvt_pk_bf16_f32 v162, v148, v149
    v_mfma_f32_16x16x32_bf16 v[128:131], v[196:199], v[96:99], v[128:131]
    ds_read_b64_tr_b16 v[194:195], v220 offset:12288
    v_add_f32 v235, v235, v147
    v_mfma_f32_16x16x32_bf16 v[128:131], v[200:203], v[100:103], v[128:131]
    ds_read_b64_tr_b16 v[196:197], v221 offset:8192
    v_cvt_pk_bf16_f32 v166, v152, v153
    v_mfma_f32_16x16x32_bf16 v[128:131], v[204:207], v[104:107], v[128:131]
    s_waitcnt lgkmcnt(3)
    ds_read_b64_tr_b16 v[198:199], v221 offset:12288
    v_exp_f32 v159, v159
    v_mfma_f32_16x16x32_bf16 v[132:135], v[176:179], v[76:79], -4.0
    ds_read_b64_tr_b16 v[200:201], v222 offset:8192
    v_add_f32 v233, v233, v148
    v_mfma_f32_16x16x32_bf16 v[132:135], v[180:183], v[80:83], v[132:135]
    ds_read_b64_tr_b16 v[202:203], v222 offset:12288
    v_cvt_pk_bf16_f32 v163, v150, v151
    v_mfma_f32_16x16x32_bf16 v[132:135], v[184:187], v[84:87], v[132:135]
    ds_read_b64_tr_b16 v[204:205], v223 offset:8192
    v_add_f32 v235, v235, v152
    v_mfma_f32_16x16x32_bf16 v[132:135], v[188:191], v[88:91], v[132:135]
    ds_read_b64_tr_b16 v[206:207], v223 offset:12288
    v_cvt_pk_bf16_f32 v167, v154, v155
    v_mfma_f32_16x16x32_bf16 v[136:139], v[176:179], v[92:95], -4.0
    ds_read_b64_tr_b16 v[176:177], v224 offset:8192
    v_add_f32 v233, v233, v149
    v_mfma_f32_16x16x32_bf16 v[136:139], v[180:183], v[96:99], v[136:139]
    ds_read_b64_tr_b16 v[178:179], v224 offset:12288
    v_cvt_pk_bf16_f32 v250, v156, v157
    v_mfma_f32_16x16x32_bf16 v[136:139], v[184:187], v[100:103], v[136:139]
    ds_read_b64_tr_b16 v[180:181], v225 offset:8192
    v_cvt_pk_bf16_f32 v251, v158, v159
    v_mfma_f32_16x16x32_bf16 v[136:139], v[188:191], v[104:107], v[136:139]
    s_waitcnt lgkmcnt(7)
    ds_read_b64_tr_b16 v[182:183], v225 offset:12288
    v_add_f32 v235, v235, v153
    v_mfma_f32_16x16x32_bf16 v[4:7], v[192:195], v[160:163], v[4:7]
    s_cbranch_vccnz L_hkm5
L_hrm5:
    v_exp_f32 v124, v124
    v_mfma_f32_16x16x32_bf16 v[36:39], v[192:195], v[164:167], v[36:39]
    ds_read_b64_tr_b16 v[184:185], v226 offset:8192
    ds_read_b64_tr_b16 v[186:187], v226 offset:12288
    ds_read_b64_tr_b16 v[188:189], v227 offset:8192
    ds_read_b64_tr_b16 v[190:191], v227 offset:12288
    v_exp_f32 v125, v125
    v_mfma_f32_16x16x32_bf16 v[8:11], v[196:199], v[160:163], v[8:11]
    v_exp_f32 v126, v126
    v_mfma_f32_16x16x32_bf16 v[40:43], v[196:199], v[164:167], v[40:43]
    s_waitcnt lgkmcnt(8)
    ds_write_b64 v230, v[250:251] offset:45056
    v_exp_f32 v127, v127
    v_mfma_f32_16x16x32_bf16 v[12:15], v[200:203], v[160:163], v[12:15]
    v_exp_f32 v128, v128
    v_mfma_f32_16x16x32_bf16 v[44:47], v[200:203], v[164:167], v[44:47]
    v_exp_f32 v129, v129
    v_add_f32 v237, v237, v156
    v_add_f32 v233, v233, v150
    v_add_f32 v237, v237, v157
    v_add_f32 v235, v235, v154
    v_mfma_f32_16x16x32_bf16 v[16:19], v[204:207], v[160:163], v[16:19]
    v_exp_f32 v130, v130
    v_mfma_f32_16x16x32_bf16 v[48:51], v[204:207], v[164:167], v[48:51]
    v_exp_f32 v131, v131
    v_add_f32 v237, v237, v158
    v_add_f32 v233, v233, v151
    v_add_f32 v237, v237, v159
    v_add_f32 v235, v235, v155
    s_waitcnt lgkmcnt(0)
    s_barrier
    v_mfma_f32_16x16x32_bf16 v[20:23], v[176:179], v[160:163], v[20:23]
    ds_read_b128 v[192:195], v212 offset:40960
    ds_read_b128 v[196:199], v213 offset:40960
    v_mfma_f32_16x16x32_bf16 v[52:55], v[176:179], v[164:167], v[52:55]
    ds_read_b128 v[200:203], v214 offset:40960
    ds_read_b128 v[204:207], v215 offset:40960
    v_exp_f32 v132, v132
    v_mfma_f32_16x16x32_bf16 v[24:27], v[180:183], v[160:163], v[24:27]
    v_exp_f32 v133, v133
    v_mfma_f32_16x16x32_bf16 v[56:59], v[180:183], v[164:167], v[56:59]
    ds_read_b128 v[176:179], v212 offset:45056
    ds_read_b128 v[180:183], v213 offset:45056
    v_exp_f32 v134, v134
    v_mfma_f32_16x16x32_bf16 v[28:31], v[184:187], v[160:163], v[28:31]
    v_exp_f32 v135, v135
    v_mfma_f32_16x16x32_bf16 v[60:63], v[184:187], v[164:167], v[60:63]
    v_exp_f32 v136, v136
    v_mfma_f32_16x16x32_bf16 v[68:71], v[184:187], v[172:175], v[68:71]
    ds_read_b128 v[184:187], v214 offset:45056
    v_exp_f32 v137, v137
    v_add_f32 v233, v233, v124
    v_mfma_f32_16x16x32_bf16 v[32:35], v[188:191], v[160:163], v[32:35]
    v_exp_f32 v138, v138
    v_mfma_f32_16x16x32_bf16 v[64:67], v[188:191], v[164:167], v[64:67]
    v_exp_f32 v139, v139
    v_mfma_f32_16x16x32_bf16 v[72:75], v[188:191], v[172:175], v[72:75]
    s_waitcnt lgkmcnt(3)
    ds_read_b128 v[188:191], v215 offset:45056
    v_add_f32 v235, v235, v128
    v_add_f32 v233, v233, v125
    v_mfma_f32_16x16x32_bf16 v[140:143], v[192:195], v[76:79], -4.0
    ds_read_b128 v[168:171], v229 offset:45056
    v_cvt_pk_bf16_f32 v160, v124, v125
    v_mfma_f32_16x16x32_bf16 v[140:143], v[196:199], v[80:83], v[140:143]
    ds_read_b128 v[172:175], v229 offset:46080
    v_add_f32 v235, v235, v129
    v_mfma_f32_16x16x32_bf16 v[140:143], v[200:203], v[84:87], v[140:143]
    v_cvt_pk_bf16_f32 v164, v128, v129
    v_add_f32 v233, v233, v126
    v_mfma_f32_16x16x32_bf16 v[140:143], v[204:207], v[88:91], v[140:143]
    v_cvt_pk_bf16_f32 v161, v126, v127
    v_add_f32 v235, v235, v130
    v_mfma_f32_16x16x32_bf16 v[144:147], v[192:195], v[92:95], -4.0
    ds_read_b64_tr_b16 v[192:193], v220 offset:32768
    v_cvt_pk_bf16_f32 v165, v130, v131
    v_mfma_f32_16x16x32_bf16 v[144:147], v[196:199], v[96:99], v[144:147]
    ds_read_b64_tr_b16 v[194:195], v220 offset:36864
    v_add_f32 v233, v233, v127
    v_mfma_f32_16x16x32_bf16 v[144:147], v[200:203], v[100:103], v[144:147]
    ds_read_b64_tr_b16 v[196:197], v221 offset:32768
    v_cvt_pk_bf16_f32 v162, v132, v133
    v_mfma_f32_16x16x32_bf16 v[144:147], v[204:207], v[104:107], v[144:147]
    s_waitcnt lgkmcnt(5)
    ds_read_b64_tr_b16 v[198:199], v221 offset:36864
    v_add_f32 v235, v235, v131
    v_mfma_f32_16x16x32_bf16 v[148:151], v[176:179], v[76:79], -4.0
    ds_read_b64_tr_b16 v[200:201], v222 offset:32768
    v_cvt_pk_bf16_f32 v166, v136, v137
    v_mfma_f32_16x16x32_bf16 v[148:151], v[180:183], v[80:83], v[148:151]
    ds_read_b64_tr_b16 v[202:203], v222 offset:36864
    v_add_f32 v233, v233, v132
    v_mfma_f32_16x16x32_bf16 v[148:151], v[184:187], v[84:87], v[148:151]
    ds_read_b64_tr_b16 v[204:205], v223 offset:32768
    v_cvt_pk_bf16_f32 v163, v134, v135
    v_mfma_f32_16x16x32_bf16 v[148:151], v[188:191], v[88:91], v[148:151]
    ds_read_b64_tr_b16 v[206:207], v223 offset:36864
    v_add_f32 v235, v235, v136
    v_mfma_f32_16x16x32_bf16 v[152:155], v[176:179], v[92:95], -4.0
    ds_read_b64_tr_b16 v[176:177], v224 offset:32768
    v_cvt_pk_bf16_f32 v167, v138, v139
    v_mfma_f32_16x16x32_bf16 v[152:155], v[180:183], v[96:99], v[152:155]
    ds_read_b64_tr_b16 v[178:179], v224 offset:36864
    v_add_f32 v233, v233, v133
    v_mfma_f32_16x16x32_bf16 v[152:155], v[184:187], v[100:103], v[152:155]
    ds_read_b64_tr_b16 v[180:181], v225 offset:32768
    v_add_f32 v235, v235, v137
    v_mfma_f32_16x16x32_bf16 v[152:155], v[188:191], v[104:107], v[152:155]
    s_waitcnt lgkmcnt(7)
    ds_read_b64_tr_b16 v[182:183], v225 offset:36864
    v_add_f32 v233, v233, v134
    v_mfma_f32_16x16x32_bf16 v[4:7], v[192:195], v[160:163], v[4:7]
    s_cbranch_vccnz L_hkm6
L_hrm6:
    v_exp_f32 v140, v140
    v_mfma_f32_16x16x32_bf16 v[36:39], v[192:195], v[164:167], v[36:39]
    ds_read_b64_tr_b16 v[184:185], v226 offset:32768
    ds_read_b64_tr_b16 v[186:187], v226 offset:36864
    ds_read_b64_tr_b16 v[188:189], v227 offset:32768
    ds_read_b64_tr_b16 v[190:191], v227 offset:36864
    v_exp_f32 v141, v141
    v_mfma_f32_16x16x32_bf16 v[8:11], v[196:199], v[160:163], v[8:11]
    v_exp_f32 v142, v142
    v_mfma_f32_16x16x32_bf16 v[40:43], v[196:199], v[164:167], v[40:43]
    s_waitcnt lgkmcnt(8)
    v_exp_f32 v143, v143
    v_mfma_f32_16x16x32_bf16 v[12:15], v[200:203], v[160:163], v[12:15]
    v_exp_f32 v144, v144
    v_mfma_f32_16x16x32_bf16 v[44:47], v[200:203], v[164:167], v[44:47]
    v_exp_f32 v145, v145
    v_add_f32 v235, v235, v138
    v_add_f32 v233, v233, v135
    v_mfma_f32_16x16x32_bf16 v[16:19], v[204:207], v[160:163], v[16:19]
    v_exp_f32 v146, v146
    v_mfma_f32_16x16x32_bf16 v[48:51], v[204:207], v[164:167], v[48:51]
    v_exp_f32 v147, v147
    v_add_f32 v235, v235, v139
    s_waitcnt lgkmcnt(0)
    s_barrier
    v_mfma_f32_16x16x32_bf16 v[20:23], v[176:179], v[160:163], v[20:23]
    ds_read_b128 v[192:195], v216 offset:0
    ds_read_b128 v[196:199], v217 offset:0
    v_mfma_f32_16x16x32_bf16 v[52:55], v[176:179], v[164:167], v[52:55]
    ds_read_b128 v[200:203], v218 offset:0
    ds_read_b128 v[204:207], v219 offset:0
    v_exp_f32 v148, v148
    v_mfma_f32_16x16x32_bf16 v[24:27], v[180:183], v[160:163], v[24:27]
    v_exp_f32 v149, v149
    v_mfma_f32_16x16x32_bf16 v[56:59], v[180:183], v[164:167], v[56:59]
    ds_read_b128 v[176:179], v212 offset:0
    ds_read_b128 v[180:183], v213 offset:0
    v_exp_f32 v150, v150
    v_mfma_f32_16x16x32_bf16 v[28:31], v[184:187], v[160:163], v[28:31]
    v_exp_f32 v151, v151
    v_mfma_f32_16x16x32_bf16 v[60:63], v[184:187], v[164:167], v[60:63]
    v_exp_f32 v152, v152
    v_mfma_f32_16x16x32_bf16 v[68:71], v[184:187], v[168:171], v[68:71]
    ds_read_b128 v[184:187], v214 offset:0
    v_exp_f32 v153, v153
    v_add_f32 v233, v233, v140
    v_mfma_f32_16x16x32_bf16 v[32:35], v[188:191], v[160:163], v[32:35]
    v_exp_f32 v154, v154
    v_mfma_f32_16x16x32_bf16 v[64:67], v[188:191], v[164:167], v[64:67]
    v_exp_f32 v155, v155
    v_mfma_f32_16x16x32_bf16 v[72:75], v[188:191], v[168:171], v[72:75]
    s_waitcnt lgkmcnt(3)
    ds_read_b128 v[188:191], v215 offset:0
    v_add_f32 v235, v235, v144
    v_add_f32 v233, v233, v141
    v_mfma_f32_16x16x32_bf16 v[156:159], v[192:195], v[108:111], -4.0
    ds_read_b128 v[192:195], v212 offset:4096
    v_cvt_pk_bf16_f32 v160, v140, v141
    v_mfma_f32_16x16x32_bf16 v[156:159], v[196:199], v[112:115], v[156:159]
    ds_read_b128 v[196:199], v213 offset:4096
    v_add_f32 v235, v235, v145
    v_mfma_f32_16x16x32_bf16 v[156:159], v[200:203], v[116:119], v[156:159]
    ds_read_b128 v[200:203], v214 offset:4096
    v_cvt_pk_bf16_f32 v164, v144, v145
    v_mfma_f32_16x16x32_bf16 v[156:159], v[204:207], v[120:123], v[156:159]
    s_waitcnt lgkmcnt(4)
    ds_read_b128 v[204:207], v215 offset:4096
    v_add_f32 v233, v233, v142
    v_mfma_f32_16x16x32_bf16 v[124:127], v[176:179], v[76:79], -4.0
    v_cvt_pk_bf16_f32 v161, v142, v143
    v_add_f32 v235, v235, v146
    v_mfma_f32_16x16x32_bf16 v[124:127], v[180:183], v[80:83], v[124:127]
    s_waitcnt lgkmcnt(4)
    v_cvt_pk_bf16_f32 v165, v146, v147
    v_add_f32 v233, v233, v143
    v_mfma_f32_16x16x32_bf16 v[124:127], v[184:187], v[84:87], v[124:127]
    s_cbranch_vccnz L_hkx7
L_hrx7:
    v_exp_f32 v156, v156
    v_mfma_f32_16x16x32_bf16 v[124:127], v[188:191], v[88:91], v[124:127]
    v_exp_f32 v157, v157
    v_exp_f32 v158, v158
    v_mfma_f32_16x16x32_bf16 v[128:131], v[176:179], v[92:95], -4.0
    ds_read_b64_tr_b16 v[176:177], v220 offset:40960
    v_cvt_pk_bf16_f32 v162, v148, v149
    v_mfma_f32_16x16x32_bf16 v[128:131], v[180:183], v[96:99], v[128:131]
    ds_read_b64_tr_b16 v[178:179], v220 offset:45056
    v_add_f32 v235, v235, v147
    v_mfma_f32_16x16x32_bf16 v[128:131], v[184:187], v[100:103], v[128:131]
    ds_read_b64_tr_b16 v[180:181], v221 offset:40960
    v_cvt_pk_bf16_f32 v166, v152, v153
    v_mfma_f32_16x16x32_bf16 v[128:131], v[188:191], v[104:107], v[128:131]
    s_waitcnt lgkmcnt(3)
    ds_read_b64_tr_b16 v[182:183], v221 offset:45056
    v_exp_f32 v159, v159
    v_mfma_f32_16x16x32_bf16 v[132:135], v[192:195], v[76:79], -4.0
    ds_read_b64_tr_b16 v[184:185], v222 offset:40960
    v_add_f32 v233, v233, v148
    v_mfma_f32_16x16x32_bf16 v[132:135], v[196:199], v[80:83], v[132:135]
    ds_read_b64_tr_b16 v[186:187], v222 offset:45056
    v_cvt_pk_bf16_f32 v163, v150, v151
    v_mfma_f32_16x16x32_bf16 v[132:135], v[200:203], v[84:87], v[132:135]
    ds_read_b64_tr_b16 v[188:189], v223 offset:40960
    v_add_f32 v235, v235, v152
    v_mfma_f32_16x16x32_bf16 v[132:135], v[204:207], v[88:91], v[132:135]
    ds_read_b64_tr_b16 v[190:191], v223 offset:45056
    v_cvt_pk_bf16_f32 v167, v154, v155
    v_mfma_f32_16x16x32_bf16 v[136:139], v[192:195], v[92:95], -4.0
    ds_read_b64_tr_b16 v[192:193], v224 offset:40960
    v_add_f32 v233, v233, v149
    v_mfma_f32_16x16x32_bf16 v[136:139], v[196:199], v[96:99], v[136:139]
    ds_read_b64_tr_b16 v[194:195], v224 offset:45056
    v_cvt_pk_bf16_f32 v250, v156, v157
    v_mfma_f32_16x16x32_bf16 v[136:139], v[200:203], v[100:103], v[136:139]
    ds_read_b64_tr_b16 v[196:197], v225 offset:40960
    v_cvt_pk_bf16_f32 v251, v158, v159
    v_mfma_f32_16x16x32_bf16 v[136:139], v[204:207], v[104:107], v[136:139]
    s_waitcnt lgkmcnt(7)
    ds_read_b64_tr_b16 v[198:199], v225 offset:45056
    v_add_f32 v235, v235, v153
    v_mfma_f32_16x16x32_bf16 v[4:7], v[176:179], v[160:163], v[4:7]
    s_cbranch_vccnz L_hkm7
L_hrm7:
    v_exp_f32 v124, v124
    v_mfma_f32_16x16x32_bf16 v[36:39], v[176:179], v[164:167], v[36:39]
    ds_read_b64_tr_b16 v[200:201], v226 offset:40960
    ds_read_b64_tr_b16 v[202:203], v226 offset:45056
    ds_read_b64_tr_b16 v[204:205], v227 offset:40960
    ds_read_b64_tr_b16 v[206:207], v227 offset:45056
    v_exp_f32 v125, v125
    v_mfma_f32_16x16x32_bf16 v[8:11], v[180:183], v[160:163], v[8:11]
    v_exp_f32 v126, v126
    v_mfma_f32_16x16x32_bf16 v[40:43], v[180:183], v[164:167], v[40:43]
    s_waitcnt lgkmcnt(8)
    ds_write_b64 v230, v[250:251] offset:45056
    v_exp_f32 v127, v127
    v_mfma_f32_16x16x32_bf16 v[12:15], v[184:187], v[160:163], v[12:15]
    v_exp_f32 v128, v128
    v_mfma_f32_16x16x32_bf16 v[44:47], v[184:187], v[164:167], v[44:47]
    v_exp_f32 v129, v129
    v_add_f32 v237, v237, v156
    v_add_f32 v233, v233, v150
    v_add_f32 v237, v237, v157
    v_add_f32 v235, v235, v154
    v_mfma_f32_16x16x32_bf16 v[16:19], v[188:191], v[160:163], v[16:19]
    v_exp_f32 v130, v130
    v_mfma_f32_16x16x32_bf16 v[48:51], v[188:191], v[164:167], v[48:51]
    v_exp_f32 v131, v131
    v_add_f32 v237, v237, v158
    v_add_f32 v233, v233, v151
    v_add_f32 v237, v237, v159
    v_add_f32 v235, v235, v155
    s_waitcnt lgkmcnt(0)
    s_barrier
    v_mfma_f32_16x16x32_bf16 v[20:23], v[192:195], v[160:163], v[20:23]
    ds_read_b128 v[176:179], v212 offset:8192
    ds_read_b128 v[180:183], v213 offset:8192
    v_mfma_f32_16x16x32_bf16 v[52:55], v[192:195], v[164:167], v[52:55]
    ds_read_b128 v[184:187], v214 offset:8192
    ds_read_b128 v[188:191], v215 offset:8192
    v_exp_f32 v132, v132
    v_mfma_f32_16x16x32_bf16 v[24:27], v[196:199], v[160:163], v[24:27]
    v_exp_f32 v133, v133
    v_mfma_f32_16x16x32_bf16 v[56:59], v[196:199], v[164:167], v[56:59]
    ds_read_b128 v[192:195], v212 offset:12288
    ds_read_b128 v[196:199], v213 offset:12288
    v_exp_f32 v134, v134
    v_mfma_f32_16x16x32_bf16 v[28:31], v[200:203], v[160:163], v[28:31]
    v_exp_f32 v135, v135
    v_mfma_f32_16x16x32_bf16 v[60:63], v[200:203], v[164:167], v[60:63]
    v_exp_f32 v136, v136
    v_mfma_f32_16x16x32_bf16 v[68:71], v[200:203], v[172:175], v[68:71]
    ds_read_b128 v[200:203], v214 offset:12288
    v_exp_f32 v137, v137
    v_add_f32 v233, v233, v124
    v_mfma_f32_16x16x32_bf16 v[32:35], v[204:207], v[160:163], v[32:35]
    v_exp_f32 v138, v138
    v_mfma_f32_16x16x32_bf16 v[64:67], v[204:207], v[164:167], v[64:67]
    v_exp_f32 v139, v139
    v_mfma_f32_16x16x32_bf16 v[72:75], v[204:207], v[172:175], v[72:75]
    s_waitcnt lgkmcnt(3)
    ds_read_b128 v[204:207], v215 offset:12288
    v_add_f32 v235, v235, v128
    v_add_f32 v233, v233, v125
    v_mfma_f32_16x16x32_bf16 v[140:143], v[176:179], v[76:79], -4.0
    ds_read_b128 v[168:171], v229 offset:45056
    v_cvt_pk_bf16_f32 v160, v124, v125
    v_mfma_f32_16x16x32_bf16 v[140:143], v[180:183], v[80:83], v[140:143]
    ds_read_b128 v[172:175], v229 offset:46080
    v_add_f32 v235, v235, v129
    v_mfma_f32_16x16x32_bf16 v[140:143], v[184:187], v[84:87], v[140:143]
    v_cvt_pk_bf16_f32 v164, v128, v129
    v_add_f32 v233, v233, v126
    v_mfma_f32_16x16x32_bf16 v[140:143], v[188:191], v[88:91], v[140:143]
    v_cvt_pk_bf16_f32 v161, v126, v127
    v_add_f32 v235, v235, v130
    v_mfma_f32_16x16x32_bf16 v[144:147], v[176:179], v[92:95], -4.0
    ds_read_b64_tr_b16 v[176:177], v220 offset:0
    v_cvt_pk_bf16_f32 v165, v130, v131
    v_mfma_f32_16x16x32_bf16 v[144:147], v[180:183], v[96:99], v[144:147]
    ds_read_b64_tr_b16 v[178:179], v220 offset:4096
    v_add_f32 v233, v233, v127
    v_mfma_f32_16x16x32_bf16 v[144:147], v[184:187], v[100:103], v[144:147]
    ds_read_b64_tr_b16 v[180:181], v221 offset:0
    v_cvt_pk_bf16_f32 v162, v132, v133
    v_mfma_f32_16x16x32_bf16 v[144:147], v[188:191], v[104:107], v[144:147]
    s_waitcnt lgkmcnt(5)
    ds_read_b64_tr_b16 v[182:183], v221 offset:4096
    v_add_f32 v235, v235, v131
    v_mfma_f32_16x16x32_bf16 v[148:151], v[192:195], v[76:79], -4.0
    ds_read_b64_tr_b16 v[184:185], v222 offset:0
    v_cvt_pk_bf16_f32 v166, v136, v137
    v_mfma_f32_16x16x32_bf16 v[148:151], v[196:199], v[80:83], v[148:151]
    ds_read_b64_tr_b16 v[186:187], v222 offset:4096
    v_add_f32 v233, v233, v132
    v_mfma_f32_16x16x32_bf16 v[148:151], v[200:203], v[84:87], v[148:151]
    ds_read_b64_tr_b16 v[188:189], v223 offset:0
    v_cvt_pk_bf16_f32 v163, v134, v135
    v_mfma_f32_16x16x32_bf16 v[148:151], v[204:207], v[88:91], v[148:151]
    ds_read_b64_tr_b16 v[190:191], v223 offset:4096
    v_add_f32 v235, v235, v136
    v_mfma_f32_16x16x32_bf16 v[152:155], v[192:195], v[92:95], -4.0
    ds_read_b64_tr_b16 v[192:193], v224 offset:0
    v_cvt_pk_bf16_f32 v167, v138, v139
    v_mfma_f32_16x16x32_bf16 v[152:155], v[196:199], v[96:99], v[152:155]
    ds_read_b64_tr_b16 v[194:195], v224 offset:4096
    v_add_f32 v233, v233, v133
    v_mfma_f32_16x16x32_bf16 v[152:155], v[200:203], v[100:103], v[152:155]
    ds_read_b64_tr_b16 v[196:197], v225 offset:0
    v_add_f32 v235, v235, v137
    v_mfma_f32_16x16x32_bf16 v[152:155], v[204:207], v[104:107], v[152:155]
    s_waitcnt lgkmcnt(7)
    ds_read_b64_tr_b16 v[198:199], v225 offset:4096
    v_add_f32 v233, v233, v134
    v_mfma_f32_16x16x32_bf16 v[4:7], v[176:179], v[160:163], v[4:7]
    s_cbranch_vccnz L_hkm8
L_hrm8:
    v_exp_f32 v140, v140
    v_mfma_f32_16x16x32_bf16 v[36:39], v[176:179], v[164:167], v[36:39]
    ds_read_b64_tr_b16 v[200:201], v226 offset:0
    ds_read_b64_tr_b16 v[202:203], v226 offset:4096
    ds_read_b64_tr_b16 v[204:205], v227 offset:0
    ds_read_b64_tr_b16 v[206:207], v227 offset:4096
    v_exp_f32 v141, v141
    v_mfma_f32_16x16x32_bf16 v[8:11], v[180:183], v[160:163], v[8:11]
    v_exp_f32 v142, v142
    v_mfma_f32_16x16x32_bf16 v[40:43], v[180:183], v[164:167], v[40:43]
    s_waitcnt lgkmcnt(8)
    v_exp_f32 v143, v143
    v_mfma_f32_16x16x32_bf16 v[12:15], v[184:187], v[160:163], v[12:15]
    v_exp_f32 v144, v144
    v_mfma_f32_16x16x32_bf16 v[44:47], v[184:187], v[164:167], v[44:47]
    v_exp_f32 v145, v145
    v_add_f32 v235, v235, v138
    v_add_f32 v233, v233, v135
    v_mfma_f32_16x16x32_bf16 v[16:19], v[188:191], v[160:163], v[16:19]
    v_exp_f32 v146, v146
    v_mfma_f32_16x16x32_bf16 v[48:51], v[188:191], v[164:167], v[48:51]
    v_exp_f32 v147, v147
    v_add_f32 v235, v235, v139
    s_waitcnt lgkmcnt(0)
    s_barrier
    v_mfma_f32_16x16x32_bf16 v[20:23], v[192:195], v[160:163], v[20:23]
    ds_read_b128 v[176:179], v216 offset:32768
    ds_read_b128 v[180:183], v217 offset:32768
    v_mfma_f32_16x16x32_bf16 v[52:55], v[192:195], v[164:167], v[52:55]
    ds_read_b128 v[184:187], v218 offset:32768
    ds_read_b128 v[188:191], v219 offset:32768
    v_exp_f32 v148, v148
    v_mfma_f32_16x16x32_bf16 v[24:27], v[196:199], v[160:163], v[24:27]
    v_exp_f32 v149, v149
    v_mfma_f32_16x16x32_bf16 v[56:59], v[196:199], v[164:167], v[56:59]
    ds_read_b128 v[192:195], v212 offset:32768
    ds_read_b128 v[196:199], v213 offset:32768
    v_exp_f32 v150, v150
    v_mfma_f32_16x16x32_bf16 v[28:31], v[200:203], v[160:163], v[28:31]
    v_exp_f32 v151, v151
    v_mfma_f32_16x16x32_bf16 v[60:63], v[200:203], v[164:167], v[60:63]
    v_exp_f32 v152, v152
    v_mfma_f32_16x16x32_bf16 v[68:71], v[200:203], v[168:171], v[68:71]
    ds_read_b128 v[200:203], v214 offset:32768
    v_exp_f32 v153, v153
    v_add_f32 v233, v233, v140
    v_mfma_f32_16x16x32_bf16 v[32:35], v[204:207], v[160:163], v[32:35]
    v_exp_f32 v154, v154
    v_mfma_f32_16x16x32_bf16 v[64:67], v[204:207], v[164:167], v[64:67]
    v_exp_f32 v155, v155
    v_mfma_f32_16x16x32_bf16 v[72:75], v[204:207], v[168:171], v[72:75]
    s_waitcnt lgkmcnt(3)
    ds_read_b128 v[204:207], v215 offset:32768
    v_add_f32 v235, v235, v144
    v_add_f32 v233, v233, v141
    v_mfma_f32_16x16x32_bf16 v[156:159], v[176:179], v[108:111], -4.0
    ds_read_b128 v[176:179], v212 offset:36864
    v_cvt_pk_bf16_f32 v160, v140, v141
    v_mfma_f32_16x16x32_bf16 v[156:159], v[180:183], v[112:115], v[156:159]
    ds_read_b128 v[180:183], v213 offset:36864
    v_add_f32 v235, v235, v145
    v_mfma_f32_16x16x32_bf16 v[156:159], v[184:187], v[116:119], v[156:159]
    ds_read_b128 v[184:187], v214 offset:36864
    v_cvt_pk_bf16_f32 v164, v144, v145
    v_mfma_f32_16x16x32_bf16 v[156:159], v[188:191], v[120:123], v[156:159]
    s_waitcnt lgkmcnt(4)
    ds_read_b128 v[188:191], v215 offset:36864
    v_add_f32 v233, v233, v142
    v_mfma_f32_16x16x32_bf16 v[124:127], v[192:195], v[76:79], -4.0
    v_cvt_pk_bf16_f32 v161, v142, v143
    v_add_f32 v235, v235, v146
    v_mfma_f32_16x16x32_bf16 v[124:127], v[196:199], v[80:83], v[124:127]
    s_waitcnt lgkmcnt(4)
    v_cvt_pk_bf16_f32 v165, v146, v147
    v_add_f32 v233, v233, v143
    v_mfma_f32_16x16x32_bf16 v[124:127], v[200:203], v[84:87], v[124:127]
    s_cbranch_vccnz L_hkx9
L_hrx9:
    v_exp_f32 v156, v156
    v_mfma_f32_16x16x32_bf16 v[124:127], v[204:207], v[88:91], v[124:127]
    v_exp_f32 v157, v157
    v_exp_f32 v158, v158
    v_mfma_f32_16x16x32_bf16 v[128:131], v[192:195], v[92:95], -4.0
    ds_read_b64_tr_b16 v[192:193], v220 offset:8192
    v_cvt_pk_bf16_f32 v162, v148, v149
    v_mfma_f32_16x16x32_bf16 v[128:131], v[196:199], v[96:99], v[128:131]
    ds_read_b64_tr_b16 v[194:195], v220 offset:12288
    v_add_f32 v235, v235, v147
    v_mfma_f32_16x16x32_bf16 v[128:131], v[200:203], v[100:103], v[128:131]
    ds_read_b64_tr_b16 v[196:197], v221 offset:8192
    v_cvt_pk_bf16_f32 v166, v152, v153
    v_mfma_f32_16x16x32_bf16 v[128:131], v[204:207], v[104:107], v[128:131]
    s_waitcnt lgkmcnt(3)
    ds_read_b64_tr_b16 v[198:199], v221 offset:12288
    v_exp_f32 v159, v159
    v_mfma_f32_16x16x32_bf16 v[132:135], v[176:179], v[76:79], -4.0
    ds_read_b64_tr_b16 v[200:201], v222 offset:8192
    v_add_f32 v233, v233, v148
    v_mfma_f32_16x16x32_bf16 v[132:135], v[180:183], v[80:83], v[132:135]
    ds_read_b64_tr_b16 v[202:203], v222 offset:12288
    v_cvt_pk_bf16_f32 v163, v150, v151
    v_mfma_f32_16x16x32_bf16 v[132:135], v[184:187], v[84:87], v[132:135]
    ds_read_b64_tr_b16 v[204:205], v223 offset:8192
    v_add_f32 v235, v235, v152
    v_mfma_f32_16x16x32_bf16 v[132:135], v[188:191], v[88:91], v[132:135]
    ds_read_b64_tr_b16 v[206:207], v223 offset:12288
    v_cvt_pk_bf16_f32 v167, v154, v155
    v_mfma_f32_16x16x32_bf16 v[136:139], v[176:179], v[92:95], -4.0
    ds_read_b64_tr_b16 v[176:177], v224 offset:8192
    v_add_f32 v233, v233, v149
    v_mfma_f32_16x16x32_bf16 v[136:139], v[180:183], v[96:99], v[136:139]
    ds_read_b64_tr_b16 v[178:179], v224 offset:12288
    v_cvt_pk_bf16_f32 v250, v156, v157
    v_mfma_f32_16x16x32_bf16 v[136:139], v[184:187], v[100:103], v[136:139]
    ds_read_b64_tr_b16 v[180:181], v225 offset:8192
    v_cvt_pk_bf16_f32 v251, v158, v159
    v_mfma_f32_16x16x32_bf16 v[136:139], v[188:191], v[104:107], v[136:139]
    s_waitcnt lgkmcnt(7)
    ds_read_b64_tr_b16 v[182:183], v225 offset:12288
    v_add_f32 v235, v235, v153
    v_mfma_f32_16x16x32_bf16 v[4:7], v[192:195], v[160:163], v[4:7]
    s_cbranch_vccnz L_hkm9
L_hrm9:
    v_exp_f32 v124, v124
    v_mfma_f32_16x16x32_bf16 v[36:39], v[192:195], v[164:167], v[36:39]
    ds_read_b64_tr_b16 v[184:185], v226 offset:8192
    ds_read_b64_tr_b16 v[186:187], v226 offset:12288
    ds_read_b64_tr_b16 v[188:189], v227 offset:8192
    ds_read_b64_tr_b16 v[190:191], v227 offset:12288
    v_exp_f32 v125, v125
    v_mfma_f32_16x16x32_bf16 v[8:11], v[196:199], v[160:163], v[8:11]
    v_exp_f32 v126, v126
    v_mfma_f32_16x16x32_bf16 v[40:43], v[196:199], v[164:167], v[40:43]
    s_waitcnt lgkmcnt(8)
    ds_write_b64 v230, v[250:251] offset:45056
    v_exp_f32 v127, v127
    v_mfma_f32_16x16x32_bf16 v[12:15], v[200:203], v[160:163], v[12:15]
    v_exp_f32 v128, v128
    v_mfma_f32_16x16x32_bf16 v[44:47], v[200:203], v[164:167], v[44:47]
    v_exp_f32 v129, v129
    v_add_f32 v237, v237, v156
    v_add_f32 v233, v233, v150
    v_add_f32 v237, v237, v157
    v_add_f32 v235, v235, v154
    v_mfma_f32_16x16x32_bf16 v[16:19], v[204:207], v[160:163], v[16:19]
    v_exp_f32 v130, v130
    v_mfma_f32_16x16x32_bf16 v[48:51], v[204:207], v[164:167], v[48:51]
    v_exp_f32 v131, v131
    v_add_f32 v237, v237, v158
    v_add_f32 v233, v233, v151
    v_add_f32 v237, v237, v159
    v_add_f32 v235, v235, v155
    s_waitcnt lgkmcnt(0)
    s_barrier
    v_mfma_f32_16x16x32_bf16 v[20:23], v[176:179], v[160:163], v[20:23]
    ds_read_b128 v[192:195], v212 offset:40960
    ds_read_b128 v[196:199], v213 offset:40960
    v_mfma_f32_16x16x32_bf16 v[52:55], v[176:179], v[164:167], v[52:55]
    ds_read_b128 v[200:203], v214 offset:40960
    ds_read_b128 v[204:207], v215 offset:40960
    v_exp_f32 v132, v132
    v_mfma_f32_16x16x32_bf16 v[24:27], v[180:183], v[160:163], v[24:27]
    v_exp_f32 v133, v133
    v_mfma_f32_16x16x32_bf16 v[56:59], v[180:183], v[164:167], v[56:59]
    ds_read_b128 v[176:179], v212 offset:45056
    ds_read_b128 v[180:183], v213 offset:45056
    v_exp_f32 v134, v134
    v_mfma_f32_16x16x32_bf16 v[28:31], v[184:187], v[160:163], v[28:31]
    v_exp_f32 v135, v135
    v_mfma_f32_16x16x32_bf16 v[60:63], v[184:187], v[164:167], v[60:63]
    v_exp_f32 v136, v136
    v_mfma_f32_16x16x32_bf16 v[68:71], v[184:187], v[172:175], v[68:71]
    ds_read_b128 v[184:187], v214 offset:45056
    v_exp_f32 v137, v137
    v_add_f32 v233, v233, v124
    v_mfma_f32_16x16x32_bf16 v[32:35], v[188:191], v[160:163], v[32:35]
    v_exp_f32 v138, v138
    v_mfma_f32_16x16x32_bf16 v[64:67], v[188:191], v[164:167], v[64:67]
    v_exp_f32 v139, v139
    v_mfma_f32_16x16x32_bf16 v[72:75], v[188:191], v[172:175], v[72:75]
    s_waitcnt lgkmcnt(3)
    ds_read_b128 v[188:191], v215 offset:45056
    v_add_f32 v235, v235, v128
    v_add_f32 v233, v233, v125
    v_mfma_f32_16x16x32_bf16 v[140:143], v[192:195], v[76:79], -4.0
    ds_read_b128 v[168:171], v229 offset:45056
    v_cvt_pk_bf16_f32 v160, v124, v125
    v_mfma_f32_16x16x32_bf16 v[140:143], v[196:199], v[80:83], v[140:143]
    ds_read_b128 v[172:175], v229 offset:46080
    v_add_f32 v235, v235, v129
    v_mfma_f32_16x16x32_bf16 v[140:143], v[200:203], v[84:87], v[140:143]
    v_cvt_pk_bf16_f32 v164, v128, v129
    v_add_f32 v233, v233, v126
    v_mfma_f32_16x16x32_bf16 v[140:143], v[204:207], v[88:91], v[140:143]
    v_cvt_pk_bf16_f32 v161, v126, v127
    v_add_f32 v235, v235, v130
    v_mfma_f32_16x16x32_bf16 v[144:147], v[192:195], v[92:95], -4.0
    ds_read_b64_tr_b16 v[192:193], v220 offset:32768
    v_cvt_pk_bf16_f32 v165, v130, v131
    v_mfma_f32_16x16x32_bf16 v[144:147], v[196:199], v[96:99], v[144:147]
    ds_read_b64_tr_b16 v[194:195], v220 offset:36864
    v_add_f32 v233, v233, v127
    v_mfma_f32_16x16x32_bf16 v[144:147], v[200:203], v[100:103], v[144:147]
    ds_read_b64_tr_b16 v[196:197], v221 offset:32768
    v_cvt_pk_bf16_f32 v162, v132, v133
    v_mfma_f32_16x16x32_bf16 v[144:147], v[204:207], v[104:107], v[144:147]
    s_waitcnt lgkmcnt(5)
    ds_read_b64_tr_b16 v[198:199], v221 offset:36864
    v_add_f32 v235, v235, v131
    v_mfma_f32_16x16x32_bf16 v[148:151], v[176:179], v[76:79], -4.0
    ds_read_b64_tr_b16 v[200:201], v222 offset:32768
    v_cvt_pk_bf16_f32 v166, v136, v137
    v_mfma_f32_16x16x32_bf16 v[148:151], v[180:183], v[80:83], v[148:151]
    ds_read_b64_tr_b16 v[202:203], v222 offset:36864
    v_add_f32 v233, v233, v132
    v_mfma_f32_16x16x32_bf16 v[148:151], v[184:187], v[84:87], v[148:151]
    ds_read_b64_tr_b16 v[204:205], v223 offset:32768
    v_cvt_pk_bf16_f32 v163, v134, v135
    v_mfma_f32_16x16x32_bf16 v[148:151], v[188:191], v[88:91], v[148:151]
    ds_read_b64_tr_b16 v[206:207], v223 offset:36864
    v_add_f32 v235, v235, v136
    v_mfma_f32_16x16x32_bf16 v[152:155], v[176:179], v[92:95], -4.0
    ds_read_b64_tr_b16 v[176:177], v224 offset:32768
    v_cvt_pk_bf16_f32 v167, v138, v139
    v_mfma_f32_16x16x32_bf16 v[152:155], v[180:183], v[96:99], v[152:155]
    ds_read_b64_tr_b16 v[178:179], v224 offset:36864
    v_add_f32 v233, v233, v133
    v_mfma_f32_16x16x32_bf16 v[152:155], v[184:187], v[100:103], v[152:155]
    ds_read_b64_tr_b16 v[180:181], v225 offset:32768
    v_add_f32 v235, v235, v137
    v_mfma_f32_16x16x32_bf16 v[152:155], v[188:191], v[104:107], v[152:155]
    s_waitcnt lgkmcnt(7)
    ds_read_b64_tr_b16 v[182:183], v225 offset:36864
    v_add_f32 v233, v233, v134
    v_mfma_f32_16x16x32_bf16 v[4:7], v[192:195], v[160:163], v[4:7]
    s_cbranch_vccnz L_hkm10
L_hrm10:
    v_exp_f32 v140, v140
    v_mfma_f32_16x16x32_bf16 v[36:39], v[192:195], v[164:167], v[36:39]
    ds_read_b64_tr_b16 v[184:185], v226 offset:32768
    ds_read_b64_tr_b16 v[186:187], v226 offset:36864
    ds_read_b64_tr_b16 v[188:189], v227 offset:32768
    ds_read_b64_tr_b16 v[190:191], v227 offset:36864
    v_exp_f32 v141, v141
    v_mfma_f32_16x16x32_bf16 v[8:11], v[196:199], v[160:163], v[8:11]
    v_exp_f32 v142, v142
    v_mfma_f32_16x16x32_bf16 v[40:43], v[196:199], v[164:167], v[40:43]
    s_waitcnt lgkmcnt(8)
    v_exp_f32 v143, v143
    v_mfma_f32_16x16x32_bf16 v[12:15], v[200:203], v[160:163], v[12:15]
    v_exp_f32 v144, v144
    v_mfma_f32_16x16x32_bf16 v[44:47], v[200:203], v[164:167], v[44:47]
    v_exp_f32 v145, v145
    v_add_f32 v235, v235, v138
    v_add_f32 v233, v233, v135
    v_mfma_f32_16x16x32_bf16 v[16:19], v[204:207], v[160:163], v[16:19]
    v_exp_f32 v146, v146
    v_mfma_f32_16x16x32_bf16 v[48:51], v[204:207], v[164:167], v[48:51]
    v_exp_f32 v147, v147
    v_add_f32 v235, v235, v139
    s_waitcnt lgkmcnt(0)
    s_barrier
    v_mfma_f32_16x16x32_bf16 v[20:23], v[176:179], v[160:163], v[20:23]
    ds_read_b128 v[192:195], v216 offset:0
    ds_read_b128 v[196:199], v217 offset:0
    v_mfma_f32_16x16x32_bf16 v[52:55], v[176:179], v[164:167], v[52:55]
    ds_read_b128 v[200:203], v218 offset:0
    ds_read_b128 v[204:207], v219 offset:0
    v_exp_f32 v148, v148
    v_mfma_f32_16x16x32_bf16 v[24:27], v[180:183], v[160:163], v[24:27]
    v_exp_f32 v149, v149
    v_mfma_f32_16x16x32_bf16 v[56:59], v[180:183], v[164:167], v[56:59]
    ds_read_b128 v[176:179], v212 offset:0
    ds_read_b128 v[180:183], v213 offset:0
    v_exp_f32 v150, v150
    v_mfma_f32_16x16x32_bf16 v[28:31], v[184:187], v[160:163], v[28:31]
    v_exp_f32 v151, v151
    v_mfma_f32_16x16x32_bf16 v[60:63], v[184:187], v[164:167], v[60:63]
    v_exp_f32 v152, v152
    v_mfma_f32_16x16x32_bf16 v[68:71], v[184:187], v[168:171], v[68:71]
    ds_read_b128 v[184:187], v214 offset:0
    v_exp_f32 v153, v153
    v_add_f32 v233, v233, v140
    v_mfma_f32_16x16x32_bf16 v[32:35], v[188:191], v[160:163], v[32:35]
    v_exp_f32 v154, v154
    v_mfma_f32_16x16x32_bf16 v[64:67], v[188:191], v[164:167], v[64:67]
    v_exp_f32 v155, v155
    v_mfma_f32_16x16x32_bf16 v[72:75], v[188:191], v[168:171], v[72:75]
    s_waitcnt lgkmcnt(3)
    ds_read_b128 v[188:191], v215 offset:0
    v_add_f32 v235, v235, v144
    v_add_f32 v233, v233, v141
    v_mfma_f32_16x16x32_bf16 v[156:159], v[192:195], v[108:111], -4.0
    ds_read_b128 v[192:195], v212 offset:4096
    v_cvt_pk_bf16_f32 v160, v140, v141
    v_mfma_f32_16x16x32_bf16 v[156:159], v[196:199], v[112:115], v[156:159]
    ds_read_b128 v[196:199], v213 offset:4096
    v_add_f32 v235, v235, v145
    v_mfma_f32_16x16x32_bf16 v[156:159], v[200:203], v[116:119], v[156:159]
    ds_read_b128 v[200:203], v214 offset:4096
    v_cvt_pk_bf16_f32 v164, v144, v145
    v_mfma_f32_16x16x32_bf16 v[156:159], v[204:207], v[120:123], v[156:159]
    s_waitcnt lgkmcnt(4)
    ds_read_b128 v[204:207], v215 offset:4096
    v_add_f32 v233, v233, v142
    v_mfma_f32_16x16x32_bf16 v[124:127], v[176:179], v[76:79], -4.0
    v_cvt_pk_bf16_f32 v161, v142, v143
    v_add_f32 v235, v235, v146
    v_mfma_f32_16x16x32_bf16 v[124:127], v[180:183], v[80:83], v[124:127]
    s_waitcnt lgkmcnt(4)
    v_cvt_pk_bf16_f32 v165, v146, v147
    v_add_f32 v233, v233, v143
    v_mfma_f32_16x16x32_bf16 v[124:127], v[184:187], v[84:87], v[124:127]
    s_cbranch_vccnz L_hkx11
L_hrx11:
    v_exp_f32 v156, v156
    v_mfma_f32_16x16x32_bf16 v[124:127], v[188:191], v[88:91], v[124:127]
    v_exp_f32 v157, v157
    v_exp_f32 v158, v158
    v_mfma_f32_16x16x32_bf16 v[128:131], v[176:179], v[92:95], -4.0
    ds_read_b64_tr_b16 v[176:177], v220 offset:40960
    v_cvt_pk_bf16_f32 v162, v148, v149
    v_mfma_f32_16x16x32_bf16 v[128:131], v[180:183], v[96:99], v[128:131]
    ds_read_b64_tr_b16 v[178:179], v220 offset:45056
    v_add_f32 v235, v235, v147
    v_mfma_f32_16x16x32_bf16 v[128:131], v[184:187], v[100:103], v[128:131]
    ds_read_b64_tr_b16 v[180:181], v221 offset:40960
    v_cvt_pk_bf16_f32 v166, v152, v153
    v_mfma_f32_16x16x32_bf16 v[128:131], v[188:191], v[104:107], v[128:131]
    s_waitcnt lgkmcnt(3)
    ds_read_b64_tr_b16 v[182:183], v221 offset:45056
    v_exp_f32 v159, v159
    v_mfma_f32_16x16x32_bf16 v[132:135], v[192:195], v[76:79], -4.0
    ds_read_b64_tr_b16 v[184:185], v222 offset:40960
    v_add_f32 v233, v233, v148
    v_mfma_f32_16x16x32_bf16 v[132:135], v[196:199], v[80:83], v[132:135]
    ds_read_b64_tr_b16 v[186:187], v222 offset:45056
    v_cvt_pk_bf16_f32 v163, v150, v151
    v_mfma_f32_16x16x32_bf16 v[132:135], v[200:203], v[84:87], v[132:135]
    ds_read_b64_tr_b16 v[188:189], v223 offset:40960
    v_add_f32 v235, v235, v152
    v_mfma_f32_16x16x32_bf16 v[132:135], v[204:207], v[88:91], v[132:135]
    ds_read_b64_tr_b16 v[190:191], v223 offset:45056
    v_cvt_pk_bf16_f32 v167, v154, v155
    v_mfma_f32_16x16x32_bf16 v[136:139], v[192:195], v[92:95], -4.0
    ds_read_b64_tr_b16 v[192:193], v224 offset:40960
    v_add_f32 v233, v233, v149
    v_mfma_f32_16x16x32_bf16 v[136:139], v[196:199], v[96:99], v[136:139]
    ds_read_b64_tr_b16 v[194:195], v224 offset:45056
    v_cvt_pk_bf16_f32 v250, v156, v157
    v_mfma_f32_16x16x32_bf16 v[136:139], v[200:203], v[100:103], v[136:139]
    ds_read_b64_tr_b16 v[196:197], v225 offset:40960
    v_cvt_pk_bf16_f32 v251, v158, v159
    v_mfma_f32_16x16x32_bf16 v[136:139], v[204:207], v[104:107], v[136:139]
    s_waitcnt lgkmcnt(7)
    ds_read_b64_tr_b16 v[198:199], v225 offset:45056
    v_add_f32 v235, v235, v153
    v_mfma_f32_16x16x32_bf16 v[4:7], v[176:179], v[160:163], v[4:7]
    s_cbranch_vccnz L_hkm11
L_hrm11:
    v_exp_f32 v124, v124
    v_mfma_f32_16x16x32_bf16 v[36:39], v[176:179], v[164:167], v[36:39]
    ds_read_b64_tr_b16 v[200:201], v226 offset:40960
    ds_read_b64_tr_b16 v[202:203], v226 offset:45056
    ds_read_b64_tr_b16 v[204:205], v227 offset:40960
    ds_read_b64_tr_b16 v[206:207], v227 offset:45056
    v_exp_f32 v125, v125
    v_mfma_f32_16x16x32_bf16 v[8:11], v[180:183], v[160:163], v[8:11]
    v_exp_f32 v126, v126
    v_mfma_f32_16x16x32_bf16 v[40:43], v[180:183], v[164:167], v[40:43]
    s_waitcnt lgkmcnt(8)
    ds_write_b64 v230, v[250:251] offset:45056
    v_exp_f32 v127, v127
    v_mfma_f32_16x16x32_bf16 v[12:15], v[184:187], v[160:163], v[12:15]
    v_exp_f32 v128, v128
    v_mfma_f32_16x16x32_bf16 v[44:47], v[184:187], v[164:167], v[44:47]
    v_exp_f32 v129, v129
    v_add_f32 v237, v237, v156
    v_add_f32 v233, v233, v150
    v_add_f32 v237, v237, v157
    v_add_f32 v235, v235, v154
    v_mfma_f32_16x16x32_bf16 v[16:19], v[188:191], v[160:163], v[16:19]
    v_exp_f32 v130, v130
    v_mfma_f32_16x16x32_bf16 v[48:51], v[188:191], v[164:167], v[48:51]
    v_exp_f32 v131, v131
    v_add_f32 v237, v237, v158
    v_add_f32 v233, v233, v151
    v_add_f32 v237, v237, v159
    v_add_f32 v235, v235, v155
    s_waitcnt lgkmcnt(0)
    s_barrier
    v_mfma_f32_16x16x32_bf16 v[20:23], v[192:195], v[160:163], v[20:23]
    ds_read_b128 v[176:179], v212 offset:8192
    ds_read_b128 v[180:183], v213 offset:8192
    v_mfma_f32_16x16x32_bf16 v[52:55], v[192:195], v[164:167], v[52:55]
    ds_read_b128 v[184:187], v214 offset:8192
    ds_read_b128 v[188:191], v215 offset:8192
    v_exp_f32 v132, v132
    v_mfma_f32_16x16x32_bf16 v[24:27], v[196:199], v[160:163], v[24:27]
    v_exp_f32 v133, v133
    v_mfma_f32_16x16x32_bf16 v[56:59], v[196:199], v[164:167], v[56:59]
    ds_read_b128 v[192:195], v212 offset:12288
    ds_read_b128 v[196:199], v213 offset:12288
    v_exp_f32 v134, v134
    v_mfma_f32_16x16x32_bf16 v[28:31], v[200:203], v[160:163], v[28:31]
    v_exp_f32 v135, v135
    v_mfma_f32_16x16x32_bf16 v[60:63], v[200:203], v[164:167], v[60:63]
    v_exp_f32 v136, v136
    v_mfma_f32_16x16x32_bf16 v[68:71], v[200:203], v[172:175], v[68:71]
    ds_read_b128 v[200:203], v214 offset:12288
    v_exp_f32 v137, v137
    v_add_f32 v233, v233, v124
    v_mfma_f32_16x16x32_bf16 v[32:35], v[204:207], v[160:163], v[32:35]
    v_exp_f32 v138, v138
    v_mfma_f32_16x16x32_bf16 v[64:67], v[204:207], v[164:167], v[64:67]
    v_exp_f32 v139, v139
    v_mfma_f32_16x16x32_bf16 v[72:75], v[204:207], v[172:175], v[72:75]
    s_waitcnt lgkmcnt(3)
    ds_read_b128 v[204:207], v215 offset:12288
    v_add_f32 v235, v235, v128
    v_add_f32 v233, v233, v125
    v_mfma_f32_16x16x32_bf16 v[140:143], v[176:179], v[76:79], -4.0
    ds_read_b128 v[168:171], v229 offset:45056
    v_cvt_pk_bf16_f32 v160, v124, v125
    v_mfma_f32_16x16x32_bf16 v[140:143], v[180:183], v[80:83], v[140:143]
    ds_read_b128 v[172:175], v229 offset:46080
    v_add_f32 v235, v235, v129
    v_mfma_f32_16x16x32_bf16 v[140:143], v[184:187], v[84:87], v[140:143]
    v_cvt_pk_bf16_f32 v164, v128, v129
    v_add_f32 v233, v233, v126
    v_mfma_f32_16x16x32_bf16 v[140:143], v[188:191], v[88:91], v[140:143]
    v_cvt_pk_bf16_f32 v161, v126, v127
    v_add_f32 v235, v235, v130
    v_mfma_f32_16x16x32_bf16 v[144:147], v[176:179], v[92:95], -4.0
    ds_read_b64_tr_b16 v[176:177], v220 offset:0
    v_cvt_pk_bf16_f32 v165, v130, v131
    v_mfma_f32_16x16x32_bf16 v[144:147], v[180:183], v[96:99], v[144:147]
    ds_read_b64_tr_b16 v[178:179], v220 offset:4096
    v_add_f32 v233, v233, v127
    v_mfma_f32_16x16x32_bf16 v[144:147], v[184:187], v[100:103], v[144:147]
    ds_read_b64_tr_b16 v[180:181], v221 offset:0
    v_cvt_pk_bf16_f32 v162, v132, v133
    v_mfma_f32_16x16x32_bf16 v[144:147], v[188:191], v[104:107], v[144:147]
    s_waitcnt lgkmcnt(5)
    ds_read_b64_tr_b16 v[182:183], v221 offset:4096
    v_add_f32 v235, v235, v131
    v_mfma_f32_16x16x32_bf16 v[148:151], v[192:195], v[76:79], -4.0
    ds_read_b64_tr_b16 v[184:185], v222 offset:0
    v_cvt_pk_bf16_f32 v166, v136, v137
    v_mfma_f32_16x16x32_bf16 v[148:151], v[196:199], v[80:83], v[148:151]
    ds_read_b64_tr_b16 v[186:187], v222 offset:4096
    v_add_f32 v233, v233, v132
    v_mfma_f32_16x16x32_bf16 v[148:151], v[200:203], v[84:87], v[148:151]
    ds_read_b64_tr_b16 v[188:189], v223 offset:0
    v_cvt_pk_bf16_f32 v163, v134, v135
    v_mfma_f32_16x16x32_bf16 v[148:151], v[204:207], v[88:91], v[148:151]
    ds_read_b64_tr_b16 v[190:191], v223 offset:4096
    v_add_f32 v235, v235, v136
    v_mfma_f32_16x16x32_bf16 v[152:155], v[192:195], v[92:95], -4.0
    ds_read_b64_tr_b16 v[192:193], v224 offset:0
    v_cvt_pk_bf16_f32 v167, v138, v139
    v_mfma_f32_16x16x32_bf16 v[152:155], v[196:199], v[96:99], v[152:155]
    ds_read_b64_tr_b16 v[194:195], v224 offset:4096
    v_add_f32 v233, v233, v133
    v_mfma_f32_16x16x32_bf16 v[152:155], v[200:203], v[100:103], v[152:155]
    ds_read_b64_tr_b16 v[196:197], v225 offset:0
    v_add_f32 v235, v235, v137
    v_mfma_f32_16x16x32_bf16 v[152:155], v[204:207], v[104:107], v[152:155]
    s_waitcnt lgkmcnt(7)
    ds_read_b64_tr_b16 v[198:199], v225 offset:4096
    v_add_f32 v233, v233, v134
    v_mfma_f32_16x16x32_bf16 v[4:7], v[176:179], v[160:163], v[4:7]
    s_cbranch_vccnz L_hkm12
L_hrm12:
    v_exp_f32 v140, v140
    v_mfma_f32_16x16x32_bf16 v[36:39], v[176:179], v[164:167], v[36:39]
    ds_read_b64_tr_b16 v[200:201], v226 offset:0
    ds_read_b64_tr_b16 v[202:203], v226 offset:4096
    ds_read_b64_tr_b16 v[204:205], v227 offset:0
    ds_read_b64_tr_b16 v[206:207], v227 offset:4096
    v_exp_f32 v141, v141
    v_mfma_f32_16x16x32_bf16 v[8:11], v[180:183], v[160:163], v[8:11]
    v_exp_f32 v142, v142
    v_mfma_f32_16x16x32_bf16 v[40:43], v[180:183], v[164:167], v[40:43]
    s_waitcnt lgkmcnt(8)
    v_exp_f32 v143, v143
    v_mfma_f32_16x16x32_bf16 v[12:15], v[184:187], v[160:163], v[12:15]
    v_exp_f32 v144, v144
    v_mfma_f32_16x16x32_bf16 v[44:47], v[184:187], v[164:167], v[44:47]
    v_exp_f32 v145, v145
    v_add_f32 v235, v235, v138
    v_add_f32 v233, v233, v135
    v_mfma_f32_16x16x32_bf16 v[16:19], v[188:191], v[160:163], v[16:19]
    v_exp_f32 v146, v146
    v_mfma_f32_16x16x32_bf16 v[48:51], v[188:191], v[164:167], v[48:51]
    v_exp_f32 v147, v147
    v_add_f32 v235, v235, v139
    s_waitcnt lgkmcnt(0)
    s_barrier
    v_mfma_f32_16x16x32_bf16 v[20:23], v[192:195], v[160:163], v[20:23]
    ds_read_b128 v[176:179], v216 offset:32768
    ds_read_b128 v[180:183], v217 offset:32768
    v_mfma_f32_16x16x32_bf16 v[52:55], v[192:195], v[164:167], v[52:55]
    ds_read_b128 v[184:187], v218 offset:32768
    ds_read_b128 v[188:191], v219 offset:32768
    v_exp_f32 v148, v148
    v_mfma_f32_16x16x32_bf16 v[24:27], v[196:199], v[160:163], v[24:27]
    v_exp_f32 v149, v149
    v_mfma_f32_16x16x32_bf16 v[56:59], v[196:199], v[164:167], v[56:59]
    ds_read_b128 v[192:195], v212 offset:32768
    ds_read_b128 v[196:199], v213 offset:32768
    v_exp_f32 v150, v150
    v_mfma_f32_16x16x32_bf16 v[28:31], v[200:203], v[160:163], v[28:31]
    v_exp_f32 v151, v151
    v_mfma_f32_16x16x32_bf16 v[60:63], v[200:203], v[164:167], v[60:63]
    v_exp_f32 v152, v152
    v_mfma_f32_16x16x32_bf16 v[68:71], v[200:203], v[168:171], v[68:71]
    ds_read_b128 v[200:203], v214 offset:32768
    v_exp_f32 v153, v153
    v_add_f32 v233, v233, v140
    v_mfma_f32_16x16x32_bf16 v[32:35], v[204:207], v[160:163], v[32:35]
    v_exp_f32 v154, v154
    v_mfma_f32_16x16x32_bf16 v[64:67], v[204:207], v[164:167], v[64:67]
    v_exp_f32 v155, v155
    v_mfma_f32_16x16x32_bf16 v[72:75], v[204:207], v[168:171], v[72:75]
    s_waitcnt lgkmcnt(3)
    ds_read_b128 v[204:207], v215 offset:32768
    v_add_f32 v235, v235, v144
    v_add_f32 v233, v233, v141
    v_mfma_f32_16x16x32_bf16 v[156:159], v[176:179], v[108:111], -4.0
    ds_read_b128 v[176:179], v212 offset:36864
    v_cvt_pk_bf16_f32 v160, v140, v141
    v_mfma_f32_16x16x32_bf16 v[156:159], v[180:183], v[112:115], v[156:159]
    ds_read_b128 v[180:183], v213 offset:36864
    v_add_f32 v235, v235, v145
    v_mfma_f32_16x16x32_bf16 v[156:159], v[184:187], v[116:119], v[156:159]
    ds_read_b128 v[184:187], v214 offset:36864
    v_cvt_pk_bf16_f32 v164, v144, v145
    v_mfma_f32_16x16x32_bf16 v[156:159], v[188:191], v[120:123], v[156:159]
    s_waitcnt lgkmcnt(4)
    ds_read_b128 v[188:191], v215 offset:36864
    v_add_f32 v233, v233, v142
    v_mfma_f32_16x16x32_bf16 v[124:127], v[192:195], v[76:79], -4.0
    v_cvt_pk_bf16_f32 v161, v142, v143
    v_add_f32 v235, v235, v146
    v_mfma_f32_16x16x32_bf16 v[124:127], v[196:199], v[80:83], v[124:127]
    s_waitcnt lgkmcnt(4)
    v_cvt_pk_bf16_f32 v165, v146, v147
    v_add_f32 v233, v233, v143
    v_mfma_f32_16x16x32_bf16 v[124:127], v[200:203], v[84:87], v[124:127]
    s_cbranch_vccnz L_hkx13
L_hrx13:
    v_exp_f32 v156, v156
    v_mfma_f32_16x16x32_bf16 v[124:127], v[204:207], v[88:91], v[124:127]
    v_exp_f32 v157, v157
    v_exp_f32 v158, v158
    v_mfma_f32_16x16x32_bf16 v[128:131], v[192:195], v[92:95], -4.0
    ds_read_b64_tr_b16 v[192:193], v220 offset:8192
    v_cvt_pk_bf16_f32 v162, v148, v149
    v_mfma_f32_16x16x32_bf16 v[128:131], v[196:199], v[96:99], v[128:131]
    ds_read_b64_tr_b16 v[194:195], v220 offset:12288
    v_add_f32 v235, v235, v147
    v_mfma_f32_16x16x32_bf16 v[128:131], v[200:203], v[100:103], v[128:131]
    ds_read_b64_tr_b16 v[196:197], v221 offset:8192
    v_cvt_pk_bf16_f32 v166, v152, v153
    v_mfma_f32_16x16x32_bf16 v[128:131], v[204:207], v[104:107], v[128:131]
    s_waitcnt lgkmcnt(3)
    ds_read_b64_tr_b16 v[198:199], v221 offset:12288
    v_exp_f32 v159, v159
    v_mfma_f32_16x16x32_bf16 v[132:135], v[176:179], v[76:79], -4.0
    ds_read_b64_tr_b16 v[200:201], v222 offset:8192
    v_add_f32 v233, v233, v148
    v_mfma_f32_16x16x32_bf16 v[132:135], v[180:183], v[80:83], v[132:135]
    ds_read_b64_tr_b16 v[202:203], v222 offset:12288
    v_cvt_pk_bf16_f32 v163, v150, v151
    v_mfma_f32_16x16x32_bf16 v[132:135], v[184:187], v[84:87], v[132:135]
    ds_read_b64_tr_b16 v[204:205], v223 offset:8192
    v_add_f32 v235, v235, v152
    v_mfma_f32_16x16x32_bf16 v[132:135], v[188:191], v[88:91], v[132:135]
    ds_read_b64_tr_b16 v[206:207], v223 offset:12288
    v_cvt_pk_bf16_f32 v167, v154, v155
    v_mfma_f32_16x16x32_bf16 v[136:139], v[176:179], v[92:95], -4.0
    ds_read_b64_tr_b16 v[176:177], v224 offset:8192
    v_add_f32 v233, v233, v149
    v_mfma_f32_16x16x32_bf16 v[136:139], v[180:183], v[96:99], v[136:139]
    ds_read_b64_tr_b16 v[178:179], v224 offset:12288
    v_cvt_pk_bf16_f32 v250, v156, v157
    v_mfma_f32_16x16x32_bf16 v[136:139], v[184:187], v[100:103], v[136:139]
    ds_read_b64_tr_b16 v[180:181], v225 offset:8192
    v_cvt_pk_bf16_f32 v251, v158, v159
    v_mfma_f32_16x16x32_bf16 v[136:139], v[188:191], v[104:107], v[136:139]
    s_waitcnt lgkmcnt(7)
    ds_read_b64_tr_b16 v[182:183], v225 offset:12288
    v_add_f32 v235, v235, v153
    v_mfma_f32_16x16x32_bf16 v[4:7], v[192:195], v[160:163], v[4:7]
    s_cbranch_vccnz L_hkm13
L_hrm13:
    v_exp_f32 v124, v124
    v_mfma_f32_16x16x32_bf16 v[36:39], v[192:195], v[164:167], v[36:39]
    ds_read_b64_tr_b16 v[184:185], v226 offset:8192
    ds_read_b64_tr_b16 v[186:187], v226 offset:12288
    ds_read_b64_tr_b16 v[188:189], v227 offset:8192
    ds_read_b64_tr_b16 v[190:191], v227 offset:12288
    v_exp_f32 v125, v125
    v_mfma_f32_16x16x32_bf16 v[8:11], v[196:199], v[160:163], v[8:11]
    v_exp_f32 v126, v126
    v_mfma_f32_16x16x32_bf16 v[40:43], v[196:199], v[164:167], v[40:43]
    s_waitcnt lgkmcnt(8)
    ds_write_b64 v230, v[250:251] offset:45056
    v_exp_f32 v127, v127
    v_mfma_f32_16x16x32_bf16 v[12:15], v[200:203], v[160:163], v[12:15]
    v_exp_f32 v128, v128
    v_mfma_f32_16x16x32_bf16 v[44:47], v[200:203], v[164:167], v[44:47]
    v_exp_f32 v129, v129
    v_add_f32 v237, v237, v156
    v_add_f32 v233, v233, v150
    v_add_f32 v237, v237, v157
    v_add_f32 v235, v235, v154
    v_mfma_f32_16x16x32_bf16 v[16:19], v[204:207], v[160:163], v[16:19]
    v_exp_f32 v130, v130
    v_mfma_f32_16x16x32_bf16 v[48:51], v[204:207], v[164:167], v[48:51]
    v_exp_f32 v131, v131
    v_add_f32 v237, v237, v158
    v_add_f32 v233, v233, v151
    v_add_f32 v237, v237, v159
    v_add_f32 v235, v235, v155
    s_waitcnt lgkmcnt(0)
    s_barrier
    v_mfma_f32_16x16x32_bf16 v[20:23], v[176:179], v[160:163], v[20:23]
    ds_read_b128 v[192:195], v212 offset:40960
    ds_read_b128 v[196:199], v213 offset:40960
    v_mfma_f32_16x16x32_bf16 v[52:55], v[176:179], v[164:167], v[52:55]
    ds_read_b128 v[200:203], v214 offset:40960
    ds_read_b128 v[204:207], v215 offset:40960
    v_exp_f32 v132, v132
    v_mfma_f32_16x16x32_bf16 v[24:27], v[180:183], v[160:163], v[24:27]
    v_exp_f32 v133, v133
    v_mfma_f32_16x16x32_bf16 v[56:59], v[180:183], v[164:167], v[56:59]
    ds_read_b128 v[176:179], v212 offset:45056
    ds_read_b128 v[180:183], v213 offset:45056
    v_exp_f32 v134, v134
    v_mfma_f32_16x16x32_bf16 v[28:31], v[184:187], v[160:163], v[28:31]
    v_exp_f32 v135, v135
    v_mfma_f32_16x16x32_bf16 v[60:63], v[184:187], v[164:167], v[60:63]
    v_exp_f32 v136, v136
    v_mfma_f32_16x16x32_bf16 v[68:71], v[184:187], v[172:175], v[68:71]
    ds_read_b128 v[184:187], v214 offset:45056
    v_exp_f32 v137, v137
    v_add_f32 v233, v233, v124
    v_mfma_f32_16x16x32_bf16 v[32:35], v[188:191], v[160:163], v[32:35]
    ds_write_b32 v231, v237
    v_exp_f32 v138, v138
    v_mfma_f32_16x16x32_bf16 v[64:67], v[188:191], v[164:167], v[64:67]
    v_exp_f32 v139, v139
    v_mfma_f32_16x16x32_bf16 v[72:75], v[188:191], v[172:175], v[72:75]
    s_waitcnt lgkmcnt(4)
    ds_read_b128 v[188:191], v215 offset:45056
    v_add_f32 v235, v235, v128
    v_add_f32 v233, v233, v125
    v_mfma_f32_16x16x32_bf16 v[140:143], v[192:195], v[76:79], -4.0
    ds_read_b128 v[168:171], v229 offset:45056
    v_cvt_pk_bf16_f32 v160, v124, v125
    v_mfma_f32_16x16x32_bf16 v[140:143], v[196:199], v[80:83], v[140:143]
    ds_read_b128 v[172:175], v229 offset:46080
    v_add_f32 v235, v235, v129
    v_mfma_f32_16x16x32_bf16 v[140:143], v[200:203], v[84:87], v[140:143]
    v_cvt_pk_bf16_f32 v164, v128, v129
    v_add_f32 v233, v233, v126
    v_mfma_f32_16x16x32_bf16 v[140:143], v[204:207], v[88:91], v[140:143]
    v_cvt_pk_bf16_f32 v161, v126, v127
    v_add_f32 v235, v235, v130
    v_mfma_f32_16x16x32_bf16 v[144:147], v[192:195], v[92:95], -4.0
    ds_read_b64_tr_b16 v[192:193], v220 offset:32768
    v_cvt_pk_bf16_f32 v165, v130, v131
    v_mfma_f32_16x16x32_bf16 v[144:147], v[196:199], v[96:99], v[144:147]
    ds_read_b64_tr_b16 v[194:195], v220 offset:36864
    v_add_f32 v233, v233, v127
    v_mfma_f32_16x16x32_bf16 v[144:147], v[200:203], v[100:103], v[144:147]
    ds_read_b64_tr_b16 v[196:197], v221 offset:32768
    v_cvt_pk_bf16_f32 v162, v132, v133
    v_mfma_f32_16x16x32_bf16 v[144:147], v[204:207], v[104:107], v[144:147]
    s_waitcnt lgkmcnt(5)
    ds_read_b64_tr_b16 v[198:199], v221 offset:36864
    v_add_f32 v235, v235, v131
    v_mfma_f32_16x16x32_bf16 v[148:151], v[176:179], v[76:79], -4.0
    ds_read_b64_tr_b16 v[200:201], v222 offset:32768
    v_cvt_pk_bf16_f32 v166, v136, v137
    v_mfma_f32_16x16x32_bf16 v[148:151], v[180:183], v[80:83], v[148:151]
    ds_read_b64_tr_b16 v[202:203], v222 offset:36864
    v_add_f32 v233, v233, v132
    v_mfma_f32_16x16x32_bf16 v[148:151], v[184:187], v[84:87], v[148:151]
    ds_read_b64_tr_b16 v[204:205], v223 offset:32768
    v_cvt_pk_bf16_f32 v163, v134, v135
    v_mfma_f32_16x16x32_bf16 v[148:151], v[188:191], v[88:91], v[148:151]
    ds_read_b64_tr_b16 v[206:207], v223 offset:36864
    v_add_f32 v235, v235, v136
    v_mfma_f32_16x16x32_bf16 v[152:155], v[176:179], v[92:95], -4.0
    ds_read_b64_tr_b16 v[176:177], v224 offset:32768
    v_cvt_pk_bf16_f32 v167, v138, v139
    v_mfma_f32_16x16x32_bf16 v[152:155], v[180:183], v[96:99], v[152:155]
    ds_read_b64_tr_b16 v[178:179], v224 offset:36864
    v_add_f32 v233, v233, v133
    v_mfma_f32_16x16x32_bf16 v[152:155], v[184:187], v[100:103], v[152:155]
    ds_read_b64_tr_b16 v[180:181], v225 offset:32768
    v_add_f32 v235, v235, v137
    v_mfma_f32_16x16x32_bf16 v[152:155], v[188:191], v[104:107], v[152:155]
    s_waitcnt lgkmcnt(7)
    ds_read_b64_tr_b16 v[182:183], v225 offset:36864
    v_add_f32 v233, v233, v134
    v_mfma_f32_16x16x32_bf16 v[4:7], v[192:195], v[160:163], v[4:7]
    s_cbranch_vccnz L_hkm14
L_hrm14:
    v_exp_f32 v140, v140
    v_mfma_f32_16x16x32_bf16 v[36:39], v[192:195], v[164:167], v[36:39]
    ds_read_b64_tr_b16 v[184:185], v226 offset:32768
    ds_read_b64_tr_b16 v[186:187], v226 offset:36864
    ds_read_b64_tr_b16 v[188:189], v227 offset:32768
    ds_read_b64_tr_b16 v[190:191], v227 offset:36864
    v_exp_f32 v141, v141
    v_mfma_f32_16x16x32_bf16 v[8:11], v[196:199], v[160:163], v[8:11]
    v_exp_f32 v142, v142
    v_mfma_f32_16x16x32_bf16 v[40:43], v[196:199], v[164:167], v[40:43]
    s_waitcnt lgkmcnt(8)
    v_exp_f32 v143, v143
    v_mfma_f32_16x16x32_bf16 v[12:15], v[200:203], v[160:163], v[12:15]
    v_exp_f32 v144, v144
    v_mfma_f32_16x16x32_bf16 v[44:47], v[200:203], v[164:167], v[44:47]
    v_exp_f32 v145, v145
    v_add_f32 v235, v235, v138
    v_add_f32 v233, v233, v135
    v_mfma_f32_16x16x32_bf16 v[16:19], v[204:207], v[160:163], v[16:19]
    v_exp_f32 v146, v146
    v_mfma_f32_16x16x32_bf16 v[48:51], v[204:207], v[164:167], v[48:51]
    v_exp_f32 v147, v147
    v_add_f32 v235, v235, v139
    s_waitcnt lgkmcnt(0)
    s_cmp_lt_u32 s38, 3
    s_cbranch_scc1 L_Aloop
    s_barrier
    v_mfma_f32_16x16x32_bf16 v[20:23], v[176:179], v[160:163], v[20:23]
    v_exp_f32 v148, v148
    v_mfma_f32_16x16x32_bf16 v[52:55], v[176:179], v[164:167], v[52:55]
    ds_read_b64_tr_b16 v[176:177], v220 offset:40960
    ds_read_b64_tr_b16 v[178:179], v220 offset:45056
    s_lshl_b32 s41, s36, 12
    s_sub_u32 s41, 4294950912, s41
    v_exp_f32 v149, v149
    v_mfma_f32_16x16x32_bf16 v[24:27], v[180:183], v[160:163], v[24:27]
    s_cmp_eq_u32 s38, 0
    v_exp_f32 v150, v150
    v_mfma_f32_16x16x32_bf16 v[56:59], v[180:183], v[164:167], v[56:59]
    ds_read_b64_tr_b16 v[180:181], v221 offset:40960
    ds_read_b64_tr_b16 v[182:183], v221 offset:45056
    s_cselect_b32 s56, s41, 4096
    v_exp_f32 v151, v151
    v_mfma_f32_16x16x32_bf16 v[28:31], v[184:187], v[160:163], v[28:31]
    s_lshl_b32 s41, s38, 12
    v_mfma_f32_16x16x32_bf16 v[60:63], v[184:187], v[164:167], v[60:63]
    s_add_u32 s41, s41, 4294950912
    v_exp_f32 v152, v152
    v_mfma_f32_16x16x32_bf16 v[68:71], v[184:187], v[168:171], v[68:71]
    ds_read_b64_tr_b16 v[184:185], v222 offset:40960
    ds_read_b64_tr_b16 v[186:187], v222 offset:45056
    s_cmp_ge_u32 s38, 2
    v_exp_f32 v153, v153
    v_mfma_f32_16x16x32_bf16 v[32:35], v[188:191], v[160:163], v[32:35]
    s_cselect_b32 s41, s41, 32768
    v_exp_f32 v154, v154
    v_mfma_f32_16x16x32_bf16 v[64:67], v[188:191], v[164:167], v[64:67]
    s_add_u32 s57, s41, s47
    v_exp_f32 v155, v155
    v_mfma_f32_16x16x32_bf16 v[72:75], v[188:191], v[168:171], v[72:75]
    ds_read_b64_tr_b16 v[188:189], v223 offset:40960
    ds_read_b64_tr_b16 v[190:191], v223 offset:45056
    ds_read_b128 v[208:211], v229 offset:47104
    s_add_u32 s38, s38, 1
    v_add_f32 v233, v233, v140
    v_add_f32 v233, v233, v141
    v_cvt_pk_bf16_f32 v160, v140, v141
    v_add_f32 v235, v235, v144
    v_add_f32 v235, v235, v145
    v_cvt_pk_bf16_f32 v164, v144, v145
    v_add_f32 v233, v233, v142
    v_add_f32 v233, v233, v143
    v_cvt_pk_bf16_f32 v161, v142, v143
    v_add_f32 v235, v235, v146
    v_add_f32 v235, v235, v147
    v_cvt_pk_bf16_f32 v165, v146, v147
    v_add_f32 v233, v233, v148
    v_add_f32 v233, v233, v149
    v_cvt_pk_bf16_f32 v162, v148, v149
    v_add_f32 v235, v235, v152
    v_add_f32 v235, v235, v153
    v_cvt_pk_bf16_f32 v166, v152, v153
    v_add_f32 v233, v233, v150
    v_add_f32 v233, v233, v151
    v_cvt_pk_bf16_f32 v163, v150, v151
    v_add_f32 v235, v235, v154
    v_add_f32 v235, v235, v155
    v_cvt_pk_bf16_f32 v167, v154, v155
    s_waitcnt lgkmcnt(0)
    v_add_f32 v208, v208, v209
    v_add_f32 v210, v210, v211
    v_add_f32 v208, v208, v210
    v_mfma_f32_16x16x32_bf16 v[4:7], v[176:179], v[160:163], v[4:7]
    ds_read_b64_tr_b16 v[192:193], v224 offset:40960
    ds_read_b64_tr_b16 v[194:195], v224 offset:45056
    v_mov_b32 v1, v233
    v_mov_b32 v2, v235
    v_mov_b32 v3, v208
    v_permlane32_swap_b32 v1, v233
    v_mfma_f32_16x16x32_bf16 v[36:39], v[176:179], v[164:167], v[36:39]
    ds_read_b64_tr_b16 v[196:197], v225 offset:40960
    ds_read_b64_tr_b16 v[198:199], v225 offset:45056
    v_permlane32_swap_b32 v2, v235
    v_permlane32_swap_b32 v3, v208
    v_add_f32 v233, v233, v1
    v_mfma_f32_16x16x32_bf16 v[8:11], v[180:183], v[160:163], v[8:11]
    ds_read_b64_tr_b16 v[200:201], v226 offset:40960
    ds_read_b64_tr_b16 v[202:203], v226 offset:45056
    v_add_f32 v235, v235, v2
    v_add_f32 v208, v208, v3
    v_mov_b32 v1, v233
    v_mov_b32 v2, v235
    v_mfma_f32_16x16x32_bf16 v[40:43], v[180:183], v[164:167], v[40:43]
    ds_read_b64_tr_b16 v[204:205], v227 offset:40960
    ds_read_b64_tr_b16 v[206:207], v227 offset:45056
    v_mov_b32 v3, v208
    v_permlane16_swap_b32 v1, v233
    v_permlane16_swap_b32 v2, v235
    v_mfma_f32_16x16x32_bf16 v[12:15], v[184:187], v[160:163], v[12:15]
    v_permlane16_swap_b32 v3, v208
    v_add_f32 v233, v233, v1
    v_add_f32 v235, v235, v2
    v_mfma_f32_16x16x32_bf16 v[44:47], v[184:187], v[164:167], v[44:47]
    v_add_f32 v208, v208, v3
    v_rcp_f32 v232, v233
    v_rcp_f32 v234, v235
    v_rcp_f32 v236, v208
    v_mfma_f32_16x16x32_bf16 v[16:19], v[188:191], v[160:163], v[16:19]
    v_min3_f32 v1, v233, v235, v208
    v_max3_f32 v2, v233, v235, v208
    v_cmp_nle_f32 s[60:61], s54, v1
    v_mfma_f32_16x16x32_bf16 v[48:51], v[188:191], v[164:167], v[48:51]
    v_cmp_nge_f32 s[62:63], s55, v2
    s_or_b64 s[58:59], s[58:59], s[60:61]
    s_or_b64 s[58:59], s[58:59], s[62:63]
    s_cbranch_vccnz L_hkfl
L_hrfl:
    s_waitcnt lgkmcnt(0)
    s_barrier
    v_mfma_f32_16x16x32_bf16 v[20:23], v[192:195], v[160:163], v[20:23]
    v_mfma_f32_16x16x32_bf16 v[52:55], v[192:195], v[164:167], v[52:55]
    v_mul_f32 v4, v232, v4
    v_mul_f32 v5, v232, v5
    v_mul_f32 v6, v232, v6
    v_mul_f32 v7, v232, v7
    v_mul_f32 v8, v232, v8
    v_mul_f32 v9, v232, v9
    v_mul_f32 v10, v232, v10
    v_mul_f32 v11, v232, v11
    v_cvt_pk_bf16_f32 v4, v4, v5
    v_cvt_pk_bf16_f32 v5, v6, v7
    v_cvt_pk_bf16_f32 v6, v8, v9
    v_cvt_pk_bf16_f32 v7, v10, v11
    v_add_u32 v238, s50, v228
    v_mfma_f32_16x16x32_bf16 v[24:27], v[196:199], v[160:163], v[24:27]
    ds_write_b128 v238, v[4:7]
    v_mfma_f32_16x16x32_bf16 v[56:59], v[196:199], v[164:167], v[56:59]
    v_mul_f32 v36, v234, v36
    v_mul_f32 v37, v234, v37
    v_mul_f32 v38, v234, v38
    v_mul_f32 v39, v234, v39
    v_mul_f32 v40, v234, v40
    v_mul_f32 v41, v234, v41
    v_mul_f32 v42, v234, v42
    v_mul_f32 v43, v234, v43
    v_cvt_pk_bf16_f32 v36, v36, v37
    v_cvt_pk_bf16_f32 v37, v38, v39
    v_cvt_pk_bf16_f32 v38, v40, v41
    v_cvt_pk_bf16_f32 v39, v42, v43
    v_add_u32 v238, s56, v238
    v_mfma_f32_16x16x32_bf16 v[28:31], v[200:203], v[160:163], v[28:31]
    ds_write_b128 v238, v[36:39]
    v_mfma_f32_16x16x32_bf16 v[60:63], v[200:203], v[164:167], v[60:63]
    v_mfma_f32_16x16x32_bf16 v[68:71], v[200:203], v[172:175], v[68:71]
    v_mul_f32 v12, v232, v12
    v_mul_f32 v13, v232, v13
    v_mul_f32 v14, v232, v14
    v_mul_f32 v15, v232, v15
    v_mul_f32 v16, v232, v16
    v_mul_f32 v17, v232, v17
    v_mul_f32 v18, v232, v18
    v_mul_f32 v19, v232, v19
    v_cvt_pk_bf16_f32 v12, v12, v13
    v_cvt_pk_bf16_f32 v13, v14, v15
    v_cvt_pk_bf16_f32 v14, v16, v17
    v_cvt_pk_bf16_f32 v15, v18, v19
    v_add_u32 v238, s51, v228
    v_mfma_f32_16x16x32_bf16 v[32:35], v[204:207], v[160:163], v[32:35]
    ds_write_b128 v238, v[12:15]
    v_mfma_f32_16x16x32_bf16 v[64:67], v[204:207], v[164:167], v[64:67]
    v_mul_f32 v44, v234, v44
    v_mul_f32 v45, v234, v45
    v_mul_f32 v46, v234, v46
    v_mul_f32 v47, v234, v47
    v_mul_f32 v48, v234, v48
    v_mul_f32 v49, v234, v49
    v_mul_f32 v50, v234, v50
    v_mul_f32 v51, v234, v51
    v_cvt_pk_bf16_f32 v44, v44, v45
    v_cvt_pk_bf16_f32 v45, v46, v47
    v_cvt_pk_bf16_f32 v46, v48, v49
    v_cvt_pk_bf16_f32 v47, v50, v51
    v_add_u32 v238, s56, v238
    v_mfma_f32_16x16x32_bf16 v[72:75], v[204:207], v[172:175], v[72:75]
    ds_write_b128 v238, v[44:47]
    s_cmp_lg_u64 s[58:59], 0
    s_cselect_b32 s41, 1, 0
    s_and_b32 s42, s49, 1
    s_cmp_eq_u32 s49, 0
    s_cselect_b32 s41, s41, s42
    s_lshl_b32 s42, s36, 2
    s_add_u32 s42, s42, 162816
    v_mov_b32 v1, s41
    v_mov_b32 v2, s42
    ds_write_b32 v2, v1
    v_mul_f32 v20, v232, v20
    v_mul_f32 v21, v232, v21
    v_mul_f32 v22, v232, v22
    v_mul_f32 v23, v232, v23
    v_mul_f32 v24, v232, v24
    v_mul_f32 v25, v232, v25
    v_mul_f32 v26, v232, v26
    v_mul_f32 v27, v232, v27
    v_cvt_pk_bf16_f32 v20, v20, v21
    v_cvt_pk_bf16_f32 v21, v22, v23
    v_cvt_pk_bf16_f32 v22, v24, v25
    v_cvt_pk_bf16_f32 v23, v26, v27
    v_add_u32 v238, s52, v228
    ds_write_b128 v238, v[20:23]
    v_mul_f32 v52, v234, v52
    v_mul_f32 v53, v234, v53
    v_mul_f32 v54, v234, v54
    v_mul_f32 v55, v234, v55
    v_mul_f32 v56, v234, v56
    v_mul_f32 v57, v234, v57
    v_mul_f32 v58, v234, v58
    v_mul_f32 v59, v234, v59
    v_cvt_pk_bf16_f32 v52, v52, v53
    v_cvt_pk_bf16_f32 v53, v54, v55
    v_cvt_pk_bf16_f32 v54, v56, v57
    v_cvt_pk_bf16_f32 v55, v58, v59
    v_add_u32 v238, s56, v238
    ds_write_b128 v238, v[52:55]
    v_mul_f32 v28, v232, v28
    v_mul_f32 v29, v232, v29
    v_mul_f32 v30, v232, v30
    v_mul_f32 v31, v232, v31
    v_mul_f32 v32, v232, v32
    v_mul_f32 v33, v232, v33
    v_mul_f32 v34, v232, v34
    v_mul_f32 v35, v232, v35
    v_cvt_pk_bf16_f32 v28, v28, v29
    v_cvt_pk_bf16_f32 v29, v30, v31
    v_cvt_pk_bf16_f32 v30, v32, v33
    v_cvt_pk_bf16_f32 v31, v34, v35
    v_add_u32 v238, s53, v228
    ds_write_b128 v238, v[28:31]
    v_mul_f32 v60, v234, v60
    v_mul_f32 v61, v234, v61
    v_mul_f32 v62, v234, v62
    v_mul_f32 v63, v234, v63
    v_mul_f32 v64, v234, v64
    v_mul_f32 v65, v234, v65
    v_mul_f32 v66, v234, v66
    v_mul_f32 v67, v234, v67
    v_cvt_pk_bf16_f32 v60, v60, v61
    v_cvt_pk_bf16_f32 v61, v62, v63
    v_cvt_pk_bf16_f32 v62, v64, v65
    v_cvt_pk_bf16_f32 v63, v66, v67
    v_add_u32 v238, s56, v238
    ds_write_b128 v238, v[60:63]
    v_mul_f32 v68, v236, v68
    v_mul_f32 v69, v236, v69
    v_mul_f32 v70, v236, v70
    v_mul_f32 v71, v236, v71
    v_mul_f32 v72, v236, v72
    v_mul_f32 v73, v236, v73
    v_mul_f32 v74, v236, v74
    v_mul_f32 v75, v236, v75
    v_cvt_pk_bf16_f32 v68, v68, v69
    v_cvt_pk_bf16_f32 v69, v70, v71
    v_cvt_pk_bf16_f32 v70, v72, v73
    v_cvt_pk_bf16_f32 v71, v74, v75
    v_add_u32 v238, s57, v229
    ds_write_b128 v238, v[68:71]
    s_waitcnt lgkmcnt(0)
    s_barrier
    v_bfe_u32 v210, v0, 0, 2
    v_lshlrev_b32 v210, 2, v210
    v_add_u32 v210, 162816, v210
    ds_read_b32 v208, v210
    v_lshrrev_b32 v210, 3, v0
    v_and_b32 v211, 6, v210
    v_and_b32 v204, 7, v0
    v_xor_b32 v204, v204, v211
    v_lshlrev_b32 v204, 4, v204
    v_lshl_add_u32 v204, v210, 10, v204
    s_lshl_b32 s43, s36, 15
    v_add_u32 v204, s43, v204
    s_lshl_b32 s62, s36, 12
    s_waitcnt lgkmcnt(0)
    v_cmp_ne_u32 vcc, 0, v208
    s_nop 0
    s_cmp_lg_u64 vcc, 0
    s_cbranch_scc1 L_restart
    s_bfe_u32 s41, s100, 262148
    s_add_u32 s41, s41, s39
    s_and_b32 s41, s41, 7
    s_lshl_b32 s41, s41, 7
    s_add_u32 m0, s62, 81920
    s_add_u32 s41, s41, s89
    s_add_u32 s41, s41, 131072
    buffer_load_dwordx4 v204, s[20:23], s41 offen  lds
    s_add_u32 s41, s41, 7168
    buffer_load_dwordx4 v204, s[20:23], s41 offen offset:1024  lds
    s_add_u32 s41, s41, 7168
    buffer_load_dwordx4 v204, s[20:23], s41 offen offset:2048  lds
    s_add_u32 s41, s41, 7168
    buffer_load_dwordx4 v204, s[20:23], s41 offen offset:3072  lds
    s_waitcnt lgkmcnt(0)
    s_barrier
    s_bfe_u32 s41, s100, 262152
    s_add_u32 s41, s41, s39
    s_and_b32 s41, s41, 7
    s_lshl_b32 s41, s41, 7
    s_add_u32 m0, s62, 0
    s_add_u32 s41, s41, s88
    buffer_load_dwordx4 v204, s[20:23], s41 offen  lds
    s_add_u32 s41, s41, 7168
    buffer_load_dwordx4 v204, s[20:23], s41 offen offset:1024  lds
    s_add_u32 s41, s41, 7168
    buffer_load_dwordx4 v204, s[20:23], s41 offen offset:2048  lds
    s_add_u32 s41, s41, 7168
    buffer_load_dwordx4 v204, s[20:23], s41 offen offset:3072  lds
    s_lshl_b32 s41, s40, 3
    s_add_u32 s41, s41, s39
    s_lshl_b32 s42, s41, 7
    v_and_b32 v210, 31, v0
    v_lshlrev_b32 v210, 2, v210
    v_add_u32 v205, s42, v210
    s_mul_i32 s41, s41, 129024
    s_add_u32 s41, s41, 8388608
    s_add_u32 s42, s41, s62
    v_lshlrev_b32 v210, 4, v0
    v_add_u32 v206, s42, v210
    v_and_b32 v210, 3, v0
    v_lshrrev_b32 v211, 4, v0
    v_lshl_add_u32 v210, v210, 4, v211
    s_lshl_b32 s43, s36, 2
    v_add_u32 v210, s43, v210
    v_bfe_u32 v213, v0, 2, 2
    v_lshlrev_b32 v207, 9, v213
    v_lshl_add_u32 v207, v211, 5, v207
    v_and_b32 v214, 3, v0
    v_lshl_add_u32 v207, v214, 3, v207
    s_lshl_b32 s43, s36, 7
    s_add_u32 s41, s41, s43
    s_add_u32 s41, s41, 16384
    v_add_u32 v207, s41, v207
    v_mul_u32_u24 v214, 9216, v213
    v_lshl_add_u32 v214, v210, 4, v214
    v_add_u32 v214, 122880, v214
    s_lshr_b32 s41, s40, 4
    s_lshl_b32 s41, s41, 10
    s_lshl_b32 s42, s94, 7
    s_add_u32 s41, s41, s42
    v_and_b32 v210, 15, v0
    v_lshlrev_b32 v213, 3, v210
    v_lshl_add_u32 v213, v211, 11, v213
    s_add_u32 s42, s48, 262144
    s_add_u32 s42, s42, s41
    v_add_u32 v213, s42, v213
    v_lshlrev_b32 v210, 11, v210
    v_add_u32 v210, s41, v210
    v_lshrrev_b32 v212, 1, v211
    v_lshl_add_u32 v210, v212, 4, v210
    v_and_b32 v211, 1, v211
    v_xor_b32 v211, s36, v211
    v_lshl_add_u32 v212, v211, 5, v210
    s_lshl_b32 s42, s36, 16
    v_add_u32 v212, s42, v212
    v_and_b32 v210, 8, v0
    v_mul_u32_u24 v210, 2056, v210
    v_xor_b32 v212, v212, v210
    s_waitcnt lgkmcnt(0)
    s_barrier
    s_bfe_u32 s41, s100, 262152
    s_add_u32 s41, s41, s39
    s_and_b32 s41, s41, 7
    s_lshl_b32 s41, s41, 7
    s_add_u32 m0, s62, 16384
    s_add_u32 s41, s41, s88
    s_add_u32 s41, s41, 131072
    buffer_load_dwordx4 v204, s[20:23], s41 offen  lds
    s_add_u32 s41, s41, 7168
    buffer_load_dwordx4 v204, s[20:23], s41 offen offset:1024  lds
    s_add_u32 s41, s41, 7168
    buffer_load_dwordx4 v204, s[20:23], s41 offen offset:2048  lds
    s_add_u32 s41, s41, 7168
    buffer_load_dwordx4 v204, s[20:23], s41 offen offset:3072  lds
    v_mov_b32 v4, 0
    v_mov_b32 v5, 0
    v_mov_b32 v6, 0
    v_mov_b32 v7, 0
    v_mov_b32 v8, 0
    v_mov_b32 v9, 0
    v_mov_b32 v10, 0
    v_mov_b32 v11, 0
    v_mov_b32 v12, 0
    v_mov_b32 v13, 0
    v_mov_b32 v14, 0
    v_mov_b32 v15, 0
    v_mov_b32 v16, 0
    v_mov_b32 v17, 0
    v_mov_b32 v18, 0
    v_mov_b32 v19, 0
    v_mov_b32 v20, 0
    v_mov_b32 v21, 0
    v_mov_b32 v22, 0
    v_mov_b32 v23, 0
    v_mov_b32 v24, 0
    v_mov_b32 v25, 0
    v_mov_b32 v26, 0
    v_mov_b32 v27, 0
    v_mov_b32 v28, 0
    v_mov_b32 v29, 0
    v_mov_b32 v30, 0
    v_mov_b32 v31, 0
    v_mov_b32 v32, 0
    v_mov_b32 v33, 0
    v_mov_b32 v34, 0
    v_mov_b32 v35, 0
    v_mov_b32 v36, 0
    v_mov_b32 v37, 0
    v_mov_b32 v38, 0
    v_mov_b32 v39, 0
    s_mov_b32 s63, 0xffffff80
    s_mov_b32 s60, 0x40000000
    s_mov_b32 s54, 0x3f800000
    s_mov_b32 s55, 0x3f80
    s_waitcnt lgkmcnt(0)
    s_barrier
    s_bfe_u32 s41, s100, 262152
    s_add_u32 s41, s41, s39
    s_and_b32 s41, s41, 7
    s_lshl_b32 s41, s41, 7
    s_add_u32 m0, s62, 32768
    s_add_u32 s41, s41, s89
    buffer_load_dwordx4 v204, s[20:23], s41 offen  lds
    s_add_u32 s41, s41, 7168
    buffer_load_dwordx4 v204, s[20:23], s41 offen offset:1024  lds
    s_add_u32 s41, s41, 7168
    buffer_load_dwordx4 v204, s[20:23], s41 offen offset:2048  lds
    s_add_u32 s41, s41, 7168
    buffer_load_dwordx4 v204, s[20:23], s41 offen offset:3072  lds
    s_waitcnt vmcnt(12) lgkmcnt(0)
    s_barrier
    s_bfe_u32 s41, s100, 262152
    s_add_u32 s41, s41, s39
    s_and_b32 s41, s41, 7
    s_lshl_b32 s41, s41, 7
    s_add_u32 m0, s62, 49152
    s_add_u32 s41, s41, s89
    s_add_u32 s41, s41, 131072
    buffer_load_dwordx4 v204, s[20:23], s41 offen  lds
    s_add_u32 s41, s41, 7168
    buffer_load_dwordx4 v204, s[20:23], s41 offen offset:1024  lds
    s_add_u32 s41, s41, 7168
    buffer_load_dwordx4 v204, s[20:23], s41 offen offset:2048  lds
    s_add_u32 s41, s41, 7168
    buffer_load_dwordx4 v204, s[20:23], s41 offen offset:3072  lds
    s_waitcnt vmcnt(12) lgkmcnt(0)
    s_barrier
    s_bfe_u32 s41, s100, 262156
    s_add_u32 s41, s41, s39
    s_and_b32 s41, s41, 7
    s_lshl_b32 s41, s41, 7
    s_add_u32 m0, s62, 65536
    s_add_u32 s41, s41, s88
    buffer_load_dwordx4 v204, s[20:23], s41 offen  lds
    s_add_u32 s41, s41, 7168
    buffer_load_dwordx4 v204, s[20:23], s41 offen offset:1024  lds
    s_add_u32 s41, s41, 7168
    buffer_load_dwordx4 v204, s[20:23], s41 offen offset:2048  lds
    s_add_u32 s41, s41, 7168
    buffer_load_dwordx4 v204, s[20:23], s41 offen offset:3072  lds
    s_waitcnt vmcnt(12) lgkmcnt(0)
    s_barrier
    s_bfe_u32 s41, s100, 262156
    s_add_u32 s41, s41, s39
    s_and_b32 s41, s41, 7
    s_lshl_b32 s41, s41, 7
    s_add_u32 m0, s62, 81920
    s_add_u32 s41, s41, s88
    s_add_u32 s41, s41, 131072
    buffer_load_dwordx4 v204, s[20:23], s41 offen  lds
    s_add_u32 s41, s41, 7168
    buffer_load_dwordx4 v204, s[20:23], s41 offen offset:1024  lds
    s_add_u32 s41, s41, 7168
    buffer_load_dwordx4 v204, s[20:23], s41 offen offset:2048  lds
    s_add_u32 s41, s41, 7168
    buffer_load_dwordx4 v204, s[20:23], s41 offen offset:3072  lds
    s_waitcnt vmcnt(12) lgkmcnt(0)
    s_barrier
    buffer_load_dword v208, v205, s[28:31], 0 offen sc1
    s_bfe_u32 s41, s100, 262156
    s_add_u32 s41, s41, s39
    s_and_b32 s41, s41, 7
    s_lshl_b32 s41, s41, 7
    s_add_u32 m0, s62, 0
    s_add_u32 s41, s41, s89
    buffer_load_dwordx4 v204, s[20:23], s41 offen  lds
    s_add_u32 s41, s41, 7168
    buffer_load_dwordx4 v204, s[20:23], s41 offen offset:1024  lds
    s_add_u32 s41, s41, 7168
    buffer_load_dwordx4 v204, s[20:23], s41 offen offset:2048  lds
    s_add_u32 s41, s41, 7168
    buffer_load_dwordx4 v204, s[20:23], s41 offen offset:3072  lds
    s_waitcnt vmcnt(13) lgkmcnt(0)
    s_barrier
    s_bfe_u32 s41, s100, 262156
    s_add_u32 s41, s41, s39
    s_and_b32 s41, s41, 7
    s_lshl_b32 s41, s41, 7
    s_add_u32 m0, s62, 16384
    s_add_u32 s41, s41, s89
    s_add_u32 s41, s41, 131072
    buffer_load_dwordx4 v204, s[20:23], s41 offen  lds
    s_add_u32 s41, s41, 7168
    buffer_load_dwordx4 v204, s[20:23], s41 offen offset:1024  lds
    s_add_u32 s41, s41, 7168
    buffer_load_dwordx4 v204, s[20:23], s41 offen offset:2048  lds
    s_add_u32 s41, s41, 7168
    buffer_load_dwordx4 v204, s[20:23], s41 offen offset:3072  lds
    s_waitcnt vmcnt(13) lgkmcnt(0)
    s_barrier
    s_bfe_u32 s41, s100, 262160
    s_add_u32 s41, s41, s39
    s_and_b32 s41, s41, 7
    s_lshl_b32 s41, s41, 7
    s_add_u32 m0, s62, 32768
    s_add_u32 s41, s41, s88
    buffer_load_dwordx4 v204, s[20:23], s41 offen  lds
    s_add_u32 s41, s41, 7168
    buffer_load_dwordx4 v204, s[20:23], s41 offen offset:1024  lds
    s_add_u32 s41, s41, 7168
    buffer_load_dwordx4 v204, s[20:23], s41 offen offset:2048  lds
    s_add_u32 s41, s41, 7168
    buffer_load_dwordx4 v204, s[20:23], s41 offen offset:3072  lds
    s_waitcnt vmcnt(12) lgkmcnt(0)
    s_barrier
    v_cmp_eq_u32 vcc, 1, v208
    s_nop 0
    s_lshr_b32 s42, vcc_lo, 16
    s_and_b32 s42, s42, vcc_lo
    s_lshr_b32 s43, s42, 8
    s_and_b32 s43, s43, s42
    s_andn2_b32 s43, s43, s63
    s_ff1_i32_b32 s42, s43
    s_mul_i32 s61, s42, 18432
    s_cmp_eq_u32 s43, 0
    s_cselect_b32 s61, s60, s61
    s_cselect_b32 s42, 7, s42
    s_bitset1_b32 s63, s42
    s_bitset0_b32 s43, s42
    buffer_load_dword v208, v205, s[28:31], 0 offen sc1
    s_bfe_u32 s41, s100, 262160
    s_add_u32 s41, s41, s39
    s_and_b32 s41, s41, 7
    s_lshl_b32 s41, s41, 7
    s_add_u32 m0, s62, 49152
    s_add_u32 s41, s41, s88
    s_add_u32 s41, s41, 131072
    buffer_load_dwordx4 v204, s[20:23], s41 offen  lds
    s_add_u32 s41, s41, 7168
    buffer_load_dwordx4 v204, s[20:23], s41 offen offset:1024  lds
    s_add_u32 s41, s41, 7168
    buffer_load_dwordx4 v204, s[20:23], s41 offen offset:2048  lds
    s_add_u32 s41, s41, 7168
    buffer_load_dwordx4 v204, s[20:23], s41 offen offset:3072  lds
    buffer_load_dwordx4 v[40:43], v206, s[28:31], s61 offen offset:0 sc1
    buffer_load_dwordx4 v[44:47], v206, s[28:31], s61 offen offset:1024 sc1
    buffer_load_dwordx4 v[48:51], v206, s[28:31], s61 offen offset:2048 sc1
    s_waitcnt vmcnt(16) lgkmcnt(0)
    s_barrier
    s_bfe_u32 s41, s100, 262160
    s_add_u32 s41, s41, s39
    s_and_b32 s41, s41, 7
    s_lshl_b32 s41, s41, 7
    s_add_u32 m0, s62, 65536
    s_add_u32 s41, s41, s89
    buffer_load_dwordx4 v204, s[20:23], s41 offen  lds
    s_add_u32 s41, s41, 7168
    buffer_load_dwordx4 v204, s[20:23], s41 offen offset:1024  lds
    s_add_u32 s41, s41, 7168
    buffer_load_dwordx4 v204, s[20:23], s41 offen offset:2048  lds
    s_add_u32 s41, s41, 7168
    buffer_load_dwordx4 v204, s[20:23], s41 offen offset:3072  lds
    buffer_load_dwordx4 v[52:55], v206, s[28:31], s61 offen offset:3072 sc1
    buffer_load_dwordx2 v[56:57], v207, s[28:31], s61 offen sc1
    s_waitcnt vmcnt(18) lgkmcnt(0)
    s_barrier
    s_bfe_u32 s41, s100, 262160
    s_add_u32 s41, s41, s39
    s_and_b32 s41, s41, 7
    s_lshl_b32 s41, s41, 7
    s_add_u32 m0, s62, 81920
    s_add_u32 s41, s41, s89
    s_add_u32 s41, s41, 131072
    buffer_load_dwordx4 v204, s[20:23], s41 offen  lds
    s_add_u32 s41, s41, 7168
    buffer_load_dwordx4 v204, s[20:23], s41 offen offset:1024  lds
    s_add_u32 s41, s41, 7168
    buffer_load_dwordx4 v204, s[20:23], s41 offen offset:2048  lds
    s_add_u32 s41, s41, 7168
    buffer_load_dwordx4 v204, s[20:23], s41 offen offset:3072  lds
    s_waitcnt vmcnt(17) lgkmcnt(0)
    s_barrier
    v_cmp_eq_u32 vcc, 1, v208
    s_nop 0
    s_lshr_b32 s42, vcc_lo, 16
    s_and_b32 s42, s42, vcc_lo
    s_lshr_b32 s43, s42, 8
    s_and_b32 s43, s43, s42
    s_andn2_b32 s43, s43, s63
    s_ff1_i32_b32 s42, s43
    s_mul_i32 s56, s42, 18432
    s_cmp_eq_u32 s43, 0
    s_cselect_b32 s56, s60, s56
    s_cselect_b32 s42, 7, s42
    s_bitset1_b32 s63, s42
    s_bitset0_b32 s43, s42
    buffer_load_dword v208, v205, s[28:31], 0 offen sc1
    s_bfe_u32 s41, s100, 262164
    s_add_u32 s41, s41, s39
    s_and_b32 s41, s41, 7
    s_lshl_b32 s41, s41, 7
    s_add_u32 m0, s62, 0
    s_add_u32 s41, s41, s88
    buffer_load_dwordx4 v204, s[20:23], s41 offen  lds
    s_add_u32 s41, s41, 7168
    buffer_load_dwordx4 v204, s[20:23], s41 offen offset:1024  lds
    s_add_u32 s41, s41, 7168
    buffer_load_dwordx4 v204, s[20:23], s41 offen offset:2048  lds
    s_add_u32 s41, s41, 7168
    buffer_load_dwordx4 v204, s[20:23], s41 offen offset:3072  lds
    buffer_load_dwordx4 v[58:61], v206, s[28:31], s56 offen offset:0 sc1
    buffer_load_dwordx4 v[62:65], v206, s[28:31], s56 offen offset:1024 sc1
    buffer_load_dwordx4 v[66:69], v206, s[28:31], s56 offen offset:2048 sc1
    s_waitcnt vmcnt(12) lgkmcnt(0)
    s_barrier
    s_bfe_u32 s41, s100, 262164
    s_add_u32 s41, s41, s39
    s_and_b32 s41, s41, 7
    s_lshl_b32 s41, s41, 7
    s_add_u32 m0, s62, 16384
    s_add_u32 s41, s41, s88
    s_add_u32 s41, s41, 131072
    buffer_load_dwordx4 v204, s[20:23], s41 offen  lds
    s_add_u32 s41, s41, 7168
    buffer_load_dwordx4 v204, s[20:23], s41 offen offset:1024  lds
    s_add_u32 s41, s41, 7168
    buffer_load_dwordx4 v204, s[20:23], s41 offen offset:2048  lds
    s_add_u32 s41, s41, 7168
    buffer_load_dwordx4 v204, s[20:23], s41 offen offset:3072  lds
    s_cmp_eq_u32 s61, s60
    s_cbranch_scc1 L_ca00
    v_lshlrev_b32 v210, 16, v40
    v_and_b32 v40, 0xffff0000, v40
    v_add_f32 v4, v4, v210
    v_add_f32 v5, v5, v40
    v_lshlrev_b32 v211, 16, v41
    v_and_b32 v41, 0xffff0000, v41
    v_add_f32 v6, v6, v211
    v_add_f32 v7, v7, v41
    v_lshlrev_b32 v210, 16, v42
    v_and_b32 v42, 0xffff0000, v42
    v_add_f32 v8, v8, v210
    v_add_f32 v9, v9, v42
    v_lshlrev_b32 v211, 16, v43
    v_and_b32 v43, 0xffff0000, v43
    v_add_f32 v10, v10, v211
    v_add_f32 v11, v11, v43
    v_lshlrev_b32 v210, 16, v44
    v_and_b32 v44, 0xffff0000, v44
    v_add_f32 v12, v12, v210
    v_add_f32 v13, v13, v44
    v_lshlrev_b32 v211, 16, v45
    v_and_b32 v45, 0xffff0000, v45
    v_add_f32 v14, v14, v211
    v_add_f32 v15, v15, v45
    v_lshlrev_b32 v210, 16, v46
    v_and_b32 v46, 0xffff0000, v46
    v_add_f32 v16, v16, v210
    v_add_f32 v17, v17, v46
    v_lshlrev_b32 v211, 16, v47
    v_and_b32 v47, 0xffff0000, v47
    v_add_f32 v18, v18, v211
    v_add_f32 v19, v19, v47
    v_lshlrev_b32 v210, 16, v48
    v_and_b32 v48, 0xffff0000, v48
    v_add_f32 v20, v20, v210
    v_add_f32 v21, v21, v48
L_ca00:
    buffer_load_dwordx4 v[70:73], v206, s[28:31], s56 offen offset:3072 sc1
    buffer_load_dwordx2 v[74:75], v207, s[28:31], s56 offen sc1
    s_waitcnt lgkmcnt(0)
    s_barrier
    s_bfe_u32 s41, s100, 262164
    s_add_u32 s41, s41, s39
    s_and_b32 s41, s41, 7
    s_lshl_b32 s41, s41, 7
    s_add_u32 m0, s62, 32768
    s_add_u32 s41, s41, s89
    buffer_load_dwordx4 v204, s[20:23], s41 offen  lds
    s_add_u32 s41, s41, 7168
    buffer_load_dwordx4 v204, s[20:23], s41 offen offset:1024  lds
    s_add_u32 s41, s41, 7168
    buffer_load_dwordx4 v204, s[20:23], s41 offen offset:2048  lds
    s_add_u32 s41, s41, 7168
    buffer_load_dwordx4 v204, s[20:23], s41 offen offset:3072  lds
    s_cmp_eq_u32 s61, s60
    s_cbranch_scc1 L_ca01
    v_lshlrev_b32 v211, 16, v49
    v_and_b32 v49, 0xffff0000, v49
    v_add_f32 v22, v22, v211
    v_add_f32 v23, v23, v49
    v_lshlrev_b32 v210, 16, v50
    v_and_b32 v50, 0xffff0000, v50
    v_add_f32 v24, v24, v210
    v_add_f32 v25, v25, v50
    v_lshlrev_b32 v211, 16, v51
    v_and_b32 v51, 0xffff0000, v51
    v_add_f32 v26, v26, v211
    v_add_f32 v27, v27, v51
    v_lshlrev_b32 v210, 16, v52
    v_and_b32 v52, 0xffff0000, v52
    v_add_f32 v28, v28, v210
    v_add_f32 v29, v29, v52
    v_lshlrev_b32 v211, 16, v53
    v_and_b32 v53, 0xffff0000, v53
    v_add_f32 v30, v30, v211
    v_add_f32 v31, v31, v53
    v_lshlrev_b32 v210, 16, v54
    v_and_b32 v54, 0xffff0000, v54
    v_add_f32 v32, v32, v210
    v_add_f32 v33, v33, v54
    v_lshlrev_b32 v211, 16, v55
    v_and_b32 v55, 0xffff0000, v55
    v_add_f32 v34, v34, v211
    v_add_f32 v35, v35, v55
    v_lshlrev_b32 v210, 16, v56
    v_and_b32 v56, 0xffff0000, v56
    v_add_f32 v36, v36, v210
    v_add_f32 v37, v37, v56
    v_lshlrev_b32 v211, 16, v57
    v_and_b32 v57, 0xffff0000, v57
    v_add_f32 v38, v38, v211
    v_add_f32 v39, v39, v57
L_ca01:
    s_waitcnt vmcnt(17) lgkmcnt(0)
    s_barrier
    v_cmp_eq_u32 vcc, 1, v208
    s_nop 0
    s_lshr_b32 s42, vcc_lo, 16
    s_and_b32 s42, s42, vcc_lo
    s_lshr_b32 s43, s42, 8
    s_and_b32 s43, s43, s42
    s_andn2_b32 s43, s43, s63
    s_ff1_i32_b32 s42, s43
    s_mul_i32 s61, s42, 18432
    s_cmp_eq_u32 s43, 0
    s_cselect_b32 s61, s60, s61
    s_cselect_b32 s42, 7, s42
    s_bitset1_b32 s63, s42
    s_bitset0_b32 s43, s42
    buffer_load_dword v208, v205, s[28:31], 0 offen sc1
    s_bfe_u32 s41, s100, 262164
    s_add_u32 s41, s41, s39
    s_and_b32 s41, s41, 7
    s_lshl_b32 s41, s41, 7
    s_add_u32 m0, s62, 49152
    s_add_u32 s41, s41, s89
    s_add_u32 s41, s41, 131072
    buffer_load_dwordx4 v204, s[20:23], s41 offen  lds
    s_add_u32 s41, s41, 7168
    buffer_load_dwordx4 v204, s[20:23], s41 offen offset:1024  lds
    s_add_u32 s41, s41, 7168
    buffer_load_dwordx4 v204, s[20:23], s41 offen offset:2048  lds
    s_add_u32 s41, s41, 7168
    buffer_load_dwordx4 v204, s[20:23], s41 offen offset:3072  lds
    buffer_load_dwordx4 v[40:43], v206, s[28:31], s61 offen offset:0 sc1
    buffer_load_dwordx4 v[44:47], v206, s[28:31], s61 offen offset:1024 sc1
    buffer_load_dwordx4 v[48:51], v206, s[28:31], s61 offen offset:2048 sc1
    s_waitcnt vmcnt(12) lgkmcnt(0)
    s_barrier
    s_bfe_u32 s41, s100, 262168
    s_add_u32 s41, s41, s39
    s_and_b32 s41, s41, 7
    s_lshl_b32 s41, s41, 7
    s_add_u32 m0, s62, 65536
    s_add_u32 s41, s41, s88
    buffer_load_dwordx4 v204, s[20:23], s41 offen  lds
    s_add_u32 s41, s41, 7168
    buffer_load_dwordx4 v204, s[20:23], s41 offen offset:1024  lds
    s_add_u32 s41, s41, 7168
    buffer_load_dwordx4 v204, s[20:23], s41 offen offset:2048  lds
    s_add_u32 s41, s41, 7168
    buffer_load_dwordx4 v204, s[20:23], s41 offen offset:3072  lds
    s_cmp_eq_u32 s56, s60
    s_cbranch_scc1 L_ca10
    v_lshlrev_b32 v210, 16, v58
    v_and_b32 v58, 0xffff0000, v58
    v_add_f32 v4, v4, v210
    v_add_f32 v5, v5, v58
    v_lshlrev_b32 v211, 16, v59
    v_and_b32 v59, 0xffff0000, v59
    v_add_f32 v6, v6, v211
    v_add_f32 v7, v7, v59
    v_lshlrev_b32 v210, 16, v60
    v_and_b32 v60, 0xffff0000, v60
    v_add_f32 v8, v8, v210
    v_add_f32 v9, v9, v60
    v_lshlrev_b32 v211, 16, v61
    v_and_b32 v61, 0xffff0000, v61
    v_add_f32 v10, v10, v211
    v_add_f32 v11, v11, v61
    v_lshlrev_b32 v210, 16, v62
    v_and_b32 v62, 0xffff0000, v62
    v_add_f32 v12, v12, v210
    v_add_f32 v13, v13, v62
    v_lshlrev_b32 v211, 16, v63
    v_and_b32 v63, 0xffff0000, v63
    v_add_f32 v14, v14, v211
    v_add_f32 v15, v15, v63
    v_lshlrev_b32 v210, 16, v64
    v_and_b32 v64, 0xffff0000, v64
    v_add_f32 v16, v16, v210
    v_add_f32 v17, v17, v64
    v_lshlrev_b32 v211, 16, v65
    v_and_b32 v65, 0xffff0000, v65
    v_add_f32 v18, v18, v211
    v_add_f32 v19, v19, v65
    v_lshlrev_b32 v210, 16, v66
    v_and_b32 v66, 0xffff0000, v66
    v_add_f32 v20, v20, v210
    v_add_f32 v21, v21, v66
L_ca10:
    buffer_load_dwordx4 v[52:55], v206, s[28:31], s61 offen offset:3072 sc1
    buffer_load_dwordx2 v[56:57], v207, s[28:31], s61 offen sc1
    s_waitcnt lgkmcnt(0)
    s_barrier
    s_bfe_u32 s41, s100, 262168
    s_add_u32 s41, s41, s39
    s_and_b32 s41, s41, 7
    s_lshl_b32 s41, s41, 7
    s_add_u32 m0, s62, 81920
    s_add_u32 s41, s41, s88
    s_add_u32 s41, s41, 131072
    buffer_load_dwordx4 v204, s[20:23], s41 offen  lds
    s_add_u32 s41, s41, 7168
    buffer_load_dwordx4 v204, s[20:23], s41 offen offset:1024  lds
    s_add_u32 s41, s41, 7168
    buffer_load_dwordx4 v204, s[20:23], s41 offen offset:2048  lds
    s_add_u32 s41, s41, 7168
    buffer_load_dwordx4 v204, s[20:23], s41 offen offset:3072  lds
    s_cmp_eq_u32 s56, s60
    s_cbranch_scc1 L_ca11
    v_lshlrev_b32 v211, 16, v67
    v_and_b32 v67, 0xffff0000, v67
    v_add_f32 v22, v22, v211
    v_add_f32 v23, v23, v67
    v_lshlrev_b32 v210, 16, v68
    v_and_b32 v68, 0xffff0000, v68
    v_add_f32 v24, v24, v210
    v_add_f32 v25, v25, v68
    v_lshlrev_b32 v211, 16, v69
    v_and_b32 v69, 0xffff0000, v69
    v_add_f32 v26, v26, v211
    v_add_f32 v27, v27, v69
    v_lshlrev_b32 v210, 16, v70
    v_and_b32 v70, 0xffff0000, v70
    v_add_f32 v28, v28, v210
    v_add_f32 v29, v29, v70
    v_lshlrev_b32 v211, 16, v71
    v_and_b32 v71, 0xffff0000, v71
    v_add_f32 v30, v30, v211
    v_add_f32 v31, v31, v71
    v_lshlrev_b32 v210, 16, v72
    v_and_b32 v72, 0xffff0000, v72
    v_add_f32 v32, v32, v210
    v_add_f32 v33, v33, v72
    v_lshlrev_b32 v211, 16, v73
    v_and_b32 v73, 0xffff0000, v73
    v_add_f32 v34, v34, v211
    v_add_f32 v35, v35, v73
    v_lshlrev_b32 v210, 16, v74
    v_and_b32 v74, 0xffff0000, v74
    v_add_f32 v36, v36, v210
    v_add_f32 v37, v37, v74
    v_lshlrev_b32 v211, 16, v75
    v_and_b32 v75, 0xffff0000, v75
    v_add_f32 v38, v38, v211
    v_add_f32 v39, v39, v75
L_ca11:
    s_waitcnt vmcnt(17) lgkmcnt(0)
    s_barrier
    v_cmp_eq_u32 vcc, 1, v208
    s_nop 0
    s_lshr_b32 s42, vcc_lo, 16
    s_and_b32 s42, s42, vcc_lo
    s_lshr_b32 s43, s42, 8
    s_and_b32 s43, s43, s42
    s_andn2_b32 s43, s43, s63
    s_ff1_i32_b32 s42, s43
    s_mul_i32 s56, s42, 18432
    s_cmp_eq_u32 s43, 0
    s_cselect_b32 s56, s60, s56
    s_cselect_b32 s42, 7, s42
    s_bitset1_b32 s63, s42
    s_bitset0_b32 s43, s42
    buffer_load_dword v208, v205, s[28:31], 0 offen sc1
    s_bfe_u32 s41, s100, 262168
    s_add_u32 s41, s41, s39
    s_and_b32 s41, s41, 7
    s_lshl_b32 s41, s41, 7
    s_add_u32 m0, s62, 0
    s_add_u32 s41, s41, s89
    buffer_load_dwordx4 v204, s[20:23], s41 offen  lds
    s_add_u32 s41, s41, 7168
    buffer_load_dwordx4 v204, s[20:23], s41 offen offset:1024  lds
    s_add_u32 s41, s41, 7168
    buffer_load_dwordx4 v204, s[20:23], s41 offen offset:2048  lds
    s_add_u32 s41, s41, 7168
    buffer_load_dwordx4 v204, s[20:23], s41 offen offset:3072  lds
    buffer_load_dwordx4 v[58:61], v206, s[28:31], s56 offen offset:0 sc1
    buffer_load_dwordx4 v[62:65], v206, s[28:31], s56 offen offset:1024 sc1
    buffer_load_dwordx4 v[66:69], v206, s[28:31], s56 offen offset:2048 sc1
    s_waitcnt vmcnt(12) lgkmcnt(0)
    s_barrier
    s_bfe_u32 s41, s100, 262168
    s_add_u32 s41, s41, s39
    s_and_b32 s41, s41, 7
    s_lshl_b32 s41, s41, 7
    s_add_u32 m0, s62, 16384
    s_add_u32 s41, s41, s89
    s_add_u32 s41, s41, 131072
    buffer_load_dwordx4 v204, s[20:23], s41 offen  lds
    s_add_u32 s41, s41, 7168
    buffer_load_dwordx4 v204, s[20:23], s41 offen offset:1024  lds
    s_add_u32 s41, s41, 7168
    buffer_load_dwordx4 v204, s[20:23], s41 offen offset:2048  lds
    s_add_u32 s41, s41, 7168
    buffer_load_dwordx4 v204, s[20:23], s41 offen offset:3072  lds
    s_cmp_eq_u32 s61, s60
    s_cbranch_scc1 L_ca20
    v_lshlrev_b32 v210, 16, v40
    v_and_b32 v40, 0xffff0000, v40
    v_add_f32 v4, v4, v210
    v_add_f32 v5, v5, v40
    v_lshlrev_b32 v211, 16, v41
    v_and_b32 v41, 0xffff0000, v41
    v_add_f32 v6, v6, v211
    v_add_f32 v7, v7, v41
    v_lshlrev_b32 v210, 16, v42
    v_and_b32 v42, 0xffff0000, v42
    v_add_f32 v8, v8, v210
    v_add_f32 v9, v9, v42
    v_lshlrev_b32 v211, 16, v43
    v_and_b32 v43, 0xffff0000, v43
    v_add_f32 v10, v10, v211
    v_add_f32 v11, v11, v43
    v_lshlrev_b32 v210, 16, v44
    v_and_b32 v44, 0xffff0000, v44
    v_add_f32 v12, v12, v210
    v_add_f32 v13, v13, v44
    v_lshlrev_b32 v211, 16, v45
    v_and_b32 v45, 0xffff0000, v45
    v_add_f32 v14, v14, v211
    v_add_f32 v15, v15, v45
    v_lshlrev_b32 v210, 16, v46
    v_and_b32 v46, 0xffff0000, v46
    v_add_f32 v16, v16, v210
    v_add_f32 v17, v17, v46
    v_lshlrev_b32 v211, 16, v47
    v_and_b32 v47, 0xffff0000, v47
    v_add_f32 v18, v18, v211
    v_add_f32 v19, v19, v47
    v_lshlrev_b32 v210, 16, v48
    v_and_b32 v48, 0xffff0000, v48
    v_add_f32 v20, v20, v210
    v_add_f32 v21, v21, v48
L_ca20:
    buffer_load_dwordx4 v[70:73], v206, s[28:31], s56 offen offset:3072 sc1
    buffer_load_dwordx2 v[74:75], v207, s[28:31], s56 offen sc1
    s_waitcnt lgkmcnt(0)
    s_barrier
    s_bfe_u32 s41, s100, 262172
    s_add_u32 s41, s41, s39
    s_and_b32 s41, s41, 7
    s_lshl_b32 s41, s41, 7
    s_add_u32 m0, s62, 32768
    s_add_u32 s41, s41, s88
    buffer_load_dwordx4 v204, s[20:23], s41 offen  lds
    s_add_u32 s41, s41, 7168
    buffer_load_dwordx4 v204, s[20:23], s41 offen offset:1024  lds
    s_add_u32 s41, s41, 7168
    buffer_load_dwordx4 v204, s[20:23], s41 offen offset:2048  lds
    s_add_u32 s41, s41, 7168
    buffer_load_dwordx4 v204, s[20:23], s41 offen offset:3072  lds
    s_cmp_eq_u32 s61, s60
    s_cbranch_scc1 L_ca21
    v_lshlrev_b32 v211, 16, v49
    v_and_b32 v49, 0xffff0000, v49
    v_add_f32 v22, v22, v211
    v_add_f32 v23, v23, v49
    v_lshlrev_b32 v210, 16, v50
    v_and_b32 v50, 0xffff0000, v50
    v_add_f32 v24, v24, v210
    v_add_f32 v25, v25, v50
    v_lshlrev_b32 v211, 16, v51
    v_and_b32 v51, 0xffff0000, v51
    v_add_f32 v26, v26, v211
    v_add_f32 v27, v27, v51
    v_lshlrev_b32 v210, 16, v52
    v_and_b32 v52, 0xffff0000, v52
    v_add_f32 v28, v28, v210
    v_add_f32 v29, v29, v52
    v_lshlrev_b32 v211, 16, v53
    v_and_b32 v53, 0xffff0000, v53
    v_add_f32 v30, v30, v211
    v_add_f32 v31, v31, v53
    v_lshlrev_b32 v210, 16, v54
    v_and_b32 v54, 0xffff0000, v54
    v_add_f32 v32, v32, v210
    v_add_f32 v33, v33, v54
    v_lshlrev_b32 v211, 16, v55
    v_and_b32 v55, 0xffff0000, v55
    v_add_f32 v34, v34, v211
    v_add_f32 v35, v35, v55
    v_lshlrev_b32 v210, 16, v56
    v_and_b32 v56, 0xffff0000, v56
    v_add_f32 v36, v36, v210
    v_add_f32 v37, v37, v56
    v_lshlrev_b32 v211, 16, v57
    v_and_b32 v57, 0xffff0000, v57
    v_add_f32 v38, v38, v211
    v_add_f32 v39, v39, v57
L_ca21:
    s_waitcnt vmcnt(17) lgkmcnt(0)
    s_barrier
    v_cmp_eq_u32 vcc, 1, v208
    s_nop 0
    s_lshr_b32 s42, vcc_lo, 16
    s_and_b32 s42, s42, vcc_lo
    s_lshr_b32 s43, s42, 8
    s_and_b32 s43, s43, s42
    s_andn2_b32 s43, s43, s63
    s_ff1_i32_b32 s42, s43
    s_mul_i32 s61, s42, 18432
    s_cmp_eq_u32 s43, 0
    s_cselect_b32 s61, s60, s61
    s_cselect_b32 s42, 7, s42
    s_bitset1_b32 s63, s42
    s_bitset0_b32 s43, s42
    buffer_load_dword v208, v205, s[28:31], 0 offen sc1
    s_bfe_u32 s41, s100, 262172
    s_add_u32 s41, s41, s39
    s_and_b32 s41, s41, 7
    s_lshl_b32 s41, s41, 7
    s_add_u32 m0, s62, 49152
    s_add_u32 s41, s41, s88
    s_add_u32 s41, s41, 131072
    buffer_load_dwordx4 v204, s[20:23], s41 offen  lds
    s_add_u32 s41, s41, 7168
    buffer_load_dwordx4 v204, s[20:23], s41 offen offset:1024  lds
    s_add_u32 s41, s41, 7168
    buffer_load_dwordx4 v204, s[20:23], s41 offen offset:2048  lds
    s_add_u32 s41, s41, 7168
    buffer_load_dwordx4 v204, s[20:23], s41 offen offset:3072  lds
    buffer_load_dwordx4 v[40:43], v206, s[28:31], s61 offen offset:0 sc1
    buffer_load_dwordx4 v[44:47], v206, s[28:31], s61 offen offset:1024 sc1
    buffer_load_dwordx4 v[48:51], v206, s[28:31], s61 offen offset:2048 sc1
    s_waitcnt vmcnt(12) lgkmcnt(0)
    s_barrier
    s_bfe_u32 s41, s100, 262172
    s_add_u32 s41, s41, s39
    s_and_b32 s41, s41, 7
    s_lshl_b32 s41, s41, 7
    s_add_u32 m0, s62, 65536
    s_add_u32 s41, s41, s89
    buffer_load_dwordx4 v204, s[20:23], s41 offen  lds
    s_add_u32 s41, s41, 7168
    buffer_load_dwordx4 v204, s[20:23], s41 offen offset:1024  lds
    s_add_u32 s41, s41, 7168
    buffer_load_dwordx4 v204, s[20:23], s41 offen offset:2048  lds
    s_add_u32 s41, s41, 7168
    buffer_load_dwordx4 v204, s[20:23], s41 offen offset:3072  lds
    s_cmp_eq_u32 s56, s60
    s_cbranch_scc1 L_ca30
    v_lshlrev_b32 v210, 16, v58
    v_and_b32 v58, 0xffff0000, v58
    v_add_f32 v4, v4, v210
    v_add_f32 v5, v5, v58
    v_lshlrev_b32 v211, 16, v59
    v_and_b32 v59, 0xffff0000, v59
    v_add_f32 v6, v6, v211
    v_add_f32 v7, v7, v59
    v_lshlrev_b32 v210, 16, v60
    v_and_b32 v60, 0xffff0000, v60
    v_add_f32 v8, v8, v210
    v_add_f32 v9, v9, v60
    v_lshlrev_b32 v211, 16, v61
    v_and_b32 v61, 0xffff0000, v61
    v_add_f32 v10, v10, v211
    v_add_f32 v11, v11, v61
    v_lshlrev_b32 v210, 16, v62
    v_and_b32 v62, 0xffff0000, v62
    v_add_f32 v12, v12, v210
    v_add_f32 v13, v13, v62
    v_lshlrev_b32 v211, 16, v63
    v_and_b32 v63, 0xffff0000, v63
    v_add_f32 v14, v14, v211
    v_add_f32 v15, v15, v63
    v_lshlrev_b32 v210, 16, v64
    v_and_b32 v64, 0xffff0000, v64
    v_add_f32 v16, v16, v210
    v_add_f32 v17, v17, v64
    v_lshlrev_b32 v211, 16, v65
    v_and_b32 v65, 0xffff0000, v65
    v_add_f32 v18, v18, v211
    v_add_f32 v19, v19, v65
    v_lshlrev_b32 v210, 16, v66
    v_and_b32 v66, 0xffff0000, v66
    v_add_f32 v20, v20, v210
    v_add_f32 v21, v21, v66
L_ca30:
    buffer_load_dwordx4 v[52:55], v206, s[28:31], s61 offen offset:3072 sc1
    buffer_load_dwordx2 v[56:57], v207, s[28:31], s61 offen sc1
    s_waitcnt lgkmcnt(0)
    s_barrier
    s_bfe_u32 s41, s100, 262172
    s_add_u32 s41, s41, s39
    s_and_b32 s41, s41, 7
    s_lshl_b32 s41, s41, 7
    s_add_u32 m0, s62, 81920
    s_add_u32 s41, s41, s89
    s_add_u32 s41, s41, 131072
    buffer_load_dwordx4 v204, s[20:23], s41 offen  lds
    s_add_u32 s41, s41, 7168
    buffer_load_dwordx4 v204, s[20:23], s41 offen offset:1024  lds
    s_add_u32 s41, s41, 7168
    buffer_load_dwordx4 v204, s[20:23], s41 offen offset:2048  lds
    s_add_u32 s41, s41, 7168
    buffer_load_dwordx4 v204, s[20:23], s41 offen offset:3072  lds
    s_cmp_eq_u32 s56, s60
    s_cbranch_scc1 L_ca31
    v_lshlrev_b32 v211, 16, v67
    v_and_b32 v67, 0xffff0000, v67
    v_add_f32 v22, v22, v211
    v_add_f32 v23, v23, v67
    v_lshlrev_b32 v210, 16, v68
    v_and_b32 v68, 0xffff0000, v68
    v_add_f32 v24, v24, v210
    v_add_f32 v25, v25, v68
    v_lshlrev_b32 v211, 16, v69
    v_and_b32 v69, 0xffff0000, v69
    v_add_f32 v26, v26, v211
    v_add_f32 v27, v27, v69
    v_lshlrev_b32 v210, 16, v70
    v_and_b32 v70, 0xffff0000, v70
    v_add_f32 v28, v28, v210
    v_add_f32 v29, v29, v70
    v_lshlrev_b32 v211, 16, v71
    v_and_b32 v71, 0xffff0000, v71
    v_add_f32 v30, v30, v211
    v_add_f32 v31, v31, v71
    v_lshlrev_b32 v210, 16, v72
    v_and_b32 v72, 0xffff0000, v72
    v_add_f32 v32, v32, v210
    v_add_f32 v33, v33, v72
    v_lshlrev_b32 v211, 16, v73
    v_and_b32 v73, 0xffff0000, v73
    v_add_f32 v34, v34, v211
    v_add_f32 v35, v35, v73
    v_lshlrev_b32 v210, 16, v74
    v_and_b32 v74, 0xffff0000, v74
    v_add_f32 v36, v36, v210
    v_add_f32 v37, v37, v74
    v_lshlrev_b32 v211, 16, v75
    v_and_b32 v75, 0xffff0000, v75
    v_add_f32 v38, v38, v211
    v_add_f32 v39, v39, v75
L_ca31:
    s_waitcnt vmcnt(17) lgkmcnt(0)
    s_barrier
    v_cmp_eq_u32 vcc, 1, v208
    s_nop 0
    s_lshr_b32 s42, vcc_lo, 16
    s_and_b32 s42, s42, vcc_lo
    s_lshr_b32 s43, s42, 8
    s_and_b32 s43, s43, s42
    s_andn2_b32 s43, s43, s63
    s_ff1_i32_b32 s42, s43
    s_mul_i32 s56, s42, 18432
    s_cmp_eq_u32 s43, 0
    s_cselect_b32 s56, s60, s56
    s_cselect_b32 s42, 7, s42
    s_bitset1_b32 s63, s42
    s_bitset0_b32 s43, s42
    buffer_load_dwordx4 v[58:61], v206, s[28:31], s56 offen offset:0 sc1
    buffer_load_dwordx4 v[62:65], v206, s[28:31], s56 offen offset:1024 sc1
    buffer_load_dwordx4 v[66:69], v206, s[28:31], s56 offen offset:2048 sc1
    s_waitcnt vmcnt(7) lgkmcnt(0)
    s_barrier
    buffer_load_dword v208, v205, s[28:31], 0 offen sc1
    s_cmp_eq_u32 s61, s60
    s_cbranch_scc1 L_ca40
    v_lshlrev_b32 v210, 16, v40
    v_and_b32 v40, 0xffff0000, v40
    v_add_f32 v4, v4, v210
    v_add_f32 v5, v5, v40
    v_lshlrev_b32 v211, 16, v41
    v_and_b32 v41, 0xffff0000, v41
    v_add_f32 v6, v6, v211
    v_add_f32 v7, v7, v41
    v_lshlrev_b32 v210, 16, v42
    v_and_b32 v42, 0xffff0000, v42
    v_add_f32 v8, v8, v210
    v_add_f32 v9, v9, v42
    v_lshlrev_b32 v211, 16, v43
    v_and_b32 v43, 0xffff0000, v43
    v_add_f32 v10, v10, v211
    v_add_f32 v11, v11, v43
    v_lshlrev_b32 v210, 16, v44
    v_and_b32 v44, 0xffff0000, v44
    v_add_f32 v12, v12, v210
    v_add_f32 v13, v13, v44
    v_lshlrev_b32 v211, 16, v45
    v_and_b32 v45, 0xffff0000, v45
    v_add_f32 v14, v14, v211
    v_add_f32 v15, v15, v45
    v_lshlrev_b32 v210, 16, v46
    v_and_b32 v46, 0xffff0000, v46
    v_add_f32 v16, v16, v210
    v_add_f32 v17, v17, v46
    v_lshlrev_b32 v211, 16, v47
    v_and_b32 v47, 0xffff0000, v47
    v_add_f32 v18, v18, v211
    v_add_f32 v19, v19, v47
    v_lshlrev_b32 v210, 16, v48
    v_and_b32 v48, 0xffff0000, v48
    v_add_f32 v20, v20, v210
    v_add_f32 v21, v21, v48
L_ca40:
    buffer_load_dwordx4 v[70:73], v206, s[28:31], s56 offen offset:3072 sc1
    buffer_load_dwordx2 v[74:75], v207, s[28:31], s56 offen sc1
    s_waitcnt vmcnt(2) lgkmcnt(0)
    s_barrier
    v_cmp_eq_u32 vcc, 1, v208
    s_nop 0
    s_lshr_b32 s42, vcc_lo, 16
    s_and_b32 s42, s42, vcc_lo
    s_lshr_b32 s43, s42, 8
    s_and_b32 s43, s43, s42
    s_andn2_b32 s43, s43, s63
    s_ff1_i32_b32 s42, s43
    s_mul_i32 s50, s42, 18432
    s_cmp_eq_u32 s43, 0
    s_cselect_b32 s50, s60, s50
    s_cselect_b32 s42, 7, s42
    s_bitset1_b32 s63, s42
    s_bitset0_b32 s43, s42
    buffer_load_dwordx4 v[76:79], v206, s[28:31], s50 offen offset:0 sc1
    buffer_load_dwordx4 v[80:83], v206, s[28:31], s50 offen offset:1024 sc1
    buffer_load_dwordx4 v[84:87], v206, s[28:31], s50 offen offset:2048 sc1
    buffer_load_dwordx4 v[88:91], v206, s[28:31], s50 offen offset:3072 sc1
    buffer_load_dwordx2 v[92:93], v207, s[28:31], s50 offen sc1
    s_ff1_i32_b32 s42, s43
    s_mul_i32 s51, s42, 18432
    s_cmp_eq_u32 s43, 0
    s_cselect_b32 s51, s60, s51
    s_cselect_b32 s42, 7, s42
    s_bitset1_b32 s63, s42
    s_bitset0_b32 s43, s42
    buffer_load_dwordx4 v[94:97], v206, s[28:31], s51 offen offset:0 sc1
    buffer_load_dwordx4 v[98:101], v206, s[28:31], s51 offen offset:1024 sc1
    buffer_load_dwordx4 v[102:105], v206, s[28:31], s51 offen offset:2048 sc1
    buffer_load_dwordx4 v[106:109], v206, s[28:31], s51 offen offset:3072 sc1
    buffer_load_dwordx2 v[110:111], v207, s[28:31], s51 offen sc1
    buffer_load_dword v208, v205, s[28:31], 0 offen sc1
    s_waitcnt vmcnt(11)
    s_cmp_eq_u32 s61, s60
    s_cbranch_scc1 L_cb4
    v_lshlrev_b32 v211, 16, v49
    v_and_b32 v49, 0xffff0000, v49
    v_add_f32 v22, v22, v211
    v_add_f32 v23, v23, v49
    v_lshlrev_b32 v210, 16, v50
    v_and_b32 v50, 0xffff0000, v50
    v_add_f32 v24, v24, v210
    v_add_f32 v25, v25, v50
    v_lshlrev_b32 v211, 16, v51
    v_and_b32 v51, 0xffff0000, v51
    v_add_f32 v26, v26, v211
    v_add_f32 v27, v27, v51
    v_lshlrev_b32 v210, 16, v52
    v_and_b32 v52, 0xffff0000, v52
    v_add_f32 v28, v28, v210
    v_add_f32 v29, v29, v52
    v_lshlrev_b32 v211, 16, v53
    v_and_b32 v53, 0xffff0000, v53
    v_add_f32 v30, v30, v211
    v_add_f32 v31, v31, v53
    v_lshlrev_b32 v210, 16, v54
    v_and_b32 v54, 0xffff0000, v54
    v_add_f32 v32, v32, v210
    v_add_f32 v33, v33, v54
    v_lshlrev_b32 v211, 16, v55
    v_and_b32 v55, 0xffff0000, v55
    v_add_f32 v34, v34, v211
    v_add_f32 v35, v35, v55
    v_lshlrev_b32 v210, 16, v56
    v_and_b32 v56, 0xffff0000, v56
    v_add_f32 v36, v36, v210
    v_add_f32 v37, v37, v56
    v_lshlrev_b32 v211, 16, v57
    v_and_b32 v57, 0xffff0000, v57
    v_add_f32 v38, v38, v211
    v_add_f32 v39, v39, v57
L_cb4:
    s_cmp_eq_u32 s56, s60
    s_cbranch_scc1 L_cb5
    v_lshlrev_b32 v210, 16, v58
    v_and_b32 v58, 0xffff0000, v58
    v_add_f32 v4, v4, v210
    v_add_f32 v5, v5, v58
    v_lshlrev_b32 v211, 16, v59
    v_and_b32 v59, 0xffff0000, v59
    v_add_f32 v6, v6, v211
    v_add_f32 v7, v7, v59
    v_lshlrev_b32 v210, 16, v60
    v_and_b32 v60, 0xffff0000, v60
    v_add_f32 v8, v8, v210
    v_add_f32 v9, v9, v60
    v_lshlrev_b32 v211, 16, v61
    v_and_b32 v61, 0xffff0000, v61
    v_add_f32 v10, v10, v211
    v_add_f32 v11, v11, v61
    v_lshlrev_b32 v210, 16, v62
    v_and_b32 v62, 0xffff0000, v62
    v_add_f32 v12, v12, v210
    v_add_f32 v13, v13, v62
    v_lshlrev_b32 v211, 16, v63
    v_and_b32 v63, 0xffff0000, v63
    v_add_f32 v14, v14, v211
    v_add_f32 v15, v15, v63
    v_lshlrev_b32 v210, 16, v64
    v_and_b32 v64, 0xffff0000, v64
    v_add_f32 v16, v16, v210
    v_add_f32 v17, v17, v64
    v_lshlrev_b32 v211, 16, v65
    v_and_b32 v65, 0xffff0000, v65
    v_add_f32 v18, v18, v211
    v_add_f32 v19, v19, v65
    v_lshlrev_b32 v210, 16, v66
    v_and_b32 v66, 0xffff0000, v66
    v_add_f32 v20, v20, v210
    v_add_f32 v21, v21, v66
    v_lshlrev_b32 v211, 16, v67
    v_and_b32 v67, 0xffff0000, v67
    v_add_f32 v22, v22, v211
    v_add_f32 v23, v23, v67
    v_lshlrev_b32 v210, 16, v68
    v_and_b32 v68, 0xffff0000, v68
    v_add_f32 v24, v24, v210
    v_add_f32 v25, v25, v68
    v_lshlrev_b32 v211, 16, v69
    v_and_b32 v69, 0xffff0000, v69
    v_add_f32 v26, v26, v211
    v_add_f32 v27, v27, v69
    v_lshlrev_b32 v210, 16, v70
    v_and_b32 v70, 0xffff0000, v70
    v_add_f32 v28, v28, v210
    v_add_f32 v29, v29, v70
    v_lshlrev_b32 v211, 16, v71
    v_and_b32 v71, 0xffff0000, v71
    v_add_f32 v30, v30, v211
    v_add_f32 v31, v31, v71
    v_lshlrev_b32 v210, 16, v72
    v_and_b32 v72, 0xffff0000, v72
    v_add_f32 v32, v32, v210
    v_add_f32 v33, v33, v72
    v_lshlrev_b32 v211, 16, v73
    v_and_b32 v73, 0xffff0000, v73
    v_add_f32 v34, v34, v211
    v_add_f32 v35, v35, v73
    v_lshlrev_b32 v210, 16, v74
    v_and_b32 v74, 0xffff0000, v74
    v_add_f32 v36, v36, v210
    v_add_f32 v37, v37, v74
    v_lshlrev_b32 v211, 16, v75
    v_and_b32 v75, 0xffff0000, v75
    v_add_f32 v38, v38, v211
    v_add_f32 v39, v39, v75
L_cb5:
    s_waitcnt vmcnt(0)
    v_cmp_eq_u32 vcc, 1, v208
    s_nop 0
    s_lshr_b32 s42, vcc_lo, 16
    s_and_b32 s42, s42, vcc_lo
    s_lshr_b32 s43, s42, 8
    s_and_b32 s43, s43, s42
    s_andn2_b32 s43, s43, s63
    s_ff1_i32_b32 s42, s43
    s_mul_i32 s53, s42, 18432
    s_cmp_eq_u32 s43, 0
    s_cselect_b32 s53, s60, s53
    s_cselect_b32 s42, 7, s42
    s_bitset1_b32 s63, s42
    s_bitset0_b32 s43, s42
    buffer_load_dwordx4 v[148:151], v206, s[28:31], s53 offen offset:0 sc1
    buffer_load_dwordx4 v[152:155], v206, s[28:31], s53 offen offset:1024 sc1
    buffer_load_dwordx4 v[156:159], v206, s[28:31], s53 offen offset:2048 sc1
    buffer_load_dwordx4 v[160:163], v206, s[28:31], s53 offen offset:3072 sc1
    buffer_load_dwordx2 v[164:165], v207, s[28:31], s53 offen sc1
    buffer_load_dword v208, v205, s[28:31], 0 offen sc1
    s_cmp_eq_u32 s50, s60
    s_cbranch_scc1 L_ce0
    v_lshlrev_b32 v210, 16, v76
    v_and_b32 v76, 0xffff0000, v76
    v_add_f32 v4, v4, v210
    v_add_f32 v5, v5, v76
    v_lshlrev_b32 v211, 16, v77
    v_and_b32 v77, 0xffff0000, v77
    v_add_f32 v6, v6, v211
    v_add_f32 v7, v7, v77
    v_lshlrev_b32 v210, 16, v78
    v_and_b32 v78, 0xffff0000, v78
    v_add_f32 v8, v8, v210
    v_add_f32 v9, v9, v78
    v_lshlrev_b32 v211, 16, v79
    v_and_b32 v79, 0xffff0000, v79
    v_add_f32 v10, v10, v211
    v_add_f32 v11, v11, v79
    v_lshlrev_b32 v210, 16, v80
    v_and_b32 v80, 0xffff0000, v80
    v_add_f32 v12, v12, v210
    v_add_f32 v13, v13, v80
    v_lshlrev_b32 v211, 16, v81
    v_and_b32 v81, 0xffff0000, v81
    v_add_f32 v14, v14, v211
    v_add_f32 v15, v15, v81
    v_lshlrev_b32 v210, 16, v82
    v_and_b32 v82, 0xffff0000, v82
    v_add_f32 v16, v16, v210
    v_add_f32 v17, v17, v82
    v_lshlrev_b32 v211, 16, v83
    v_and_b32 v83, 0xffff0000, v83
    v_add_f32 v18, v18, v211
    v_add_f32 v19, v19, v83
    v_lshlrev_b32 v210, 16, v84
    v_and_b32 v84, 0xffff0000, v84
    v_add_f32 v20, v20, v210
    v_add_f32 v21, v21, v84
    v_lshlrev_b32 v211, 16, v85
    v_and_b32 v85, 0xffff0000, v85
    v_add_f32 v22, v22, v211
    v_add_f32 v23, v23, v85
    v_lshlrev_b32 v210, 16, v86
    v_and_b32 v86, 0xffff0000, v86
    v_add_f32 v24, v24, v210
    v_add_f32 v25, v25, v86
    v_lshlrev_b32 v211, 16, v87
    v_and_b32 v87, 0xffff0000, v87
    v_add_f32 v26, v26, v211
    v_add_f32 v27, v27, v87
    v_lshlrev_b32 v210, 16, v88
    v_and_b32 v88, 0xffff0000, v88
    v_add_f32 v28, v28, v210
    v_add_f32 v29, v29, v88
    v_lshlrev_b32 v211, 16, v89
    v_and_b32 v89, 0xffff0000, v89
    v_add_f32 v30, v30, v211
    v_add_f32 v31, v31, v89
    v_lshlrev_b32 v210, 16, v90
    v_and_b32 v90, 0xffff0000, v90
    v_add_f32 v32, v32, v210
    v_add_f32 v33, v33, v90
    v_lshlrev_b32 v211, 16, v91
    v_and_b32 v91, 0xffff0000, v91
    v_add_f32 v34, v34, v211
    v_add_f32 v35, v35, v91
    v_lshlrev_b32 v210, 16, v92
    v_and_b32 v92, 0xffff0000, v92
    v_add_f32 v36, v36, v210
    v_add_f32 v37, v37, v92
    v_lshlrev_b32 v211, 16, v93
    v_and_b32 v93, 0xffff0000, v93
    v_add_f32 v38, v38, v211
    v_add_f32 v39, v39, v93
L_ce0:
    s_cmp_eq_u32 s51, s60
    s_cbranch_scc1 L_ce1
    v_lshlrev_b32 v210, 16, v94
    v_and_b32 v94, 0xffff0000, v94
    v_add_f32 v4, v4, v210
    v_add_f32 v5, v5, v94
    v_lshlrev_b32 v211, 16, v95
    v_and_b32 v95, 0xffff0000, v95
    v_add_f32 v6, v6, v211
    v_add_f32 v7, v7, v95
    v_lshlrev_b32 v210, 16, v96
    v_and_b32 v96, 0xffff0000, v96
    v_add_f32 v8, v8, v210
    v_add_f32 v9, v9, v96
    v_lshlrev_b32 v211, 16, v97
    v_and_b32 v97, 0xffff0000, v97
    v_add_f32 v10, v10, v211
    v_add_f32 v11, v11, v97
    v_lshlrev_b32 v210, 16, v98
    v_and_b32 v98, 0xffff0000, v98
    v_add_f32 v12, v12, v210
    v_add_f32 v13, v13, v98
    v_lshlrev_b32 v211, 16, v99
    v_and_b32 v99, 0xffff0000, v99
    v_add_f32 v14, v14, v211
    v_add_f32 v15, v15, v99
    v_lshlrev_b32 v210, 16, v100
    v_and_b32 v100, 0xffff0000, v100
    v_add_f32 v16, v16, v210
    v_add_f32 v17, v17, v100
    v_lshlrev_b32 v211, 16, v101
    v_and_b32 v101, 0xffff0000, v101
    v_add_f32 v18, v18, v211
    v_add_f32 v19, v19, v101
    v_lshlrev_b32 v210, 16, v102
    v_and_b32 v102, 0xffff0000, v102
    v_add_f32 v20, v20, v210
    v_add_f32 v21, v21, v102
    v_lshlrev_b32 v211, 16, v103
    v_and_b32 v103, 0xffff0000, v103
    v_add_f32 v22, v22, v211
    v_add_f32 v23, v23, v103
    v_lshlrev_b32 v210, 16, v104
    v_and_b32 v104, 0xffff0000, v104
    v_add_f32 v24, v24, v210
    v_add_f32 v25, v25, v104
    v_lshlrev_b32 v211, 16, v105
    v_and_b32 v105, 0xffff0000, v105
    v_add_f32 v26, v26, v211
    v_add_f32 v27, v27, v105
    v_lshlrev_b32 v210, 16, v106
    v_and_b32 v106, 0xffff0000, v106
    v_add_f32 v28, v28, v210
    v_add_f32 v29, v29, v106
    v_lshlrev_b32 v211, 16, v107
    v_and_b32 v107, 0xffff0000, v107
    v_add_f32 v30, v30, v211
    v_add_f32 v31, v31, v107
    v_lshlrev_b32 v210, 16, v108
    v_and_b32 v108, 0xffff0000, v108
    v_add_f32 v32, v32, v210
    v_add_f32 v33, v33, v108
    v_lshlrev_b32 v211, 16, v109
    v_and_b32 v109, 0xffff0000, v109
    v_add_f32 v34, v34, v211
    v_add_f32 v35, v35, v109
    v_lshlrev_b32 v210, 16, v110
    v_and_b32 v110, 0xffff0000, v110
    v_add_f32 v36, v36, v210
    v_add_f32 v37, v37, v110
    v_lshlrev_b32 v211, 16, v111
    v_and_b32 v111, 0xffff0000, v111
    v_add_f32 v38, v38, v211
    v_add_f32 v39, v39, v111
L_ce1:
    s_barrier
    s_mul_i32 s41, s36, 9216
    v_add_u32 v211, s41, v229
    ds_read_b128 v[168:171], v211 offset:0
    ds_read_b128 v[172:175], v211 offset:1024
    ds_read_b128 v[176:179], v211 offset:2048
    ds_read_b128 v[180:183], v211 offset:3072
    ds_read_b128 v[184:187], v211 offset:4096
    ds_read_b128 v[188:191], v211 offset:5120
    ds_read_b128 v[192:195], v211 offset:6144
    ds_read_b128 v[196:199], v211 offset:7168
    ds_read_b128 v[200:203], v214
    s_waitcnt lgkmcnt(0)
    s_mov_b32 s44, 2097152
L_fin:
    s_cmp_eq_u32 s63, -1
    s_cbranch_scc1 L_find
    s_waitcnt vmcnt(0)
    s_cmp_eq_u32 s53, s60
    s_cbranch_scc1 L_cf
    v_lshlrev_b32 v210, 16, v148
    v_and_b32 v148, 0xffff0000, v148
    v_add_f32 v4, v4, v210
    v_add_f32 v5, v5, v148
    v_lshlrev_b32 v211, 16, v149
    v_and_b32 v149, 0xffff0000, v149
    v_add_f32 v6, v6, v211
    v_add_f32 v7, v7, v149
    v_lshlrev_b32 v210, 16, v150
    v_and_b32 v150, 0xffff0000, v150
    v_add_f32 v8, v8, v210
    v_add_f32 v9, v9, v150
    v_lshlrev_b32 v211, 16, v151
    v_and_b32 v151, 0xffff0000, v151
    v_add_f32 v10, v10, v211
    v_add_f32 v11, v11, v151
    v_lshlrev_b32 v210, 16, v152
    v_and_b32 v152, 0xffff0000, v152
    v_add_f32 v12, v12, v210
    v_add_f32 v13, v13, v152
    v_lshlrev_b32 v211, 16, v153
    v_and_b32 v153, 0xffff0000, v153
    v_add_f32 v14, v14, v211
    v_add_f32 v15, v15, v153
    v_lshlrev_b32 v210, 16, v154
    v_and_b32 v154, 0xffff0000, v154
    v_add_f32 v16, v16, v210
    v_add_f32 v17, v17, v154
    v_lshlrev_b32 v211, 16, v155
    v_and_b32 v155, 0xffff0000, v155
    v_add_f32 v18, v18, v211
    v_add_f32 v19, v19, v155
    v_lshlrev_b32 v210, 16, v156
    v_and_b32 v156, 0xffff0000, v156
    v_add_f32 v20, v20, v210
    v_add_f32 v21, v21, v156
    v_lshlrev_b32 v211, 16, v157
    v_and_b32 v157, 0xffff0000, v157
    v_add_f32 v22, v22, v211
    v_add_f32 v23, v23, v157
    v_lshlrev_b32 v210, 16, v158
    v_and_b32 v158, 0xffff0000, v158
    v_add_f32 v24, v24, v210
    v_add_f32 v25, v25, v158
    v_lshlrev_b32 v211, 16, v159
    v_and_b32 v159, 0xffff0000, v159
    v_add_f32 v26, v26, v211
    v_add_f32 v27, v27, v159
    v_lshlrev_b32 v210, 16, v160
    v_and_b32 v160, 0xffff0000, v160
    v_add_f32 v28, v28, v210
    v_add_f32 v29, v29, v160
    v_lshlrev_b32 v211, 16, v161
    v_and_b32 v161, 0xffff0000, v161
    v_add_f32 v30, v30, v211
    v_add_f32 v31, v31, v161
    v_lshlrev_b32 v210, 16, v162
    v_and_b32 v162, 0xffff0000, v162
    v_add_f32 v32, v32, v210
    v_add_f32 v33, v33, v162
    v_lshlrev_b32 v211, 16, v163
    v_and_b32 v163, 0xffff0000, v163
    v_add_f32 v34, v34, v211
    v_add_f32 v35, v35, v163
    v_lshlrev_b32 v210, 16, v164
    v_and_b32 v164, 0xffff0000, v164
    v_add_f32 v36, v36, v210
    v_add_f32 v37, v37, v164
    v_lshlrev_b32 v211, 16, v165
    v_and_b32 v165, 0xffff0000, v165
    v_add_f32 v38, v38, v211
    v_add_f32 v39, v39, v165
L_cf:
L_finp:
    v_cmp_eq_u32 vcc, 1, v208
    s_nop 0
    s_lshr_b32 s42, vcc_lo, 16
    s_and_b32 s42, s42, vcc_lo
    s_lshr_b32 s43, s42, 8
    s_and_b32 s43, s43, s42
    s_andn2_b32 s43, s43, s63
    s_cbranch_scc1 L_fing
    s_sub_u32 s44, s44, 1
    s_cbranch_scc1 L_fing0
    buffer_load_dword v208, v205, s[28:31], 0 offen sc1
    s_waitcnt vmcnt(0)
    s_branch L_finp
L_fing0:
    s_mov_b32 s63, -1
L_fing:
    s_ff1_i32_b32 s42, s43
    s_mul_i32 s53, s42, 18432
    s_cmp_eq_u32 s43, 0
    s_cselect_b32 s53, s60, s53
    s_cselect_b32 s42, 7, s42
    s_bitset1_b32 s63, s42
    s_bitset0_b32 s43, s42
    buffer_load_dwordx4 v[148:151], v206, s[28:31], s53 offen offset:0 sc1
    buffer_load_dwordx4 v[152:155], v206, s[28:31], s53 offen offset:1024 sc1
    buffer_load_dwordx4 v[156:159], v206, s[28:31], s53 offen offset:2048 sc1
    buffer_load_dwordx4 v[160:163], v206, s[28:31], s53 offen offset:3072 sc1
    buffer_load_dwordx2 v[164:165], v207, s[28:31], s53 offen sc1
    buffer_load_dword v208, v205, s[28:31], 0 offen sc1
    s_branch L_fin
L_find:
    s_cmp_eq_u32 s53, s60
    s_cbranch_scc1 L_cz0
    s_waitcnt vmcnt(4)
    v_lshlrev_b32 v210, 16, v148
    v_and_b32 v148, 0xffff0000, v148
    v_add_f32 v4, v4, v210
    v_add_f32 v5, v5, v148
    v_lshlrev_b32 v211, 16, v149
    v_and_b32 v149, 0xffff0000, v149
    v_add_f32 v6, v6, v211
    v_add_f32 v7, v7, v149
    v_lshlrev_b32 v210, 16, v150
    v_and_b32 v150, 0xffff0000, v150
    v_add_f32 v8, v8, v210
    v_add_f32 v9, v9, v150
    v_lshlrev_b32 v211, 16, v151
    v_and_b32 v151, 0xffff0000, v151
    v_add_f32 v10, v10, v211
    v_add_f32 v11, v11, v151
    v_lshlrev_b32 v210, 16, v152
    v_and_b32 v152, 0xffff0000, v152
    v_add_f32 v12, v12, v210
    v_add_f32 v13, v13, v152
    v_lshlrev_b32 v211, 16, v153
    v_and_b32 v153, 0xffff0000, v153
    v_add_f32 v14, v14, v211
    v_add_f32 v15, v15, v153
    v_lshlrev_b32 v210, 16, v154
    v_and_b32 v154, 0xffff0000, v154
    v_add_f32 v16, v16, v210
    v_add_f32 v17, v17, v154
    v_lshlrev_b32 v211, 16, v155
    v_and_b32 v155, 0xffff0000, v155
    v_add_f32 v18, v18, v211
    v_add_f32 v19, v19, v155
L_cz0:
    v_pk_add_f32 v[4:5], v[4:5], v[168:169]
    v_pk_add_f32 v[6:7], v[6:7], v[170:171]
    v_pk_add_f32 v[8:9], v[8:9], v[172:173]
    v_pk_add_f32 v[10:11], v[10:11], v[174:175]
    v_pk_add_f32 v[12:13], v[12:13], v[176:177]
    v_pk_add_f32 v[14:15], v[14:15], v[178:179]
    v_pk_add_f32 v[16:17], v[16:17], v[180:181]
    v_pk_add_f32 v[18:19], v[18:19], v[182:183]
    v_cvt_pk_bf16_f32 v4, v4, v5
    v_cvt_pk_bf16_f32 v5, v6, v7
    v_cvt_pk_bf16_f32 v6, v8, v9
    v_cvt_pk_bf16_f32 v7, v10, v11
    v_cvt_pk_bf16_f32 v12, v12, v13
    v_cvt_pk_bf16_f32 v13, v14, v15
    v_cvt_pk_bf16_f32 v14, v16, v17
    v_cvt_pk_bf16_f32 v15, v18, v19
    v_permlane16_swap_b32 v4, v6
    v_permlane16_swap_b32 v5, v7
    v_permlane16_swap_b32 v12, v14
    v_permlane16_swap_b32 v13, v15
    v_mov_b32 v8, v4
    v_mov_b32 v9, v5
    v_mov_b32 v10, v6
    v_mov_b32 v11, v7
    v_mov_b32_dpp v4, v12 row_ror:8 row_mask:0xf bank_mask:0xc
    v_mov_b32_dpp v5, v13 row_ror:8 row_mask:0xf bank_mask:0xc
    v_mov_b32_dpp v6, v14 row_ror:8 row_mask:0xf bank_mask:0xc
    v_mov_b32_dpp v7, v15 row_ror:8 row_mask:0xf bank_mask:0xc
    v_mov_b32_dpp v12, v8 row_ror:8 row_mask:0xf bank_mask:0x3
    v_mov_b32_dpp v13, v9 row_ror:8 row_mask:0xf bank_mask:0x3
    v_mov_b32_dpp v14, v10 row_ror:8 row_mask:0xf bank_mask:0x3
    v_mov_b32_dpp v15, v11 row_ror:8 row_mask:0xf bank_mask:0x3
    s_mov_b32 s41, 0
    buffer_store_dwordx4 v[4:7], v212, s[24:27], s41 offen sc1
    s_mov_b32 s41, 16384
    buffer_store_dwordx4 v[12:15], v212, s[24:27], s41 offen sc1
    s_cmp_eq_u32 s53, s60
    s_cbranch_scc1 L_cz1
    s_waitcnt vmcnt(3)
    v_lshlrev_b32 v210, 16, v156
    v_and_b32 v156, 0xffff0000, v156
    v_add_f32 v20, v20, v210
    v_add_f32 v21, v21, v156
    v_lshlrev_b32 v211, 16, v157
    v_and_b32 v157, 0xffff0000, v157
    v_add_f32 v22, v22, v211
    v_add_f32 v23, v23, v157
    v_lshlrev_b32 v210, 16, v158
    v_and_b32 v158, 0xffff0000, v158
    v_add_f32 v24, v24, v210
    v_add_f32 v25, v25, v158
    v_lshlrev_b32 v211, 16, v159
    v_and_b32 v159, 0xffff0000, v159
    v_add_f32 v26, v26, v211
    v_add_f32 v27, v27, v159
    v_lshlrev_b32 v210, 16, v160
    v_and_b32 v160, 0xffff0000, v160
    v_add_f32 v28, v28, v210
    v_add_f32 v29, v29, v160
    v_lshlrev_b32 v211, 16, v161
    v_and_b32 v161, 0xffff0000, v161
    v_add_f32 v30, v30, v211
    v_add_f32 v31, v31, v161
    v_lshlrev_b32 v210, 16, v162
    v_and_b32 v162, 0xffff0000, v162
    v_add_f32 v32, v32, v210
    v_add_f32 v33, v33, v162
    v_lshlrev_b32 v211, 16, v163
    v_and_b32 v163, 0xffff0000, v163
    v_add_f32 v34, v34, v211
    v_add_f32 v35, v35, v163
    v_lshlrev_b32 v210, 16, v164
    v_and_b32 v164, 0xffff0000, v164
    v_add_f32 v36, v36, v210
    v_add_f32 v37, v37, v164
    v_lshlrev_b32 v211, 16, v165
    v_and_b32 v165, 0xffff0000, v165
    v_add_f32 v38, v38, v211
    v_add_f32 v39, v39, v165
L_cz1:
    v_pk_add_f32 v[20:21], v[20:21], v[184:185]
    v_pk_add_f32 v[22:23], v[22:23], v[186:187]
    v_pk_add_f32 v[24:25], v[24:25], v[188:189]
    v_pk_add_f32 v[26:27], v[26:27], v[190:191]
    v_pk_add_f32 v[28:29], v[28:29], v[192:193]
    v_pk_add_f32 v[30:31], v[30:31], v[194:195]
    v_pk_add_f32 v[32:33], v[32:33], v[196:197]
    v_pk_add_f32 v[34:35], v[34:35], v[198:199]
    v_cvt_pk_bf16_f32 v20, v20, v21
    v_cvt_pk_bf16_f32 v21, v22, v23
    v_cvt_pk_bf16_f32 v22, v24, v25
    v_cvt_pk_bf16_f32 v23, v26, v27
    v_cvt_pk_bf16_f32 v28, v28, v29
    v_cvt_pk_bf16_f32 v29, v30, v31
    v_cvt_pk_bf16_f32 v30, v32, v33
    v_cvt_pk_bf16_f32 v31, v34, v35
    v_permlane16_swap_b32 v20, v22
    v_permlane16_swap_b32 v21, v23
    v_permlane16_swap_b32 v28, v30
    v_permlane16_swap_b32 v29, v31
    v_mov_b32 v24, v20
    v_mov_b32 v25, v21
    v_mov_b32 v26, v22
    v_mov_b32 v27, v23
    v_mov_b32_dpp v20, v28 row_ror:8 row_mask:0xf bank_mask:0xc
    v_mov_b32_dpp v21, v29 row_ror:8 row_mask:0xf bank_mask:0xc
    v_mov_b32_dpp v22, v30 row_ror:8 row_mask:0xf bank_mask:0xc
    v_mov_b32_dpp v23, v31 row_ror:8 row_mask:0xf bank_mask:0xc
    v_mov_b32_dpp v28, v24 row_ror:8 row_mask:0xf bank_mask:0x3
    v_mov_b32_dpp v29, v25 row_ror:8 row_mask:0xf bank_mask:0x3
    v_mov_b32_dpp v30, v26 row_ror:8 row_mask:0xf bank_mask:0x3
    v_mov_b32_dpp v31, v27 row_ror:8 row_mask:0xf bank_mask:0x3
    s_mov_b32 s41, 32768
    buffer_store_dwordx4 v[20:23], v212, s[24:27], s41 offen sc1
    s_mov_b32 s41, 49152
    buffer_store_dwordx4 v[28:31], v212, s[24:27], s41 offen sc1
    v_pk_add_f32 v[36:37], v[36:37], v[200:201]
    v_pk_add_f32 v[38:39], v[38:39], v[202:203]
    v_cvt_pk_bf16_f32 v36, v36, v37
    v_cvt_pk_bf16_f32 v37, v38, v39
    buffer_store_dwordx2 v[36:37], v213, s[24:27], 0 offen sc1
    s_endpgm
    .p2align 12
L_B:
    s_setprio 1
    s_waitcnt lgkmcnt(0)
    s_add_u32 s12, s12, s50
    s_addc_u32 s13, s13, 0
    s_add_u32 s4, s4, s52
    s_addc_u32 s5, s5, 0
    s_add_u32 s8, s8, s52
    s_addc_u32 s9, s9, 0
    s_add_u32 s24, s24, s53
    s_addc_u32 s25, s25, 0
    v_and_b32 v204, 15, v0
    v_lshrrev_b32 v205, 4, v0
    s_and_b32 s41, s36, 1
    s_lshr_b32 s42, s36, 1
    s_lshl_b32 s43, s41, 3
    v_lshlrev_b32 v206, 1, v205
    v_add_u32 v206, s43, v206
    v_xor_b32 v206, v206, v204
    v_lshlrev_b32 v206, 4, v206
    v_lshl_add_u32 v253, v205, 13, v206
    s_lshl_b32 s43, s36, 16
    v_add_u32 v253, s43, v253
    v_lshl_add_u32 v252, v205, 8, v206
    v_add_u32 v252, s45, v252
    v_lshrrev_b32 v206, 3, v0
    v_and_b32 v207, 7, v0
    v_and_b32 v242, 6, v206
    v_xor_b32 v242, v242, v207
    v_lshlrev_b32 v242, 4, v242
    v_lshl_add_u32 v242, v206, 10, v242
    s_lshl_b32 s43, s36, 15
    v_add_u32 v242, s43, v242
    v_xor_b32 v254, v205, v207
    v_lshlrev_b32 v254, 4, v254
    v_lshl_add_u32 v254, v206, 10, v254
    s_lshl_b32 s43, s41, 13
    s_lshl_b32 s44, s42, 7
    s_add_u32 s43, s43, s44
    s_add_u32 s43, s43, 131072
    v_add_u32 v254, s43, v254
    s_lshr_b32 s57, s88, 9
    s_lshl_b32 s41, s95, 12
    s_add_u32 s57, s57, s41
    s_lshl_b32 s61, s36, 12
    s_add_u32 s55, s57, 786688
    s_and_b32 s55, s55, 0x3fffff
    v_and_b32 v206, 6, v0
    v_xor_b32 v206, v206, v205
    v_lshlrev_b32 v206, 4, v206
    v_lshl_add_u32 v206, v204, 7, v206
    s_lshl_b32 s41, s36, 12
    v_add_u32 v240, s41, v206
    v_xor_b32 v241, 64, v240
    v_bfe_u32 v206, v0, 1, 2
    v_xor_b32 v206, v206, v205
    v_lshlrev_b32 v206, 4, v206
    v_lshl_add_u32 v206, v204, 7, v206
    v_add_u32 v3, 147456, v206
    v_bfe_u32 v206, v0, 2, 3
    s_lshl_b32 s41, s36, 1
    v_xor_b32 v206, s41, v206
    v_lshlrev_b32 v206, 5, v206
    v_lshl_add_u32 v206, v205, 11, v206
    v_bfe_u32 v207, v0, 2, 2
    v_lshl_add_u32 v206, v207, 8, v206
    v_and_b32 v207, 3, v0
    v_lshl_add_u32 v206, v207, 3, v206
    v_add_u32 v206, 65536, v206
    v_xor_b32 v244, 0, v206
    v_xor_b32 v245, 32, v206
    v_xor_b32 v246, 64, v206
    v_xor_b32 v247, 96, v206
    v_xor_b32 v248, 128, v206
    v_xor_b32 v249, 160, v206
    v_xor_b32 v250, 192, v206
    v_xor_b32 v251, 224, v206
    v_lshrrev_b32 v206, 1, v205
    v_lshl_add_u32 v206, v206, 4, v204
    v_lshlrev_b32 v206, 4, v206
    v_and_b32 v205, 1, v205
    v_lshl_add_u32 v206, v205, 3, v206
    v_add_u32 v2, 114688, v206
    v_lshlrev_b32 v0, 4, v0
    s_mov_b32 s58, 0x3e0293ee
    s_mov_b32 s59, 0x3e0293ee
    s_add_u32 s54, s88, 24576
    s_add_u32 s63, s88, 8192
    s_sub_u32 s60, s89, s88
    s_ashr_i32 s60, s60, 9
    s_add_u32 s60, s60, 261888
    s_xor_b32 s50, s47, 0
    s_add_u32 s50, s50, s48
    s_xor_b32 s51, s47, 1024
    s_add_u32 s51, s51, s48
    s_xor_b32 s52, s47, 2048
    s_add_u32 s52, s52, s48
    s_xor_b32 s53, s47, 3072
    s_add_u32 s53, s53, s48
    s_waitcnt lgkmcnt(0)
    s_barrier
    s_add_u32 m0, s46, 16384
    s_add_u32 s41, s57, 524288
    s_and_b32 s41, s41, 0x3fffff
    buffer_load_dwordx4 v253, s[16:19], s41 offen  lds
    s_add_u32 s41, s41, 31744
    buffer_load_dwordx4 v253, s[16:19], s41 offen offset:1024  lds
    ds_read_b128 v[220:223], v3 offset:4096
    ds_read_b64_tr_b16 v[224:225], v244 offset:0
    ds_read_b64_tr_b16 v[226:227], v244 offset:1024
    s_add_u32 m0, s46, 24576
    s_add_u32 s41, s57, 786432
    s_and_b32 s41, s41, 0x3fffff
    buffer_load_dwordx4 v253, s[16:19], s41 offen  lds
    ds_read_b64_tr_b16 v[228:229], v245 offset:0
    ds_read_b64_tr_b16 v[230:231], v245 offset:1024
    ds_read_b128 v[204:207], v3 offset:4160
    s_add_u32 s41, s41, 31744
    buffer_load_dwordx4 v253, s[16:19], s41 offen offset:1024  lds
    ds_read_b64_tr_b16 v[232:233], v244 offset:8192
    ds_read_b64_tr_b16 v[234:235], v244 offset:9216
    ds_read_b64_tr_b16 v[236:237], v245 offset:8192
    s_add_u32 m0, s61, 32768
    s_add_u32 s41, s95, 256
    s_and_b32 s41, s41, 0x3ff
    buffer_load_dwordx4 v242, s[12:15], s41 offen  lds
    ds_read_b64_tr_b16 v[238:239], v245 offset:9216
    ds_read_b128 v[4:7], v240 offset:0
    ds_read_b128 v[68:71], v240 offset:2048
    s_add_u32 s41, s41, 7168
    buffer_load_dwordx4 v242, s[12:15], s41 offen offset:1024  lds
    ds_read_b128 v[8:11], v241 offset:0
    ds_read_b128 v[72:75], v241 offset:2048
    s_waitcnt lgkmcnt(11)
    v_mfma_f32_16x16x32_bf16 v[196:199], v[224:227], v[220:223], 0
    s_add_u32 s41, s41, 7168
    buffer_load_dwordx4 v242, s[12:15], s41 offen offset:2048  lds
    s_waitcnt lgkmcnt(9)
    v_mfma_f32_16x16x32_bf16 v[200:203], v[228:231], v[220:223], 0
    s_waitcnt lgkmcnt(6)
    v_mfma_f32_16x16x32_bf16 v[196:199], v[232:235], v[204:207], v[196:199]
    s_waitcnt lgkmcnt(4)
    v_mfma_f32_16x16x32_bf16 v[200:203], v[236:239], v[204:207], v[200:203]
    s_add_u32 s41, s41, 7168
    buffer_load_dwordx4 v242, s[12:15], s41 offen offset:3072  lds
    s_add_u32 m0, s47, 155648
    s_add_u32 s41, s95, 256
    s_and_b32 s41, s41, 0x3ff
    buffer_load_dwordx4 v254, s[12:15], s41 offen  lds
    s_add_u32 m0, s46, 49152
    s_add_u32 s41, s57, 1048576
    s_and_b32 s41, s41, 0x3fffff
    buffer_load_dwordx4 v253, s[16:19], s41 offen  lds
    s_add_u32 s41, s41, 31744
    buffer_load_dwordx4 v253, s[16:19], s41 offen offset:1024  lds
    s_add_u32 m0, s46, 57344
    s_add_u32 s41, s57, 1310720
    s_and_b32 s41, s41, 0x3fffff
    buffer_load_dwordx4 v253, s[16:19], s41 offen  lds
    s_add_u32 s41, s41, 31744
    buffer_load_dwordx4 v253, s[16:19], s41 offen offset:1024  lds
    s_add_u32 m0, s61, 49152
    s_add_u32 s41, s95, 384
    s_and_b32 s41, s41, 0x3ff
    buffer_load_dwordx4 v242, s[12:15], s41 offen  lds
    s_add_u32 s41, s41, 7168
    buffer_load_dwordx4 v242, s[12:15], s41 offen offset:1024  lds
    s_add_u32 s41, s41, 7168
    buffer_load_dwordx4 v242, s[12:15], s41 offen offset:2048  lds
    s_add_u32 s41, s41, 7168
    buffer_load_dwordx4 v242, s[12:15], s41 offen offset:3072  lds
    s_waitcnt vmcnt(13) lgkmcnt(0)
    s_barrier
    s_add_u32 m0, s46, 32768
    s_add_u32 s41, s57, 1572864
    s_and_b32 s41, s41, 0x3fffff
    buffer_load_dwordx4 v253, s[16:19], s41 offen  lds
    s_add_u32 s41, s41, 31744
    buffer_load_dwordx4 v253, s[16:19], s41 offen offset:1024  lds
    ds_read_b128 v[220:223], v3 offset:6144
    ds_read_b64_tr_b16 v[224:225], v244 offset:16384
    ds_read_b64_tr_b16 v[226:227], v244 offset:17408
    s_add_u32 m0, s46, 40960
    s_add_u32 s41, s57, 1835008
    s_and_b32 s41, s41, 0x3fffff
    buffer_load_dwordx4 v253, s[16:19], s41 offen  lds
    ds_read_b64_tr_b16 v[228:229], v245 offset:16384
    ds_read_b64_tr_b16 v[230:231], v245 offset:17408
    ds_read_b128 v[204:207], v3 offset:6208
    s_add_u32 s41, s41, 31744
    buffer_load_dwordx4 v253, s[16:19], s41 offen offset:1024  lds
    ds_read_b64_tr_b16 v[232:233], v244 offset:24576
    ds_read_b64_tr_b16 v[234:235], v244 offset:25600
    ds_read_b64_tr_b16 v[236:237], v245 offset:24576
    s_add_u32 m0, s61, 0
    s_add_u32 s41, s95, 512
    s_and_b32 s41, s41, 0x3ff
    buffer_load_dwordx4 v242, s[12:15], s41 offen  lds
    ds_read_b64_tr_b16 v[238:239], v245 offset:25600
    ds_read_b128 v[12:15], v240 offset:16384
    ds_read_b128 v[76:79], v240 offset:18432
    s_add_u32 s41, s41, 7168
    buffer_load_dwordx4 v242, s[12:15], s41 offen offset:1024  lds
    ds_read_b128 v[16:19], v241 offset:16384
    ds_read_b128 v[80:83], v241 offset:18432
    s_waitcnt lgkmcnt(11)
    v_mfma_f32_16x16x32_bf16 v[196:199], v[224:227], v[220:223], v[196:199]
    s_add_u32 s41, s41, 7168
    buffer_load_dwordx4 v242, s[12:15], s41 offen offset:2048  lds
    s_waitcnt lgkmcnt(9)
    v_mfma_f32_16x16x32_bf16 v[200:203], v[228:231], v[220:223], v[200:203]
    s_waitcnt lgkmcnt(6)
    v_mfma_f32_16x16x32_bf16 v[196:199], v[232:235], v[204:207], v[196:199]
    s_waitcnt lgkmcnt(4)
    v_mfma_f32_16x16x32_bf16 v[200:203], v[236:239], v[204:207], v[200:203]
    s_add_u32 s41, s41, 7168
    buffer_load_dwordx4 v242, s[12:15], s41 offen offset:3072  lds
    s_add_u32 m0, s47, 147456
    s_add_u32 s41, s95, 512
    s_and_b32 s41, s41, 0x3ff
    buffer_load_dwordx4 v254, s[12:15], s41 offen  lds
    s_add_u32 m0, s46, 0
    s_add_u32 s41, s57, 2097152
    s_and_b32 s41, s41, 0x3fffff
    buffer_load_dwordx4 v253, s[16:19], s41 offen  lds
    s_add_u32 s41, s41, 31744
    buffer_load_dwordx4 v253, s[16:19], s41 offen offset:1024  lds
    s_add_u32 m0, s46, 8192
    s_add_u32 s41, s57, 2359296
    s_and_b32 s41, s41, 0x3fffff
    buffer_load_dwordx4 v253, s[16:19], s41 offen  lds
    s_add_u32 s41, s41, 31744
    buffer_load_dwordx4 v253, s[16:19], s41 offen offset:1024  lds
    s_waitcnt vmcnt(17) lgkmcnt(0)
    s_barrier
    s_add_u32 m0, s61, 16384
    s_add_u32 s41, s95, 640
    s_and_b32 s41, s41, 0x3ff
    buffer_load_dwordx4 v242, s[12:15], s41 offen  lds
    s_add_u32 s41, s41, 7168
    buffer_load_dwordx4 v242, s[12:15], s41 offen offset:1024  lds
    ds_read_b128 v[220:223], v3 offset:8192
    ds_read_b64_tr_b16 v[224:225], v244 offset:49152
    ds_read_b64_tr_b16 v[226:227], v244 offset:50176
    s_add_u32 s41, s41, 7168
    buffer_load_dwordx4 v242, s[12:15], s41 offen offset:2048  lds
    ds_read_b64_tr_b16 v[228:229], v245 offset:49152
    ds_read_b64_tr_b16 v[230:231], v245 offset:50176
    ds_read_b128 v[204:207], v3 offset:8256
    s_add_u32 s41, s41, 7168
    buffer_load_dwordx4 v242, s[12:15], s41 offen offset:3072  lds
    ds_read_b64_tr_b16 v[232:233], v244 offset:57344
    ds_read_b64_tr_b16 v[234:235], v244 offset:58368
    ds_read_b64_tr_b16 v[236:237], v245 offset:57344
    s_add_u32 m0, s46, 16384
    s_add_u32 s41, s57, 2621440
    s_and_b32 s41, s41, 0x3fffff
    buffer_load_dwordx4 v253, s[16:19], s41 offen  lds
    ds_read_b64_tr_b16 v[238:239], v245 offset:58368
    ds_read_b128 v[20:23], v240 offset:32768
    ds_read_b128 v[84:87], v240 offset:34816
    s_add_u32 s41, s41, 31744
    buffer_load_dwordx4 v253, s[16:19], s41 offen offset:1024  lds
    ds_read_b128 v[24:27], v241 offset:32768
    ds_read_b128 v[88:91], v241 offset:34816
    s_waitcnt lgkmcnt(11)
    v_mfma_f32_16x16x32_bf16 v[196:199], v[224:227], v[220:223], v[196:199]
    s_add_u32 m0, s46, 24576
    s_add_u32 s41, s57, 2883584
    s_and_b32 s41, s41, 0x3fffff
    buffer_load_dwordx4 v253, s[16:19], s41 offen  lds
    s_waitcnt lgkmcnt(9)
    v_mfma_f32_16x16x32_bf16 v[200:203], v[228:231], v[220:223], v[200:203]
    s_waitcnt lgkmcnt(6)
    v_mfma_f32_16x16x32_bf16 v[196:199], v[232:235], v[204:207], v[196:199]
    s_waitcnt lgkmcnt(4)
    v_mfma_f32_16x16x32_bf16 v[200:203], v[236:239], v[204:207], v[200:203]
    s_add_u32 s41, s41, 31744
    buffer_load_dwordx4 v253, s[16:19], s41 offen offset:1024  lds
    s_waitcnt vmcnt(17) lgkmcnt(0)
    s_barrier
    s_add_u32 m0, s61, 32768
    s_add_u32 s41, s95, 768
    s_and_b32 s41, s41, 0x3ff
    buffer_load_dwordx4 v242, s[12:15], s41 offen  lds
    s_add_u32 s41, s41, 7168
    buffer_load_dwordx4 v242, s[12:15], s41 offen offset:1024  lds
    ds_read_b128 v[220:223], v3 offset:10240
    ds_read_b64_tr_b16 v[224:225], v244 offset:32768
    ds_read_b64_tr_b16 v[226:227], v244 offset:33792
    s_add_u32 s41, s41, 7168
    buffer_load_dwordx4 v242, s[12:15], s41 offen offset:2048  lds
    ds_read_b64_tr_b16 v[228:229], v245 offset:32768
    ds_read_b64_tr_b16 v[230:231], v245 offset:33792
    ds_read_b128 v[204:207], v3 offset:10304
    s_add_u32 s41, s41, 7168
    buffer_load_dwordx4 v242, s[12:15], s41 offen offset:3072  lds
    ds_read_b64_tr_b16 v[232:233], v244 offset:40960
    ds_read_b64_tr_b16 v[234:235], v244 offset:41984
    ds_read_b64_tr_b16 v[236:237], v245 offset:40960
    s_add_u32 m0, s47, 159744
    s_add_u32 s41, s95, 768
    s_and_b32 s41, s41, 0x3ff
    buffer_load_dwordx4 v254, s[12:15], s41 offen  lds
    ds_read_b64_tr_b16 v[238:239], v245 offset:41984
    ds_read_b128 v[28:31], v240 offset:49152
    ds_read_b128 v[92:95], v240 offset:51200
    s_add_u32 m0, s46, 49152
    s_add_u32 s41, s57, 3145728
    s_and_b32 s41, s41, 0x3fffff
    buffer_load_dwordx4 v253, s[16:19], s41 offen  lds
    ds_read_b128 v[32:35], v241 offset:49152
    ds_read_b128 v[96:99], v241 offset:51200
    s_waitcnt lgkmcnt(11)
    v_mfma_f32_16x16x32_bf16 v[196:199], v[224:227], v[220:223], v[196:199]
    s_add_u32 s41, s41, 31744
    buffer_load_dwordx4 v253, s[16:19], s41 offen offset:1024  lds
    s_waitcnt lgkmcnt(9)
    v_mfma_f32_16x16x32_bf16 v[200:203], v[228:231], v[220:223], v[200:203]
    s_waitcnt lgkmcnt(6)
    v_mfma_f32_16x16x32_bf16 v[196:199], v[232:235], v[204:207], v[196:199]
    s_waitcnt lgkmcnt(4)
    v_mfma_f32_16x16x32_bf16 v[200:203], v[236:239], v[204:207], v[200:203]
    s_add_u32 m0, s46, 57344
    s_add_u32 s41, s57, 3407872
    s_and_b32 s41, s41, 0x3fffff
    buffer_load_dwordx4 v253, s[16:19], s41 offen  lds
    s_add_u32 s41, s41, 31744
    buffer_load_dwordx4 v253, s[16:19], s41 offen offset:1024  lds
    s_waitcnt vmcnt(17) lgkmcnt(0)
    s_barrier
    s_add_u32 m0, s61, 49152
    s_add_u32 s41, s95, 896
    s_and_b32 s41, s41, 0x3ff
    buffer_load_dwordx4 v242, s[12:15], s41 offen  lds
    s_add_u32 s41, s41, 7168
    buffer_load_dwordx4 v242, s[12:15], s41 offen offset:1024  lds
    ds_read_b128 v[220:223], v3 offset:0
    ds_read_b64_tr_b16 v[224:225], v244 offset:0
    ds_read_b64_tr_b16 v[226:227], v244 offset:1024
    s_add_u32 s41, s41, 7168
    buffer_load_dwordx4 v242, s[12:15], s41 offen offset:2048  lds
    ds_read_b64_tr_b16 v[228:229], v245 offset:0
    ds_read_b64_tr_b16 v[230:231], v245 offset:1024
    ds_read_b128 v[204:207], v3 offset:64
    s_add_u32 s41, s41, 7168
    buffer_load_dwordx4 v242, s[12:15], s41 offen offset:3072  lds
    ds_read_b64_tr_b16 v[232:233], v244 offset:8192
    ds_read_b64_tr_b16 v[234:235], v244 offset:9216
    ds_read_b64_tr_b16 v[236:237], v245 offset:8192
    s_add_u32 m0, s46, 32768
    s_add_u32 s41, s57, 3670016
    s_and_b32 s41, s41, 0x3fffff
    buffer_load_dwordx4 v253, s[16:19], s41 offen  lds
    ds_read_b64_tr_b16 v[238:239], v245 offset:9216
    ds_read_b128 v[36:39], v240 offset:0
    ds_read_b128 v[100:103], v240 offset:2048
    s_add_u32 s41, s41, 31744
    buffer_load_dwordx4 v253, s[16:19], s41 offen offset:1024  lds
    ds_read_b128 v[40:43], v241 offset:0
    ds_read_b128 v[104:107], v241 offset:2048
    s_waitcnt lgkmcnt(11)
    v_mfma_f32_16x16x32_bf16 v[196:199], v[224:227], v[220:223], v[196:199]
    s_add_u32 m0, s46, 40960
    s_add_u32 s41, s57, 3932160
    s_and_b32 s41, s41, 0x3fffff
    buffer_load_dwordx4 v253, s[16:19], s41 offen  lds
    s_waitcnt lgkmcnt(9)
    v_mfma_f32_16x16x32_bf16 v[200:203], v[228:231], v[220:223], v[200:203]
    s_waitcnt lgkmcnt(6)
    v_mfma_f32_16x16x32_bf16 v[196:199], v[232:235], v[204:207], v[196:199]
    s_waitcnt lgkmcnt(4)
    v_mfma_f32_16x16x32_bf16 v[200:203], v[236:239], v[204:207], v[200:203]
    s_add_u32 s41, s41, 31744
    buffer_load_dwordx4 v253, s[16:19], s41 offen offset:1024  lds
    s_waitcnt vmcnt(17) lgkmcnt(0)
    s_barrier
    s_add_u32 m0, s46, 0
    s_add_u32 s41, s57, 256
    s_and_b32 s41, s41, 0x3fffff
    buffer_load_dwordx4 v253, s[16:19], s41 offen  lds
    s_add_u32 s41, s41, 31744
    buffer_load_dwordx4 v253, s[16:19], s41 offen offset:1024  lds
    ds_read_b128 v[220:223], v3 offset:2048
    ds_read_b64_tr_b16 v[224:225], v244 offset:16384
    ds_read_b64_tr_b16 v[226:227], v244 offset:17408
    s_add_u32 m0, s45, 0
    s_add_u32 s41, s88, 0
    buffer_load_dwordx4 v252, s[4:7], s41 offen nt lds
    ds_read_b64_tr_b16 v[228:229], v245 offset:16384
    ds_read_b64_tr_b16 v[230:231], v245 offset:17408
    ds_read_b128 v[204:207], v3 offset:2112
    buffer_load_dwordx4 v252, s[4:7], s41 offen offset:2048 nt lds
    ds_read_b64_tr_b16 v[232:233], v244 offset:24576
    ds_read_b64_tr_b16 v[234:235], v244 offset:25600
    ds_read_b64_tr_b16 v[236:237], v245 offset:24576
    s_add_u32 m0, s45, 8192
    s_add_u32 s41, s88, 8192
    buffer_load_dwordx4 v252, s[4:7], s41 offen nt lds
    ds_read_b64_tr_b16 v[238:239], v245 offset:25600
    ds_read_b128 v[44:47], v240 offset:16384
    ds_read_b128 v[108:111], v240 offset:18432
    buffer_load_dwordx4 v252, s[4:7], s41 offen offset:2048 nt lds
    ds_read_b128 v[48:51], v241 offset:16384
    ds_read_b128 v[112:115], v241 offset:18432
    s_waitcnt lgkmcnt(11)
    v_mfma_f32_16x16x32_bf16 v[196:199], v[224:227], v[220:223], v[196:199]
    s_add_u32 m0, s46, 8192
    s_add_u32 s41, s57, 262400
    s_and_b32 s41, s41, 0x3fffff
    buffer_load_dwordx4 v253, s[16:19], s41 offen  lds
    s_waitcnt lgkmcnt(9)
    v_mfma_f32_16x16x32_bf16 v[200:203], v[228:231], v[220:223], v[200:203]
    s_waitcnt lgkmcnt(6)
    v_mfma_f32_16x16x32_bf16 v[196:199], v[232:235], v[204:207], v[196:199]
    s_waitcnt lgkmcnt(4)
    v_mfma_f32_16x16x32_bf16 v[200:203], v[236:239], v[204:207], v[200:203]
    s_add_u32 s41, s41, 31744
    buffer_load_dwordx4 v253, s[16:19], s41 offen offset:1024  lds
    s_waitcnt vmcnt(16) lgkmcnt(0)
    s_barrier
    s_add_u32 m0, s45, 16384
    s_add_u32 s41, s88, 0
    buffer_load_dwordx4 v252, s[8:11], s41 offen nt lds
    buffer_load_dwordx4 v252, s[8:11], s41 offen offset:2048 nt lds
    ds_read_b128 v[220:223], v3 offset:12288
    ds_read_b64_tr_b16 v[224:225], v244 offset:49152
    ds_read_b64_tr_b16 v[226:227], v244 offset:50176
    s_add_u32 m0, s46, 16384
    s_add_u32 s41, s57, 524544
    s_and_b32 s41, s41, 0x3fffff
    buffer_load_dwordx4 v253, s[16:19], s41 offen  lds
    ds_read_b64_tr_b16 v[228:229], v245 offset:49152
    ds_read_b64_tr_b16 v[230:231], v245 offset:50176
    ds_read_b128 v[204:207], v3 offset:12352
    s_add_u32 s41, s41, 31744
    buffer_load_dwordx4 v253, s[16:19], s41 offen offset:1024  lds
    ds_read_b64_tr_b16 v[232:233], v244 offset:57344
    ds_read_b64_tr_b16 v[234:235], v244 offset:58368
    ds_read_b64_tr_b16 v[236:237], v245 offset:57344
    ds_read_b64_tr_b16 v[238:239], v245 offset:58368
    ds_read_b128 v[52:55], v240 offset:32768
    ds_read_b128 v[116:119], v240 offset:34816
    ds_read_b128 v[56:59], v241 offset:32768
    ds_read_b128 v[120:123], v241 offset:34816
    s_waitcnt lgkmcnt(11)
    v_mfma_f32_16x16x32_bf16 v[196:199], v[224:227], v[220:223], v[196:199]
    s_waitcnt lgkmcnt(9)
    v_mfma_f32_16x16x32_bf16 v[200:203], v[228:231], v[220:223], v[200:203]
    s_waitcnt lgkmcnt(6)
    v_mfma_f32_16x16x32_bf16 v[196:199], v[232:235], v[204:207], v[196:199]
    s_waitcnt lgkmcnt(4)
    v_mfma_f32_16x16x32_bf16 v[200:203], v[236:239], v[204:207], v[200:203]
    s_waitcnt vmcnt(10) lgkmcnt(0)
    s_barrier
    s_add_u32 m0, s45, 24576
    s_add_u32 s41, s88, 8192
    buffer_load_dwordx4 v252, s[8:11], s41 offen nt lds
    buffer_load_dwordx4 v252, s[8:11], s41 offen offset:2048 nt lds
    ds_read_b128 v[220:223], v3 offset:14336
    ds_read_b64_tr_b16 v[224:225], v244 offset:32768
    ds_read_b64_tr_b16 v[226:227], v244 offset:33792
    s_add_u32 m0, s45, 32768
    s_add_u32 s41, s88, 16384
    buffer_load_dwordx4 v252, s[4:7], s41 offen nt lds
    ds_read_b64_tr_b16 v[228:229], v245 offset:32768
    ds_read_b64_tr_b16 v[230:231], v245 offset:33792
    ds_read_b128 v[204:207], v3 offset:14400
    buffer_load_dwordx4 v252, s[4:7], s41 offen offset:2048 nt lds
    ds_read_b64_tr_b16 v[232:233], v244 offset:40960
    ds_read_b64_tr_b16 v[234:235], v244 offset:41984
    ds_read_b64_tr_b16 v[236:237], v245 offset:40960
    s_add_u32 m0, s45, 40960
    s_add_u32 s41, s88, 24576
    buffer_load_dwordx4 v252, s[4:7], s41 offen nt lds
    ds_read_b64_tr_b16 v[238:239], v245 offset:41984
    ds_read_b128 v[60:63], v240 offset:49152
    ds_read_b128 v[124:127], v240 offset:51200
    buffer_load_dwordx4 v252, s[4:7], s41 offen offset:2048 nt lds
    ds_read_b128 v[64:67], v241 offset:49152
    ds_read_b128 v[128:131], v241 offset:51200
    s_waitcnt lgkmcnt(11)
    v_mfma_f32_16x16x32_bf16 v[196:199], v[224:227], v[220:223], v[196:199]
    s_waitcnt lgkmcnt(9)
    v_mfma_f32_16x16x32_bf16 v[200:203], v[228:231], v[220:223], v[200:203]
    s_waitcnt lgkmcnt(6)
    v_mfma_f32_16x16x32_bf16 v[196:199], v[232:235], v[204:207], v[196:199]
    s_waitcnt lgkmcnt(4)
    v_mfma_f32_16x16x32_bf16 v[200:203], v[236:239], v[204:207], v[200:203]
    v_add_u32 v1, s47, v2
    s_nop 4
    v_mul_f32 v196, s58, v196
    v_mul_f32 v197, s58, v197
    v_mul_f32 v198, s58, v198
    v_mul_f32 v199, s58, v199
    v_cvt_pk_bf16_f32 v196, v196, v197
    v_cvt_pk_bf16_f32 v197, v198, v199
    ds_write_b64 v1, v[196:197] offset:32768
    v_mul_f32 v200, s58, v200
    v_mul_f32 v201, s58, v201
    v_mul_f32 v202, s58, v202
    v_mul_f32 v203, s58, v203
    v_cvt_pk_bf16_f32 v200, v200, v201
    v_cvt_pk_bf16_f32 v201, v202, v203
    ds_write_b64 v1, v[200:201] offset:33280
    s_waitcnt lgkmcnt(0)
L_Bmain:
    s_setprio 0
    ds_read_b64_tr_b16 v[204:205], v244 offset:0
    ds_read_b64_tr_b16 v[206:207], v244 offset:1024
    ds_read_b128 v[220:223], v3 offset:4096
    ds_read_b64_tr_b16 v[208:209], v245 offset:0
    ds_read_b64_tr_b16 v[210:211], v245 offset:1024
    ds_read_b64_tr_b16 v[212:213], v246 offset:0
    ds_read_b64_tr_b16 v[214:215], v246 offset:1024
    ds_read_b64_tr_b16 v[216:217], v247 offset:0
    ds_read_b64_tr_b16 v[218:219], v247 offset:1024
    s_waitcnt lgkmcnt(7)
    v_mfma_f32_16x16x32_bf16 v[132:135], v[204:207], v[4:7], 0
    v_mfma_f32_16x16x32_bf16 v[164:167], v[204:207], v[68:71], 0
    s_waitcnt lgkmcnt(6)
    v_mfma_f32_16x16x32_bf16 v[196:199], v[204:207], v[220:223], 0
    s_waitcnt lgkmcnt(4)
    ds_read_b64_tr_b16 v[204:205], v248 offset:0
    v_mfma_f32_16x16x32_bf16 v[136:139], v[208:211], v[4:7], 0
    ds_read_b64_tr_b16 v[206:207], v248 offset:1024
    v_mfma_f32_16x16x32_bf16 v[168:171], v[208:211], v[68:71], 0
    v_mfma_f32_16x16x32_bf16 v[200:203], v[208:211], v[220:223], 0
    s_waitcnt lgkmcnt(4)
    ds_read_b64_tr_b16 v[208:209], v249 offset:0
    v_mfma_f32_16x16x32_bf16 v[140:143], v[212:215], v[4:7], 0
    ds_read_b64_tr_b16 v[210:211], v249 offset:1024
    v_mfma_f32_16x16x32_bf16 v[172:175], v[212:215], v[68:71], 0
    s_waitcnt lgkmcnt(4)
    ds_read_b64_tr_b16 v[212:213], v250 offset:0
    v_mfma_f32_16x16x32_bf16 v[144:147], v[216:219], v[4:7], 0
    ds_read_b64_tr_b16 v[214:215], v250 offset:1024
    v_mfma_f32_16x16x32_bf16 v[176:179], v[216:219], v[68:71], 0
    s_waitcnt lgkmcnt(4)
    ds_read_b64_tr_b16 v[216:217], v251 offset:0
    v_mfma_f32_16x16x32_bf16 v[148:151], v[204:207], v[4:7], 0
    ds_read_b64_tr_b16 v[218:219], v251 offset:1024
    v_mfma_f32_16x16x32_bf16 v[180:183], v[204:207], v[68:71], 0
    s_waitcnt lgkmcnt(4)
    v_mfma_f32_16x16x32_bf16 v[152:155], v[208:211], v[4:7], 0
    v_mfma_f32_16x16x32_bf16 v[184:187], v[208:211], v[68:71], 0
    s_waitcnt vmcnt(10) lgkmcnt(0)
    s_barrier
    ds_read_b64_tr_b16 v[204:205], v244 offset:8192
    ds_read_b64_tr_b16 v[206:207], v244 offset:9216
    ds_read_b128 v[220:223], v3 offset:4160
    ds_read_b64_tr_b16 v[208:209], v245 offset:8192
    ds_read_b64_tr_b16 v[210:211], v245 offset:9216
    v_mfma_f32_16x16x32_bf16 v[156:159], v[212:215], v[4:7], 0
    s_add_u32 m0, s46, 0
    s_add_u32 s56, s55, 31744
    buffer_load_dwordx4 v253, s[16:19], s55 offen  lds
    s_add_u32 s55, s55, 262144
    v_mfma_f32_16x16x32_bf16 v[188:191], v[212:215], v[68:71], 0
    ds_read_b64_tr_b16 v[212:213], v246 offset:8192
    buffer_load_dwordx4 v253, s[16:19], s56 offen offset:1024  lds
    s_and_b32 s55, s55, 0x3fffff
    v_mfma_f32_16x16x32_bf16 v[160:163], v[216:219], v[4:7], 0
    ds_read_b64_tr_b16 v[214:215], v246 offset:9216
    v_mfma_f32_16x16x32_bf16 v[192:195], v[216:219], v[68:71], 0
    s_waitcnt lgkmcnt(5)
    ds_read_b64_tr_b16 v[216:217], v247 offset:8192
    v_mfma_f32_16x16x32_bf16 v[132:135], v[204:207], v[8:11], v[132:135]
    ds_read_b64_tr_b16 v[218:219], v247 offset:9216
    v_mfma_f32_16x16x32_bf16 v[164:167], v[204:207], v[72:75], v[164:167]
    s_add_u32 m0, s45, 49152
    s_add_u32 s63, s63, 8192
    buffer_load_dwordx4 v252, s[8:11], s63 offen nt lds
    buffer_load_dwordx4 v252, s[8:11], s63 offen offset:2048 nt lds
    s_add_u32 m0, s45, 57344
    s_add_u32 s63, s63, 8192
    buffer_load_dwordx4 v252, s[8:11], s63 offen nt lds
    buffer_load_dwordx4 v252, s[8:11], s63 offen offset:2048 nt lds
    s_waitcnt lgkmcnt(6)
    v_mfma_f32_16x16x32_bf16 v[196:199], v[204:207], v[220:223], v[196:199]
    s_waitcnt lgkmcnt(4)
    ds_read_b64_tr_b16 v[204:205], v248 offset:8192
    v_mfma_f32_16x16x32_bf16 v[136:139], v[208:211], v[8:11], v[136:139]
    ds_read_b64_tr_b16 v[206:207], v248 offset:9216
    v_mfma_f32_16x16x32_bf16 v[168:171], v[208:211], v[72:75], v[168:171]
    v_mfma_f32_16x16x32_bf16 v[200:203], v[208:211], v[220:223], v[200:203]
    s_waitcnt lgkmcnt(4)
    ds_read_b64_tr_b16 v[208:209], v249 offset:8192
    v_mfma_f32_16x16x32_bf16 v[140:143], v[212:215], v[8:11], v[140:143]
    ds_read_b64_tr_b16 v[210:211], v249 offset:9216
    v_mfma_f32_16x16x32_bf16 v[172:175], v[212:215], v[72:75], v[172:175]
    s_waitcnt lgkmcnt(4)
    ds_read_b64_tr_b16 v[212:213], v250 offset:8192
    v_mfma_f32_16x16x32_bf16 v[144:147], v[216:219], v[8:11], v[144:147]
    ds_read_b64_tr_b16 v[214:215], v250 offset:9216
    v_mfma_f32_16x16x32_bf16 v[176:179], v[216:219], v[72:75], v[176:179]
    s_waitcnt lgkmcnt(4)
    ds_read_b64_tr_b16 v[216:217], v251 offset:8192
    v_mfma_f32_16x16x32_bf16 v[148:151], v[204:207], v[8:11], v[148:151]
    ds_read_b64_tr_b16 v[218:219], v251 offset:9216
    v_mfma_f32_16x16x32_bf16 v[180:183], v[204:207], v[72:75], v[180:183]
    s_waitcnt lgkmcnt(4)
    v_mfma_f32_16x16x32_bf16 v[152:155], v[208:211], v[8:11], v[152:155]
    v_mfma_f32_16x16x32_bf16 v[184:187], v[208:211], v[72:75], v[184:187]
    s_waitcnt vmcnt(12) lgkmcnt(0)
    s_barrier
    ds_read_b64_tr_b16 v[204:205], v244 offset:16384
    ds_read_b64_tr_b16 v[206:207], v244 offset:17408
    ds_read_b128 v[220:223], v3 offset:6144
    ds_read_b64_tr_b16 v[208:209], v245 offset:16384
    ds_read_b64_tr_b16 v[210:211], v245 offset:17408
    v_mfma_f32_16x16x32_bf16 v[156:159], v[212:215], v[8:11], v[156:159]
    s_add_u32 m0, s46, 8192
    s_add_u32 s56, s55, 31744
    buffer_load_dwordx4 v253, s[16:19], s55 offen  lds
    s_add_u32 s55, s55, 262144
    v_mfma_f32_16x16x32_bf16 v[188:191], v[212:215], v[72:75], v[188:191]
    ds_read_b64_tr_b16 v[212:213], v246 offset:16384
    buffer_load_dwordx4 v253, s[16:19], s56 offen offset:1024  lds
    s_and_b32 s55, s55, 0x3fffff
    v_mfma_f32_16x16x32_bf16 v[160:163], v[216:219], v[8:11], v[160:163]
    ds_read_b64_tr_b16 v[214:215], v246 offset:17408
    v_mfma_f32_16x16x32_bf16 v[192:195], v[216:219], v[72:75], v[192:195]
    s_waitcnt lgkmcnt(5)
    ds_read_b64_tr_b16 v[216:217], v247 offset:16384
    v_mfma_f32_16x16x32_bf16 v[132:135], v[204:207], v[12:15], v[132:135]
    ds_read_b64_tr_b16 v[218:219], v247 offset:17408
    v_mfma_f32_16x16x32_bf16 v[164:167], v[204:207], v[76:79], v[164:167]
    s_waitcnt lgkmcnt(6)
    v_mfma_f32_16x16x32_bf16 v[196:199], v[204:207], v[220:223], v[196:199]
    s_waitcnt lgkmcnt(4)
    ds_read_b64_tr_b16 v[204:205], v248 offset:16384
    v_mfma_f32_16x16x32_bf16 v[136:139], v[208:211], v[12:15], v[136:139]
    ds_read_b64_tr_b16 v[206:207], v248 offset:17408
    v_mfma_f32_16x16x32_bf16 v[168:171], v[208:211], v[76:79], v[168:171]
    v_mfma_f32_16x16x32_bf16 v[200:203], v[208:211], v[220:223], v[200:203]
    s_waitcnt lgkmcnt(4)
    ds_read_b64_tr_b16 v[208:209], v249 offset:16384
    v_mfma_f32_16x16x32_bf16 v[140:143], v[212:215], v[12:15], v[140:143]
    ds_read_b64_tr_b16 v[210:211], v249 offset:17408
    v_mfma_f32_16x16x32_bf16 v[172:175], v[212:215], v[76:79], v[172:175]
    s_waitcnt lgkmcnt(4)
    ds_read_b64_tr_b16 v[212:213], v250 offset:16384
    v_mfma_f32_16x16x32_bf16 v[144:147], v[216:219], v[12:15], v[144:147]
    ds_read_b64_tr_b16 v[214:215], v250 offset:17408
    v_mfma_f32_16x16x32_bf16 v[176:179], v[216:219], v[76:79], v[176:179]
    s_waitcnt lgkmcnt(4)
    ds_read_b64_tr_b16 v[216:217], v251 offset:16384
    v_mfma_f32_16x16x32_bf16 v[148:151], v[204:207], v[12:15], v[148:151]
    ds_read_b64_tr_b16 v[218:219], v251 offset:17408
    v_mfma_f32_16x16x32_bf16 v[180:183], v[204:207], v[76:79], v[180:183]
    s_waitcnt lgkmcnt(4)
    v_mfma_f32_16x16x32_bf16 v[152:155], v[208:211], v[12:15], v[152:155]
    v_mfma_f32_16x16x32_bf16 v[184:187], v[208:211], v[76:79], v[184:187]
    s_waitcnt vmcnt(6) lgkmcnt(0)
    s_barrier
    ds_read_b64_tr_b16 v[204:205], v244 offset:0
    ds_read_b64_tr_b16 v[206:207], v244 offset:1024
    ds_read_b128 v[220:223], v3 offset:6208
    ds_read_b64_tr_b16 v[208:209], v245 offset:0
    ds_read_b64_tr_b16 v[210:211], v245 offset:1024
    v_mfma_f32_16x16x32_bf16 v[156:159], v[212:215], v[12:15], v[156:159]
    s_add_u32 m0, s46, 16384
    s_add_u32 s56, s55, 31744
    buffer_load_dwordx4 v253, s[16:19], s55 offen  lds
    s_add_u32 s55, s55, 262144
    v_mfma_f32_16x16x32_bf16 v[188:191], v[212:215], v[76:79], v[188:191]
    ds_read_b64_tr_b16 v[212:213], v246 offset:0
    buffer_load_dwordx4 v253, s[16:19], s56 offen offset:1024  lds
    s_and_b32 s55, s55, 0x3fffff
    v_mfma_f32_16x16x32_bf16 v[160:163], v[216:219], v[12:15], v[160:163]
    ds_read_b64_tr_b16 v[214:215], v246 offset:1024
    s_add_u32 m0, s47, 90112
    s_add_u32 s42, s95, 512
    s_and_b32 s42, s42, 0x3ff
    buffer_load_dwordx4 v254, s[12:15], s42 offen  lds
    v_mfma_f32_16x16x32_bf16 v[192:195], v[216:219], v[76:79], v[192:195]
    s_waitcnt lgkmcnt(5)
    ds_read_b64_tr_b16 v[216:217], v247 offset:0
    v_mfma_f32_16x16x32_bf16 v[132:135], v[204:207], v[16:19], v[132:135]
    ds_read_b64_tr_b16 v[218:219], v247 offset:1024
    v_mfma_f32_16x16x32_bf16 v[164:167], v[204:207], v[80:83], v[164:167]
    s_add_u32 m0, s45, 0
    s_add_u32 s54, s54, 8192
    buffer_load_dwordx4 v252, s[4:7], s54 offen nt lds
    buffer_load_dwordx4 v252, s[4:7], s54 offen offset:2048 nt lds
    s_add_u32 m0, s45, 8192
    s_add_u32 s54, s54, 8192
    buffer_load_dwordx4 v252, s[4:7], s54 offen nt lds
    buffer_load_dwordx4 v252, s[4:7], s54 offen offset:2048 nt lds
    s_waitcnt lgkmcnt(6)
    v_mfma_f32_16x16x32_bf16 v[196:199], v[204:207], v[220:223], v[196:199]
    s_waitcnt lgkmcnt(4)
    ds_read_b64_tr_b16 v[204:205], v248 offset:0
    v_mfma_f32_16x16x32_bf16 v[136:139], v[208:211], v[16:19], v[136:139]
    ds_read_b64_tr_b16 v[206:207], v248 offset:1024
    v_mfma_f32_16x16x32_bf16 v[168:171], v[208:211], v[80:83], v[168:171]
    v_mfma_f32_16x16x32_bf16 v[200:203], v[208:211], v[220:223], v[200:203]
    s_waitcnt lgkmcnt(4)
    ds_read_b64_tr_b16 v[208:209], v249 offset:0
    v_mfma_f32_16x16x32_bf16 v[140:143], v[212:215], v[16:19], v[140:143]
    ds_read_b64_tr_b16 v[210:211], v249 offset:1024
    v_mfma_f32_16x16x32_bf16 v[172:175], v[212:215], v[80:83], v[172:175]
    s_waitcnt lgkmcnt(4)
    ds_read_b64_tr_b16 v[212:213], v250 offset:0
    v_mfma_f32_16x16x32_bf16 v[144:147], v[216:219], v[16:19], v[144:147]
    ds_read_b64_tr_b16 v[214:215], v250 offset:1024
    v_mfma_f32_16x16x32_bf16 v[176:179], v[216:219], v[80:83], v[176:179]
    s_waitcnt lgkmcnt(4)
    ds_read_b64_tr_b16 v[216:217], v251 offset:0
    v_mfma_f32_16x16x32_bf16 v[148:151], v[204:207], v[16:19], v[148:151]
    ds_read_b64_tr_b16 v[218:219], v251 offset:1024
    v_mfma_f32_16x16x32_bf16 v[180:183], v[204:207], v[80:83], v[180:183]
    s_waitcnt lgkmcnt(4)
    v_mfma_f32_16x16x32_bf16 v[152:155], v[208:211], v[16:19], v[152:155]
    v_mfma_f32_16x16x32_bf16 v[184:187], v[208:211], v[80:83], v[184:187]
    s_waitcnt vmcnt(7) lgkmcnt(0)
    s_barrier
    ds_read_b64_tr_b16 v[204:205], v244 offset:8192
    ds_read_b64_tr_b16 v[206:207], v244 offset:9216
    ds_read_b128 v[220:223], v3 offset:8192
    ds_read_b64_tr_b16 v[208:209], v245 offset:8192
    ds_read_b64_tr_b16 v[210:211], v245 offset:9216
    v_mfma_f32_16x16x32_bf16 v[156:159], v[212:215], v[16:19], v[156:159]
    s_add_u32 m0, s46, 0
    s_add_u32 s56, s55, 31744
    buffer_load_dwordx4 v253, s[16:19], s55 offen  lds
    s_add_u32 s55, s55, 262144
    v_mfma_f32_16x16x32_bf16 v[188:191], v[212:215], v[80:83], v[188:191]
    ds_read_b64_tr_b16 v[212:213], v246 offset:8192
    buffer_load_dwordx4 v253, s[16:19], s56 offen offset:1024  lds
    s_and_b32 s55, s55, 0x3fffff
    v_mfma_f32_16x16x32_bf16 v[160:163], v[216:219], v[16:19], v[160:163]
    ds_read_b64_tr_b16 v[214:215], v246 offset:9216
    s_add_u32 m0, s47, 94208
    s_add_u32 s42, s95, 768
    s_and_b32 s42, s42, 0x3ff
    buffer_load_dwordx4 v254, s[12:15], s42 offen  lds
    v_mfma_f32_16x16x32_bf16 v[192:195], v[216:219], v[80:83], v[192:195]
    s_waitcnt lgkmcnt(5)
    ds_read_b64_tr_b16 v[216:217], v247 offset:8192
    v_mfma_f32_16x16x32_bf16 v[132:135], v[204:207], v[20:23], v[132:135]
    ds_read_b64_tr_b16 v[218:219], v247 offset:9216
    v_mfma_f32_16x16x32_bf16 v[164:167], v[204:207], v[84:87], v[164:167]
    s_add_u32 m0, s45, 16384
    s_add_u32 s63, s63, 8192
    buffer_load_dwordx4 v252, s[8:11], s63 offen nt lds
    buffer_load_dwordx4 v252, s[8:11], s63 offen offset:2048 nt lds
    s_add_u32 m0, s45, 24576
    s_add_u32 s63, s63, 8192
    buffer_load_dwordx4 v252, s[8:11], s63 offen nt lds
    buffer_load_dwordx4 v252, s[8:11], s63 offen offset:2048 nt lds
    s_waitcnt lgkmcnt(6)
    v_mfma_f32_16x16x32_bf16 v[196:199], v[204:207], v[220:223], v[196:199]
    s_waitcnt lgkmcnt(4)
    ds_read_b64_tr_b16 v[204:205], v248 offset:8192
    v_mfma_f32_16x16x32_bf16 v[136:139], v[208:211], v[20:23], v[136:139]
    ds_read_b64_tr_b16 v[206:207], v248 offset:9216
    v_mfma_f32_16x16x32_bf16 v[168:171], v[208:211], v[84:87], v[168:171]
    v_mfma_f32_16x16x32_bf16 v[200:203], v[208:211], v[220:223], v[200:203]
    s_waitcnt lgkmcnt(4)
    ds_read_b64_tr_b16 v[208:209], v249 offset:8192
    v_mfma_f32_16x16x32_bf16 v[140:143], v[212:215], v[20:23], v[140:143]
    ds_read_b64_tr_b16 v[210:211], v249 offset:9216
    v_mfma_f32_16x16x32_bf16 v[172:175], v[212:215], v[84:87], v[172:175]
    s_waitcnt lgkmcnt(4)
    ds_read_b64_tr_b16 v[212:213], v250 offset:8192
    v_mfma_f32_16x16x32_bf16 v[144:147], v[216:219], v[20:23], v[144:147]
    ds_read_b64_tr_b16 v[214:215], v250 offset:9216
    v_mfma_f32_16x16x32_bf16 v[176:179], v[216:219], v[84:87], v[176:179]
    s_waitcnt lgkmcnt(4)
    ds_read_b64_tr_b16 v[216:217], v251 offset:8192
    v_mfma_f32_16x16x32_bf16 v[148:151], v[204:207], v[20:23], v[148:151]
    ds_read_b64_tr_b16 v[218:219], v251 offset:9216
    v_mfma_f32_16x16x32_bf16 v[180:183], v[204:207], v[84:87], v[180:183]
    s_waitcnt lgkmcnt(4)
    v_mfma_f32_16x16x32_bf16 v[152:155], v[208:211], v[20:23], v[152:155]
    v_mfma_f32_16x16x32_bf16 v[184:187], v[208:211], v[84:87], v[184:187]
    s_waitcnt vmcnt(7) lgkmcnt(0)
    s_barrier
    ds_read_b64_tr_b16 v[204:205], v244 offset:16384
    ds_read_b64_tr_b16 v[206:207], v244 offset:17408
    ds_read_b128 v[220:223], v3 offset:8256
    ds_read_b64_tr_b16 v[208:209], v245 offset:16384
    ds_read_b64_tr_b16 v[210:211], v245 offset:17408
    v_mfma_f32_16x16x32_bf16 v[156:159], v[212:215], v[20:23], v[156:159]
    s_add_u32 m0, s46, 8192
    s_add_u32 s56, s55, 31744
    buffer_load_dwordx4 v253, s[16:19], s55 offen  lds
    s_add_u32 s55, s55, 262144
    v_mfma_f32_16x16x32_bf16 v[188:191], v[212:215], v[84:87], v[188:191]
    ds_read_b64_tr_b16 v[212:213], v246 offset:16384
    buffer_load_dwordx4 v253, s[16:19], s56 offen offset:1024  lds
    s_and_b32 s55, s55, 0x3fffff
    v_mfma_f32_16x16x32_bf16 v[160:163], v[216:219], v[20:23], v[160:163]
    ds_read_b64_tr_b16 v[214:215], v246 offset:17408
    v_mfma_f32_16x16x32_bf16 v[192:195], v[216:219], v[84:87], v[192:195]
    s_waitcnt lgkmcnt(5)
    ds_read_b64_tr_b16 v[216:217], v247 offset:16384
    v_mfma_f32_16x16x32_bf16 v[132:135], v[204:207], v[24:27], v[132:135]
    ds_read_b64_tr_b16 v[218:219], v247 offset:17408
    v_mfma_f32_16x16x32_bf16 v[164:167], v[204:207], v[88:91], v[164:167]
    s_add_u32 m0, s45, 32768
    s_add_u32 s54, s54, 8192
    buffer_load_dwordx4 v252, s[4:7], s54 offen nt lds
    buffer_load_dwordx4 v252, s[4:7], s54 offen offset:2048 nt lds
    s_add_u32 m0, s45, 40960
    s_add_u32 s54, s54, 8192
    buffer_load_dwordx4 v252, s[4:7], s54 offen nt lds
    buffer_load_dwordx4 v252, s[4:7], s54 offen offset:2048 nt lds
    s_waitcnt lgkmcnt(6)
    v_mfma_f32_16x16x32_bf16 v[196:199], v[204:207], v[220:223], v[196:199]
    s_waitcnt lgkmcnt(4)
    ds_read_b64_tr_b16 v[204:205], v248 offset:16384
    v_mfma_f32_16x16x32_bf16 v[136:139], v[208:211], v[24:27], v[136:139]
    ds_read_b64_tr_b16 v[206:207], v248 offset:17408
    v_mfma_f32_16x16x32_bf16 v[168:171], v[208:211], v[88:91], v[168:171]
    v_mfma_f32_16x16x32_bf16 v[200:203], v[208:211], v[220:223], v[200:203]
    s_waitcnt lgkmcnt(4)
    ds_read_b64_tr_b16 v[208:209], v249 offset:16384
    v_mfma_f32_16x16x32_bf16 v[140:143], v[212:215], v[24:27], v[140:143]
    ds_read_b64_tr_b16 v[210:211], v249 offset:17408
    v_mfma_f32_16x16x32_bf16 v[172:175], v[212:215], v[88:91], v[172:175]
    s_waitcnt lgkmcnt(4)
    ds_read_b64_tr_b16 v[212:213], v250 offset:16384
    v_mfma_f32_16x16x32_bf16 v[144:147], v[216:219], v[24:27], v[144:147]
    ds_read_b64_tr_b16 v[214:215], v250 offset:17408
    v_mfma_f32_16x16x32_bf16 v[176:179], v[216:219], v[88:91], v[176:179]
    s_waitcnt lgkmcnt(4)
    ds_read_b64_tr_b16 v[216:217], v251 offset:16384
    v_mfma_f32_16x16x32_bf16 v[148:151], v[204:207], v[24:27], v[148:151]
    ds_read_b64_tr_b16 v[218:219], v251 offset:17408
    v_mfma_f32_16x16x32_bf16 v[180:183], v[204:207], v[88:91], v[180:183]
    s_waitcnt lgkmcnt(4)
    v_mfma_f32_16x16x32_bf16 v[152:155], v[208:211], v[24:27], v[152:155]
    v_mfma_f32_16x16x32_bf16 v[184:187], v[208:211], v[88:91], v[184:187]
    s_waitcnt vmcnt(8) lgkmcnt(0)
    s_barrier
    ds_read_b64_tr_b16 v[204:205], v244 offset:0
    ds_read_b64_tr_b16 v[206:207], v244 offset:1024
    ds_read_b128 v[220:223], v3 offset:10240
    ds_read_b64_tr_b16 v[208:209], v245 offset:0
    ds_read_b64_tr_b16 v[210:211], v245 offset:1024
    v_mfma_f32_16x16x32_bf16 v[156:159], v[212:215], v[24:27], v[156:159]
    s_add_u32 m0, s46, 16384
    s_add_u32 s56, s55, 31744
    buffer_load_dwordx4 v253, s[16:19], s55 offen  lds
    s_add_u32 s55, s55, 262144
    v_mfma_f32_16x16x32_bf16 v[188:191], v[212:215], v[88:91], v[188:191]
    ds_read_b64_tr_b16 v[212:213], v246 offset:0
    buffer_load_dwordx4 v253, s[16:19], s56 offen offset:1024  lds
    s_and_b32 s55, s55, 0x3fffff
    v_mfma_f32_16x16x32_bf16 v[160:163], v[216:219], v[24:27], v[160:163]
    ds_read_b64_tr_b16 v[214:215], v246 offset:1024
    v_mfma_f32_16x16x32_bf16 v[192:195], v[216:219], v[88:91], v[192:195]
    s_waitcnt lgkmcnt(5)
    ds_read_b64_tr_b16 v[216:217], v247 offset:0
    v_mfma_f32_16x16x32_bf16 v[132:135], v[204:207], v[28:31], v[132:135]
    ds_read_b64_tr_b16 v[218:219], v247 offset:1024
    v_mfma_f32_16x16x32_bf16 v[164:167], v[204:207], v[92:95], v[164:167]
    s_add_u32 m0, s45, 49152
    s_add_u32 s63, s63, 8192
    buffer_load_dwordx4 v252, s[8:11], s63 offen nt lds
    buffer_load_dwordx4 v252, s[8:11], s63 offen offset:2048 nt lds
    s_add_u32 m0, s45, 57344
    s_add_u32 s63, s63, 8192
    buffer_load_dwordx4 v252, s[8:11], s63 offen nt lds
    buffer_load_dwordx4 v252, s[8:11], s63 offen offset:2048 nt lds
    s_waitcnt lgkmcnt(6)
    v_mfma_f32_16x16x32_bf16 v[196:199], v[204:207], v[220:223], v[196:199]
    s_waitcnt lgkmcnt(4)
    ds_read_b64_tr_b16 v[204:205], v248 offset:0
    v_mfma_f32_16x16x32_bf16 v[136:139], v[208:211], v[28:31], v[136:139]
    ds_read_b64_tr_b16 v[206:207], v248 offset:1024
    v_mfma_f32_16x16x32_bf16 v[168:171], v[208:211], v[92:95], v[168:171]
    v_mfma_f32_16x16x32_bf16 v[200:203], v[208:211], v[220:223], v[200:203]
    s_waitcnt lgkmcnt(4)
    ds_read_b64_tr_b16 v[208:209], v249 offset:0
    v_mfma_f32_16x16x32_bf16 v[140:143], v[212:215], v[28:31], v[140:143]
    ds_read_b64_tr_b16 v[210:211], v249 offset:1024
    v_mfma_f32_16x16x32_bf16 v[172:175], v[212:215], v[92:95], v[172:175]
    s_waitcnt lgkmcnt(4)
    ds_read_b64_tr_b16 v[212:213], v250 offset:0
    v_mfma_f32_16x16x32_bf16 v[144:147], v[216:219], v[28:31], v[144:147]
    ds_read_b64_tr_b16 v[214:215], v250 offset:1024
    v_mfma_f32_16x16x32_bf16 v[176:179], v[216:219], v[92:95], v[176:179]
    s_waitcnt lgkmcnt(4)
    ds_read_b64_tr_b16 v[216:217], v251 offset:0
    v_mfma_f32_16x16x32_bf16 v[148:151], v[204:207], v[28:31], v[148:151]
    ds_read_b64_tr_b16 v[218:219], v251 offset:1024
    v_mfma_f32_16x16x32_bf16 v[180:183], v[204:207], v[92:95], v[180:183]
    s_waitcnt lgkmcnt(4)
    v_mfma_f32_16x16x32_bf16 v[152:155], v[208:211], v[28:31], v[152:155]
    v_mfma_f32_16x16x32_bf16 v[184:187], v[208:211], v[92:95], v[184:187]
    s_waitcnt vmcnt(6) lgkmcnt(0)
    s_barrier
    ds_read_b64_tr_b16 v[204:205], v244 offset:8192
    ds_read_b64_tr_b16 v[206:207], v244 offset:9216
    ds_read_b128 v[220:223], v3 offset:10304
    ds_read_b64_tr_b16 v[208:209], v245 offset:8192
    ds_read_b64_tr_b16 v[210:211], v245 offset:9216
    v_mfma_f32_16x16x32_bf16 v[156:159], v[212:215], v[28:31], v[156:159]
    s_add_u32 m0, s46, 0
    s_add_u32 s56, s55, 31744
    buffer_load_dwordx4 v253, s[16:19], s55 offen  lds
    s_add_u32 s55, s55, 262144
    v_mfma_f32_16x16x32_bf16 v[188:191], v[212:215], v[92:95], v[188:191]
    ds_read_b64_tr_b16 v[212:213], v246 offset:8192
    buffer_load_dwordx4 v253, s[16:19], s56 offen offset:1024  lds
    s_and_b32 s55, s55, 0x3fffff
    v_mfma_f32_16x16x32_bf16 v[160:163], v[216:219], v[28:31], v[160:163]
    ds_read_b64_tr_b16 v[214:215], v246 offset:9216
    v_mfma_f32_16x16x32_bf16 v[192:195], v[216:219], v[92:95], v[192:195]
    s_waitcnt lgkmcnt(5)
    ds_read_b64_tr_b16 v[216:217], v247 offset:8192
    v_mfma_f32_16x16x32_bf16 v[132:135], v[204:207], v[32:35], v[132:135]
    ds_read_b64_tr_b16 v[218:219], v247 offset:9216
    v_mfma_f32_16x16x32_bf16 v[164:167], v[204:207], v[96:99], v[164:167]
    s_add_u32 m0, s45, 0
    s_add_u32 s54, s54, 8192
    buffer_load_dwordx4 v252, s[4:7], s54 offen nt lds
    buffer_load_dwordx4 v252, s[4:7], s54 offen offset:2048 nt lds
    s_add_u32 m0, s45, 8192
    s_add_u32 s54, s54, 8192
    buffer_load_dwordx4 v252, s[4:7], s54 offen nt lds
    buffer_load_dwordx4 v252, s[4:7], s54 offen offset:2048 nt lds
    s_waitcnt lgkmcnt(6)
    v_mfma_f32_16x16x32_bf16 v[196:199], v[204:207], v[220:223], v[196:199]
    s_waitcnt lgkmcnt(4)
    ds_read_b64_tr_b16 v[204:205], v248 offset:8192
    v_mfma_f32_16x16x32_bf16 v[136:139], v[208:211], v[32:35], v[136:139]
    ds_read_b64_tr_b16 v[206:207], v248 offset:9216
    v_mfma_f32_16x16x32_bf16 v[168:171], v[208:211], v[96:99], v[168:171]
    v_mfma_f32_16x16x32_bf16 v[200:203], v[208:211], v[220:223], v[200:203]
    s_waitcnt lgkmcnt(4)
    ds_read_b64_tr_b16 v[208:209], v249 offset:8192
    v_mfma_f32_16x16x32_bf16 v[140:143], v[212:215], v[32:35], v[140:143]
    ds_read_b64_tr_b16 v[210:211], v249 offset:9216
    v_mfma_f32_16x16x32_bf16 v[172:175], v[212:215], v[96:99], v[172:175]
    s_waitcnt lgkmcnt(4)
    ds_read_b64_tr_b16 v[212:213], v250 offset:8192
    v_mfma_f32_16x16x32_bf16 v[144:147], v[216:219], v[32:35], v[144:147]
    ds_read_b64_tr_b16 v[214:215], v250 offset:9216
    v_mfma_f32_16x16x32_bf16 v[176:179], v[216:219], v[96:99], v[176:179]
    s_waitcnt lgkmcnt(4)
    ds_read_b64_tr_b16 v[216:217], v251 offset:8192
    v_mfma_f32_16x16x32_bf16 v[148:151], v[204:207], v[32:35], v[148:151]
    ds_read_b64_tr_b16 v[218:219], v251 offset:9216
    v_mfma_f32_16x16x32_bf16 v[180:183], v[204:207], v[96:99], v[180:183]
    s_waitcnt lgkmcnt(4)
    v_mfma_f32_16x16x32_bf16 v[152:155], v[208:211], v[32:35], v[152:155]
    v_mfma_f32_16x16x32_bf16 v[184:187], v[208:211], v[96:99], v[184:187]
    s_waitcnt vmcnt(8) lgkmcnt(0)
    s_barrier
    ds_read_b64_tr_b16 v[204:205], v244 offset:16384
    ds_read_b64_tr_b16 v[206:207], v244 offset:17408
    v_add_u32 v3, 4294905856, v3
    ds_read_b128 v[220:223], v3 offset:4096
    ds_read_b64_tr_b16 v[208:209], v245 offset:16384
    ds_read_b64_tr_b16 v[210:211], v245 offset:17408
    v_mfma_f32_16x16x32_bf16 v[156:159], v[212:215], v[32:35], v[156:159]
    s_add_u32 m0, s46, 8192
    s_add_u32 s56, s55, 31744
    buffer_load_dwordx4 v253, s[16:19], s55 offen  lds
    s_add_u32 s55, s55, 262144
    v_mfma_f32_16x16x32_bf16 v[188:191], v[212:215], v[96:99], v[188:191]
    ds_read_b64_tr_b16 v[212:213], v246 offset:16384
    buffer_load_dwordx4 v253, s[16:19], s56 offen offset:1024  lds
    s_and_b32 s55, s55, 0x3fffff
    v_mfma_f32_16x16x32_bf16 v[160:163], v[216:219], v[32:35], v[160:163]
    ds_read_b64_tr_b16 v[214:215], v246 offset:17408
    v_mfma_f32_16x16x32_bf16 v[192:195], v[216:219], v[96:99], v[192:195]
    s_waitcnt lgkmcnt(5)
    ds_read_b64_tr_b16 v[216:217], v247 offset:16384
    v_mfma_f32_16x16x32_bf16 v[132:135], v[204:207], v[36:39], v[132:135]
    ds_read_b64_tr_b16 v[218:219], v247 offset:17408
    v_mfma_f32_16x16x32_bf16 v[164:167], v[204:207], v[100:103], v[164:167]
    s_add_u32 m0, s45, 16384
    s_add_u32 s63, s63, 8192
    buffer_load_dwordx4 v252, s[8:11], s63 offen nt lds
    buffer_load_dwordx4 v252, s[8:11], s63 offen offset:2048 nt lds
    s_add_u32 m0, s45, 24576
    s_add_u32 s63, s63, 8192
    buffer_load_dwordx4 v252, s[8:11], s63 offen nt lds
    buffer_load_dwordx4 v252, s[8:11], s63 offen offset:2048 nt lds
    s_waitcnt lgkmcnt(6)
    v_mfma_f32_16x16x32_bf16 v[196:199], v[204:207], v[220:223], v[196:199]
    s_waitcnt lgkmcnt(4)
    ds_read_b64_tr_b16 v[204:205], v248 offset:16384
    v_mfma_f32_16x16x32_bf16 v[136:139], v[208:211], v[36:39], v[136:139]
    ds_read_b64_tr_b16 v[206:207], v248 offset:17408
    v_mfma_f32_16x16x32_bf16 v[168:171], v[208:211], v[100:103], v[168:171]
    v_mfma_f32_16x16x32_bf16 v[200:203], v[208:211], v[220:223], v[200:203]
    s_waitcnt lgkmcnt(4)
    ds_read_b64_tr_b16 v[208:209], v249 offset:16384
    v_mfma_f32_16x16x32_bf16 v[140:143], v[212:215], v[36:39], v[140:143]
    ds_read_b64_tr_b16 v[210:211], v249 offset:17408
    v_mfma_f32_16x16x32_bf16 v[172:175], v[212:215], v[100:103], v[172:175]
    s_waitcnt lgkmcnt(4)
    ds_read_b64_tr_b16 v[212:213], v250 offset:16384
    v_mfma_f32_16x16x32_bf16 v[144:147], v[216:219], v[36:39], v[144:147]
    ds_read_b64_tr_b16 v[214:215], v250 offset:17408
    v_mfma_f32_16x16x32_bf16 v[176:179], v[216:219], v[100:103], v[176:179]
    s_waitcnt lgkmcnt(4)
    ds_read_b64_tr_b16 v[216:217], v251 offset:16384
    v_mfma_f32_16x16x32_bf16 v[148:151], v[204:207], v[36:39], v[148:151]
    ds_read_b64_tr_b16 v[218:219], v251 offset:17408
    v_mfma_f32_16x16x32_bf16 v[180:183], v[204:207], v[100:103], v[180:183]
    s_waitcnt lgkmcnt(4)
    v_mfma_f32_16x16x32_bf16 v[152:155], v[208:211], v[36:39], v[152:155]
    v_mfma_f32_16x16x32_bf16 v[184:187], v[208:211], v[100:103], v[184:187]
    s_waitcnt vmcnt(6) lgkmcnt(0)
    s_barrier
    ds_read_b64_tr_b16 v[204:205], v244 offset:0
    ds_read_b64_tr_b16 v[206:207], v244 offset:1024
    ds_read_b128 v[220:223], v3 offset:4160
    ds_read_b64_tr_b16 v[208:209], v245 offset:0
    ds_read_b64_tr_b16 v[210:211], v245 offset:1024
    v_mfma_f32_16x16x32_bf16 v[156:159], v[212:215], v[36:39], v[156:159]
    s_add_u32 m0, s46, 16384
    s_add_u32 s56, s55, 31744
    buffer_load_dwordx4 v253, s[16:19], s55 offen  lds
    s_add_u32 s55, s55, 262144
    v_mfma_f32_16x16x32_bf16 v[188:191], v[212:215], v[100:103], v[188:191]
    ds_read_b64_tr_b16 v[212:213], v246 offset:0
    buffer_load_dwordx4 v253, s[16:19], s56 offen offset:1024  lds
    s_and_b32 s55, s55, 0x3fffff
    v_mfma_f32_16x16x32_bf16 v[160:163], v[216:219], v[36:39], v[160:163]
    ds_read_b64_tr_b16 v[214:215], v246 offset:1024
    v_mfma_f32_16x16x32_bf16 v[192:195], v[216:219], v[100:103], v[192:195]
    s_waitcnt lgkmcnt(5)
    ds_read_b64_tr_b16 v[216:217], v247 offset:0
    v_mfma_f32_16x16x32_bf16 v[132:135], v[204:207], v[40:43], v[132:135]
    ds_read_b64_tr_b16 v[218:219], v247 offset:1024
    v_mfma_f32_16x16x32_bf16 v[164:167], v[204:207], v[104:107], v[164:167]
    s_add_u32 m0, s45, 32768
    s_add_u32 s54, s54, 8192
    buffer_load_dwordx4 v252, s[4:7], s54 offen nt lds
    buffer_load_dwordx4 v252, s[4:7], s54 offen offset:2048 nt lds
    s_add_u32 m0, s45, 40960
    s_add_u32 s54, s54, 8192
    buffer_load_dwordx4 v252, s[4:7], s54 offen nt lds
    buffer_load_dwordx4 v252, s[4:7], s54 offen offset:2048 nt lds
    s_waitcnt lgkmcnt(6)
    v_mfma_f32_16x16x32_bf16 v[196:199], v[204:207], v[220:223], v[196:199]
    s_waitcnt lgkmcnt(4)
    ds_read_b64_tr_b16 v[204:205], v248 offset:0
    v_mfma_f32_16x16x32_bf16 v[136:139], v[208:211], v[40:43], v[136:139]
    ds_read_b64_tr_b16 v[206:207], v248 offset:1024
    v_mfma_f32_16x16x32_bf16 v[168:171], v[208:211], v[104:107], v[168:171]
    v_mfma_f32_16x16x32_bf16 v[200:203], v[208:211], v[220:223], v[200:203]
    s_waitcnt lgkmcnt(4)
    ds_read_b64_tr_b16 v[208:209], v249 offset:0
    v_mfma_f32_16x16x32_bf16 v[140:143], v[212:215], v[40:43], v[140:143]
    ds_read_b64_tr_b16 v[210:211], v249 offset:1024
    v_mfma_f32_16x16x32_bf16 v[172:175], v[212:215], v[104:107], v[172:175]
    s_waitcnt lgkmcnt(4)
    ds_read_b64_tr_b16 v[212:213], v250 offset:0
    v_mfma_f32_16x16x32_bf16 v[144:147], v[216:219], v[40:43], v[144:147]
    ds_read_b64_tr_b16 v[214:215], v250 offset:1024
    v_mfma_f32_16x16x32_bf16 v[176:179], v[216:219], v[104:107], v[176:179]
    s_waitcnt lgkmcnt(4)
    ds_read_b64_tr_b16 v[216:217], v251 offset:0
    v_mfma_f32_16x16x32_bf16 v[148:151], v[204:207], v[40:43], v[148:151]
    ds_read_b64_tr_b16 v[218:219], v251 offset:1024
    v_mfma_f32_16x16x32_bf16 v[180:183], v[204:207], v[104:107], v[180:183]
    s_waitcnt lgkmcnt(4)
    v_mfma_f32_16x16x32_bf16 v[152:155], v[208:211], v[40:43], v[152:155]
    v_mfma_f32_16x16x32_bf16 v[184:187], v[208:211], v[104:107], v[184:187]
    s_waitcnt vmcnt(8) lgkmcnt(0)
    s_barrier
    ds_read_b64_tr_b16 v[204:205], v244 offset:8192
    ds_read_b64_tr_b16 v[206:207], v244 offset:9216
    ds_read_b128 v[220:223], v3 offset:6144
    ds_read_b64_tr_b16 v[208:209], v245 offset:8192
    ds_read_b64_tr_b16 v[210:211], v245 offset:9216
    v_mfma_f32_16x16x32_bf16 v[156:159], v[212:215], v[40:43], v[156:159]
    s_add_u32 m0, s46, 0
    s_add_u32 s56, s55, 31744
    buffer_load_dwordx4 v253, s[16:19], s55 offen  lds
    s_add_u32 s55, s55, 262144
    v_mfma_f32_16x16x32_bf16 v[188:191], v[212:215], v[104:107], v[188:191]
    ds_read_b64_tr_b16 v[212:213], v246 offset:8192
    buffer_load_dwordx4 v253, s[16:19], s56 offen offset:1024  lds
    s_and_b32 s55, s55, 0x3fffff
    v_mfma_f32_16x16x32_bf16 v[160:163], v[216:219], v[40:43], v[160:163]
    ds_read_b64_tr_b16 v[214:215], v246 offset:9216
    v_mfma_f32_16x16x32_bf16 v[192:195], v[216:219], v[104:107], v[192:195]
    s_waitcnt lgkmcnt(5)
    ds_read_b64_tr_b16 v[216:217], v247 offset:8192
    v_mfma_f32_16x16x32_bf16 v[132:135], v[204:207], v[44:47], v[132:135]
    ds_read_b64_tr_b16 v[218:219], v247 offset:9216
    v_mfma_f32_16x16x32_bf16 v[164:167], v[204:207], v[108:111], v[164:167]
    s_add_u32 m0, s45, 49152
    s_add_u32 s63, s63, 8192
    buffer_load_dwordx4 v252, s[8:11], s63 offen nt lds
    buffer_load_dwordx4 v252, s[8:11], s63 offen offset:2048 nt lds
    s_add_u32 m0, s45, 57344
    s_add_u32 s63, s63, 8192
    buffer_load_dwordx4 v252, s[8:11], s63 offen nt lds
    buffer_load_dwordx4 v252, s[8:11], s63 offen offset:2048 nt lds
    s_waitcnt lgkmcnt(6)
    v_mfma_f32_16x16x32_bf16 v[196:199], v[204:207], v[220:223], v[196:199]
    s_waitcnt lgkmcnt(4)
    ds_read_b64_tr_b16 v[204:205], v248 offset:8192
    v_mfma_f32_16x16x32_bf16 v[136:139], v[208:211], v[44:47], v[136:139]
    ds_read_b64_tr_b16 v[206:207], v248 offset:9216
    v_mfma_f32_16x16x32_bf16 v[168:171], v[208:211], v[108:111], v[168:171]
    v_mfma_f32_16x16x32_bf16 v[200:203], v[208:211], v[220:223], v[200:203]
    s_waitcnt lgkmcnt(4)
    ds_read_b64_tr_b16 v[208:209], v249 offset:8192
    v_mfma_f32_16x16x32_bf16 v[140:143], v[212:215], v[44:47], v[140:143]
    ds_read_b64_tr_b16 v[210:211], v249 offset:9216
    v_mfma_f32_16x16x32_bf16 v[172:175], v[212:215], v[108:111], v[172:175]
    s_waitcnt lgkmcnt(4)
    ds_read_b64_tr_b16 v[212:213], v250 offset:8192
    v_mfma_f32_16x16x32_bf16 v[144:147], v[216:219], v[44:47], v[144:147]
    ds_read_b64_tr_b16 v[214:215], v250 offset:9216
    v_mfma_f32_16x16x32_bf16 v[176:179], v[216:219], v[108:111], v[176:179]
    s_waitcnt lgkmcnt(4)
    ds_read_b64_tr_b16 v[216:217], v251 offset:8192
    v_mfma_f32_16x16x32_bf16 v[148:151], v[204:207], v[44:47], v[148:151]
    ds_read_b64_tr_b16 v[218:219], v251 offset:9216
    v_mfma_f32_16x16x32_bf16 v[180:183], v[204:207], v[108:111], v[180:183]
    s_waitcnt lgkmcnt(4)
    v_mfma_f32_16x16x32_bf16 v[152:155], v[208:211], v[44:47], v[152:155]
    v_mfma_f32_16x16x32_bf16 v[184:187], v[208:211], v[108:111], v[184:187]
    s_waitcnt vmcnt(6) lgkmcnt(0)
    s_barrier
    ds_read_b64_tr_b16 v[204:205], v244 offset:16384
    ds_read_b64_tr_b16 v[206:207], v244 offset:17408
    ds_read_b128 v[220:223], v3 offset:6208
    ds_read_b64_tr_b16 v[208:209], v245 offset:16384
    ds_read_b64_tr_b16 v[210:211], v245 offset:17408
    v_mfma_f32_16x16x32_bf16 v[156:159], v[212:215], v[44:47], v[156:159]
    s_add_u32 m0, s46, 8192
    s_add_u32 s56, s55, 31744
    buffer_load_dwordx4 v253, s[16:19], s55 offen  lds
    s_add_u32 s55, s55, 262144
    v_mfma_f32_16x16x32_bf16 v[188:191], v[212:215], v[108:111], v[188:191]
    ds_read_b64_tr_b16 v[212:213], v246 offset:16384
    buffer_load_dwordx4 v253, s[16:19], s56 offen offset:1024  lds
    s_and_b32 s55, s55, 0x3fffff
    v_mfma_f32_16x16x32_bf16 v[160:163], v[216:219], v[44:47], v[160:163]
    ds_read_b64_tr_b16 v[214:215], v246 offset:17408
    v_mfma_f32_16x16x32_bf16 v[192:195], v[216:219], v[108:111], v[192:195]
    s_waitcnt lgkmcnt(5)
    ds_read_b64_tr_b16 v[216:217], v247 offset:16384
    v_mfma_f32_16x16x32_bf16 v[132:135], v[204:207], v[48:51], v[132:135]
    ds_read_b64_tr_b16 v[218:219], v247 offset:17408
    v_mfma_f32_16x16x32_bf16 v[164:167], v[204:207], v[112:115], v[164:167]
    s_add_u32 m0, s45, 0
    s_add_u32 s54, s54, 8192
    buffer_load_dwordx4 v252, s[4:7], s54 offen nt lds
    buffer_load_dwordx4 v252, s[4:7], s54 offen offset:2048 nt lds
    s_add_u32 m0, s45, 8192
    s_add_u32 s54, s54, 8192
    buffer_load_dwordx4 v252, s[4:7], s54 offen nt lds
    buffer_load_dwordx4 v252, s[4:7], s54 offen offset:2048 nt lds
    s_waitcnt lgkmcnt(6)
    v_mfma_f32_16x16x32_bf16 v[196:199], v[204:207], v[220:223], v[196:199]
    s_waitcnt lgkmcnt(4)
    ds_read_b64_tr_b16 v[204:205], v248 offset:16384
    v_mfma_f32_16x16x32_bf16 v[136:139], v[208:211], v[48:51], v[136:139]
    ds_read_b64_tr_b16 v[206:207], v248 offset:17408
    v_mfma_f32_16x16x32_bf16 v[168:171], v[208:211], v[112:115], v[168:171]
    v_mfma_f32_16x16x32_bf16 v[200:203], v[208:211], v[220:223], v[200:203]
    s_waitcnt lgkmcnt(4)
    ds_read_b64_tr_b16 v[208:209], v249 offset:16384
    v_mfma_f32_16x16x32_bf16 v[140:143], v[212:215], v[48:51], v[140:143]
    ds_read_b64_tr_b16 v[210:211], v249 offset:17408
    v_mfma_f32_16x16x32_bf16 v[172:175], v[212:215], v[112:115], v[172:175]
    s_waitcnt lgkmcnt(4)
    ds_read_b64_tr_b16 v[212:213], v250 offset:16384
    v_mfma_f32_16x16x32_bf16 v[144:147], v[216:219], v[48:51], v[144:147]
    ds_read_b64_tr_b16 v[214:215], v250 offset:17408
    v_mfma_f32_16x16x32_bf16 v[176:179], v[216:219], v[112:115], v[176:179]
    s_waitcnt lgkmcnt(4)
    ds_read_b64_tr_b16 v[216:217], v251 offset:16384
    v_mfma_f32_16x16x32_bf16 v[148:151], v[204:207], v[48:51], v[148:151]
    ds_read_b64_tr_b16 v[218:219], v251 offset:17408
    v_mfma_f32_16x16x32_bf16 v[180:183], v[204:207], v[112:115], v[180:183]
    s_waitcnt lgkmcnt(4)
    v_mfma_f32_16x16x32_bf16 v[152:155], v[208:211], v[48:51], v[152:155]
    v_mfma_f32_16x16x32_bf16 v[184:187], v[208:211], v[112:115], v[184:187]
    s_waitcnt vmcnt(8) lgkmcnt(0)
    s_barrier
    ds_read_b64_tr_b16 v[204:205], v244 offset:0
    ds_read_b64_tr_b16 v[206:207], v244 offset:1024
    ds_read_b128 v[220:223], v3 offset:8192
    ds_read_b64_tr_b16 v[208:209], v245 offset:0
    ds_read_b64_tr_b16 v[210:211], v245 offset:1024
    v_mfma_f32_16x16x32_bf16 v[156:159], v[212:215], v[48:51], v[156:159]
    s_add_u32 m0, s46, 16384
    s_add_u32 s56, s55, 31744
    buffer_load_dwordx4 v253, s[16:19], s55 offen  lds
    s_add_u32 s55, s55, 262144
    v_mfma_f32_16x16x32_bf16 v[188:191], v[212:215], v[112:115], v[188:191]
    ds_read_b64_tr_b16 v[212:213], v246 offset:0
    buffer_load_dwordx4 v253, s[16:19], s56 offen offset:1024  lds
    s_and_b32 s55, s55, 0x3fffff
    v_mfma_f32_16x16x32_bf16 v[160:163], v[216:219], v[48:51], v[160:163]
    ds_read_b64_tr_b16 v[214:215], v246 offset:1024
    v_mfma_f32_16x16x32_bf16 v[192:195], v[216:219], v[112:115], v[192:195]
    s_waitcnt lgkmcnt(5)
    ds_read_b64_tr_b16 v[216:217], v247 offset:0
    v_mfma_f32_16x16x32_bf16 v[132:135], v[204:207], v[52:55], v[132:135]
    ds_read_b64_tr_b16 v[218:219], v247 offset:1024
    v_mfma_f32_16x16x32_bf16 v[164:167], v[204:207], v[116:119], v[164:167]
    s_add_u32 m0, s45, 16384
    s_add_u32 s63, s63, 8192
    buffer_load_dwordx4 v252, s[8:11], s63 offen nt lds
    buffer_load_dwordx4 v252, s[8:11], s63 offen offset:2048 nt lds
    s_add_u32 m0, s45, 24576
    s_add_u32 s63, s63, 8192
    buffer_load_dwordx4 v252, s[8:11], s63 offen nt lds
    buffer_load_dwordx4 v252, s[8:11], s63 offen offset:2048 nt lds
    s_waitcnt lgkmcnt(6)
    v_mfma_f32_16x16x32_bf16 v[196:199], v[204:207], v[220:223], v[196:199]
    s_waitcnt lgkmcnt(4)
    ds_read_b64_tr_b16 v[204:205], v248 offset:0
    v_mfma_f32_16x16x32_bf16 v[136:139], v[208:211], v[52:55], v[136:139]
    ds_read_b64_tr_b16 v[206:207], v248 offset:1024
    v_mfma_f32_16x16x32_bf16 v[168:171], v[208:211], v[116:119], v[168:171]
    v_mfma_f32_16x16x32_bf16 v[200:203], v[208:211], v[220:223], v[200:203]
    s_waitcnt lgkmcnt(4)
    ds_read_b64_tr_b16 v[208:209], v249 offset:0
    v_mfma_f32_16x16x32_bf16 v[140:143], v[212:215], v[52:55], v[140:143]
    ds_read_b64_tr_b16 v[210:211], v249 offset:1024
    v_mfma_f32_16x16x32_bf16 v[172:175], v[212:215], v[116:119], v[172:175]
    s_waitcnt lgkmcnt(4)
    ds_read_b64_tr_b16 v[212:213], v250 offset:0
    v_mfma_f32_16x16x32_bf16 v[144:147], v[216:219], v[52:55], v[144:147]
    ds_read_b64_tr_b16 v[214:215], v250 offset:1024
    v_mfma_f32_16x16x32_bf16 v[176:179], v[216:219], v[116:119], v[176:179]
    s_waitcnt lgkmcnt(4)
    ds_read_b64_tr_b16 v[216:217], v251 offset:0
    v_mfma_f32_16x16x32_bf16 v[148:151], v[204:207], v[52:55], v[148:151]
    ds_read_b64_tr_b16 v[218:219], v251 offset:1024
    v_mfma_f32_16x16x32_bf16 v[180:183], v[204:207], v[116:119], v[180:183]
    s_waitcnt lgkmcnt(4)
    v_mfma_f32_16x16x32_bf16 v[152:155], v[208:211], v[52:55], v[152:155]
    v_mfma_f32_16x16x32_bf16 v[184:187], v[208:211], v[116:119], v[184:187]
    s_waitcnt vmcnt(6) lgkmcnt(0)
    s_barrier
    ds_read_b64_tr_b16 v[204:205], v244 offset:8192
    ds_read_b64_tr_b16 v[206:207], v244 offset:9216
    ds_read_b128 v[220:223], v3 offset:8256
    ds_read_b64_tr_b16 v[208:209], v245 offset:8192
    ds_read_b64_tr_b16 v[210:211], v245 offset:9216
    v_mfma_f32_16x16x32_bf16 v[156:159], v[212:215], v[52:55], v[156:159]
    s_add_u32 m0, s46, 0
    s_add_u32 s56, s55, 31744
    buffer_load_dwordx4 v253, s[16:19], s55 offen  lds
    s_add_u32 s55, s55, s60
    v_mfma_f32_16x16x32_bf16 v[188:191], v[212:215], v[116:119], v[188:191]
    ds_read_b64_tr_b16 v[212:213], v246 offset:8192
    buffer_load_dwordx4 v253, s[16:19], s56 offen offset:1024  lds
    s_and_b32 s55, s55, 0x3fffff
    v_mfma_f32_16x16x32_bf16 v[160:163], v[216:219], v[52:55], v[160:163]
    ds_read_b64_tr_b16 v[214:215], v246 offset:9216
    v_mfma_f32_16x16x32_bf16 v[192:195], v[216:219], v[116:119], v[192:195]
    s_waitcnt lgkmcnt(5)
    ds_read_b64_tr_b16 v[216:217], v247 offset:8192
    v_mfma_f32_16x16x32_bf16 v[132:135], v[204:207], v[56:59], v[132:135]
    ds_read_b64_tr_b16 v[218:219], v247 offset:9216
    v_mfma_f32_16x16x32_bf16 v[164:167], v[204:207], v[120:123], v[164:167]
    s_add_u32 m0, s45, 32768
    s_add_u32 s54, s54, 8192
    buffer_load_dwordx4 v252, s[4:7], s54 offen nt lds
    buffer_load_dwordx4 v252, s[4:7], s54 offen offset:2048 nt lds
    s_add_u32 m0, s45, 40960
    s_add_u32 s54, s54, 8192
    buffer_load_dwordx4 v252, s[4:7], s54 offen nt lds
    buffer_load_dwordx4 v252, s[4:7], s54 offen offset:2048 nt lds
    s_waitcnt lgkmcnt(6)
    v_mfma_f32_16x16x32_bf16 v[196:199], v[204:207], v[220:223], v[196:199]
    s_waitcnt lgkmcnt(4)
    ds_read_b64_tr_b16 v[204:205], v248 offset:8192
    v_mfma_f32_16x16x32_bf16 v[136:139], v[208:211], v[56:59], v[136:139]
    ds_read_b64_tr_b16 v[206:207], v248 offset:9216
    v_mfma_f32_16x16x32_bf16 v[168:171], v[208:211], v[120:123], v[168:171]
    v_mfma_f32_16x16x32_bf16 v[200:203], v[208:211], v[220:223], v[200:203]
    s_waitcnt lgkmcnt(4)
    ds_read_b64_tr_b16 v[208:209], v249 offset:8192
    v_mfma_f32_16x16x32_bf16 v[140:143], v[212:215], v[56:59], v[140:143]
    ds_read_b64_tr_b16 v[210:211], v249 offset:9216
    v_mfma_f32_16x16x32_bf16 v[172:175], v[212:215], v[120:123], v[172:175]
    s_waitcnt lgkmcnt(4)
    ds_read_b64_tr_b16 v[212:213], v250 offset:8192
    v_mfma_f32_16x16x32_bf16 v[144:147], v[216:219], v[56:59], v[144:147]
    ds_read_b64_tr_b16 v[214:215], v250 offset:9216
    v_mfma_f32_16x16x32_bf16 v[176:179], v[216:219], v[120:123], v[176:179]
    s_waitcnt lgkmcnt(4)
    ds_read_b64_tr_b16 v[216:217], v251 offset:8192
    v_mfma_f32_16x16x32_bf16 v[148:151], v[204:207], v[56:59], v[148:151]
    ds_read_b64_tr_b16 v[218:219], v251 offset:9216
    v_mfma_f32_16x16x32_bf16 v[180:183], v[204:207], v[120:123], v[180:183]
    s_waitcnt lgkmcnt(4)
    v_mfma_f32_16x16x32_bf16 v[152:155], v[208:211], v[56:59], v[152:155]
    v_mfma_f32_16x16x32_bf16 v[184:187], v[208:211], v[120:123], v[184:187]
    s_waitcnt vmcnt(8) lgkmcnt(0)
    s_barrier
    ds_read_b64_tr_b16 v[204:205], v244 offset:16384
    ds_read_b64_tr_b16 v[206:207], v244 offset:17408
    ds_read_b128 v[220:223], v3 offset:10240
    ds_read_b64_tr_b16 v[208:209], v245 offset:16384
    ds_read_b64_tr_b16 v[210:211], v245 offset:17408
    v_mfma_f32_16x16x32_bf16 v[156:159], v[212:215], v[56:59], v[156:159]
    s_add_u32 m0, s46, 8192
    s_add_u32 s56, s55, 31744
    buffer_load_dwordx4 v253, s[16:19], s55 offen  lds
    s_add_u32 s55, s55, 262144
    v_mfma_f32_16x16x32_bf16 v[188:191], v[212:215], v[120:123], v[188:191]
    ds_read_b64_tr_b16 v[212:213], v246 offset:16384
    buffer_load_dwordx4 v253, s[16:19], s56 offen offset:1024  lds
    s_and_b32 s55, s55, 0x3fffff
    v_mfma_f32_16x16x32_bf16 v[160:163], v[216:219], v[56:59], v[160:163]
    ds_read_b64_tr_b16 v[214:215], v246 offset:17408
    v_mfma_f32_16x16x32_bf16 v[192:195], v[216:219], v[120:123], v[192:195]
    s_waitcnt lgkmcnt(5)
    ds_read_b64_tr_b16 v[216:217], v247 offset:16384
    v_mfma_f32_16x16x32_bf16 v[132:135], v[204:207], v[60:63], v[132:135]
    ds_read_b64_tr_b16 v[218:219], v247 offset:17408
    v_mfma_f32_16x16x32_bf16 v[164:167], v[204:207], v[124:127], v[164:167]
    s_add_u32 m0, s45, 49152
    s_add_u32 s63, s63, 8192
    buffer_load_dwordx4 v252, s[8:11], s63 offen nt lds
    buffer_load_dwordx4 v252, s[8:11], s63 offen offset:2048 nt lds
    s_add_u32 m0, s45, 57344
    s_add_u32 s63, s63, 8192
    buffer_load_dwordx4 v252, s[8:11], s63 offen nt lds
    buffer_load_dwordx4 v252, s[8:11], s63 offen offset:2048 nt lds
    s_waitcnt lgkmcnt(6)
    v_mfma_f32_16x16x32_bf16 v[196:199], v[204:207], v[220:223], v[196:199]
    s_waitcnt lgkmcnt(4)
    ds_read_b64_tr_b16 v[204:205], v248 offset:16384
    v_mfma_f32_16x16x32_bf16 v[136:139], v[208:211], v[60:63], v[136:139]
    ds_read_b64_tr_b16 v[206:207], v248 offset:17408
    v_mfma_f32_16x16x32_bf16 v[168:171], v[208:211], v[124:127], v[168:171]
    v_mfma_f32_16x16x32_bf16 v[200:203], v[208:211], v[220:223], v[200:203]
    s_waitcnt lgkmcnt(4)
    ds_read_b64_tr_b16 v[208:209], v249 offset:16384
    v_mfma_f32_16x16x32_bf16 v[140:143], v[212:215], v[60:63], v[140:143]
    ds_read_b64_tr_b16 v[210:211], v249 offset:17408
    v_mfma_f32_16x16x32_bf16 v[172:175], v[212:215], v[124:127], v[172:175]
    s_waitcnt lgkmcnt(4)
    ds_read_b64_tr_b16 v[212:213], v250 offset:16384
    v_mfma_f32_16x16x32_bf16 v[144:147], v[216:219], v[60:63], v[144:147]
    ds_read_b64_tr_b16 v[214:215], v250 offset:17408
    v_mfma_f32_16x16x32_bf16 v[176:179], v[216:219], v[124:127], v[176:179]
    s_waitcnt lgkmcnt(4)
    ds_read_b64_tr_b16 v[216:217], v251 offset:16384
    v_mfma_f32_16x16x32_bf16 v[148:151], v[204:207], v[60:63], v[148:151]
    ds_read_b64_tr_b16 v[218:219], v251 offset:17408
    v_mfma_f32_16x16x32_bf16 v[180:183], v[204:207], v[124:127], v[180:183]
    s_waitcnt lgkmcnt(4)
    v_mfma_f32_16x16x32_bf16 v[152:155], v[208:211], v[60:63], v[152:155]
    v_mfma_f32_16x16x32_bf16 v[184:187], v[208:211], v[124:127], v[184:187]
    s_waitcnt vmcnt(6) lgkmcnt(0)
    s_barrier
    ds_read_b64_tr_b16 v[204:205], v244 offset:0
    ds_read_b64_tr_b16 v[206:207], v244 offset:1024
    ds_read_b128 v[220:223], v3 offset:10304
    ds_read_b64_tr_b16 v[208:209], v245 offset:0
    ds_read_b64_tr_b16 v[210:211], v245 offset:1024
    v_mfma_f32_16x16x32_bf16 v[156:159], v[212:215], v[60:63], v[156:159]
    s_add_u32 m0, s46, 16384
    s_add_u32 s56, s55, 31744
    buffer_load_dwordx4 v253, s[16:19], s55 offen  lds
    s_add_u32 s55, s55, 262144
    buffer_load_dwordx4 v253, s[16:19], s56 offen offset:1024  lds
    s_and_b32 s55, s55, 0x3fffff
    s_add_u32 m0, s45, 0
    s_add_u32 s54, s54, 8192
    buffer_load_dwordx4 v252, s[4:7], s54 offen nt lds
    buffer_load_dwordx4 v252, s[4:7], s54 offen offset:2048 nt lds
    s_add_u32 m0, s45, 8192
    s_add_u32 s54, s54, 8192
    buffer_load_dwordx4 v252, s[4:7], s54 offen nt lds
    buffer_load_dwordx4 v252, s[4:7], s54 offen offset:2048 nt lds
    v_mfma_f32_16x16x32_bf16 v[188:191], v[212:215], v[124:127], v[188:191]
    ds_read_b64_tr_b16 v[212:213], v246 offset:0
    v_mfma_f32_16x16x32_bf16 v[160:163], v[216:219], v[60:63], v[160:163]
    ds_read_b64_tr_b16 v[214:215], v246 offset:1024
    v_mfma_f32_16x16x32_bf16 v[192:195], v[216:219], v[124:127], v[192:195]
    s_waitcnt lgkmcnt(5)
    ds_read_b64_tr_b16 v[216:217], v247 offset:0
    v_mfma_f32_16x16x32_bf16 v[132:135], v[204:207], v[64:67], v[132:135]
    ds_read_b64_tr_b16 v[218:219], v247 offset:1024
    v_mfma_f32_16x16x32_bf16 v[164:167], v[204:207], v[128:131], v[164:167]
    s_waitcnt lgkmcnt(6)
    v_mfma_f32_16x16x32_bf16 v[196:199], v[204:207], v[220:223], v[196:199]
    s_waitcnt lgkmcnt(4)
    ds_read_b64_tr_b16 v[204:205], v248 offset:0
    v_mfma_f32_16x16x32_bf16 v[136:139], v[208:211], v[64:67], v[136:139]
    ds_read_b64_tr_b16 v[206:207], v248 offset:1024
    v_mfma_f32_16x16x32_bf16 v[168:171], v[208:211], v[128:131], v[168:171]
    v_mfma_f32_16x16x32_bf16 v[200:203], v[208:211], v[220:223], v[200:203]
    s_waitcnt lgkmcnt(4)
    ds_read_b64_tr_b16 v[208:209], v249 offset:0
    v_mfma_f32_16x16x32_bf16 v[140:143], v[212:215], v[64:67], v[140:143]
    ds_read_b64_tr_b16 v[210:211], v249 offset:1024
    v_mfma_f32_16x16x32_bf16 v[172:175], v[212:215], v[128:131], v[172:175]
    s_waitcnt lgkmcnt(4)
    ds_read_b64_tr_b16 v[212:213], v250 offset:0
    v_mfma_f32_16x16x32_bf16 v[144:147], v[216:219], v[64:67], v[144:147]
    ds_read_b64_tr_b16 v[214:215], v250 offset:1024
    v_mfma_f32_16x16x32_bf16 v[176:179], v[216:219], v[128:131], v[176:179]
    s_waitcnt lgkmcnt(4)
    ds_read_b64_tr_b16 v[216:217], v251 offset:0
    v_mfma_f32_16x16x32_bf16 v[148:151], v[204:207], v[64:67], v[148:151]
    ds_read_b64_tr_b16 v[218:219], v251 offset:1024
    v_mfma_f32_16x16x32_bf16 v[180:183], v[204:207], v[128:131], v[180:183]
    s_waitcnt lgkmcnt(4)
    v_mfma_f32_16x16x32_bf16 v[152:155], v[208:211], v[64:67], v[152:155]
    v_mfma_f32_16x16x32_bf16 v[184:187], v[208:211], v[128:131], v[184:187]
    s_waitcnt lgkmcnt(2)
    v_mfma_f32_16x16x32_bf16 v[156:159], v[212:215], v[64:67], v[156:159]
    v_mfma_f32_16x16x32_bf16 v[188:191], v[212:215], v[128:131], v[188:191]
    s_waitcnt lgkmcnt(0)
    v_mfma_f32_16x16x32_bf16 v[160:163], v[216:219], v[64:67], v[160:163]
    v_mfma_f32_16x16x32_bf16 v[192:195], v[216:219], v[128:131], v[192:195]
    s_waitcnt vmcnt(8) lgkmcnt(0)
    s_barrier
    s_add_u32 m0, s46, 0
    s_add_u32 s56, s55, 31744
    buffer_load_dwordx4 v253, s[16:19], s55 offen  lds
    s_add_u32 s55, s55, 262144
    buffer_load_dwordx4 v253, s[16:19], s56 offen offset:1024  lds
    s_and_b32 s55, s55, 0x3fffff
    v_add_u32 v1, s47, v2
    v_mul_f32 v196, s58, v196
    v_mul_f32 v197, s58, v197
    v_mul_f32 v198, s58, v198
    v_mul_f32 v199, s58, v199
    v_cvt_pk_bf16_f32 v196, v196, v197
    v_cvt_pk_bf16_f32 v197, v198, v199
    ds_write_b64 v1, v[196:197] offset:32768
    v_mul_f32 v200, s58, v200
    v_mul_f32 v201, s58, v201
    v_mul_f32 v202, s58, v202
    v_mul_f32 v203, s58, v203
    v_cvt_pk_bf16_f32 v200, v200, v201
    v_cvt_pk_bf16_f32 v201, v202, v203
    ds_write_b64 v1, v[200:201] offset:33280
    v_add_u32 v1, s50, v2
    v_mul_f32 v132, s58, v132
    v_mul_f32 v133, s58, v133
    v_mul_f32 v134, s58, v134
    v_mul_f32 v135, s58, v135
    v_cvt_pk_bf16_f32 v132, v132, v133
    v_cvt_pk_bf16_f32 v133, v134, v135
    ds_write_b64 v1, v[132:133] offset:0
    v_mul_f32 v164, s58, v164
    v_mul_f32 v165, s58, v165
    v_mul_f32 v166, s58, v166
    v_mul_f32 v167, s58, v167
    v_cvt_pk_bf16_f32 v164, v164, v165
    v_cvt_pk_bf16_f32 v165, v166, v167
    ds_write_b64 v1, v[164:165] offset:4096
    v_mul_f32 v136, s58, v136
    v_mul_f32 v137, s58, v137
    v_mul_f32 v138, s58, v138
    v_mul_f32 v139, s58, v139
    v_cvt_pk_bf16_f32 v136, v136, v137
    v_cvt_pk_bf16_f32 v137, v138, v139
    ds_write_b64 v1, v[136:137] offset:512
    v_mul_f32 v168, s58, v168
    v_mul_f32 v169, s58, v169
    v_mul_f32 v170, s58, v170
    v_mul_f32 v171, s58, v171
    v_cvt_pk_bf16_f32 v168, v168, v169
    v_cvt_pk_bf16_f32 v169, v170, v171
    ds_write_b64 v1, v[168:169] offset:4608
    v_add_u32 v1, s51, v2
    v_mul_f32 v140, s58, v140
    v_mul_f32 v141, s58, v141
    v_mul_f32 v142, s58, v142
    v_mul_f32 v143, s58, v143
    v_cvt_pk_bf16_f32 v140, v140, v141
    v_cvt_pk_bf16_f32 v141, v142, v143
    ds_write_b64 v1, v[140:141] offset:0
    v_mul_f32 v172, s58, v172
    v_mul_f32 v173, s58, v173
    v_mul_f32 v174, s58, v174
    v_mul_f32 v175, s58, v175
    v_cvt_pk_bf16_f32 v172, v172, v173
    v_cvt_pk_bf16_f32 v173, v174, v175
    ds_write_b64 v1, v[172:173] offset:4096
    v_mul_f32 v144, s58, v144
    v_mul_f32 v145, s58, v145
    v_mul_f32 v146, s58, v146
    v_mul_f32 v147, s58, v147
    v_cvt_pk_bf16_f32 v144, v144, v145
    v_cvt_pk_bf16_f32 v145, v146, v147
    ds_write_b64 v1, v[144:145] offset:512
    v_mul_f32 v176, s58, v176
    v_mul_f32 v177, s58, v177
    v_mul_f32 v178, s58, v178
    v_mul_f32 v179, s58, v179
    v_cvt_pk_bf16_f32 v176, v176, v177
    v_cvt_pk_bf16_f32 v177, v178, v179
    ds_write_b64 v1, v[176:177] offset:4608
    v_add_u32 v1, s52, v2
    v_mul_f32 v148, s58, v148
    v_mul_f32 v149, s58, v149
    v_mul_f32 v150, s58, v150
    v_mul_f32 v151, s58, v151
    v_cvt_pk_bf16_f32 v148, v148, v149
    v_cvt_pk_bf16_f32 v149, v150, v151
    ds_write_b64 v1, v[148:149] offset:0
    v_mul_f32 v180, s58, v180
    v_mul_f32 v181, s58, v181
    v_mul_f32 v182, s58, v182
    v_mul_f32 v183, s58, v183
    v_cvt_pk_bf16_f32 v180, v180, v181
    v_cvt_pk_bf16_f32 v181, v182, v183
    ds_write_b64 v1, v[180:181] offset:4096
    v_mul_f32 v152, s58, v152
    v_mul_f32 v153, s58, v153
    v_mul_f32 v154, s58, v154
    v_mul_f32 v155, s58, v155
    v_cvt_pk_bf16_f32 v152, v152, v153
    v_cvt_pk_bf16_f32 v153, v154, v155
    ds_write_b64 v1, v[152:153] offset:512
    v_mul_f32 v184, s58, v184
    v_mul_f32 v185, s58, v185
    v_mul_f32 v186, s58, v186
    v_mul_f32 v187, s58, v187
    v_cvt_pk_bf16_f32 v184, v184, v185
    v_cvt_pk_bf16_f32 v185, v186, v187
    ds_write_b64 v1, v[184:185] offset:4608
    v_add_u32 v1, s53, v2
    v_mul_f32 v156, s58, v156
    v_mul_f32 v157, s58, v157
    v_mul_f32 v158, s58, v158
    v_mul_f32 v159, s58, v159
    v_cvt_pk_bf16_f32 v156, v156, v157
    v_cvt_pk_bf16_f32 v157, v158, v159
    ds_write_b64 v1, v[156:157] offset:0
    v_mul_f32 v188, s58, v188
    v_mul_f32 v189, s58, v189
    v_mul_f32 v190, s58, v190
    v_mul_f32 v191, s58, v191
    v_cvt_pk_bf16_f32 v188, v188, v189
    v_cvt_pk_bf16_f32 v189, v190, v191
    ds_write_b64 v1, v[188:189] offset:4096
    v_mul_f32 v160, s58, v160
    v_mul_f32 v161, s58, v161
    v_mul_f32 v162, s58, v162
    v_mul_f32 v163, s58, v163
    v_cvt_pk_bf16_f32 v160, v160, v161
    v_cvt_pk_bf16_f32 v161, v162, v163
    ds_write_b64 v1, v[160:161] offset:512
    v_mul_f32 v192, s58, v192
    v_mul_f32 v193, s58, v193
    v_mul_f32 v194, s58, v194
    v_mul_f32 v195, s58, v195
    v_cvt_pk_bf16_f32 v192, v192, v193
    v_cvt_pk_bf16_f32 v193, v194, v195
    ds_write_b64 v1, v[192:193] offset:4608
    s_add_u32 m0, s45, 16384
    s_add_u32 s63, s63, 8192
    buffer_load_dwordx4 v252, s[8:11], s63 offen nt lds
    buffer_load_dwordx4 v252, s[8:11], s63 offen offset:2048 nt lds
    s_add_u32 m0, s45, 24576
    s_add_u32 s63, s63, 8192
    buffer_load_dwordx4 v252, s[8:11], s63 offen nt lds
    buffer_load_dwordx4 v252, s[8:11], s63 offen offset:2048 nt lds
    v_lshlrev_b32 v255, 3, v0
    s_mul_i32 s41, s36, 32768
    s_add_u32 s41, s41, s88
    s_add_u32 s41, s41, 188416
    s_cmp_lt_u32 s36, 2
    s_cselect_b32 s41, s41, 0x40000000
    buffer_load_dword v255, v255, s[4:7], s41 offen
    s_waitcnt vmcnt(7) lgkmcnt(0)
    s_barrier
    ds_read_b64_tr_b16 v[204:205], v244 offset:8192
    ds_read_b64_tr_b16 v[206:207], v244 offset:9216
    v_add_u32 v3, 61440, v3
    ds_read_b128 v[220:223], v3 offset:4096
    ds_read_b64_tr_b16 v[208:209], v245 offset:8192
    ds_read_b64_tr_b16 v[210:211], v245 offset:9216
    ds_read_b64_tr_b16 v[212:213], v246 offset:8192
    ds_read_b64_tr_b16 v[214:215], v246 offset:9216
    ds_read_b64_tr_b16 v[216:217], v247 offset:8192
    ds_read_b64_tr_b16 v[218:219], v247 offset:9216
    s_waitcnt lgkmcnt(7)
    v_mfma_f32_16x16x32_bf16 v[132:135], v[204:207], v[4:7], 0
    s_add_u32 m0, s45, 32768
    s_add_u32 s54, s54, 8192
    buffer_load_dwordx4 v252, s[4:7], s54 offen nt lds
    buffer_load_dwordx4 v252, s[4:7], s54 offen offset:2048 nt lds
    s_add_u32 m0, s45, 40960
    s_add_u32 s54, s54, 8192
    buffer_load_dwordx4 v252, s[4:7], s54 offen nt lds
    buffer_load_dwordx4 v252, s[4:7], s54 offen offset:2048 nt lds
    v_mfma_f32_16x16x32_bf16 v[164:167], v[204:207], v[68:71], 0
    s_waitcnt lgkmcnt(6)
    v_mfma_f32_16x16x32_bf16 v[196:199], v[204:207], v[220:223], 0
    s_waitcnt lgkmcnt(4)
    ds_read_b64_tr_b16 v[204:205], v248 offset:8192
    v_mfma_f32_16x16x32_bf16 v[136:139], v[208:211], v[4:7], 0
    ds_read_b64_tr_b16 v[206:207], v248 offset:9216
    v_mfma_f32_16x16x32_bf16 v[168:171], v[208:211], v[68:71], 0
    v_mfma_f32_16x16x32_bf16 v[200:203], v[208:211], v[220:223], 0
    s_waitcnt lgkmcnt(4)
    ds_read_b64_tr_b16 v[208:209], v249 offset:8192
    v_mfma_f32_16x16x32_bf16 v[140:143], v[212:215], v[4:7], 0
    ds_read_b64_tr_b16 v[210:211], v249 offset:9216
    v_mfma_f32_16x16x32_bf16 v[172:175], v[212:215], v[68:71], 0
    s_waitcnt lgkmcnt(4)
    ds_read_b64_tr_b16 v[212:213], v250 offset:8192
    v_mfma_f32_16x16x32_bf16 v[144:147], v[216:219], v[4:7], 0
    ds_read_b64_tr_b16 v[214:215], v250 offset:9216
    v_mfma_f32_16x16x32_bf16 v[176:179], v[216:219], v[68:71], 0
    s_waitcnt lgkmcnt(4)
    ds_read_b64_tr_b16 v[216:217], v251 offset:8192
    v_mfma_f32_16x16x32_bf16 v[148:151], v[204:207], v[4:7], 0
    ds_read_b64_tr_b16 v[218:219], v251 offset:9216
    v_mfma_f32_16x16x32_bf16 v[180:183], v[204:207], v[68:71], 0
    s_waitcnt lgkmcnt(4)
    ds_read_b64_tr_b16 v[204:205], v244 offset:16384
    v_mfma_f32_16x16x32_bf16 v[152:155], v[208:211], v[4:7], 0
    ds_read_b64_tr_b16 v[206:207], v244 offset:17408
    v_mfma_f32_16x16x32_bf16 v[184:187], v[208:211], v[68:71], 0
    s_waitcnt lgkmcnt(4)
    ds_read_b128 v[220:223], v3 offset:4160
    v_mfma_f32_16x16x32_bf16 v[156:159], v[212:215], v[4:7], 0
    ds_read_b64_tr_b16 v[208:209], v245 offset:16384
    v_mfma_f32_16x16x32_bf16 v[188:191], v[212:215], v[68:71], 0
    s_waitcnt lgkmcnt(4)
    ds_read_b64_tr_b16 v[210:211], v245 offset:17408
    v_mfma_f32_16x16x32_bf16 v[160:163], v[216:219], v[4:7], 0
    ds_read_b64_tr_b16 v[212:213], v246 offset:16384
    v_mfma_f32_16x16x32_bf16 v[192:195], v[216:219], v[68:71], 0
    s_waitcnt lgkmcnt(4)
    ds_read_b64_tr_b16 v[214:215], v246 offset:17408
    v_mfma_f32_16x16x32_bf16 v[132:135], v[204:207], v[8:11], v[132:135]
    ds_read_b64_tr_b16 v[216:217], v247 offset:16384
    v_mfma_f32_16x16x32_bf16 v[164:167], v[204:207], v[72:75], v[164:167]
    s_waitcnt lgkmcnt(5)
    ds_read_b64_tr_b16 v[218:219], v247 offset:17408
    v_mfma_f32_16x16x32_bf16 v[196:199], v[204:207], v[220:223], v[196:199]
    s_waitcnt lgkmcnt(4)
    ds_read_b64_tr_b16 v[204:205], v248 offset:16384
    v_mfma_f32_16x16x32_bf16 v[136:139], v[208:211], v[8:11], v[136:139]
    ds_read_b64_tr_b16 v[206:207], v248 offset:17408
    v_mfma_f32_16x16x32_bf16 v[168:171], v[208:211], v[72:75], v[168:171]
    v_mfma_f32_16x16x32_bf16 v[200:203], v[208:211], v[220:223], v[200:203]
    s_waitcnt lgkmcnt(4)
    ds_read_b64_tr_b16 v[208:209], v249 offset:16384
    v_mfma_f32_16x16x32_bf16 v[140:143], v[212:215], v[8:11], v[140:143]
    ds_read_b64_tr_b16 v[210:211], v249 offset:17408
    v_mfma_f32_16x16x32_bf16 v[172:175], v[212:215], v[72:75], v[172:175]
    s_waitcnt lgkmcnt(4)
    ds_read_b64_tr_b16 v[212:213], v250 offset:16384
    v_mfma_f32_16x16x32_bf16 v[144:147], v[216:219], v[8:11], v[144:147]
    ds_read_b64_tr_b16 v[214:215], v250 offset:17408
    v_mfma_f32_16x16x32_bf16 v[176:179], v[216:219], v[72:75], v[176:179]
    s_waitcnt lgkmcnt(4)
    ds_read_b64_tr_b16 v[216:217], v251 offset:16384
    v_mfma_f32_16x16x32_bf16 v[148:151], v[204:207], v[8:11], v[148:151]
    ds_read_b64_tr_b16 v[218:219], v251 offset:17408
    v_mfma_f32_16x16x32_bf16 v[180:183], v[204:207], v[72:75], v[180:183]
    s_waitcnt lgkmcnt(4)
    v_mfma_f32_16x16x32_bf16 v[152:155], v[208:211], v[8:11], v[152:155]
    v_mfma_f32_16x16x32_bf16 v[184:187], v[208:211], v[72:75], v[184:187]
    s_waitcnt vmcnt(7) lgkmcnt(0)
    s_barrier
    ds_read_b64_tr_b16 v[204:205], v244 offset:0
    ds_read_b64_tr_b16 v[206:207], v244 offset:1024
    ds_read_b128 v[220:223], v3 offset:6144
    ds_read_b64_tr_b16 v[208:209], v245 offset:0
    ds_read_b64_tr_b16 v[210:211], v245 offset:1024
    v_mfma_f32_16x16x32_bf16 v[156:159], v[212:215], v[8:11], v[156:159]
    s_add_u32 m0, s46, 8192
    s_add_u32 s56, s55, 31744
    buffer_load_dwordx4 v253, s[16:19], s55 offen  lds
    s_add_u32 s55, s55, 262144
    buffer_load_dwordx4 v253, s[16:19], s56 offen offset:1024  lds
    s_and_b32 s55, s55, 0x3fffff
    s_add_u32 m0, s46, 16384
    s_add_u32 s56, s55, 31744
    buffer_load_dwordx4 v253, s[16:19], s55 offen  lds
    s_add_u32 s55, s55, 262144
    buffer_load_dwordx4 v253, s[16:19], s56 offen offset:1024  lds
    s_and_b32 s55, s55, 0x3fffff
    s_add_u32 m0, s45, 49152
    s_add_u32 s63, s63, 8192
    buffer_load_dwordx4 v252, s[8:11], s63 offen nt lds
    buffer_load_dwordx4 v252, s[8:11], s63 offen offset:2048 nt lds
    s_add_u32 m0, s45, 57344
    s_add_u32 s63, s63, 8192
    buffer_load_dwordx4 v252, s[8:11], s63 offen nt lds
    buffer_load_dwordx4 v252, s[8:11], s63 offen offset:2048 nt lds
    v_mfma_f32_16x16x32_bf16 v[188:191], v[212:215], v[72:75], v[188:191]
    ds_read_b64_tr_b16 v[212:213], v246 offset:0
    v_mfma_f32_16x16x32_bf16 v[160:163], v[216:219], v[8:11], v[160:163]
    ds_read_b64_tr_b16 v[214:215], v246 offset:1024
    v_mfma_f32_16x16x32_bf16 v[192:195], v[216:219], v[72:75], v[192:195]
    s_waitcnt lgkmcnt(5)
    ds_read_b64_tr_b16 v[216:217], v247 offset:0
    v_mfma_f32_16x16x32_bf16 v[132:135], v[204:207], v[12:15], v[132:135]
    ds_read_b64_tr_b16 v[218:219], v247 offset:1024
    v_mfma_f32_16x16x32_bf16 v[164:167], v[204:207], v[76:79], v[164:167]
    s_waitcnt lgkmcnt(6)
    v_mfma_f32_16x16x32_bf16 v[196:199], v[204:207], v[220:223], v[196:199]
    s_waitcnt lgkmcnt(4)
    ds_read_b64_tr_b16 v[204:205], v248 offset:0
    v_mfma_f32_16x16x32_bf16 v[136:139], v[208:211], v[12:15], v[136:139]
    ds_read_b64_tr_b16 v[206:207], v248 offset:1024
    v_mfma_f32_16x16x32_bf16 v[168:171], v[208:211], v[76:79], v[168:171]
    v_mfma_f32_16x16x32_bf16 v[200:203], v[208:211], v[220:223], v[200:203]
    s_waitcnt lgkmcnt(4)
    ds_read_b64_tr_b16 v[208:209], v249 offset:0
    v_mfma_f32_16x16x32_bf16 v[140:143], v[212:215], v[12:15], v[140:143]
    ds_read_b64_tr_b16 v[210:211], v249 offset:1024
    v_mfma_f32_16x16x32_bf16 v[172:175], v[212:215], v[76:79], v[172:175]
    s_waitcnt lgkmcnt(4)
    ds_read_b64_tr_b16 v[212:213], v250 offset:0
    v_mfma_f32_16x16x32_bf16 v[144:147], v[216:219], v[12:15], v[144:147]
    ds_read_b64_tr_b16 v[214:215], v250 offset:1024
    v_mfma_f32_16x16x32_bf16 v[176:179], v[216:219], v[76:79], v[176:179]
    s_waitcnt lgkmcnt(4)
    ds_read_b64_tr_b16 v[216:217], v251 offset:0
    v_mfma_f32_16x16x32_bf16 v[148:151], v[204:207], v[12:15], v[148:151]
    ds_read_b64_tr_b16 v[218:219], v251 offset:1024
    v_mfma_f32_16x16x32_bf16 v[180:183], v[204:207], v[76:79], v[180:183]
    s_waitcnt lgkmcnt(4)
    v_mfma_f32_16x16x32_bf16 v[152:155], v[208:211], v[12:15], v[152:155]
    v_mfma_f32_16x16x32_bf16 v[184:187], v[208:211], v[76:79], v[184:187]
    s_waitcnt vmcnt(6) lgkmcnt(0)
    s_barrier
    ds_read_b64_tr_b16 v[204:205], v244 offset:8192
    ds_read_b64_tr_b16 v[206:207], v244 offset:9216
    ds_read_b128 v[220:223], v3 offset:6208
    ds_read_b64_tr_b16 v[208:209], v245 offset:8192
    ds_read_b64_tr_b16 v[210:211], v245 offset:9216
    v_mfma_f32_16x16x32_bf16 v[156:159], v[212:215], v[12:15], v[156:159]
    s_add_u32 m0, s46, 0
    s_add_u32 s56, s55, 31744
    buffer_load_dwordx4 v253, s[16:19], s55 offen  lds
    s_add_u32 s55, s55, 262144
    v_mfma_f32_16x16x32_bf16 v[188:191], v[212:215], v[76:79], v[188:191]
    ds_read_b64_tr_b16 v[212:213], v246 offset:8192
    buffer_load_dwordx4 v253, s[16:19], s56 offen offset:1024  lds
    s_and_b32 s55, s55, 0x3fffff
    v_mfma_f32_16x16x32_bf16 v[160:163], v[216:219], v[12:15], v[160:163]
    ds_read_b64_tr_b16 v[214:215], v246 offset:9216
    v_mfma_f32_16x16x32_bf16 v[192:195], v[216:219], v[76:79], v[192:195]
    s_waitcnt lgkmcnt(5)
    ds_read_b64_tr_b16 v[216:217], v247 offset:8192
    v_mfma_f32_16x16x32_bf16 v[132:135], v[204:207], v[16:19], v[132:135]
    ds_read_b64_tr_b16 v[218:219], v247 offset:9216
    v_mfma_f32_16x16x32_bf16 v[164:167], v[204:207], v[80:83], v[164:167]
    s_waitcnt lgkmcnt(6)
    v_mfma_f32_16x16x32_bf16 v[196:199], v[204:207], v[220:223], v[196:199]
    s_waitcnt lgkmcnt(4)
    ds_read_b64_tr_b16 v[204:205], v248 offset:8192
    v_mfma_f32_16x16x32_bf16 v[136:139], v[208:211], v[16:19], v[136:139]
    ds_read_b64_tr_b16 v[206:207], v248 offset:9216
    v_mfma_f32_16x16x32_bf16 v[168:171], v[208:211], v[80:83], v[168:171]
    v_mfma_f32_16x16x32_bf16 v[200:203], v[208:211], v[220:223], v[200:203]
    s_waitcnt lgkmcnt(4)
    ds_read_b64_tr_b16 v[208:209], v249 offset:8192
    v_mfma_f32_16x16x32_bf16 v[140:143], v[212:215], v[16:19], v[140:143]
    ds_read_b64_tr_b16 v[210:211], v249 offset:9216
    v_mfma_f32_16x16x32_bf16 v[172:175], v[212:215], v[80:83], v[172:175]
    s_waitcnt lgkmcnt(4)
    ds_read_b64_tr_b16 v[212:213], v250 offset:8192
    v_mfma_f32_16x16x32_bf16 v[144:147], v[216:219], v[16:19], v[144:147]
    ds_read_b64_tr_b16 v[214:215], v250 offset:9216
    v_mfma_f32_16x16x32_bf16 v[176:179], v[216:219], v[80:83], v[176:179]
    ds_read_b64_tr_b16 v[216:217], v251 offset:8192
    s_add_u32 m0, s45, 0
    s_add_u32 s54, s54, 8192
    buffer_load_dwordx4 v252, s[4:7], s54 offen nt lds
    buffer_load_dwordx4 v252, s[4:7], s54 offen offset:2048 nt lds
    s_add_u32 m0, s45, 8192
    s_add_u32 s54, s54, 8192
    buffer_load_dwordx4 v252, s[4:7], s54 offen nt lds
    buffer_load_dwordx4 v252, s[4:7], s54 offen offset:2048 nt lds
    s_waitcnt lgkmcnt(5)
    v_mfma_f32_16x16x32_bf16 v[148:151], v[204:207], v[16:19], v[148:151]
    ds_read_b64_tr_b16 v[218:219], v251 offset:9216
    v_mfma_f32_16x16x32_bf16 v[180:183], v[204:207], v[80:83], v[180:183]
    s_waitcnt lgkmcnt(4)
    v_mfma_f32_16x16x32_bf16 v[152:155], v[208:211], v[16:19], v[152:155]
    v_mfma_f32_16x16x32_bf16 v[184:187], v[208:211], v[80:83], v[184:187]
    s_waitcnt vmcnt(8) lgkmcnt(0)
    s_barrier
    ds_read_b64_tr_b16 v[204:205], v244 offset:16384
    ds_read_b64_tr_b16 v[206:207], v244 offset:17408
    ds_read_b128 v[220:223], v3 offset:8192
    ds_read_b64_tr_b16 v[208:209], v245 offset:16384
    ds_read_b64_tr_b16 v[210:211], v245 offset:17408
    v_mfma_f32_16x16x32_bf16 v[156:159], v[212:215], v[16:19], v[156:159]
    s_add_u32 m0, s46, 8192
    s_add_u32 s56, s55, 31744
    buffer_load_dwordx4 v253, s[16:19], s55 offen  lds
    s_add_u32 s55, s55, 262144
    v_mfma_f32_16x16x32_bf16 v[188:191], v[212:215], v[80:83], v[188:191]
    ds_read_b64_tr_b16 v[212:213], v246 offset:16384
    buffer_load_dwordx4 v253, s[16:19], s56 offen offset:1024  lds
    s_and_b32 s55, s55, 0x3fffff
    v_mfma_f32_16x16x32_bf16 v[160:163], v[216:219], v[16:19], v[160:163]
    ds_read_b64_tr_b16 v[214:215], v246 offset:17408
    v_mfma_f32_16x16x32_bf16 v[192:195], v[216:219], v[80:83], v[192:195]
    s_waitcnt lgkmcnt(5)
    ds_read_b64_tr_b16 v[216:217], v247 offset:16384
    v_mfma_f32_16x16x32_bf16 v[132:135], v[204:207], v[20:23], v[132:135]
    ds_read_b64_tr_b16 v[218:219], v247 offset:17408
    v_mfma_f32_16x16x32_bf16 v[164:167], v[204:207], v[84:87], v[164:167]
    s_waitcnt lgkmcnt(6)
    v_mfma_f32_16x16x32_bf16 v[196:199], v[204:207], v[220:223], v[196:199]
    s_waitcnt lgkmcnt(4)
    ds_read_b64_tr_b16 v[204:205], v248 offset:16384
    v_mfma_f32_16x16x32_bf16 v[136:139], v[208:211], v[20:23], v[136:139]
    ds_read_b64_tr_b16 v[206:207], v248 offset:17408
    v_mfma_f32_16x16x32_bf16 v[168:171], v[208:211], v[84:87], v[168:171]
    v_mfma_f32_16x16x32_bf16 v[200:203], v[208:211], v[220:223], v[200:203]
    s_waitcnt lgkmcnt(4)
    ds_read_b64_tr_b16 v[208:209], v249 offset:16384
    v_mfma_f32_16x16x32_bf16 v[140:143], v[212:215], v[20:23], v[140:143]
    ds_read_b64_tr_b16 v[210:211], v249 offset:17408
    v_mfma_f32_16x16x32_bf16 v[172:175], v[212:215], v[84:87], v[172:175]
    s_waitcnt lgkmcnt(4)
    ds_read_b64_tr_b16 v[212:213], v250 offset:16384
    v_mfma_f32_16x16x32_bf16 v[144:147], v[216:219], v[20:23], v[144:147]
    ds_read_b64_tr_b16 v[214:215], v250 offset:17408
    v_mfma_f32_16x16x32_bf16 v[176:179], v[216:219], v[84:87], v[176:179]
    ds_read_b64_tr_b16 v[216:217], v251 offset:16384
    s_add_u32 m0, s45, 16384
    s_add_u32 s63, s63, 8192
    buffer_load_dwordx4 v252, s[8:11], s63 offen nt lds
    buffer_load_dwordx4 v252, s[8:11], s63 offen offset:2048 nt lds
    s_add_u32 m0, s45, 24576
    s_add_u32 s63, s63, 8192
    buffer_load_dwordx4 v252, s[8:11], s63 offen nt lds
    buffer_load_dwordx4 v252, s[8:11], s63 offen offset:2048 nt lds
    s_waitcnt lgkmcnt(5)
    v_mfma_f32_16x16x32_bf16 v[148:151], v[204:207], v[20:23], v[148:151]
    ds_read_b64_tr_b16 v[218:219], v251 offset:17408
    v_mfma_f32_16x16x32_bf16 v[180:183], v[204:207], v[84:87], v[180:183]
    s_waitcnt lgkmcnt(4)
    v_mfma_f32_16x16x32_bf16 v[152:155], v[208:211], v[20:23], v[152:155]
    v_mfma_f32_16x16x32_bf16 v[184:187], v[208:211], v[84:87], v[184:187]
    s_waitcnt vmcnt(6) lgkmcnt(0)
    s_barrier
    ds_read_b64_tr_b16 v[204:205], v244 offset:0
    ds_read_b64_tr_b16 v[206:207], v244 offset:1024
    ds_read_b128 v[220:223], v3 offset:8256
    ds_read_b64_tr_b16 v[208:209], v245 offset:0
    ds_read_b64_tr_b16 v[210:211], v245 offset:1024
    v_mfma_f32_16x16x32_bf16 v[156:159], v[212:215], v[20:23], v[156:159]
    s_add_u32 m0, s46, 16384
    s_add_u32 s56, s55, 31744
    buffer_load_dwordx4 v253, s[16:19], s55 offen  lds
    s_add_u32 s55, s55, 262144
    v_mfma_f32_16x16x32_bf16 v[188:191], v[212:215], v[84:87], v[188:191]
    ds_read_b64_tr_b16 v[212:213], v246 offset:0
    buffer_load_dwordx4 v253, s[16:19], s56 offen offset:1024  lds
    s_and_b32 s55, s55, 0x3fffff
    v_mfma_f32_16x16x32_bf16 v[160:163], v[216:219], v[20:23], v[160:163]
    ds_read_b64_tr_b16 v[214:215], v246 offset:1024
    v_mfma_f32_16x16x32_bf16 v[192:195], v[216:219], v[84:87], v[192:195]
    s_waitcnt lgkmcnt(5)
    ds_read_b64_tr_b16 v[216:217], v247 offset:0
    v_mfma_f32_16x16x32_bf16 v[132:135], v[204:207], v[24:27], v[132:135]
    ds_read_b64_tr_b16 v[218:219], v247 offset:1024
    v_mfma_f32_16x16x32_bf16 v[164:167], v[204:207], v[88:91], v[164:167]
    s_waitcnt lgkmcnt(6)
    v_mfma_f32_16x16x32_bf16 v[196:199], v[204:207], v[220:223], v[196:199]
    s_waitcnt lgkmcnt(4)
    ds_read_b64_tr_b16 v[204:205], v248 offset:0
    v_mfma_f32_16x16x32_bf16 v[136:139], v[208:211], v[24:27], v[136:139]
    ds_read_b64_tr_b16 v[206:207], v248 offset:1024
    v_mfma_f32_16x16x32_bf16 v[168:171], v[208:211], v[88:91], v[168:171]
    v_mfma_f32_16x16x32_bf16 v[200:203], v[208:211], v[220:223], v[200:203]
    s_waitcnt lgkmcnt(4)
    ds_read_b64_tr_b16 v[208:209], v249 offset:0
    v_mfma_f32_16x16x32_bf16 v[140:143], v[212:215], v[24:27], v[140:143]
    ds_read_b64_tr_b16 v[210:211], v249 offset:1024
    v_mfma_f32_16x16x32_bf16 v[172:175], v[212:215], v[88:91], v[172:175]
    s_waitcnt lgkmcnt(4)
    ds_read_b64_tr_b16 v[212:213], v250 offset:0
    v_mfma_f32_16x16x32_bf16 v[144:147], v[216:219], v[24:27], v[144:147]
    ds_read_b64_tr_b16 v[214:215], v250 offset:1024
    v_mfma_f32_16x16x32_bf16 v[176:179], v[216:219], v[88:91], v[176:179]
    ds_read_b64_tr_b16 v[216:217], v251 offset:0
    s_add_u32 m0, s45, 32768
    s_add_u32 s54, s54, 8192
    buffer_load_dwordx4 v252, s[4:7], s54 offen nt lds
    buffer_load_dwordx4 v252, s[4:7], s54 offen offset:2048 nt lds
    s_add_u32 m0, s45, 40960
    s_add_u32 s54, s54, 8192
    buffer_load_dwordx4 v252, s[4:7], s54 offen nt lds
    buffer_load_dwordx4 v252, s[4:7], s54 offen offset:2048 nt lds
    s_waitcnt lgkmcnt(5)
    v_mfma_f32_16x16x32_bf16 v[148:151], v[204:207], v[24:27], v[148:151]
    ds_read_b64_tr_b16 v[218:219], v251 offset:1024
    v_mfma_f32_16x16x32_bf16 v[180:183], v[204:207], v[88:91], v[180:183]
    s_waitcnt lgkmcnt(4)
    v_mfma_f32_16x16x32_bf16 v[152:155], v[208:211], v[24:27], v[152:155]
    v_mfma_f32_16x16x32_bf16 v[184:187], v[208:211], v[88:91], v[184:187]
    s_add_u32 s41, s48, 114688
    v_add_u32 v1, s41, v0
    ds_read_b128 v[224:227], v1 offset:0
    ds_read_b128 v[228:231], v1 offset:1024
    ds_read_b128 v[232:235], v1 offset:2048
    ds_read_b128 v[236:239], v1 offset:3072
    s_add_u32 s41, s47, 147456
    v_add_u32 v1, s41, v0
    ds_read_b128 v[240:243], v1 offset:0
    s_waitcnt vmcnt(8) lgkmcnt(0)
    s_barrier
    ds_read_b64_tr_b16 v[204:205], v244 offset:8192
    ds_read_b64_tr_b16 v[206:207], v244 offset:9216
    ds_read_b128 v[220:223], v3 offset:10240
    ds_read_b64_tr_b16 v[208:209], v245 offset:8192
    ds_read_b64_tr_b16 v[210:211], v245 offset:9216
    v_mfma_f32_16x16x32_bf16 v[156:159], v[212:215], v[24:27], v[156:159]
    s_add_u32 m0, s46, 0
    s_add_u32 s56, s55, 31744
    buffer_load_dwordx4 v253, s[16:19], s55 offen  lds
    s_add_u32 s55, s55, 262144
    v_mfma_f32_16x16x32_bf16 v[188:191], v[212:215], v[88:91], v[188:191]
    ds_read_b64_tr_b16 v[212:213], v246 offset:8192
    buffer_load_dwordx4 v253, s[16:19], s56 offen offset:1024  lds
    s_and_b32 s55, s55, 0x3fffff
    v_mfma_f32_16x16x32_bf16 v[160:163], v[216:219], v[24:27], v[160:163]
    ds_read_b64_tr_b16 v[214:215], v246 offset:9216
    v_mfma_f32_16x16x32_bf16 v[192:195], v[216:219], v[88:91], v[192:195]
    s_waitcnt lgkmcnt(5)
    ds_read_b64_tr_b16 v[216:217], v247 offset:8192
    v_mfma_f32_16x16x32_bf16 v[132:135], v[204:207], v[28:31], v[132:135]
    ds_read_b64_tr_b16 v[218:219], v247 offset:9216
    v_mfma_f32_16x16x32_bf16 v[164:167], v[204:207], v[92:95], v[164:167]
    s_waitcnt lgkmcnt(6)
    v_mfma_f32_16x16x32_bf16 v[196:199], v[204:207], v[220:223], v[196:199]
    s_waitcnt lgkmcnt(4)
    ds_read_b64_tr_b16 v[204:205], v248 offset:8192
    v_mfma_f32_16x16x32_bf16 v[136:139], v[208:211], v[28:31], v[136:139]
    ds_read_b64_tr_b16 v[206:207], v248 offset:9216
    v_mfma_f32_16x16x32_bf16 v[168:171], v[208:211], v[92:95], v[168:171]
    v_mfma_f32_16x16x32_bf16 v[200:203], v[208:211], v[220:223], v[200:203]
    s_waitcnt lgkmcnt(4)
    ds_read_b64_tr_b16 v[208:209], v249 offset:8192
    v_mfma_f32_16x16x32_bf16 v[140:143], v[212:215], v[28:31], v[140:143]
    ds_read_b64_tr_b16 v[210:211], v249 offset:9216
    v_mfma_f32_16x16x32_bf16 v[172:175], v[212:215], v[92:95], v[172:175]
    s_waitcnt lgkmcnt(4)
    ds_read_b64_tr_b16 v[212:213], v250 offset:8192
    v_mfma_f32_16x16x32_bf16 v[144:147], v[216:219], v[28:31], v[144:147]
    ds_read_b64_tr_b16 v[214:215], v250 offset:9216
    v_mfma_f32_16x16x32_bf16 v[176:179], v[216:219], v[92:95], v[176:179]
    ds_read_b64_tr_b16 v[216:217], v251 offset:8192
    s_add_u32 m0, s45, 49152
    s_add_u32 s63, s63, 8192
    buffer_load_dwordx4 v252, s[8:11], s63 offen nt lds
    buffer_load_dwordx4 v252, s[8:11], s63 offen offset:2048 nt lds
    s_add_u32 m0, s45, 57344
    s_add_u32 s63, s63, 8192
    buffer_load_dwordx4 v252, s[8:11], s63 offen nt lds
    buffer_load_dwordx4 v252, s[8:11], s63 offen offset:2048 nt lds
    s_waitcnt lgkmcnt(5)
    v_mfma_f32_16x16x32_bf16 v[148:151], v[204:207], v[28:31], v[148:151]
    ds_read_b64_tr_b16 v[218:219], v251 offset:9216
    v_mfma_f32_16x16x32_bf16 v[180:183], v[204:207], v[92:95], v[180:183]
    s_waitcnt lgkmcnt(4)
    v_mfma_f32_16x16x32_bf16 v[152:155], v[208:211], v[28:31], v[152:155]
    v_mfma_f32_16x16x32_bf16 v[184:187], v[208:211], v[92:95], v[184:187]
    s_waitcnt vmcnt(6) lgkmcnt(0)
    s_barrier
    ds_read_b64_tr_b16 v[204:205], v244 offset:16384
    ds_read_b64_tr_b16 v[206:207], v244 offset:17408
    ds_read_b128 v[220:223], v3 offset:10304
    ds_read_b64_tr_b16 v[208:209], v245 offset:16384
    ds_read_b64_tr_b16 v[210:211], v245 offset:17408
    v_mfma_f32_16x16x32_bf16 v[156:159], v[212:215], v[28:31], v[156:159]
    s_add_u32 m0, s46, 8192
    s_add_u32 s56, s55, 31744
    buffer_load_dwordx4 v253, s[16:19], s55 offen  lds
    s_add_u32 s55, s55, 262144
    v_mfma_f32_16x16x32_bf16 v[188:191], v[212:215], v[92:95], v[188:191]
    ds_read_b64_tr_b16 v[212:213], v246 offset:16384
    buffer_load_dwordx4 v253, s[16:19], s56 offen offset:1024  lds
    s_and_b32 s55, s55, 0x3fffff
    v_mfma_f32_16x16x32_bf16 v[160:163], v[216:219], v[28:31], v[160:163]
    ds_read_b64_tr_b16 v[214:215], v246 offset:17408
    v_mfma_f32_16x16x32_bf16 v[192:195], v[216:219], v[92:95], v[192:195]
    s_waitcnt lgkmcnt(5)
    ds_read_b64_tr_b16 v[216:217], v247 offset:16384
    v_mfma_f32_16x16x32_bf16 v[132:135], v[204:207], v[32:35], v[132:135]
    ds_read_b64_tr_b16 v[218:219], v247 offset:17408
    v_mfma_f32_16x16x32_bf16 v[164:167], v[204:207], v[96:99], v[164:167]
    s_waitcnt lgkmcnt(6)
    v_mfma_f32_16x16x32_bf16 v[196:199], v[204:207], v[220:223], v[196:199]
    s_waitcnt lgkmcnt(4)
    ds_read_b64_tr_b16 v[204:205], v248 offset:16384
    v_mfma_f32_16x16x32_bf16 v[136:139], v[208:211], v[32:35], v[136:139]
    ds_read_b64_tr_b16 v[206:207], v248 offset:17408
    v_mfma_f32_16x16x32_bf16 v[168:171], v[208:211], v[96:99], v[168:171]
    v_mfma_f32_16x16x32_bf16 v[200:203], v[208:211], v[220:223], v[200:203]
    s_waitcnt lgkmcnt(4)
    ds_read_b64_tr_b16 v[208:209], v249 offset:16384
    v_mfma_f32_16x16x32_bf16 v[140:143], v[212:215], v[32:35], v[140:143]
    ds_read_b64_tr_b16 v[210:211], v249 offset:17408
    v_mfma_f32_16x16x32_bf16 v[172:175], v[212:215], v[96:99], v[172:175]
    s_waitcnt lgkmcnt(4)
    ds_read_b64_tr_b16 v[212:213], v250 offset:16384
    v_mfma_f32_16x16x32_bf16 v[144:147], v[216:219], v[32:35], v[144:147]
    ds_read_b64_tr_b16 v[214:215], v250 offset:17408
    v_mfma_f32_16x16x32_bf16 v[176:179], v[216:219], v[96:99], v[176:179]
    ds_read_b64_tr_b16 v[216:217], v251 offset:16384
    s_add_u32 m0, s45, 0
    s_add_u32 s54, s54, 8192
    buffer_load_dwordx4 v252, s[4:7], s54 offen nt lds
    buffer_load_dwordx4 v252, s[4:7], s54 offen offset:2048 nt lds
    s_add_u32 m0, s45, 8192
    s_add_u32 s54, s54, 8192
    buffer_load_dwordx4 v252, s[4:7], s54 offen nt lds
    buffer_load_dwordx4 v252, s[4:7], s54 offen offset:2048 nt lds
    s_waitcnt lgkmcnt(5)
    v_mfma_f32_16x16x32_bf16 v[148:151], v[204:207], v[32:35], v[148:151]
    ds_read_b64_tr_b16 v[218:219], v251 offset:17408
    v_mfma_f32_16x16x32_bf16 v[180:183], v[204:207], v[96:99], v[180:183]
    s_waitcnt lgkmcnt(4)
    v_mfma_f32_16x16x32_bf16 v[152:155], v[208:211], v[32:35], v[152:155]
    v_mfma_f32_16x16x32_bf16 v[184:187], v[208:211], v[96:99], v[184:187]
    s_waitcnt vmcnt(8) lgkmcnt(0)
    s_barrier
    ds_read_b64_tr_b16 v[204:205], v244 offset:0
    ds_read_b64_tr_b16 v[206:207], v244 offset:1024
    v_add_u32 v3, 4294905856, v3
    ds_read_b128 v[220:223], v3 offset:4096
    ds_read_b64_tr_b16 v[208:209], v245 offset:0
    ds_read_b64_tr_b16 v[210:211], v245 offset:1024
    v_mfma_f32_16x16x32_bf16 v[156:159], v[212:215], v[32:35], v[156:159]
    s_add_u32 m0, s46, 16384
    s_add_u32 s56, s55, 31744
    buffer_load_dwordx4 v253, s[16:19], s55 offen  lds
    s_add_u32 s55, s55, 262144
    v_mfma_f32_16x16x32_bf16 v[188:191], v[212:215], v[96:99], v[188:191]
    ds_read_b64_tr_b16 v[212:213], v246 offset:0
    buffer_load_dwordx4 v253, s[16:19], s56 offen offset:1024  lds
    s_and_b32 s55, s55, 0x3fffff
    v_mfma_f32_16x16x32_bf16 v[160:163], v[216:219], v[32:35], v[160:163]
    ds_read_b64_tr_b16 v[214:215], v246 offset:1024
    v_mfma_f32_16x16x32_bf16 v[192:195], v[216:219], v[96:99], v[192:195]
    s_waitcnt lgkmcnt(5)
    ds_read_b64_tr_b16 v[216:217], v247 offset:0
    v_mfma_f32_16x16x32_bf16 v[132:135], v[204:207], v[36:39], v[132:135]
    ds_read_b64_tr_b16 v[218:219], v247 offset:1024
    v_mfma_f32_16x16x32_bf16 v[164:167], v[204:207], v[100:103], v[164:167]
    s_waitcnt lgkmcnt(6)
    v_mfma_f32_16x16x32_bf16 v[196:199], v[204:207], v[220:223], v[196:199]
    s_waitcnt lgkmcnt(4)
    ds_read_b64_tr_b16 v[204:205], v248 offset:0
    v_mfma_f32_16x16x32_bf16 v[136:139], v[208:211], v[36:39], v[136:139]
    ds_read_b64_tr_b16 v[206:207], v248 offset:1024
    v_mfma_f32_16x16x32_bf16 v[168:171], v[208:211], v[100:103], v[168:171]
    v_mfma_f32_16x16x32_bf16 v[200:203], v[208:211], v[220:223], v[200:203]
    s_waitcnt lgkmcnt(4)
    ds_read_b64_tr_b16 v[208:209], v249 offset:0
    v_mfma_f32_16x16x32_bf16 v[140:143], v[212:215], v[36:39], v[140:143]
    ds_read_b64_tr_b16 v[210:211], v249 offset:1024
    v_mfma_f32_16x16x32_bf16 v[172:175], v[212:215], v[100:103], v[172:175]
    s_waitcnt lgkmcnt(4)
    ds_read_b64_tr_b16 v[212:213], v250 offset:0
    v_mfma_f32_16x16x32_bf16 v[144:147], v[216:219], v[36:39], v[144:147]
    ds_read_b64_tr_b16 v[214:215], v250 offset:1024
    v_mfma_f32_16x16x32_bf16 v[176:179], v[216:219], v[100:103], v[176:179]
    ds_read_b64_tr_b16 v[216:217], v251 offset:0
    s_add_u32 m0, s45, 16384
    s_add_u32 s63, s63, 8192
    buffer_load_dwordx4 v252, s[8:11], s63 offen nt lds
    buffer_load_dwordx4 v252, s[8:11], s63 offen offset:2048 nt lds
    s_add_u32 m0, s45, 24576
    s_add_u32 s63, s63, 8192
    buffer_load_dwordx4 v252, s[8:11], s63 offen nt lds
    buffer_load_dwordx4 v252, s[8:11], s63 offen offset:2048 nt lds
    s_waitcnt lgkmcnt(5)
    v_mfma_f32_16x16x32_bf16 v[148:151], v[204:207], v[36:39], v[148:151]
    ds_read_b64_tr_b16 v[218:219], v251 offset:1024
    v_mfma_f32_16x16x32_bf16 v[180:183], v[204:207], v[100:103], v[180:183]
    s_waitcnt lgkmcnt(4)
    v_mfma_f32_16x16x32_bf16 v[152:155], v[208:211], v[36:39], v[152:155]
    v_mfma_f32_16x16x32_bf16 v[184:187], v[208:211], v[100:103], v[184:187]
    s_waitcnt vmcnt(6) lgkmcnt(0)
    s_barrier
    ds_read_b64_tr_b16 v[204:205], v244 offset:8192
    ds_read_b64_tr_b16 v[206:207], v244 offset:9216
    ds_read_b128 v[220:223], v3 offset:4160
    ds_read_b64_tr_b16 v[208:209], v245 offset:8192
    ds_read_b64_tr_b16 v[210:211], v245 offset:9216
    v_mfma_f32_16x16x32_bf16 v[156:159], v[212:215], v[36:39], v[156:159]
    s_add_u32 m0, s46, 0
    s_add_u32 s56, s55, 31744
    buffer_load_dwordx4 v253, s[16:19], s55 offen  lds
    s_add_u32 s55, s55, 262144
    v_mfma_f32_16x16x32_bf16 v[188:191], v[212:215], v[100:103], v[188:191]
    ds_read_b64_tr_b16 v[212:213], v246 offset:8192
    buffer_load_dwordx4 v253, s[16:19], s56 offen offset:1024  lds
    s_and_b32 s55, s55, 0x3fffff
    v_mfma_f32_16x16x32_bf16 v[160:163], v[216:219], v[36:39], v[160:163]
    ds_read_b64_tr_b16 v[214:215], v246 offset:9216
    v_mfma_f32_16x16x32_bf16 v[192:195], v[216:219], v[100:103], v[192:195]
    s_waitcnt lgkmcnt(5)
    ds_read_b64_tr_b16 v[216:217], v247 offset:8192
    v_mfma_f32_16x16x32_bf16 v[132:135], v[204:207], v[40:43], v[132:135]
    ds_read_b64_tr_b16 v[218:219], v247 offset:9216
    v_mfma_f32_16x16x32_bf16 v[164:167], v[204:207], v[104:107], v[164:167]
    s_waitcnt lgkmcnt(6)
    v_mfma_f32_16x16x32_bf16 v[196:199], v[204:207], v[220:223], v[196:199]
    s_waitcnt lgkmcnt(4)
    ds_read_b64_tr_b16 v[204:205], v248 offset:8192
    v_mfma_f32_16x16x32_bf16 v[136:139], v[208:211], v[40:43], v[136:139]
    ds_read_b64_tr_b16 v[206:207], v248 offset:9216
    v_mfma_f32_16x16x32_bf16 v[168:171], v[208:211], v[104:107], v[168:171]
    v_mfma_f32_16x16x32_bf16 v[200:203], v[208:211], v[220:223], v[200:203]
    s_waitcnt lgkmcnt(4)
    ds_read_b64_tr_b16 v[208:209], v249 offset:8192
    v_mfma_f32_16x16x32_bf16 v[140:143], v[212:215], v[40:43], v[140:143]
    ds_read_b64_tr_b16 v[210:211], v249 offset:9216
    v_mfma_f32_16x16x32_bf16 v[172:175], v[212:215], v[104:107], v[172:175]
    s_waitcnt lgkmcnt(4)
    ds_read_b64_tr_b16 v[212:213], v250 offset:8192
    v_mfma_f32_16x16x32_bf16 v[144:147], v[216:219], v[40:43], v[144:147]
    ds_read_b64_tr_b16 v[214:215], v250 offset:9216
    v_mfma_f32_16x16x32_bf16 v[176:179], v[216:219], v[104:107], v[176:179]
    ds_read_b64_tr_b16 v[216:217], v251 offset:8192
    s_add_u32 m0, s45, 32768
    s_add_u32 s54, s54, 8192
    buffer_load_dwordx4 v252, s[4:7], s54 offen nt lds
    buffer_load_dwordx4 v252, s[4:7], s54 offen offset:2048 nt lds
    s_add_u32 m0, s45, 40960
    s_add_u32 s54, s54, 8192
    buffer_load_dwordx4 v252, s[4:7], s54 offen nt lds
    buffer_load_dwordx4 v252, s[4:7], s54 offen offset:2048 nt lds
    s_waitcnt lgkmcnt(5)
    v_mfma_f32_16x16x32_bf16 v[148:151], v[204:207], v[40:43], v[148:151]
    ds_read_b64_tr_b16 v[218:219], v251 offset:9216
    v_mfma_f32_16x16x32_bf16 v[180:183], v[204:207], v[104:107], v[180:183]
    s_waitcnt lgkmcnt(4)
    v_mfma_f32_16x16x32_bf16 v[152:155], v[208:211], v[40:43], v[152:155]
    v_mfma_f32_16x16x32_bf16 v[184:187], v[208:211], v[104:107], v[184:187]
    s_waitcnt vmcnt(8) lgkmcnt(0)
    s_barrier
    ds_read_b64_tr_b16 v[204:205], v244 offset:16384
    ds_read_b64_tr_b16 v[206:207], v244 offset:17408
    ds_read_b128 v[220:223], v3 offset:6144
    ds_read_b64_tr_b16 v[208:209], v245 offset:16384
    ds_read_b64_tr_b16 v[210:211], v245 offset:17408
    v_mfma_f32_16x16x32_bf16 v[156:159], v[212:215], v[40:43], v[156:159]
    s_add_u32 m0, s46, 8192
    s_add_u32 s56, s55, 31744
    buffer_load_dwordx4 v253, s[16:19], s55 offen  lds
    s_add_u32 s55, s55, 262144
    v_mfma_f32_16x16x32_bf16 v[188:191], v[212:215], v[104:107], v[188:191]
    ds_read_b64_tr_b16 v[212:213], v246 offset:16384
    buffer_load_dwordx4 v253, s[16:19], s56 offen offset:1024  lds
    s_and_b32 s55, s55, 0x3fffff
    v_mfma_f32_16x16x32_bf16 v[160:163], v[216:219], v[40:43], v[160:163]
    ds_read_b64_tr_b16 v[214:215], v246 offset:17408
    v_mfma_f32_16x16x32_bf16 v[192:195], v[216:219], v[104:107], v[192:195]
    s_waitcnt lgkmcnt(5)
    ds_read_b64_tr_b16 v[216:217], v247 offset:16384
    v_mfma_f32_16x16x32_bf16 v[132:135], v[204:207], v[44:47], v[132:135]
    ds_read_b64_tr_b16 v[218:219], v247 offset:17408
    v_mfma_f32_16x16x32_bf16 v[164:167], v[204:207], v[108:111], v[164:167]
    s_waitcnt lgkmcnt(6)
    v_mfma_f32_16x16x32_bf16 v[196:199], v[204:207], v[220:223], v[196:199]
    s_waitcnt lgkmcnt(4)
    ds_read_b64_tr_b16 v[204:205], v248 offset:16384
    v_mfma_f32_16x16x32_bf16 v[136:139], v[208:211], v[44:47], v[136:139]
    ds_read_b64_tr_b16 v[206:207], v248 offset:17408
    v_mfma_f32_16x16x32_bf16 v[168:171], v[208:211], v[108:111], v[168:171]
    v_mfma_f32_16x16x32_bf16 v[200:203], v[208:211], v[220:223], v[200:203]
    s_waitcnt lgkmcnt(4)
    ds_read_b64_tr_b16 v[208:209], v249 offset:16384
    v_mfma_f32_16x16x32_bf16 v[140:143], v[212:215], v[44:47], v[140:143]
    ds_read_b64_tr_b16 v[210:211], v249 offset:17408
    v_mfma_f32_16x16x32_bf16 v[172:175], v[212:215], v[108:111], v[172:175]
    s_waitcnt lgkmcnt(4)
    ds_read_b64_tr_b16 v[212:213], v250 offset:16384
    v_mfma_f32_16x16x32_bf16 v[144:147], v[216:219], v[44:47], v[144:147]
    ds_read_b64_tr_b16 v[214:215], v250 offset:17408
    v_mfma_f32_16x16x32_bf16 v[176:179], v[216:219], v[108:111], v[176:179]
    ds_read_b64_tr_b16 v[216:217], v251 offset:16384
    s_add_u32 m0, s45, 49152
    s_add_u32 s63, s63, 8192
    buffer_load_dwordx4 v252, s[8:11], s63 offen nt lds
    buffer_load_dwordx4 v252, s[8:11], s63 offen offset:2048 nt lds
    s_add_u32 m0, s45, 57344
    s_add_u32 s63, s63, 8192
    buffer_load_dwordx4 v252, s[8:11], s63 offen nt lds
    buffer_load_dwordx4 v252, s[8:11], s63 offen offset:2048 nt lds
    s_waitcnt lgkmcnt(5)
    v_mfma_f32_16x16x32_bf16 v[148:151], v[204:207], v[44:47], v[148:151]
    ds_read_b64_tr_b16 v[218:219], v251 offset:17408
    v_mfma_f32_16x16x32_bf16 v[180:183], v[204:207], v[108:111], v[180:183]
    s_waitcnt lgkmcnt(4)
    v_mfma_f32_16x16x32_bf16 v[152:155], v[208:211], v[44:47], v[152:155]
    v_mfma_f32_16x16x32_bf16 v[184:187], v[208:211], v[108:111], v[184:187]
    s_waitcnt vmcnt(6) lgkmcnt(0)
    s_barrier
    ds_read_b64_tr_b16 v[204:205], v244 offset:0
    ds_read_b64_tr_b16 v[206:207], v244 offset:1024
    ds_read_b128 v[220:223], v3 offset:6208
    ds_read_b64_tr_b16 v[208:209], v245 offset:0
    ds_read_b64_tr_b16 v[210:211], v245 offset:1024
    v_mfma_f32_16x16x32_bf16 v[156:159], v[212:215], v[44:47], v[156:159]
    s_add_u32 m0, s46, 16384
    s_add_u32 s56, s55, 31744
    buffer_load_dwordx4 v253, s[16:19], s55 offen  lds
    s_add_u32 s55, s55, 262144
    v_mfma_f32_16x16x32_bf16 v[188:191], v[212:215], v[108:111], v[188:191]
    ds_read_b64_tr_b16 v[212:213], v246 offset:0
    buffer_load_dwordx4 v253, s[16:19], s56 offen offset:1024  lds
    s_and_b32 s55, s55, 0x3fffff
    v_mfma_f32_16x16x32_bf16 v[160:163], v[216:219], v[44:47], v[160:163]
    ds_read_b64_tr_b16 v[214:215], v246 offset:1024
    v_mfma_f32_16x16x32_bf16 v[192:195], v[216:219], v[108:111], v[192:195]
    s_waitcnt lgkmcnt(5)
    ds_read_b64_tr_b16 v[216:217], v247 offset:0
    v_mfma_f32_16x16x32_bf16 v[132:135], v[204:207], v[48:51], v[132:135]
    ds_read_b64_tr_b16 v[218:219], v247 offset:1024
    v_mfma_f32_16x16x32_bf16 v[164:167], v[204:207], v[112:115], v[164:167]
    s_waitcnt lgkmcnt(6)
    v_mfma_f32_16x16x32_bf16 v[196:199], v[204:207], v[220:223], v[196:199]
    s_waitcnt lgkmcnt(4)
    ds_read_b64_tr_b16 v[204:205], v248 offset:0
    v_mfma_f32_16x16x32_bf16 v[136:139], v[208:211], v[48:51], v[136:139]
    ds_read_b64_tr_b16 v[206:207], v248 offset:1024
    v_mfma_f32_16x16x32_bf16 v[168:171], v[208:211], v[112:115], v[168:171]
    v_mfma_f32_16x16x32_bf16 v[200:203], v[208:211], v[220:223], v[200:203]
    s_waitcnt lgkmcnt(4)
    ds_read_b64_tr_b16 v[208:209], v249 offset:0
    v_mfma_f32_16x16x32_bf16 v[140:143], v[212:215], v[48:51], v[140:143]
    ds_read_b64_tr_b16 v[210:211], v249 offset:1024
    v_mfma_f32_16x16x32_bf16 v[172:175], v[212:215], v[112:115], v[172:175]
    s_waitcnt lgkmcnt(4)
    ds_read_b64_tr_b16 v[212:213], v250 offset:0
    v_mfma_f32_16x16x32_bf16 v[144:147], v[216:219], v[48:51], v[144:147]
    ds_read_b64_tr_b16 v[214:215], v250 offset:1024
    v_mfma_f32_16x16x32_bf16 v[176:179], v[216:219], v[112:115], v[176:179]
    ds_read_b64_tr_b16 v[216:217], v251 offset:0
    s_add_u32 m0, s45, 0
    s_add_u32 s54, s54, 8192
    buffer_load_dwordx4 v252, s[4:7], s54 offen nt lds
    buffer_load_dwordx4 v252, s[4:7], s54 offen offset:2048 nt lds
    s_add_u32 m0, s45, 8192
    s_add_u32 s54, s54, 8192
    buffer_load_dwordx4 v252, s[4:7], s54 offen nt lds
    buffer_load_dwordx4 v252, s[4:7], s54 offen offset:2048 nt lds
    s_waitcnt lgkmcnt(5)
    v_mfma_f32_16x16x32_bf16 v[148:151], v[204:207], v[48:51], v[148:151]
    ds_read_b64_tr_b16 v[218:219], v251 offset:1024
    v_mfma_f32_16x16x32_bf16 v[180:183], v[204:207], v[112:115], v[180:183]
    s_waitcnt lgkmcnt(4)
    v_mfma_f32_16x16x32_bf16 v[152:155], v[208:211], v[48:51], v[152:155]
    v_mfma_f32_16x16x32_bf16 v[184:187], v[208:211], v[112:115], v[184:187]
    s_waitcnt vmcnt(8) lgkmcnt(0)
    s_barrier
    ds_read_b64_tr_b16 v[204:205], v244 offset:8192
    ds_read_b64_tr_b16 v[206:207], v244 offset:9216
    ds_read_b128 v[220:223], v3 offset:8192
    ds_read_b64_tr_b16 v[208:209], v245 offset:8192
    ds_read_b64_tr_b16 v[210:211], v245 offset:9216
    v_mfma_f32_16x16x32_bf16 v[156:159], v[212:215], v[48:51], v[156:159]
    s_add_u32 m0, s46, 0
    s_add_u32 s56, s55, 31744
    buffer_load_dwordx4 v253, s[16:19], s55 offen  lds
    s_add_u32 s55, s55, 262144
    v_mfma_f32_16x16x32_bf16 v[188:191], v[212:215], v[112:115], v[188:191]
    ds_read_b64_tr_b16 v[212:213], v246 offset:8192
    buffer_load_dwordx4 v253, s[16:19], s56 offen offset:1024  lds
    s_and_b32 s55, s55, 0x3fffff
    v_mfma_f32_16x16x32_bf16 v[160:163], v[216:219], v[48:51], v[160:163]
    ds_read_b64_tr_b16 v[214:215], v246 offset:9216
    v_mfma_f32_16x16x32_bf16 v[192:195], v[216:219], v[112:115], v[192:195]
    s_waitcnt lgkmcnt(5)
    ds_read_b64_tr_b16 v[216:217], v247 offset:8192
    v_mfma_f32_16x16x32_bf16 v[132:135], v[204:207], v[52:55], v[132:135]
    ds_read_b64_tr_b16 v[218:219], v247 offset:9216
    v_mfma_f32_16x16x32_bf16 v[164:167], v[204:207], v[116:119], v[164:167]
    s_waitcnt lgkmcnt(6)
    v_mfma_f32_16x16x32_bf16 v[196:199], v[204:207], v[220:223], v[196:199]
    s_waitcnt lgkmcnt(4)
    ds_read_b64_tr_b16 v[204:205], v248 offset:8192
    v_mfma_f32_16x16x32_bf16 v[136:139], v[208:211], v[52:55], v[136:139]
    ds_read_b64_tr_b16 v[206:207], v248 offset:9216
    v_mfma_f32_16x16x32_bf16 v[168:171], v[208:211], v[116:119], v[168:171]
    v_mfma_f32_16x16x32_bf16 v[200:203], v[208:211], v[220:223], v[200:203]
    s_waitcnt lgkmcnt(4)
    ds_read_b64_tr_b16 v[208:209], v249 offset:8192
    v_mfma_f32_16x16x32_bf16 v[140:143], v[212:215], v[52:55], v[140:143]
    ds_read_b64_tr_b16 v[210:211], v249 offset:9216
    v_mfma_f32_16x16x32_bf16 v[172:175], v[212:215], v[116:119], v[172:175]
    s_waitcnt lgkmcnt(4)
    ds_read_b64_tr_b16 v[212:213], v250 offset:8192
    v_mfma_f32_16x16x32_bf16 v[144:147], v[216:219], v[52:55], v[144:147]
    ds_read_b64_tr_b16 v[214:215], v250 offset:9216
    v_mfma_f32_16x16x32_bf16 v[176:179], v[216:219], v[116:119], v[176:179]
    ds_read_b64_tr_b16 v[216:217], v251 offset:8192
    s_add_u32 m0, s45, 16384
    s_add_u32 s63, s63, 8192
    buffer_load_dwordx4 v252, s[8:11], s63 offen nt lds
    buffer_load_dwordx4 v252, s[8:11], s63 offen offset:2048 nt lds
    s_add_u32 m0, s45, 24576
    s_add_u32 s63, s63, 8192
    buffer_load_dwordx4 v252, s[8:11], s63 offen nt lds
    buffer_load_dwordx4 v252, s[8:11], s63 offen offset:2048 nt lds
    s_waitcnt lgkmcnt(5)
    v_mfma_f32_16x16x32_bf16 v[148:151], v[204:207], v[52:55], v[148:151]
    ds_read_b64_tr_b16 v[218:219], v251 offset:9216
    v_mfma_f32_16x16x32_bf16 v[180:183], v[204:207], v[116:119], v[180:183]
    s_waitcnt lgkmcnt(4)
    v_mfma_f32_16x16x32_bf16 v[152:155], v[208:211], v[52:55], v[152:155]
    v_mfma_f32_16x16x32_bf16 v[184:187], v[208:211], v[116:119], v[184:187]
    s_waitcnt vmcnt(6) lgkmcnt(0)
    s_barrier
    ds_read_b64_tr_b16 v[204:205], v244 offset:16384
    ds_read_b64_tr_b16 v[206:207], v244 offset:17408
    ds_read_b128 v[220:223], v3 offset:8256
    ds_read_b64_tr_b16 v[208:209], v245 offset:16384
    ds_read_b64_tr_b16 v[210:211], v245 offset:17408
    v_mfma_f32_16x16x32_bf16 v[156:159], v[212:215], v[52:55], v[156:159]
    s_add_u32 m0, s46, 8192
    s_add_u32 s56, s55, 31744
    buffer_load_dwordx4 v253, s[16:19], s55 offen  lds
    s_add_u32 s55, s55, 262400
    v_mfma_f32_16x16x32_bf16 v[188:191], v[212:215], v[116:119], v[188:191]
    ds_read_b64_tr_b16 v[212:213], v246 offset:16384
    buffer_load_dwordx4 v253, s[16:19], s56 offen offset:1024  lds
    s_and_b32 s55, s55, 0x3fffff
    v_mfma_f32_16x16x32_bf16 v[160:163], v[216:219], v[52:55], v[160:163]
    ds_read_b64_tr_b16 v[214:215], v246 offset:17408
    v_mfma_f32_16x16x32_bf16 v[192:195], v[216:219], v[116:119], v[192:195]
    s_waitcnt lgkmcnt(5)
    ds_read_b64_tr_b16 v[216:217], v247 offset:16384
    v_mfma_f32_16x16x32_bf16 v[132:135], v[204:207], v[56:59], v[132:135]
    ds_read_b64_tr_b16 v[218:219], v247 offset:17408
    v_mfma_f32_16x16x32_bf16 v[164:167], v[204:207], v[120:123], v[164:167]
    s_waitcnt lgkmcnt(6)
    v_mfma_f32_16x16x32_bf16 v[196:199], v[204:207], v[220:223], v[196:199]
    s_waitcnt lgkmcnt(4)
    ds_read_b64_tr_b16 v[204:205], v248 offset:16384
    v_mfma_f32_16x16x32_bf16 v[136:139], v[208:211], v[56:59], v[136:139]
    ds_read_b64_tr_b16 v[206:207], v248 offset:17408
    v_mfma_f32_16x16x32_bf16 v[168:171], v[208:211], v[120:123], v[168:171]
    v_mfma_f32_16x16x32_bf16 v[200:203], v[208:211], v[220:223], v[200:203]
    s_waitcnt lgkmcnt(4)
    ds_read_b64_tr_b16 v[208:209], v249 offset:16384
    v_mfma_f32_16x16x32_bf16 v[140:143], v[212:215], v[56:59], v[140:143]
    ds_read_b64_tr_b16 v[210:211], v249 offset:17408
    v_mfma_f32_16x16x32_bf16 v[172:175], v[212:215], v[120:123], v[172:175]
    s_waitcnt lgkmcnt(4)
    ds_read_b64_tr_b16 v[212:213], v250 offset:16384
    v_mfma_f32_16x16x32_bf16 v[144:147], v[216:219], v[56:59], v[144:147]
    ds_read_b64_tr_b16 v[214:215], v250 offset:17408
    v_mfma_f32_16x16x32_bf16 v[176:179], v[216:219], v[120:123], v[176:179]
    ds_read_b64_tr_b16 v[216:217], v251 offset:16384
    s_add_u32 m0, s45, 32768
    s_add_u32 s54, s54, 8192
    buffer_load_dwordx4 v252, s[4:7], s54 offen nt lds
    buffer_load_dwordx4 v252, s[4:7], s54 offen offset:2048 nt lds
    s_add_u32 m0, s45, 40960
    s_add_u32 s54, s54, 8192
    buffer_load_dwordx4 v252, s[4:7], s54 offen nt lds
    buffer_load_dwordx4 v252, s[4:7], s54 offen offset:2048 nt lds
    s_waitcnt lgkmcnt(5)
    v_mfma_f32_16x16x32_bf16 v[148:151], v[204:207], v[56:59], v[148:151]
    ds_read_b64_tr_b16 v[218:219], v251 offset:17408
    v_mfma_f32_16x16x32_bf16 v[180:183], v[204:207], v[120:123], v[180:183]
    s_waitcnt lgkmcnt(4)
    v_mfma_f32_16x16x32_bf16 v[152:155], v[208:211], v[56:59], v[152:155]
    v_mfma_f32_16x16x32_bf16 v[184:187], v[208:211], v[120:123], v[184:187]
    s_waitcnt vmcnt(8) lgkmcnt(0)
    s_barrier
    ds_read_b64_tr_b16 v[204:205], v244 offset:0
    ds_read_b64_tr_b16 v[206:207], v244 offset:1024
    ds_read_b128 v[220:223], v3 offset:10240
    ds_read_b64_tr_b16 v[208:209], v245 offset:0
    ds_read_b64_tr_b16 v[210:211], v245 offset:1024
    v_mfma_f32_16x16x32_bf16 v[156:159], v[212:215], v[56:59], v[156:159]
    s_add_u32 m0, s46, 16384
    s_add_u32 s56, s55, 31744
    buffer_load_dwordx4 v253, s[16:19], s55 offen  lds
    s_add_u32 s55, s55, 262144
    v_mfma_f32_16x16x32_bf16 v[188:191], v[212:215], v[120:123], v[188:191]
    ds_read_b64_tr_b16 v[212:213], v246 offset:0
    buffer_load_dwordx4 v253, s[16:19], s56 offen offset:1024  lds
    s_and_b32 s55, s55, 0x3fffff
    v_mfma_f32_16x16x32_bf16 v[160:163], v[216:219], v[56:59], v[160:163]
    ds_read_b64_tr_b16 v[214:215], v246 offset:1024
    v_mfma_f32_16x16x32_bf16 v[192:195], v[216:219], v[120:123], v[192:195]
    s_waitcnt lgkmcnt(5)
    ds_read_b64_tr_b16 v[216:217], v247 offset:0
    v_mfma_f32_16x16x32_bf16 v[132:135], v[204:207], v[60:63], v[132:135]
    ds_read_b64_tr_b16 v[218:219], v247 offset:1024
    v_mfma_f32_16x16x32_bf16 v[164:167], v[204:207], v[124:127], v[164:167]
    s_waitcnt lgkmcnt(6)
    v_mfma_f32_16x16x32_bf16 v[196:199], v[204:207], v[220:223], v[196:199]
    s_waitcnt lgkmcnt(4)
    ds_read_b64_tr_b16 v[204:205], v248 offset:0
    v_mfma_f32_16x16x32_bf16 v[136:139], v[208:211], v[60:63], v[136:139]
    ds_read_b64_tr_b16 v[206:207], v248 offset:1024
    v_mfma_f32_16x16x32_bf16 v[168:171], v[208:211], v[124:127], v[168:171]
    v_mfma_f32_16x16x32_bf16 v[200:203], v[208:211], v[220:223], v[200:203]
    s_waitcnt lgkmcnt(4)
    ds_read_b64_tr_b16 v[208:209], v249 offset:0
    v_mfma_f32_16x16x32_bf16 v[140:143], v[212:215], v[60:63], v[140:143]
    ds_read_b64_tr_b16 v[210:211], v249 offset:1024
    v_mfma_f32_16x16x32_bf16 v[172:175], v[212:215], v[124:127], v[172:175]
    s_waitcnt lgkmcnt(4)
    ds_read_b64_tr_b16 v[212:213], v250 offset:0
    v_mfma_f32_16x16x32_bf16 v[144:147], v[216:219], v[60:63], v[144:147]
    ds_read_b64_tr_b16 v[214:215], v250 offset:1024
    v_mfma_f32_16x16x32_bf16 v[176:179], v[216:219], v[124:127], v[176:179]
    ds_read_b64_tr_b16 v[216:217], v251 offset:0
    s_add_u32 m0, s45, 49152
    s_add_u32 s63, s63, 8192
    buffer_load_dwordx4 v252, s[8:11], s63 offen nt lds
    buffer_load_dwordx4 v252, s[8:11], s63 offen offset:2048 nt lds
    s_add_u32 m0, s45, 57344
    s_add_u32 s63, s63, 8192
    buffer_load_dwordx4 v252, s[8:11], s63 offen nt lds
    buffer_load_dwordx4 v252, s[8:11], s63 offen offset:2048 nt lds
    s_waitcnt lgkmcnt(5)
    v_mfma_f32_16x16x32_bf16 v[148:151], v[204:207], v[60:63], v[148:151]
    ds_read_b64_tr_b16 v[218:219], v251 offset:1024
    v_mfma_f32_16x16x32_bf16 v[180:183], v[204:207], v[124:127], v[180:183]
    s_waitcnt lgkmcnt(4)
    v_mfma_f32_16x16x32_bf16 v[152:155], v[208:211], v[60:63], v[152:155]
    v_mfma_f32_16x16x32_bf16 v[184:187], v[208:211], v[124:127], v[184:187]
    s_waitcnt vmcnt(6) lgkmcnt(0)
    s_barrier
    ds_read_b64_tr_b16 v[204:205], v244 offset:8192
    ds_read_b64_tr_b16 v[206:207], v244 offset:9216
    ds_read_b128 v[220:223], v3 offset:10304
    ds_read_b64_tr_b16 v[208:209], v245 offset:8192
    ds_read_b64_tr_b16 v[210:211], v245 offset:9216
    v_mfma_f32_16x16x32_bf16 v[156:159], v[212:215], v[60:63], v[156:159]
    s_add_u32 m0, s46, 0
    s_add_u32 s56, s55, 31744
    buffer_load_dwordx4 v253, s[16:19], s55 offen  lds
    s_add_u32 s55, s55, 262144
    buffer_load_dwordx4 v253, s[16:19], s56 offen offset:1024  lds
    s_and_b32 s55, s55, 0x3fffff
    s_add_u32 m0, s45, 0
    s_mov_b32 s54, s89
    buffer_load_dwordx4 v252, s[4:7], s54 offen nt lds
    buffer_load_dwordx4 v252, s[4:7], s54 offen offset:2048 nt lds
    s_add_u32 m0, s45, 8192
    s_add_u32 s54, s54, 8192
    buffer_load_dwordx4 v252, s[4:7], s54 offen nt lds
    buffer_load_dwordx4 v252, s[4:7], s54 offen offset:2048 nt lds
    v_mfma_f32_16x16x32_bf16 v[188:191], v[212:215], v[124:127], v[188:191]
    ds_read_b64_tr_b16 v[212:213], v246 offset:8192
    v_mfma_f32_16x16x32_bf16 v[160:163], v[216:219], v[60:63], v[160:163]
    ds_read_b64_tr_b16 v[214:215], v246 offset:9216
    v_mfma_f32_16x16x32_bf16 v[192:195], v[216:219], v[124:127], v[192:195]
    s_waitcnt lgkmcnt(5)
    ds_read_b64_tr_b16 v[216:217], v247 offset:8192
    v_mfma_f32_16x16x32_bf16 v[132:135], v[204:207], v[64:67], v[132:135]
    ds_read_b64_tr_b16 v[218:219], v247 offset:9216
    v_mfma_f32_16x16x32_bf16 v[164:167], v[204:207], v[128:131], v[164:167]
    s_waitcnt lgkmcnt(6)
    v_mfma_f32_16x16x32_bf16 v[196:199], v[204:207], v[220:223], v[196:199]
    s_waitcnt lgkmcnt(4)
    ds_read_b64_tr_b16 v[204:205], v248 offset:8192
    v_mfma_f32_16x16x32_bf16 v[136:139], v[208:211], v[64:67], v[136:139]
    ds_read_b64_tr_b16 v[206:207], v248 offset:9216
    v_mfma_f32_16x16x32_bf16 v[168:171], v[208:211], v[128:131], v[168:171]
    v_mfma_f32_16x16x32_bf16 v[200:203], v[208:211], v[220:223], v[200:203]
    s_waitcnt lgkmcnt(4)
    ds_read_b64_tr_b16 v[208:209], v249 offset:8192
    v_mfma_f32_16x16x32_bf16 v[140:143], v[212:215], v[64:67], v[140:143]
    ds_read_b64_tr_b16 v[210:211], v249 offset:9216
    v_mfma_f32_16x16x32_bf16 v[172:175], v[212:215], v[128:131], v[172:175]
    s_waitcnt lgkmcnt(4)
    ds_read_b64_tr_b16 v[212:213], v250 offset:8192
    v_mfma_f32_16x16x32_bf16 v[144:147], v[216:219], v[64:67], v[144:147]
    ds_read_b64_tr_b16 v[214:215], v250 offset:9216
    v_mfma_f32_16x16x32_bf16 v[176:179], v[216:219], v[128:131], v[176:179]
    s_waitcnt lgkmcnt(4)
    ds_read_b64_tr_b16 v[216:217], v251 offset:8192
    v_mfma_f32_16x16x32_bf16 v[148:151], v[204:207], v[64:67], v[148:151]
    ds_read_b64_tr_b16 v[218:219], v251 offset:9216
    v_mfma_f32_16x16x32_bf16 v[180:183], v[204:207], v[128:131], v[180:183]
    s_waitcnt lgkmcnt(4)
    v_mfma_f32_16x16x32_bf16 v[152:155], v[208:211], v[64:67], v[152:155]
    v_mfma_f32_16x16x32_bf16 v[184:187], v[208:211], v[128:131], v[184:187]
    s_waitcnt lgkmcnt(2)
    v_mfma_f32_16x16x32_bf16 v[156:159], v[212:215], v[64:67], v[156:159]
    v_mfma_f32_16x16x32_bf16 v[188:191], v[212:215], v[128:131], v[188:191]
    s_waitcnt lgkmcnt(0)
    v_mfma_f32_16x16x32_bf16 v[160:163], v[216:219], v[64:67], v[160:163]
    v_mfma_f32_16x16x32_bf16 v[192:195], v[216:219], v[128:131], v[192:195]
    s_waitcnt vmcnt(8) lgkmcnt(0)
    s_barrier
    s_add_u32 m0, s46, 8192
    s_add_u32 s56, s55, 31744
    buffer_load_dwordx4 v253, s[16:19], s55 offen  lds
    s_add_u32 s55, s55, 262144
    buffer_load_dwordx4 v253, s[16:19], s56 offen offset:1024  lds
    s_and_b32 s55, s55, 0x3fffff
    v_add_u32 v1, s47, v2
    v_mul_f32 v196, s58, v196
    v_mul_f32 v197, s58, v197
    v_mul_f32 v198, s58, v198
    v_mul_f32 v199, s58, v199
    v_cvt_pk_bf16_f32 v196, v196, v197
    v_cvt_pk_bf16_f32 v197, v198, v199
    ds_write_b64 v1, v[196:197] offset:32768
    v_mul_f32 v200, s58, v200
    v_mul_f32 v201, s58, v201
    v_mul_f32 v202, s58, v202
    v_mul_f32 v203, s58, v203
    v_cvt_pk_bf16_f32 v200, v200, v201
    v_cvt_pk_bf16_f32 v201, v202, v203
    ds_write_b64 v1, v[200:201] offset:33280
    v_add_u32 v1, s50, v2
    v_mul_f32 v132, s58, v132
    v_mul_f32 v133, s58, v133
    v_mul_f32 v134, s58, v134
    v_mul_f32 v135, s58, v135
    v_cvt_pk_bf16_f32 v132, v132, v133
    v_cvt_pk_bf16_f32 v133, v134, v135
    ds_write_b64 v1, v[132:133] offset:0
    v_mul_f32 v164, s58, v164
    v_mul_f32 v165, s58, v165
    v_mul_f32 v166, s58, v166
    v_mul_f32 v167, s58, v167
    v_cvt_pk_bf16_f32 v164, v164, v165
    v_cvt_pk_bf16_f32 v165, v166, v167
    ds_write_b64 v1, v[164:165] offset:4096
    v_mul_f32 v136, s58, v136
    v_mul_f32 v137, s58, v137
    v_mul_f32 v138, s58, v138
    v_mul_f32 v139, s58, v139
    v_cvt_pk_bf16_f32 v136, v136, v137
    v_cvt_pk_bf16_f32 v137, v138, v139
    ds_write_b64 v1, v[136:137] offset:512
    v_mul_f32 v168, s58, v168
    v_mul_f32 v169, s58, v169
    v_mul_f32 v170, s58, v170
    v_mul_f32 v171, s58, v171
    v_cvt_pk_bf16_f32 v168, v168, v169
    v_cvt_pk_bf16_f32 v169, v170, v171
    ds_write_b64 v1, v[168:169] offset:4608
    v_add_u32 v1, s51, v2
    v_mul_f32 v140, s58, v140
    v_mul_f32 v141, s58, v141
    v_mul_f32 v142, s58, v142
    v_mul_f32 v143, s58, v143
    v_cvt_pk_bf16_f32 v140, v140, v141
    v_cvt_pk_bf16_f32 v141, v142, v143
    ds_write_b64 v1, v[140:141] offset:0
    v_mul_f32 v172, s58, v172
    v_mul_f32 v173, s58, v173
    v_mul_f32 v174, s58, v174
    v_mul_f32 v175, s58, v175
    v_cvt_pk_bf16_f32 v172, v172, v173
    v_cvt_pk_bf16_f32 v173, v174, v175
    ds_write_b64 v1, v[172:173] offset:4096
    v_mul_f32 v144, s58, v144
    v_mul_f32 v145, s58, v145
    v_mul_f32 v146, s58, v146
    v_mul_f32 v147, s58, v147
    v_cvt_pk_bf16_f32 v144, v144, v145
    v_cvt_pk_bf16_f32 v145, v146, v147
    ds_write_b64 v1, v[144:145] offset:512
    v_mul_f32 v176, s58, v176
    v_mul_f32 v177, s58, v177
    v_mul_f32 v178, s58, v178
    v_mul_f32 v179, s58, v179
    v_cvt_pk_bf16_f32 v176, v176, v177
    v_cvt_pk_bf16_f32 v177, v178, v179
    ds_write_b64 v1, v[176:177] offset:4608
    v_add_u32 v1, s52, v2
    v_mul_f32 v148, s58, v148
    v_mul_f32 v149, s58, v149
    v_mul_f32 v150, s58, v150
    v_mul_f32 v151, s58, v151
    v_cvt_pk_bf16_f32 v148, v148, v149
    v_cvt_pk_bf16_f32 v149, v150, v151
    ds_write_b64 v1, v[148:149] offset:0
    v_mul_f32 v180, s58, v180
    v_mul_f32 v181, s58, v181
    v_mul_f32 v182, s58, v182
    v_mul_f32 v183, s58, v183
    v_cvt_pk_bf16_f32 v180, v180, v181
    v_cvt_pk_bf16_f32 v181, v182, v183
    ds_write_b64 v1, v[180:181] offset:4096
    v_mul_f32 v152, s58, v152
    v_mul_f32 v153, s58, v153
    v_mul_f32 v154, s58, v154
    v_mul_f32 v155, s58, v155
    v_cvt_pk_bf16_f32 v152, v152, v153
    v_cvt_pk_bf16_f32 v153, v154, v155
    ds_write_b64 v1, v[152:153] offset:512
    v_mul_f32 v184, s58, v184
    v_mul_f32 v185, s58, v185
    v_mul_f32 v186, s58, v186
    v_mul_f32 v187, s58, v187
    v_cvt_pk_bf16_f32 v184, v184, v185
    v_cvt_pk_bf16_f32 v185, v186, v187
    ds_write_b64 v1, v[184:185] offset:4608
    v_add_u32 v1, s53, v2
    v_mul_f32 v156, s58, v156
    v_mul_f32 v157, s58, v157
    v_mul_f32 v158, s58, v158
    v_mul_f32 v159, s58, v159
    v_cvt_pk_bf16_f32 v156, v156, v157
    v_cvt_pk_bf16_f32 v157, v158, v159
    ds_write_b64 v1, v[156:157] offset:0
    v_mul_f32 v188, s58, v188
    v_mul_f32 v189, s58, v189
    v_mul_f32 v190, s58, v190
    v_mul_f32 v191, s58, v191
    v_cvt_pk_bf16_f32 v188, v188, v189
    v_cvt_pk_bf16_f32 v189, v190, v191
    ds_write_b64 v1, v[188:189] offset:4096
    v_mul_f32 v160, s58, v160
    v_mul_f32 v161, s58, v161
    v_mul_f32 v162, s58, v162
    v_mul_f32 v163, s58, v163
    v_cvt_pk_bf16_f32 v160, v160, v161
    v_cvt_pk_bf16_f32 v161, v162, v163
    ds_write_b64 v1, v[160:161] offset:512
    v_mul_f32 v192, s58, v192
    v_mul_f32 v193, s58, v193
    v_mul_f32 v194, s58, v194
    v_mul_f32 v195, s58, v195
    v_cvt_pk_bf16_f32 v192, v192, v193
    v_cvt_pk_bf16_f32 v193, v194, v195
    ds_write_b64 v1, v[192:193] offset:4608
    s_add_u32 m0, s45, 16384
    s_mov_b32 s63, s89
    buffer_load_dwordx4 v252, s[8:11], s63 offen nt lds
    buffer_load_dwordx4 v252, s[8:11], s63 offen offset:2048 nt lds
    s_add_u32 m0, s45, 24576
    s_add_u32 s63, s63, 8192
    buffer_load_dwordx4 v252, s[8:11], s63 offen nt lds
    buffer_load_dwordx4 v252, s[8:11], s63 offen offset:2048 nt lds
    v_lshlrev_b32 v255, 3, v0
    s_mul_i32 s41, s36, 32768
    s_add_u32 s41, s41, s88
    s_add_u32 s41, s41, 319488
    s_cmp_lt_u32 s36, 2
    s_cselect_b32 s41, s41, 0x40000000
    buffer_load_dword v255, v255, s[4:7], s41 offen
    s_waitcnt vmcnt(7) lgkmcnt(0)
    s_barrier
    ds_read_b64_tr_b16 v[204:205], v244 offset:16384
    ds_read_b64_tr_b16 v[206:207], v244 offset:17408
    v_add_u32 v3, 61440, v3
    ds_read_b128 v[220:223], v3 offset:4096
    ds_read_b64_tr_b16 v[208:209], v245 offset:16384
    ds_read_b64_tr_b16 v[210:211], v245 offset:17408
    ds_read_b64_tr_b16 v[212:213], v246 offset:16384
    ds_read_b64_tr_b16 v[214:215], v246 offset:17408
    ds_read_b64_tr_b16 v[216:217], v247 offset:16384
    ds_read_b64_tr_b16 v[218:219], v247 offset:17408
    s_waitcnt lgkmcnt(7)
    v_mfma_f32_16x16x32_bf16 v[132:135], v[204:207], v[4:7], 0
    s_add_u32 m0, s45, 32768
    s_add_u32 s54, s54, 8192
    buffer_load_dwordx4 v252, s[4:7], s54 offen nt lds
    buffer_load_dwordx4 v252, s[4:7], s54 offen offset:2048 nt lds
    s_add_u32 m0, s45, 40960
    s_add_u32 s54, s54, 8192
    buffer_load_dwordx4 v252, s[4:7], s54 offen nt lds
    buffer_load_dwordx4 v252, s[4:7], s54 offen offset:2048 nt lds
    v_mfma_f32_16x16x32_bf16 v[164:167], v[204:207], v[68:71], 0
    s_waitcnt lgkmcnt(6)
    v_mfma_f32_16x16x32_bf16 v[196:199], v[204:207], v[220:223], 0
    s_waitcnt lgkmcnt(4)
    ds_read_b64_tr_b16 v[204:205], v248 offset:16384
    v_mfma_f32_16x16x32_bf16 v[136:139], v[208:211], v[4:7], 0
    ds_read_b64_tr_b16 v[206:207], v248 offset:17408
    v_mfma_f32_16x16x32_bf16 v[168:171], v[208:211], v[68:71], 0
    v_mfma_f32_16x16x32_bf16 v[200:203], v[208:211], v[220:223], 0
    s_waitcnt lgkmcnt(4)
    ds_read_b64_tr_b16 v[208:209], v249 offset:16384
    v_mfma_f32_16x16x32_bf16 v[140:143], v[212:215], v[4:7], 0
    ds_read_b64_tr_b16 v[210:211], v249 offset:17408
    v_mfma_f32_16x16x32_bf16 v[172:175], v[212:215], v[68:71], 0
    s_waitcnt lgkmcnt(4)
    ds_read_b64_tr_b16 v[212:213], v250 offset:16384
    v_mfma_f32_16x16x32_bf16 v[144:147], v[216:219], v[4:7], 0
    ds_read_b64_tr_b16 v[214:215], v250 offset:17408
    v_mfma_f32_16x16x32_bf16 v[176:179], v[216:219], v[68:71], 0
    s_waitcnt lgkmcnt(4)
    ds_read_b64_tr_b16 v[216:217], v251 offset:16384
    v_mfma_f32_16x16x32_bf16 v[148:151], v[204:207], v[4:7], 0
    ds_read_b64_tr_b16 v[218:219], v251 offset:17408
    v_mfma_f32_16x16x32_bf16 v[180:183], v[204:207], v[68:71], 0
    s_waitcnt lgkmcnt(4)
    ds_read_b64_tr_b16 v[204:205], v244 offset:0
    v_mfma_f32_16x16x32_bf16 v[152:155], v[208:211], v[4:7], 0
    ds_read_b64_tr_b16 v[206:207], v244 offset:1024
    v_mfma_f32_16x16x32_bf16 v[184:187], v[208:211], v[68:71], 0
    s_waitcnt lgkmcnt(4)
    ds_read_b128 v[220:223], v3 offset:4160
    v_mfma_f32_16x16x32_bf16 v[156:159], v[212:215], v[4:7], 0
    ds_read_b64_tr_b16 v[208:209], v245 offset:0
    v_mfma_f32_16x16x32_bf16 v[188:191], v[212:215], v[68:71], 0
    s_waitcnt lgkmcnt(4)
    ds_read_b64_tr_b16 v[210:211], v245 offset:1024
    v_mfma_f32_16x16x32_bf16 v[160:163], v[216:219], v[4:7], 0
    ds_read_b64_tr_b16 v[212:213], v246 offset:0
    v_mfma_f32_16x16x32_bf16 v[192:195], v[216:219], v[68:71], 0
    s_waitcnt lgkmcnt(4)
    ds_read_b64_tr_b16 v[214:215], v246 offset:1024
    v_mfma_f32_16x16x32_bf16 v[132:135], v[204:207], v[8:11], v[132:135]
    ds_read_b64_tr_b16 v[216:217], v247 offset:0
    v_mfma_f32_16x16x32_bf16 v[164:167], v[204:207], v[72:75], v[164:167]
    s_waitcnt lgkmcnt(5)
    ds_read_b64_tr_b16 v[218:219], v247 offset:1024
    v_mfma_f32_16x16x32_bf16 v[196:199], v[204:207], v[220:223], v[196:199]
    s_waitcnt lgkmcnt(4)
    ds_read_b64_tr_b16 v[204:205], v248 offset:0
    v_mfma_f32_16x16x32_bf16 v[136:139], v[208:211], v[8:11], v[136:139]
    ds_read_b64_tr_b16 v[206:207], v248 offset:1024
    v_mfma_f32_16x16x32_bf16 v[168:171], v[208:211], v[72:75], v[168:171]
    v_mfma_f32_16x16x32_bf16 v[200:203], v[208:211], v[220:223], v[200:203]
    s_waitcnt lgkmcnt(4)
    ds_read_b64_tr_b16 v[208:209], v249 offset:0
    v_mfma_f32_16x16x32_bf16 v[140:143], v[212:215], v[8:11], v[140:143]
    ds_read_b64_tr_b16 v[210:211], v249 offset:1024
    v_mfma_f32_16x16x32_bf16 v[172:175], v[212:215], v[72:75], v[172:175]
    s_waitcnt lgkmcnt(4)
    ds_read_b64_tr_b16 v[212:213], v250 offset:0
    v_mfma_f32_16x16x32_bf16 v[144:147], v[216:219], v[8:11], v[144:147]
    ds_read_b64_tr_b16 v[214:215], v250 offset:1024
    v_mfma_f32_16x16x32_bf16 v[176:179], v[216:219], v[72:75], v[176:179]
    s_waitcnt lgkmcnt(4)
    ds_read_b64_tr_b16 v[216:217], v251 offset:0
    v_mfma_f32_16x16x32_bf16 v[148:151], v[204:207], v[8:11], v[148:151]
    ds_read_b64_tr_b16 v[218:219], v251 offset:1024
    v_mfma_f32_16x16x32_bf16 v[180:183], v[204:207], v[72:75], v[180:183]
    s_waitcnt lgkmcnt(4)
    v_mfma_f32_16x16x32_bf16 v[152:155], v[208:211], v[8:11], v[152:155]
    v_mfma_f32_16x16x32_bf16 v[184:187], v[208:211], v[72:75], v[184:187]
    s_waitcnt vmcnt(7) lgkmcnt(0)
    s_barrier
    ds_read_b64_tr_b16 v[204:205], v244 offset:8192
    ds_read_b64_tr_b16 v[206:207], v244 offset:9216
    ds_read_b128 v[220:223], v3 offset:6144
    ds_read_b64_tr_b16 v[208:209], v245 offset:8192
    ds_read_b64_tr_b16 v[210:211], v245 offset:9216
    v_mfma_f32_16x16x32_bf16 v[156:159], v[212:215], v[8:11], v[156:159]
    s_add_u32 m0, s46, 16384
    s_add_u32 s56, s55, 31744
    buffer_load_dwordx4 v253, s[16:19], s55 offen  lds
    s_add_u32 s55, s55, 262144
    buffer_load_dwordx4 v253, s[16:19], s56 offen offset:1024  lds
    s_and_b32 s55, s55, 0x3fffff
    s_add_u32 m0, s46, 0
    s_add_u32 s56, s55, 31744
    buffer_load_dwordx4 v253, s[16:19], s55 offen  lds
    s_add_u32 s55, s55, 262144
    buffer_load_dwordx4 v253, s[16:19], s56 offen offset:1024  lds
    s_and_b32 s55, s55, 0x3fffff
    s_add_u32 m0, s45, 49152
    s_add_u32 s63, s63, 8192
    buffer_load_dwordx4 v252, s[8:11], s63 offen nt lds
    buffer_load_dwordx4 v252, s[8:11], s63 offen offset:2048 nt lds
    s_add_u32 m0, s45, 57344
    s_add_u32 s63, s63, 8192
    buffer_load_dwordx4 v252, s[8:11], s63 offen nt lds
    buffer_load_dwordx4 v252, s[8:11], s63 offen offset:2048 nt lds
    v_mfma_f32_16x16x32_bf16 v[188:191], v[212:215], v[72:75], v[188:191]
    ds_read_b64_tr_b16 v[212:213], v246 offset:8192
    v_mfma_f32_16x16x32_bf16 v[160:163], v[216:219], v[8:11], v[160:163]
    ds_read_b64_tr_b16 v[214:215], v246 offset:9216
    v_mfma_f32_16x16x32_bf16 v[192:195], v[216:219], v[72:75], v[192:195]
    s_waitcnt lgkmcnt(5)
    ds_read_b64_tr_b16 v[216:217], v247 offset:8192
    v_mfma_f32_16x16x32_bf16 v[132:135], v[204:207], v[12:15], v[132:135]
    ds_read_b64_tr_b16 v[218:219], v247 offset:9216
    v_mfma_f32_16x16x32_bf16 v[164:167], v[204:207], v[76:79], v[164:167]
    s_waitcnt lgkmcnt(6)
    v_mfma_f32_16x16x32_bf16 v[196:199], v[204:207], v[220:223], v[196:199]
    s_waitcnt lgkmcnt(4)
    ds_read_b64_tr_b16 v[204:205], v248 offset:8192
    v_mfma_f32_16x16x32_bf16 v[136:139], v[208:211], v[12:15], v[136:139]
    ds_read_b64_tr_b16 v[206:207], v248 offset:9216
    v_mfma_f32_16x16x32_bf16 v[168:171], v[208:211], v[76:79], v[168:171]
    v_mfma_f32_16x16x32_bf16 v[200:203], v[208:211], v[220:223], v[200:203]
    s_waitcnt lgkmcnt(4)
    ds_read_b64_tr_b16 v[208:209], v249 offset:8192
    v_mfma_f32_16x16x32_bf16 v[140:143], v[212:215], v[12:15], v[140:143]
    ds_read_b64_tr_b16 v[210:211], v249 offset:9216
    v_mfma_f32_16x16x32_bf16 v[172:175], v[212:215], v[76:79], v[172:175]
    s_waitcnt lgkmcnt(4)
    ds_read_b64_tr_b16 v[212:213], v250 offset:8192
    v_mfma_f32_16x16x32_bf16 v[144:147], v[216:219], v[12:15], v[144:147]
    ds_read_b64_tr_b16 v[214:215], v250 offset:9216
    v_mfma_f32_16x16x32_bf16 v[176:179], v[216:219], v[76:79], v[176:179]
    s_waitcnt lgkmcnt(4)
    ds_read_b64_tr_b16 v[216:217], v251 offset:8192
    v_mfma_f32_16x16x32_bf16 v[148:151], v[204:207], v[12:15], v[148:151]
    ds_read_b64_tr_b16 v[218:219], v251 offset:9216
    v_mfma_f32_16x16x32_bf16 v[180:183], v[204:207], v[76:79], v[180:183]
    s_waitcnt lgkmcnt(4)
    v_mfma_f32_16x16x32_bf16 v[152:155], v[208:211], v[12:15], v[152:155]
    v_mfma_f32_16x16x32_bf16 v[184:187], v[208:211], v[76:79], v[184:187]
    s_waitcnt vmcnt(6) lgkmcnt(0)
    s_barrier
    ds_read_b64_tr_b16 v[204:205], v244 offset:16384
    ds_read_b64_tr_b16 v[206:207], v244 offset:17408
    ds_read_b128 v[220:223], v3 offset:6208
    ds_read_b64_tr_b16 v[208:209], v245 offset:16384
    ds_read_b64_tr_b16 v[210:211], v245 offset:17408
    v_mfma_f32_16x16x32_bf16 v[156:159], v[212:215], v[12:15], v[156:159]
    s_add_u32 m0, s46, 8192
    s_add_u32 s56, s55, 31744
    buffer_load_dwordx4 v253, s[16:19], s55 offen  lds
    s_add_u32 s55, s55, 262144
    v_mfma_f32_16x16x32_bf16 v[188:191], v[212:215], v[76:79], v[188:191]
    ds_read_b64_tr_b16 v[212:213], v246 offset:16384
    buffer_load_dwordx4 v253, s[16:19], s56 offen offset:1024  lds
    s_and_b32 s55, s55, 0x3fffff
    v_mfma_f32_16x16x32_bf16 v[160:163], v[216:219], v[12:15], v[160:163]
    ds_read_b64_tr_b16 v[214:215], v246 offset:17408
    v_mfma_f32_16x16x32_bf16 v[192:195], v[216:219], v[76:79], v[192:195]
    s_waitcnt lgkmcnt(5)
    ds_read_b64_tr_b16 v[216:217], v247 offset:16384
    v_mfma_f32_16x16x32_bf16 v[132:135], v[204:207], v[16:19], v[132:135]
    ds_read_b64_tr_b16 v[218:219], v247 offset:17408
    v_mfma_f32_16x16x32_bf16 v[164:167], v[204:207], v[80:83], v[164:167]
    s_waitcnt lgkmcnt(6)
    v_mfma_f32_16x16x32_bf16 v[196:199], v[204:207], v[220:223], v[196:199]
    s_waitcnt lgkmcnt(4)
    ds_read_b64_tr_b16 v[204:205], v248 offset:16384
    v_mfma_f32_16x16x32_bf16 v[136:139], v[208:211], v[16:19], v[136:139]
    ds_read_b64_tr_b16 v[206:207], v248 offset:17408
    v_mfma_f32_16x16x32_bf16 v[168:171], v[208:211], v[80:83], v[168:171]
    v_mfma_f32_16x16x32_bf16 v[200:203], v[208:211], v[220:223], v[200:203]
    s_waitcnt lgkmcnt(4)
    ds_read_b64_tr_b16 v[208:209], v249 offset:16384
    v_mfma_f32_16x16x32_bf16 v[140:143], v[212:215], v[16:19], v[140:143]
    ds_read_b64_tr_b16 v[210:211], v249 offset:17408
    v_mfma_f32_16x16x32_bf16 v[172:175], v[212:215], v[80:83], v[172:175]
    s_waitcnt lgkmcnt(4)
    ds_read_b64_tr_b16 v[212:213], v250 offset:16384
    v_mfma_f32_16x16x32_bf16 v[144:147], v[216:219], v[16:19], v[144:147]
    ds_read_b64_tr_b16 v[214:215], v250 offset:17408
    v_mfma_f32_16x16x32_bf16 v[176:179], v[216:219], v[80:83], v[176:179]
    ds_read_b64_tr_b16 v[216:217], v251 offset:16384
    s_add_u32 m0, s45, 0
    s_add_u32 s54, s54, 8192
    buffer_load_dwordx4 v252, s[4:7], s54 offen nt lds
    buffer_load_dwordx4 v252, s[4:7], s54 offen offset:2048 nt lds
    s_add_u32 m0, s45, 8192
    s_add_u32 s54, s54, 8192
    buffer_load_dwordx4 v252, s[4:7], s54 offen nt lds
    buffer_load_dwordx4 v252, s[4:7], s54 offen offset:2048 nt lds
    s_waitcnt lgkmcnt(5)
    v_mfma_f32_16x16x32_bf16 v[148:151], v[204:207], v[16:19], v[148:151]
    ds_read_b64_tr_b16 v[218:219], v251 offset:17408
    v_mfma_f32_16x16x32_bf16 v[180:183], v[204:207], v[80:83], v[180:183]
    s_waitcnt lgkmcnt(4)
    v_mfma_f32_16x16x32_bf16 v[152:155], v[208:211], v[16:19], v[152:155]
    v_mfma_f32_16x16x32_bf16 v[184:187], v[208:211], v[80:83], v[184:187]
    s_waitcnt vmcnt(8) lgkmcnt(0)
    s_barrier
    ds_read_b64_tr_b16 v[204:205], v244 offset:0
    ds_read_b64_tr_b16 v[206:207], v244 offset:1024
    ds_read_b128 v[220:223], v3 offset:8192
    ds_read_b64_tr_b16 v[208:209], v245 offset:0
    ds_read_b64_tr_b16 v[210:211], v245 offset:1024
    v_mfma_f32_16x16x32_bf16 v[156:159], v[212:215], v[16:19], v[156:159]
    s_add_u32 m0, s46, 16384
    s_add_u32 s56, s55, 31744
    buffer_load_dwordx4 v253, s[16:19], s55 offen  lds
    s_add_u32 s55, s55, 262144
    v_mfma_f32_16x16x32_bf16 v[188:191], v[212:215], v[80:83], v[188:191]
    ds_read_b64_tr_b16 v[212:213], v246 offset:0
    buffer_load_dwordx4 v253, s[16:19], s56 offen offset:1024  lds
    s_and_b32 s55, s55, 0x3fffff
    v_mfma_f32_16x16x32_bf16 v[160:163], v[216:219], v[16:19], v[160:163]
    ds_read_b64_tr_b16 v[214:215], v246 offset:1024
    v_mfma_f32_16x16x32_bf16 v[192:195], v[216:219], v[80:83], v[192:195]
    s_waitcnt lgkmcnt(5)
    ds_read_b64_tr_b16 v[216:217], v247 offset:0
    v_mfma_f32_16x16x32_bf16 v[132:135], v[204:207], v[20:23], v[132:135]
    ds_read_b64_tr_b16 v[218:219], v247 offset:1024
    v_mfma_f32_16x16x32_bf16 v[164:167], v[204:207], v[84:87], v[164:167]
    s_waitcnt lgkmcnt(6)
    v_mfma_f32_16x16x32_bf16 v[196:199], v[204:207], v[220:223], v[196:199]
    s_waitcnt lgkmcnt(4)
    ds_read_b64_tr_b16 v[204:205], v248 offset:0
    v_mfma_f32_16x16x32_bf16 v[136:139], v[208:211], v[20:23], v[136:139]
    ds_read_b64_tr_b16 v[206:207], v248 offset:1024
    v_mfma_f32_16x16x32_bf16 v[168:171], v[208:211], v[84:87], v[168:171]
    v_mfma_f32_16x16x32_bf16 v[200:203], v[208:211], v[220:223], v[200:203]
    s_waitcnt lgkmcnt(4)
    ds_read_b64_tr_b16 v[208:209], v249 offset:0
    v_mfma_f32_16x16x32_bf16 v[140:143], v[212:215], v[20:23], v[140:143]
    ds_read_b64_tr_b16 v[210:211], v249 offset:1024
    v_mfma_f32_16x16x32_bf16 v[172:175], v[212:215], v[84:87], v[172:175]
    s_waitcnt lgkmcnt(4)
    ds_read_b64_tr_b16 v[212:213], v250 offset:0
    v_mfma_f32_16x16x32_bf16 v[144:147], v[216:219], v[20:23], v[144:147]
    ds_read_b64_tr_b16 v[214:215], v250 offset:1024
    v_mfma_f32_16x16x32_bf16 v[176:179], v[216:219], v[84:87], v[176:179]
    ds_read_b64_tr_b16 v[216:217], v251 offset:0
    s_add_u32 m0, s45, 16384
    s_add_u32 s63, s63, 8192
    buffer_load_dwordx4 v252, s[8:11], s63 offen nt lds
    buffer_load_dwordx4 v252, s[8:11], s63 offen offset:2048 nt lds
    s_add_u32 m0, s45, 24576
    s_add_u32 s63, s63, 8192
    buffer_load_dwordx4 v252, s[8:11], s63 offen nt lds
    buffer_load_dwordx4 v252, s[8:11], s63 offen offset:2048 nt lds
    s_waitcnt lgkmcnt(5)
    v_mfma_f32_16x16x32_bf16 v[148:151], v[204:207], v[20:23], v[148:151]
    ds_read_b64_tr_b16 v[218:219], v251 offset:1024
    v_mfma_f32_16x16x32_bf16 v[180:183], v[204:207], v[84:87], v[180:183]
    s_waitcnt lgkmcnt(4)
    v_mfma_f32_16x16x32_bf16 v[152:155], v[208:211], v[20:23], v[152:155]
    v_mfma_f32_16x16x32_bf16 v[184:187], v[208:211], v[84:87], v[184:187]
    s_lshr_b32 s42, s48, 1
    s_add_u32 s41, s42, 98304
    v_add_u32 v1, s41, v0
    ds_read_b128 v[68:71], v1 offset:0
    ds_read_b128 v[72:75], v1 offset:1024
    ds_read_b128 v[76:79], v1 offset:2048
    ds_read_b128 v[80:83], v1 offset:3072
    s_add_u32 s41, s47, 147456
    v_add_u32 v1, s41, v0
    ds_read_b128 v[4:7], v1 offset:0
    s_waitcnt vmcnt(6) lgkmcnt(0)
    s_barrier
    ds_read_b64_tr_b16 v[204:205], v244 offset:8192
    ds_read_b64_tr_b16 v[206:207], v244 offset:9216
    ds_read_b128 v[220:223], v3 offset:8256
    ds_read_b64_tr_b16 v[208:209], v245 offset:8192
    ds_read_b64_tr_b16 v[210:211], v245 offset:9216
    v_mfma_f32_16x16x32_bf16 v[156:159], v[212:215], v[20:23], v[156:159]
    s_add_u32 m0, s46, 0
    s_add_u32 s56, s55, 31744
    buffer_load_dwordx4 v253, s[16:19], s55 offen  lds
    s_add_u32 s55, s55, 262144
    v_mfma_f32_16x16x32_bf16 v[188:191], v[212:215], v[84:87], v[188:191]
    ds_read_b64_tr_b16 v[212:213], v246 offset:8192
    buffer_load_dwordx4 v253, s[16:19], s56 offen offset:1024  lds
    s_and_b32 s55, s55, 0x3fffff
    v_mfma_f32_16x16x32_bf16 v[160:163], v[216:219], v[20:23], v[160:163]
    ds_read_b64_tr_b16 v[214:215], v246 offset:9216
    v_mfma_f32_16x16x32_bf16 v[192:195], v[216:219], v[84:87], v[192:195]
    s_waitcnt lgkmcnt(5)
    ds_read_b64_tr_b16 v[216:217], v247 offset:8192
    v_mfma_f32_16x16x32_bf16 v[132:135], v[204:207], v[24:27], v[132:135]
    ds_read_b64_tr_b16 v[218:219], v247 offset:9216
    v_mfma_f32_16x16x32_bf16 v[164:167], v[204:207], v[88:91], v[164:167]
    s_waitcnt lgkmcnt(6)
    v_mfma_f32_16x16x32_bf16 v[196:199], v[204:207], v[220:223], v[196:199]
    s_waitcnt lgkmcnt(4)
    ds_read_b64_tr_b16 v[204:205], v248 offset:8192
    v_mfma_f32_16x16x32_bf16 v[136:139], v[208:211], v[24:27], v[136:139]
    ds_read_b64_tr_b16 v[206:207], v248 offset:9216
    v_mfma_f32_16x16x32_bf16 v[168:171], v[208:211], v[88:91], v[168:171]
    v_mfma_f32_16x16x32_bf16 v[200:203], v[208:211], v[220:223], v[200:203]
    s_waitcnt lgkmcnt(4)
    ds_read_b64_tr_b16 v[208:209], v249 offset:8192
    v_mfma_f32_16x16x32_bf16 v[140:143], v[212:215], v[24:27], v[140:143]
    ds_read_b64_tr_b16 v[210:211], v249 offset:9216
    v_mfma_f32_16x16x32_bf16 v[172:175], v[212:215], v[88:91], v[172:175]
    s_waitcnt lgkmcnt(4)
    ds_read_b64_tr_b16 v[212:213], v250 offset:8192
    v_mfma_f32_16x16x32_bf16 v[144:147], v[216:219], v[24:27], v[144:147]
    ds_read_b64_tr_b16 v[214:215], v250 offset:9216
    v_mfma_f32_16x16x32_bf16 v[176:179], v[216:219], v[88:91], v[176:179]
    ds_read_b64_tr_b16 v[216:217], v251 offset:8192
    s_add_u32 m0, s45, 32768
    s_add_u32 s54, s54, 8192
    buffer_load_dwordx4 v252, s[4:7], s54 offen nt lds
    buffer_load_dwordx4 v252, s[4:7], s54 offen offset:2048 nt lds
    s_add_u32 m0, s45, 40960
    s_add_u32 s54, s54, 8192
    buffer_load_dwordx4 v252, s[4:7], s54 offen nt lds
    buffer_load_dwordx4 v252, s[4:7], s54 offen offset:2048 nt lds
    s_waitcnt lgkmcnt(5)
    v_mfma_f32_16x16x32_bf16 v[148:151], v[204:207], v[24:27], v[148:151]
    ds_read_b64_tr_b16 v[218:219], v251 offset:9216
    v_mfma_f32_16x16x32_bf16 v[180:183], v[204:207], v[88:91], v[180:183]
    s_waitcnt lgkmcnt(4)
    v_mfma_f32_16x16x32_bf16 v[152:155], v[208:211], v[24:27], v[152:155]
    v_mfma_f32_16x16x32_bf16 v[184:187], v[208:211], v[88:91], v[184:187]
    s_waitcnt vmcnt(8) lgkmcnt(0)
    s_barrier
    ds_read_b64_tr_b16 v[204:205], v244 offset:16384
    ds_read_b64_tr_b16 v[206:207], v244 offset:17408
    ds_read_b128 v[220:223], v3 offset:10240
    ds_read_b64_tr_b16 v[208:209], v245 offset:16384
    ds_read_b64_tr_b16 v[210:211], v245 offset:17408
    v_mfma_f32_16x16x32_bf16 v[156:159], v[212:215], v[24:27], v[156:159]
    s_add_u32 m0, s46, 8192
    s_add_u32 s56, s55, 31744
    buffer_load_dwordx4 v253, s[16:19], s55 offen  lds
    s_add_u32 s55, s55, 262144
    v_mfma_f32_16x16x32_bf16 v[188:191], v[212:215], v[88:91], v[188:191]
    ds_read_b64_tr_b16 v[212:213], v246 offset:16384
    buffer_load_dwordx4 v253, s[16:19], s56 offen offset:1024  lds
    s_and_b32 s55, s55, 0x3fffff
    v_mfma_f32_16x16x32_bf16 v[160:163], v[216:219], v[24:27], v[160:163]
    ds_read_b64_tr_b16 v[214:215], v246 offset:17408
    v_mfma_f32_16x16x32_bf16 v[192:195], v[216:219], v[88:91], v[192:195]
    s_waitcnt lgkmcnt(5)
    ds_read_b64_tr_b16 v[216:217], v247 offset:16384
    v_mfma_f32_16x16x32_bf16 v[132:135], v[204:207], v[28:31], v[132:135]
    ds_read_b64_tr_b16 v[218:219], v247 offset:17408
    v_mfma_f32_16x16x32_bf16 v[164:167], v[204:207], v[92:95], v[164:167]
    s_waitcnt lgkmcnt(6)
    v_mfma_f32_16x16x32_bf16 v[196:199], v[204:207], v[220:223], v[196:199]
    s_waitcnt lgkmcnt(4)
    ds_read_b64_tr_b16 v[204:205], v248 offset:16384
    v_mfma_f32_16x16x32_bf16 v[136:139], v[208:211], v[28:31], v[136:139]
    ds_read_b64_tr_b16 v[206:207], v248 offset:17408
    v_mfma_f32_16x16x32_bf16 v[168:171], v[208:211], v[92:95], v[168:171]
    v_mfma_f32_16x16x32_bf16 v[200:203], v[208:211], v[220:223], v[200:203]
    s_waitcnt lgkmcnt(4)
    ds_read_b64_tr_b16 v[208:209], v249 offset:16384
    v_mfma_f32_16x16x32_bf16 v[140:143], v[212:215], v[28:31], v[140:143]
    ds_read_b64_tr_b16 v[210:211], v249 offset:17408
    v_mfma_f32_16x16x32_bf16 v[172:175], v[212:215], v[92:95], v[172:175]
    s_waitcnt lgkmcnt(4)
    ds_read_b64_tr_b16 v[212:213], v250 offset:16384
    v_mfma_f32_16x16x32_bf16 v[144:147], v[216:219], v[28:31], v[144:147]
    ds_read_b64_tr_b16 v[214:215], v250 offset:17408
    v_mfma_f32_16x16x32_bf16 v[176:179], v[216:219], v[92:95], v[176:179]
    ds_read_b64_tr_b16 v[216:217], v251 offset:16384
    s_add_u32 m0, s45, 49152
    s_add_u32 s63, s63, 8192
    buffer_load_dwordx4 v252, s[8:11], s63 offen nt lds
    buffer_load_dwordx4 v252, s[8:11], s63 offen offset:2048 nt lds
    s_add_u32 m0, s45, 57344
    s_add_u32 s63, s63, 8192
    buffer_load_dwordx4 v252, s[8:11], s63 offen nt lds
    buffer_load_dwordx4 v252, s[8:11], s63 offen offset:2048 nt lds
    s_waitcnt lgkmcnt(5)
    v_mfma_f32_16x16x32_bf16 v[148:151], v[204:207], v[28:31], v[148:151]
    ds_read_b64_tr_b16 v[218:219], v251 offset:17408
    v_mfma_f32_16x16x32_bf16 v[180:183], v[204:207], v[92:95], v[180:183]
    s_waitcnt lgkmcnt(4)
    v_mfma_f32_16x16x32_bf16 v[152:155], v[208:211], v[28:31], v[152:155]
    v_mfma_f32_16x16x32_bf16 v[184:187], v[208:211], v[92:95], v[184:187]
    s_waitcnt vmcnt(6) lgkmcnt(0)
    s_barrier
    ds_read_b64_tr_b16 v[204:205], v244 offset:0
    ds_read_b64_tr_b16 v[206:207], v244 offset:1024
    ds_read_b128 v[220:223], v3 offset:10304
    ds_read_b64_tr_b16 v[208:209], v245 offset:0
    ds_read_b64_tr_b16 v[210:211], v245 offset:1024
    v_mfma_f32_16x16x32_bf16 v[156:159], v[212:215], v[28:31], v[156:159]
    s_add_u32 m0, s46, 16384
    s_add_u32 s56, s55, 31744
    buffer_load_dwordx4 v253, s[16:19], s55 offen  lds
    s_add_u32 s55, s55, 262144
    v_mfma_f32_16x16x32_bf16 v[188:191], v[212:215], v[92:95], v[188:191]
    ds_read_b64_tr_b16 v[212:213], v246 offset:0
    buffer_load_dwordx4 v253, s[16:19], s56 offen offset:1024  lds
    s_and_b32 s55, s55, 0x3fffff
    v_mfma_f32_16x16x32_bf16 v[160:163], v[216:219], v[28:31], v[160:163]
    ds_read_b64_tr_b16 v[214:215], v246 offset:1024
    v_mfma_f32_16x16x32_bf16 v[192:195], v[216:219], v[92:95], v[192:195]
    s_waitcnt lgkmcnt(5)
    ds_read_b64_tr_b16 v[216:217], v247 offset:0
    v_mfma_f32_16x16x32_bf16 v[132:135], v[204:207], v[32:35], v[132:135]
    ds_read_b64_tr_b16 v[218:219], v247 offset:1024
    v_mfma_f32_16x16x32_bf16 v[164:167], v[204:207], v[96:99], v[164:167]
    s_waitcnt lgkmcnt(6)
    v_mfma_f32_16x16x32_bf16 v[196:199], v[204:207], v[220:223], v[196:199]
    s_waitcnt lgkmcnt(4)
    ds_read_b64_tr_b16 v[204:205], v248 offset:0
    v_mfma_f32_16x16x32_bf16 v[136:139], v[208:211], v[32:35], v[136:139]
    ds_read_b64_tr_b16 v[206:207], v248 offset:1024
    v_mfma_f32_16x16x32_bf16 v[168:171], v[208:211], v[96:99], v[168:171]
    v_mfma_f32_16x16x32_bf16 v[200:203], v[208:211], v[220:223], v[200:203]
    s_waitcnt lgkmcnt(4)
    ds_read_b64_tr_b16 v[208:209], v249 offset:0
    v_mfma_f32_16x16x32_bf16 v[140:143], v[212:215], v[32:35], v[140:143]
    ds_read_b64_tr_b16 v[210:211], v249 offset:1024
    v_mfma_f32_16x16x32_bf16 v[172:175], v[212:215], v[96:99], v[172:175]
    s_waitcnt lgkmcnt(4)
    ds_read_b64_tr_b16 v[212:213], v250 offset:0
    v_mfma_f32_16x16x32_bf16 v[144:147], v[216:219], v[32:35], v[144:147]
    ds_read_b64_tr_b16 v[214:215], v250 offset:1024
    v_mfma_f32_16x16x32_bf16 v[176:179], v[216:219], v[96:99], v[176:179]
    ds_read_b64_tr_b16 v[216:217], v251 offset:0
    s_add_u32 m0, s45, 0
    s_add_u32 s54, s54, 8192
    buffer_load_dwordx4 v252, s[4:7], s54 offen nt lds
    buffer_load_dwordx4 v252, s[4:7], s54 offen offset:2048 nt lds
    s_add_u32 m0, s45, 8192
    s_add_u32 s54, s54, 8192
    buffer_load_dwordx4 v252, s[4:7], s54 offen nt lds
    buffer_load_dwordx4 v252, s[4:7], s54 offen offset:2048 nt lds
    s_waitcnt lgkmcnt(5)
    v_mfma_f32_16x16x32_bf16 v[148:151], v[204:207], v[32:35], v[148:151]
    ds_read_b64_tr_b16 v[218:219], v251 offset:1024
    v_mfma_f32_16x16x32_bf16 v[180:183], v[204:207], v[96:99], v[180:183]
    s_waitcnt lgkmcnt(4)
    v_mfma_f32_16x16x32_bf16 v[152:155], v[208:211], v[32:35], v[152:155]
    v_mfma_f32_16x16x32_bf16 v[184:187], v[208:211], v[96:99], v[184:187]
    s_waitcnt vmcnt(8) lgkmcnt(0)
    s_barrier
    ds_read_b64_tr_b16 v[204:205], v244 offset:8192
    ds_read_b64_tr_b16 v[206:207], v244 offset:9216
    v_add_u32 v3, 4294905856, v3
    ds_read_b128 v[220:223], v3 offset:4096
    ds_read_b64_tr_b16 v[208:209], v245 offset:8192
    ds_read_b64_tr_b16 v[210:211], v245 offset:9216
    v_mfma_f32_16x16x32_bf16 v[156:159], v[212:215], v[32:35], v[156:159]
    s_add_u32 m0, s46, 0
    s_add_u32 s56, s55, 31744
    buffer_load_dwordx4 v253, s[16:19], s55 offen  lds
    s_add_u32 s55, s55, 262144
    v_mfma_f32_16x16x32_bf16 v[188:191], v[212:215], v[96:99], v[188:191]
    ds_read_b64_tr_b16 v[212:213], v246 offset:8192
    buffer_load_dwordx4 v253, s[16:19], s56 offen offset:1024  lds
    s_and_b32 s55, s55, 0x3fffff
    v_mfma_f32_16x16x32_bf16 v[160:163], v[216:219], v[32:35], v[160:163]
    ds_read_b64_tr_b16 v[214:215], v246 offset:9216
    v_mfma_f32_16x16x32_bf16 v[192:195], v[216:219], v[96:99], v[192:195]
    s_waitcnt lgkmcnt(5)
    ds_read_b64_tr_b16 v[216:217], v247 offset:8192
    v_mfma_f32_16x16x32_bf16 v[132:135], v[204:207], v[36:39], v[132:135]
    ds_read_b64_tr_b16 v[218:219], v247 offset:9216
    v_mfma_f32_16x16x32_bf16 v[164:167], v[204:207], v[100:103], v[164:167]
    s_waitcnt lgkmcnt(6)
    v_mfma_f32_16x16x32_bf16 v[196:199], v[204:207], v[220:223], v[196:199]
    s_waitcnt lgkmcnt(4)
    ds_read_b64_tr_b16 v[204:205], v248 offset:8192
    v_mfma_f32_16x16x32_bf16 v[136:139], v[208:211], v[36:39], v[136:139]
    ds_read_b64_tr_b16 v[206:207], v248 offset:9216
    v_mfma_f32_16x16x32_bf16 v[168:171], v[208:211], v[100:103], v[168:171]
    v_mfma_f32_16x16x32_bf16 v[200:203], v[208:211], v[220:223], v[200:203]
    s_waitcnt lgkmcnt(4)
    ds_read_b64_tr_b16 v[208:209], v249 offset:8192
    v_mfma_f32_16x16x32_bf16 v[140:143], v[212:215], v[36:39], v[140:143]
    ds_read_b64_tr_b16 v[210:211], v249 offset:9216
    v_mfma_f32_16x16x32_bf16 v[172:175], v[212:215], v[100:103], v[172:175]
    s_waitcnt lgkmcnt(4)
    ds_read_b64_tr_b16 v[212:213], v250 offset:8192
    v_mfma_f32_16x16x32_bf16 v[144:147], v[216:219], v[36:39], v[144:147]
    ds_read_b64_tr_b16 v[214:215], v250 offset:9216
    v_mfma_f32_16x16x32_bf16 v[176:179], v[216:219], v[100:103], v[176:179]
    ds_read_b64_tr_b16 v[216:217], v251 offset:8192
    s_add_u32 m0, s45, 16384
    s_add_u32 s63, s63, 8192
    buffer_load_dwordx4 v252, s[8:11], s63 offen nt lds
    buffer_load_dwordx4 v252, s[8:11], s63 offen offset:2048 nt lds
    s_add_u32 m0, s45, 24576
    s_add_u32 s63, s63, 8192
    buffer_load_dwordx4 v252, s[8:11], s63 offen nt lds
    buffer_load_dwordx4 v252, s[8:11], s63 offen offset:2048 nt lds
    s_waitcnt lgkmcnt(5)
    v_mfma_f32_16x16x32_bf16 v[148:151], v[204:207], v[36:39], v[148:151]
    ds_read_b64_tr_b16 v[218:219], v251 offset:9216
    v_mfma_f32_16x16x32_bf16 v[180:183], v[204:207], v[100:103], v[180:183]
    s_waitcnt lgkmcnt(4)
    v_mfma_f32_16x16x32_bf16 v[152:155], v[208:211], v[36:39], v[152:155]
    v_mfma_f32_16x16x32_bf16 v[184:187], v[208:211], v[100:103], v[184:187]
    s_add_u32 s41, s48, 114688
    v_add_u32 v1, s41, v0
    ds_read_b128 v[20:23], v1 offset:0
    ds_read_b128 v[24:27], v1 offset:1024
    ds_read_b128 v[28:31], v1 offset:2048
    ds_read_b128 v[32:35], v1 offset:3072
    ds_read_b128 v[84:87], v1 offset:4096
    ds_read_b128 v[88:91], v1 offset:5120
    ds_read_b128 v[92:95], v1 offset:6144
    ds_read_b128 v[96:99], v1 offset:7168
    s_waitcnt vmcnt(6) lgkmcnt(0)
    s_barrier
    ds_read_b64_tr_b16 v[204:205], v244 offset:16384
    ds_read_b64_tr_b16 v[206:207], v244 offset:17408
    ds_read_b128 v[220:223], v3 offset:4160
    ds_read_b64_tr_b16 v[208:209], v245 offset:16384
    ds_read_b64_tr_b16 v[210:211], v245 offset:17408
    v_mfma_f32_16x16x32_bf16 v[156:159], v[212:215], v[36:39], v[156:159]
    s_add_u32 m0, s46, 8192
    s_add_u32 s56, s55, 31744
    buffer_load_dwordx4 v253, s[16:19], s55 offen  lds
    s_add_u32 s55, s55, 262144
    v_mfma_f32_16x16x32_bf16 v[188:191], v[212:215], v[100:103], v[188:191]
    ds_read_b64_tr_b16 v[212:213], v246 offset:16384
    buffer_load_dwordx4 v253, s[16:19], s56 offen offset:1024  lds
    s_and_b32 s55, s55, 0x3fffff
    v_mfma_f32_16x16x32_bf16 v[160:163], v[216:219], v[36:39], v[160:163]
    ds_read_b64_tr_b16 v[214:215], v246 offset:17408
    v_mfma_f32_16x16x32_bf16 v[192:195], v[216:219], v[100:103], v[192:195]
    s_waitcnt lgkmcnt(5)
    ds_read_b64_tr_b16 v[216:217], v247 offset:16384
    v_mfma_f32_16x16x32_bf16 v[132:135], v[204:207], v[40:43], v[132:135]
    ds_read_b64_tr_b16 v[218:219], v247 offset:17408
    v_mfma_f32_16x16x32_bf16 v[164:167], v[204:207], v[104:107], v[164:167]
    s_waitcnt lgkmcnt(6)
    v_mfma_f32_16x16x32_bf16 v[196:199], v[204:207], v[220:223], v[196:199]
    s_waitcnt lgkmcnt(4)
    ds_read_b64_tr_b16 v[204:205], v248 offset:16384
    v_mfma_f32_16x16x32_bf16 v[136:139], v[208:211], v[40:43], v[136:139]
    ds_read_b64_tr_b16 v[206:207], v248 offset:17408
    v_mfma_f32_16x16x32_bf16 v[168:171], v[208:211], v[104:107], v[168:171]
    v_mfma_f32_16x16x32_bf16 v[200:203], v[208:211], v[220:223], v[200:203]
    s_waitcnt lgkmcnt(4)
    ds_read_b64_tr_b16 v[208:209], v249 offset:16384
    v_mfma_f32_16x16x32_bf16 v[140:143], v[212:215], v[40:43], v[140:143]
    ds_read_b64_tr_b16 v[210:211], v249 offset:17408
    v_mfma_f32_16x16x32_bf16 v[172:175], v[212:215], v[104:107], v[172:175]
    s_waitcnt lgkmcnt(4)
    ds_read_b64_tr_b16 v[212:213], v250 offset:16384
    v_mfma_f32_16x16x32_bf16 v[144:147], v[216:219], v[40:43], v[144:147]
    ds_read_b64_tr_b16 v[214:215], v250 offset:17408
    v_mfma_f32_16x16x32_bf16 v[176:179], v[216:219], v[104:107], v[176:179]
    ds_read_b64_tr_b16 v[216:217], v251 offset:16384
    s_add_u32 m0, s45, 32768
    s_add_u32 s54, s54, 8192
    buffer_load_dwordx4 v252, s[4:7], s54 offen nt lds
    buffer_load_dwordx4 v252, s[4:7], s54 offen offset:2048 nt lds
    s_add_u32 m0, s45, 40960
    s_add_u32 s54, s54, 8192
    buffer_load_dwordx4 v252, s[4:7], s54 offen nt lds
    buffer_load_dwordx4 v252, s[4:7], s54 offen offset:2048 nt lds
    s_waitcnt lgkmcnt(5)
    v_mfma_f32_16x16x32_bf16 v[148:151], v[204:207], v[40:43], v[148:151]
    ds_read_b64_tr_b16 v[218:219], v251 offset:17408
    v_mfma_f32_16x16x32_bf16 v[180:183], v[204:207], v[104:107], v[180:183]
    s_waitcnt lgkmcnt(4)
    v_mfma_f32_16x16x32_bf16 v[152:155], v[208:211], v[40:43], v[152:155]
    v_mfma_f32_16x16x32_bf16 v[184:187], v[208:211], v[104:107], v[184:187]
    s_waitcnt vmcnt(8) lgkmcnt(0)
    s_barrier
    ds_read_b64_tr_b16 v[204:205], v244 offset:0
    ds_read_b64_tr_b16 v[206:207], v244 offset:1024
    ds_read_b128 v[220:223], v3 offset:6144
    ds_read_b64_tr_b16 v[208:209], v245 offset:0
    ds_read_b64_tr_b16 v[210:211], v245 offset:1024
    v_mfma_f32_16x16x32_bf16 v[156:159], v[212:215], v[40:43], v[156:159]
    s_add_u32 m0, s46, 16384
    s_add_u32 s56, s55, 31744
    buffer_load_dwordx4 v253, s[16:19], s55 offen  lds
    s_add_u32 s55, s55, 262144
    v_mfma_f32_16x16x32_bf16 v[188:191], v[212:215], v[104:107], v[188:191]
    ds_read_b64_tr_b16 v[212:213], v246 offset:0
    buffer_load_dwordx4 v253, s[16:19], s56 offen offset:1024  lds
    s_and_b32 s55, s55, 0x3fffff
    v_mfma_f32_16x16x32_bf16 v[160:163], v[216:219], v[40:43], v[160:163]
    ds_read_b64_tr_b16 v[214:215], v246 offset:1024
    v_mfma_f32_16x16x32_bf16 v[192:195], v[216:219], v[104:107], v[192:195]
    s_waitcnt lgkmcnt(5)
    ds_read_b64_tr_b16 v[216:217], v247 offset:0
    v_mfma_f32_16x16x32_bf16 v[132:135], v[204:207], v[44:47], v[132:135]
    ds_read_b64_tr_b16 v[218:219], v247 offset:1024
    v_mfma_f32_16x16x32_bf16 v[164:167], v[204:207], v[108:111], v[164:167]
    s_waitcnt lgkmcnt(6)
    v_mfma_f32_16x16x32_bf16 v[196:199], v[204:207], v[220:223], v[196:199]
    s_waitcnt lgkmcnt(4)
    ds_read_b64_tr_b16 v[204:205], v248 offset:0
    v_mfma_f32_16x16x32_bf16 v[136:139], v[208:211], v[44:47], v[136:139]
    ds_read_b64_tr_b16 v[206:207], v248 offset:1024
    v_mfma_f32_16x16x32_bf16 v[168:171], v[208:211], v[108:111], v[168:171]
    v_mfma_f32_16x16x32_bf16 v[200:203], v[208:211], v[220:223], v[200:203]
    s_waitcnt lgkmcnt(4)
    ds_read_b64_tr_b16 v[208:209], v249 offset:0
    v_mfma_f32_16x16x32_bf16 v[140:143], v[212:215], v[44:47], v[140:143]
    ds_read_b64_tr_b16 v[210:211], v249 offset:1024
    v_mfma_f32_16x16x32_bf16 v[172:175], v[212:215], v[108:111], v[172:175]
    s_waitcnt lgkmcnt(4)
    ds_read_b64_tr_b16 v[212:213], v250 offset:0
    v_mfma_f32_16x16x32_bf16 v[144:147], v[216:219], v[44:47], v[144:147]
    ds_read_b64_tr_b16 v[214:215], v250 offset:1024
    v_mfma_f32_16x16x32_bf16 v[176:179], v[216:219], v[108:111], v[176:179]
    ds_read_b64_tr_b16 v[216:217], v251 offset:0
    s_add_u32 m0, s45, 49152
    s_add_u32 s63, s63, 8192
    buffer_load_dwordx4 v252, s[8:11], s63 offen nt lds
    buffer_load_dwordx4 v252, s[8:11], s63 offen offset:2048 nt lds
    s_add_u32 m0, s45, 57344
    s_add_u32 s63, s63, 8192
    buffer_load_dwordx4 v252, s[8:11], s63 offen nt lds
    buffer_load_dwordx4 v252, s[8:11], s63 offen offset:2048 nt lds
    s_waitcnt lgkmcnt(5)
    v_mfma_f32_16x16x32_bf16 v[148:151], v[204:207], v[44:47], v[148:151]
    ds_read_b64_tr_b16 v[218:219], v251 offset:1024
    v_mfma_f32_16x16x32_bf16 v[180:183], v[204:207], v[108:111], v[180:183]
    s_waitcnt lgkmcnt(4)
    v_mfma_f32_16x16x32_bf16 v[152:155], v[208:211], v[44:47], v[152:155]
    v_mfma_f32_16x16x32_bf16 v[184:187], v[208:211], v[108:111], v[184:187]
    s_waitcnt vmcnt(6) lgkmcnt(0)
    s_barrier
    ds_read_b64_tr_b16 v[204:205], v244 offset:8192
    ds_read_b64_tr_b16 v[206:207], v244 offset:9216
    ds_read_b128 v[220:223], v3 offset:6208
    ds_read_b64_tr_b16 v[208:209], v245 offset:8192
    ds_read_b64_tr_b16 v[210:211], v245 offset:9216
    v_mfma_f32_16x16x32_bf16 v[156:159], v[212:215], v[44:47], v[156:159]
    s_add_u32 m0, s46, 0
    s_add_u32 s56, s55, 31744
    buffer_load_dwordx4 v253, s[16:19], s55 offen  lds
    s_add_u32 s55, s55, 262144
    v_mfma_f32_16x16x32_bf16 v[188:191], v[212:215], v[108:111], v[188:191]
    ds_read_b64_tr_b16 v[212:213], v246 offset:8192
    buffer_load_dwordx4 v253, s[16:19], s56 offen offset:1024  lds
    s_and_b32 s55, s55, 0x3fffff
    v_mfma_f32_16x16x32_bf16 v[160:163], v[216:219], v[44:47], v[160:163]
    ds_read_b64_tr_b16 v[214:215], v246 offset:9216
    v_mfma_f32_16x16x32_bf16 v[192:195], v[216:219], v[108:111], v[192:195]
    s_waitcnt lgkmcnt(5)
    ds_read_b64_tr_b16 v[216:217], v247 offset:8192
    v_mfma_f32_16x16x32_bf16 v[132:135], v[204:207], v[48:51], v[132:135]
    ds_read_b64_tr_b16 v[218:219], v247 offset:9216
    v_mfma_f32_16x16x32_bf16 v[164:167], v[204:207], v[112:115], v[164:167]
    s_waitcnt lgkmcnt(6)
    v_mfma_f32_16x16x32_bf16 v[196:199], v[204:207], v[220:223], v[196:199]
    s_waitcnt lgkmcnt(4)
    ds_read_b64_tr_b16 v[204:205], v248 offset:8192
    v_mfma_f32_16x16x32_bf16 v[136:139], v[208:211], v[48:51], v[136:139]
    ds_read_b64_tr_b16 v[206:207], v248 offset:9216
    v_mfma_f32_16x16x32_bf16 v[168:171], v[208:211], v[112:115], v[168:171]
    v_mfma_f32_16x16x32_bf16 v[200:203], v[208:211], v[220:223], v[200:203]
    s_waitcnt lgkmcnt(4)
    ds_read_b64_tr_b16 v[208:209], v249 offset:8192
    v_mfma_f32_16x16x32_bf16 v[140:143], v[212:215], v[48:51], v[140:143]
    ds_read_b64_tr_b16 v[210:211], v249 offset:9216
    v_mfma_f32_16x16x32_bf16 v[172:175], v[212:215], v[112:115], v[172:175]
    s_waitcnt lgkmcnt(4)
    ds_read_b64_tr_b16 v[212:213], v250 offset:8192
    v_mfma_f32_16x16x32_bf16 v[144:147], v[216:219], v[48:51], v[144:147]
    ds_read_b64_tr_b16 v[214:215], v250 offset:9216
    v_mfma_f32_16x16x32_bf16 v[176:179], v[216:219], v[112:115], v[176:179]
    ds_read_b64_tr_b16 v[216:217], v251 offset:8192
    s_add_u32 m0, s45, 0
    s_add_u32 s54, s54, 8192
    buffer_load_dwordx4 v252, s[4:7], s54 offen nt lds
    buffer_load_dwordx4 v252, s[4:7], s54 offen offset:2048 nt lds
    s_add_u32 m0, s45, 8192
    s_add_u32 s54, s54, 8192
    buffer_load_dwordx4 v252, s[4:7], s54 offen nt lds
    buffer_load_dwordx4 v252, s[4:7], s54 offen offset:2048 nt lds
    s_waitcnt lgkmcnt(5)
    v_mfma_f32_16x16x32_bf16 v[148:151], v[204:207], v[48:51], v[148:151]
    ds_read_b64_tr_b16 v[218:219], v251 offset:9216
    v_mfma_f32_16x16x32_bf16 v[180:183], v[204:207], v[112:115], v[180:183]
    s_waitcnt lgkmcnt(4)
    v_mfma_f32_16x16x32_bf16 v[152:155], v[208:211], v[48:51], v[152:155]
    v_mfma_f32_16x16x32_bf16 v[184:187], v[208:211], v[112:115], v[184:187]
    s_waitcnt vmcnt(8) lgkmcnt(0)
    s_barrier
    ds_read_b64_tr_b16 v[204:205], v244 offset:16384
    ds_read_b64_tr_b16 v[206:207], v244 offset:17408
    ds_read_b128 v[220:223], v3 offset:8192
    ds_read_b64_tr_b16 v[208:209], v245 offset:16384
    ds_read_b64_tr_b16 v[210:211], v245 offset:17408
    v_mfma_f32_16x16x32_bf16 v[156:159], v[212:215], v[48:51], v[156:159]
    s_add_u32 m0, s46, 8192
    s_add_u32 s56, s55, 31744
    buffer_load_dwordx4 v253, s[16:19], s55 offen  lds
    s_add_u32 s55, s55, 262144
    v_mfma_f32_16x16x32_bf16 v[188:191], v[212:215], v[112:115], v[188:191]
    ds_read_b64_tr_b16 v[212:213], v246 offset:16384
    buffer_load_dwordx4 v253, s[16:19], s56 offen offset:1024  lds
    s_and_b32 s55, s55, 0x3fffff
    v_mfma_f32_16x16x32_bf16 v[160:163], v[216:219], v[48:51], v[160:163]
    ds_read_b64_tr_b16 v[214:215], v246 offset:17408
    v_mfma_f32_16x16x32_bf16 v[192:195], v[216:219], v[112:115], v[192:195]
    s_waitcnt lgkmcnt(5)
    ds_read_b64_tr_b16 v[216:217], v247 offset:16384
    v_mfma_f32_16x16x32_bf16 v[132:135], v[204:207], v[52:55], v[132:135]
    ds_read_b64_tr_b16 v[218:219], v247 offset:17408
    v_mfma_f32_16x16x32_bf16 v[164:167], v[204:207], v[116:119], v[164:167]
    s_waitcnt lgkmcnt(6)
    v_mfma_f32_16x16x32_bf16 v[196:199], v[204:207], v[220:223], v[196:199]
    s_waitcnt lgkmcnt(4)
    ds_read_b64_tr_b16 v[204:205], v248 offset:16384
    v_mfma_f32_16x16x32_bf16 v[136:139], v[208:211], v[52:55], v[136:139]
    ds_read_b64_tr_b16 v[206:207], v248 offset:17408
    v_mfma_f32_16x16x32_bf16 v[168:171], v[208:211], v[116:119], v[168:171]
    v_mfma_f32_16x16x32_bf16 v[200:203], v[208:211], v[220:223], v[200:203]
    s_waitcnt lgkmcnt(4)
    ds_read_b64_tr_b16 v[208:209], v249 offset:16384
    v_mfma_f32_16x16x32_bf16 v[140:143], v[212:215], v[52:55], v[140:143]
    ds_read_b64_tr_b16 v[210:211], v249 offset:17408
    v_mfma_f32_16x16x32_bf16 v[172:175], v[212:215], v[116:119], v[172:175]
    s_waitcnt lgkmcnt(4)
    ds_read_b64_tr_b16 v[212:213], v250 offset:16384
    v_mfma_f32_16x16x32_bf16 v[144:147], v[216:219], v[52:55], v[144:147]
    ds_read_b64_tr_b16 v[214:215], v250 offset:17408
    v_mfma_f32_16x16x32_bf16 v[176:179], v[216:219], v[116:119], v[176:179]
    ds_read_b64_tr_b16 v[216:217], v251 offset:16384
    s_add_u32 m0, s45, 16384
    s_add_u32 s63, s63, 8192
    buffer_load_dwordx4 v252, s[8:11], s63 offen nt lds
    buffer_load_dwordx4 v252, s[8:11], s63 offen offset:2048 nt lds
    s_add_u32 m0, s45, 24576
    s_add_u32 s63, s63, 8192
    buffer_load_dwordx4 v252, s[8:11], s63 offen nt lds
    buffer_load_dwordx4 v252, s[8:11], s63 offen offset:2048 nt lds
    s_waitcnt lgkmcnt(5)
    v_mfma_f32_16x16x32_bf16 v[148:151], v[204:207], v[52:55], v[148:151]
    ds_read_b64_tr_b16 v[218:219], v251 offset:17408
    v_mfma_f32_16x16x32_bf16 v[180:183], v[204:207], v[116:119], v[180:183]
    s_waitcnt lgkmcnt(4)
    v_mfma_f32_16x16x32_bf16 v[152:155], v[208:211], v[52:55], v[152:155]
    v_mfma_f32_16x16x32_bf16 v[184:187], v[208:211], v[116:119], v[184:187]
    s_waitcnt vmcnt(6) lgkmcnt(0)
    s_barrier
    ds_read_b64_tr_b16 v[204:205], v244 offset:0
    ds_read_b64_tr_b16 v[206:207], v244 offset:1024
    ds_read_b128 v[220:223], v3 offset:8256
    ds_read_b64_tr_b16 v[208:209], v245 offset:0
    ds_read_b64_tr_b16 v[210:211], v245 offset:1024
    v_mfma_f32_16x16x32_bf16 v[156:159], v[212:215], v[52:55], v[156:159]
    s_add_u32 m0, s46, 16384
    s_add_u32 s56, s55, 31744
    buffer_load_dwordx4 v253, s[16:19], s55 offen  lds
    s_add_u32 s55, s55, 262400
    v_mfma_f32_16x16x32_bf16 v[188:191], v[212:215], v[116:119], v[188:191]
    ds_read_b64_tr_b16 v[212:213], v246 offset:0
    buffer_load_dwordx4 v253, s[16:19], s56 offen offset:1024  lds
    s_and_b32 s55, s55, 0x3fffff
    v_mfma_f32_16x16x32_bf16 v[160:163], v[216:219], v[52:55], v[160:163]
    ds_read_b64_tr_b16 v[214:215], v246 offset:1024
    v_mfma_f32_16x16x32_bf16 v[192:195], v[216:219], v[116:119], v[192:195]
    s_waitcnt lgkmcnt(5)
    ds_read_b64_tr_b16 v[216:217], v247 offset:0
    v_mfma_f32_16x16x32_bf16 v[132:135], v[204:207], v[56:59], v[132:135]
    ds_read_b64_tr_b16 v[218:219], v247 offset:1024
    v_mfma_f32_16x16x32_bf16 v[164:167], v[204:207], v[120:123], v[164:167]
    s_waitcnt lgkmcnt(6)
    v_mfma_f32_16x16x32_bf16 v[196:199], v[204:207], v[220:223], v[196:199]
    s_waitcnt lgkmcnt(4)
    ds_read_b64_tr_b16 v[204:205], v248 offset:0
    v_mfma_f32_16x16x32_bf16 v[136:139], v[208:211], v[56:59], v[136:139]
    ds_read_b64_tr_b16 v[206:207], v248 offset:1024
    v_mfma_f32_16x16x32_bf16 v[168:171], v[208:211], v[120:123], v[168:171]
    v_mfma_f32_16x16x32_bf16 v[200:203], v[208:211], v[220:223], v[200:203]
    s_waitcnt lgkmcnt(4)
    ds_read_b64_tr_b16 v[208:209], v249 offset:0
    v_mfma_f32_16x16x32_bf16 v[140:143], v[212:215], v[56:59], v[140:143]
    ds_read_b64_tr_b16 v[210:211], v249 offset:1024
    v_mfma_f32_16x16x32_bf16 v[172:175], v[212:215], v[120:123], v[172:175]
    s_waitcnt lgkmcnt(4)
    ds_read_b64_tr_b16 v[212:213], v250 offset:0
    v_mfma_f32_16x16x32_bf16 v[144:147], v[216:219], v[56:59], v[144:147]
    ds_read_b64_tr_b16 v[214:215], v250 offset:1024
    v_mfma_f32_16x16x32_bf16 v[176:179], v[216:219], v[120:123], v[176:179]
    ds_read_b64_tr_b16 v[216:217], v251 offset:0
    s_add_u32 m0, s45, 32768
    s_add_u32 s54, s54, 8192
    buffer_load_dwordx4 v252, s[4:7], s54 offen nt lds
    buffer_load_dwordx4 v252, s[4:7], s54 offen offset:2048 nt lds
    s_add_u32 m0, s45, 40960
    s_add_u32 s54, s54, 8192
    buffer_load_dwordx4 v252, s[4:7], s54 offen nt lds
    buffer_load_dwordx4 v252, s[4:7], s54 offen offset:2048 nt lds
    s_waitcnt lgkmcnt(5)
    v_mfma_f32_16x16x32_bf16 v[148:151], v[204:207], v[56:59], v[148:151]
    ds_read_b64_tr_b16 v[218:219], v251 offset:1024
    v_mfma_f32_16x16x32_bf16 v[180:183], v[204:207], v[120:123], v[180:183]
    s_waitcnt lgkmcnt(4)
    v_mfma_f32_16x16x32_bf16 v[152:155], v[208:211], v[56:59], v[152:155]
    v_mfma_f32_16x16x32_bf16 v[184:187], v[208:211], v[120:123], v[184:187]
    s_waitcnt vmcnt(8) lgkmcnt(0)
    s_barrier
    ds_read_b64_tr_b16 v[204:205], v244 offset:8192
    ds_read_b64_tr_b16 v[206:207], v244 offset:9216
    ds_read_b128 v[220:223], v3 offset:10240
    ds_read_b64_tr_b16 v[208:209], v245 offset:8192
    ds_read_b64_tr_b16 v[210:211], v245 offset:9216
    v_mfma_f32_16x16x32_bf16 v[156:159], v[212:215], v[56:59], v[156:159]
    v_mfma_f32_16x16x32_bf16 v[188:191], v[212:215], v[120:123], v[188:191]
    ds_read_b64_tr_b16 v[212:213], v246 offset:8192
    v_mfma_f32_16x16x32_bf16 v[160:163], v[216:219], v[56:59], v[160:163]
    ds_read_b64_tr_b16 v[214:215], v246 offset:9216
    v_mfma_f32_16x16x32_bf16 v[192:195], v[216:219], v[120:123], v[192:195]
    s_waitcnt lgkmcnt(5)
    ds_read_b64_tr_b16 v[216:217], v247 offset:8192
    v_mfma_f32_16x16x32_bf16 v[132:135], v[204:207], v[60:63], v[132:135]
    ds_read_b64_tr_b16 v[218:219], v247 offset:9216
    v_mfma_f32_16x16x32_bf16 v[164:167], v[204:207], v[124:127], v[164:167]
    s_waitcnt lgkmcnt(6)
    v_mfma_f32_16x16x32_bf16 v[196:199], v[204:207], v[220:223], v[196:199]
    s_waitcnt lgkmcnt(4)
    ds_read_b64_tr_b16 v[204:205], v248 offset:8192
    v_mfma_f32_16x16x32_bf16 v[136:139], v[208:211], v[60:63], v[136:139]
    ds_read_b64_tr_b16 v[206:207], v248 offset:9216
    v_mfma_f32_16x16x32_bf16 v[168:171], v[208:211], v[124:127], v[168:171]
    v_mfma_f32_16x16x32_bf16 v[200:203], v[208:211], v[220:223], v[200:203]
    s_waitcnt lgkmcnt(4)
    ds_read_b64_tr_b16 v[208:209], v249 offset:8192
    v_mfma_f32_16x16x32_bf16 v[140:143], v[212:215], v[60:63], v[140:143]
    ds_read_b64_tr_b16 v[210:211], v249 offset:9216
    v_mfma_f32_16x16x32_bf16 v[172:175], v[212:215], v[124:127], v[172:175]
    s_waitcnt lgkmcnt(4)
    ds_read_b64_tr_b16 v[212:213], v250 offset:8192
    v_mfma_f32_16x16x32_bf16 v[144:147], v[216:219], v[60:63], v[144:147]
    ds_read_b64_tr_b16 v[214:215], v250 offset:9216
    v_mfma_f32_16x16x32_bf16 v[176:179], v[216:219], v[124:127], v[176:179]
    ds_read_b64_tr_b16 v[216:217], v251 offset:8192
    s_add_u32 m0, s45, 49152
    s_add_u32 s63, s63, 8192
    buffer_load_dwordx4 v252, s[8:11], s63 offen nt lds
    buffer_load_dwordx4 v252, s[8:11], s63 offen offset:2048 nt lds
    s_add_u32 m0, s45, 57344
    s_add_u32 s63, s63, 8192
    buffer_load_dwordx4 v252, s[8:11], s63 offen nt lds
    buffer_load_dwordx4 v252, s[8:11], s63 offen offset:2048 nt lds
    s_waitcnt lgkmcnt(5)
    v_mfma_f32_16x16x32_bf16 v[148:151], v[204:207], v[60:63], v[148:151]
    ds_read_b64_tr_b16 v[218:219], v251 offset:9216
    v_mfma_f32_16x16x32_bf16 v[180:183], v[204:207], v[124:127], v[180:183]
    s_waitcnt lgkmcnt(4)
    v_mfma_f32_16x16x32_bf16 v[152:155], v[208:211], v[60:63], v[152:155]
    v_mfma_f32_16x16x32_bf16 v[184:187], v[208:211], v[124:127], v[184:187]
    s_waitcnt vmcnt(4) lgkmcnt(0)
    s_barrier
    ds_read_b64_tr_b16 v[204:205], v244 offset:16384
    ds_read_b64_tr_b16 v[206:207], v244 offset:17408
    ds_read_b128 v[220:223], v3 offset:10304
    ds_read_b64_tr_b16 v[208:209], v245 offset:16384
    ds_read_b64_tr_b16 v[210:211], v245 offset:17408
    v_mfma_f32_16x16x32_bf16 v[156:159], v[212:215], v[60:63], v[156:159]
    s_add_u32 m0, s45, 0
    s_add_u32 s54, s54, 8192
    buffer_load_dwordx4 v252, s[4:7], s54 offen nt lds
    buffer_load_dwordx4 v252, s[4:7], s54 offen offset:2048 nt lds
    s_add_u32 m0, s45, 8192
    s_add_u32 s54, s54, 8192
    buffer_load_dwordx4 v252, s[4:7], s54 offen nt lds
    buffer_load_dwordx4 v252, s[4:7], s54 offen offset:2048 nt lds
    v_mfma_f32_16x16x32_bf16 v[188:191], v[212:215], v[124:127], v[188:191]
    ds_read_b64_tr_b16 v[212:213], v246 offset:16384
    v_mfma_f32_16x16x32_bf16 v[160:163], v[216:219], v[60:63], v[160:163]
    ds_read_b64_tr_b16 v[214:215], v246 offset:17408
    v_mfma_f32_16x16x32_bf16 v[192:195], v[216:219], v[124:127], v[192:195]
    s_waitcnt lgkmcnt(5)
    ds_read_b64_tr_b16 v[216:217], v247 offset:16384
    v_mfma_f32_16x16x32_bf16 v[132:135], v[204:207], v[64:67], v[132:135]
    ds_read_b64_tr_b16 v[218:219], v247 offset:17408
    v_mfma_f32_16x16x32_bf16 v[164:167], v[204:207], v[128:131], v[164:167]
    s_waitcnt lgkmcnt(6)
    v_mfma_f32_16x16x32_bf16 v[196:199], v[204:207], v[220:223], v[196:199]
    s_waitcnt lgkmcnt(4)
    ds_read_b64_tr_b16 v[204:205], v248 offset:16384
    v_mfma_f32_16x16x32_bf16 v[136:139], v[208:211], v[64:67], v[136:139]
    ds_read_b64_tr_b16 v[206:207], v248 offset:17408
    v_mfma_f32_16x16x32_bf16 v[168:171], v[208:211], v[128:131], v[168:171]
    v_mfma_f32_16x16x32_bf16 v[200:203], v[208:211], v[220:223], v[200:203]
    s_waitcnt lgkmcnt(4)
    ds_read_b64_tr_b16 v[208:209], v249 offset:16384
    v_mfma_f32_16x16x32_bf16 v[140:143], v[212:215], v[64:67], v[140:143]
    ds_read_b64_tr_b16 v[210:211], v249 offset:17408
    v_mfma_f32_16x16x32_bf16 v[172:175], v[212:215], v[128:131], v[172:175]
    s_waitcnt lgkmcnt(4)
    ds_read_b64_tr_b16 v[212:213], v250 offset:16384
    v_mfma_f32_16x16x32_bf16 v[144:147], v[216:219], v[64:67], v[144:147]
    ds_read_b64_tr_b16 v[214:215], v250 offset:17408
    v_mfma_f32_16x16x32_bf16 v[176:179], v[216:219], v[128:131], v[176:179]
    s_waitcnt lgkmcnt(4)
    ds_read_b64_tr_b16 v[216:217], v251 offset:16384
    v_mfma_f32_16x16x32_bf16 v[148:151], v[204:207], v[64:67], v[148:151]
    ds_read_b64_tr_b16 v[218:219], v251 offset:17408
    v_mfma_f32_16x16x32_bf16 v[180:183], v[204:207], v[128:131], v[180:183]
    s_waitcnt lgkmcnt(4)
    v_mfma_f32_16x16x32_bf16 v[152:155], v[208:211], v[64:67], v[152:155]
    v_mfma_f32_16x16x32_bf16 v[184:187], v[208:211], v[128:131], v[184:187]
    s_waitcnt lgkmcnt(2)
    v_mfma_f32_16x16x32_bf16 v[156:159], v[212:215], v[64:67], v[156:159]
    v_mfma_f32_16x16x32_bf16 v[188:191], v[212:215], v[128:131], v[188:191]
    s_waitcnt lgkmcnt(0)
    v_mfma_f32_16x16x32_bf16 v[160:163], v[216:219], v[64:67], v[160:163]
    v_mfma_f32_16x16x32_bf16 v[192:195], v[216:219], v[128:131], v[192:195]
    s_waitcnt vmcnt(6) lgkmcnt(0)
    s_barrier
    s_add_u32 m0, s45, 16384
    s_add_u32 s63, s63, 8192
    buffer_load_dwordx4 v252, s[8:11], s63 offen nt lds
    buffer_load_dwordx4 v252, s[8:11], s63 offen offset:2048 nt lds
    s_add_u32 m0, s45, 24576
    s_add_u32 s63, s63, 8192
    buffer_load_dwordx4 v252, s[8:11], s63 offen nt lds
    buffer_load_dwordx4 v252, s[8:11], s63 offen offset:2048 nt lds
    v_add_u32 v1, s47, v2
    v_mul_f32 v196, s58, v196
    v_mul_f32 v197, s58, v197
    v_mul_f32 v198, s58, v198
    v_mul_f32 v199, s58, v199
    v_cvt_pk_bf16_f32 v196, v196, v197
    v_cvt_pk_bf16_f32 v197, v198, v199
    ds_write_b64 v1, v[196:197] offset:32768
    v_mul_f32 v200, s58, v200
    v_mul_f32 v201, s58, v201
    v_mul_f32 v202, s58, v202
    v_mul_f32 v203, s58, v203
    v_cvt_pk_bf16_f32 v200, v200, v201
    v_cvt_pk_bf16_f32 v201, v202, v203
    ds_write_b64 v1, v[200:201] offset:33280
    v_add_u32 v1, s50, v2
    v_mul_f32 v132, s58, v132
    v_mul_f32 v133, s58, v133
    v_mul_f32 v134, s58, v134
    v_mul_f32 v135, s58, v135
    v_cvt_pk_bf16_f32 v132, v132, v133
    v_cvt_pk_bf16_f32 v133, v134, v135
    ds_write_b64 v1, v[132:133] offset:0
    v_mul_f32 v164, s58, v164
    v_mul_f32 v165, s58, v165
    v_mul_f32 v166, s58, v166
    v_mul_f32 v167, s58, v167
    v_cvt_pk_bf16_f32 v164, v164, v165
    v_cvt_pk_bf16_f32 v165, v166, v167
    ds_write_b64 v1, v[164:165] offset:4096
    v_mul_f32 v136, s58, v136
    v_mul_f32 v137, s58, v137
    v_mul_f32 v138, s58, v138
    v_mul_f32 v139, s58, v139
    v_cvt_pk_bf16_f32 v136, v136, v137
    v_cvt_pk_bf16_f32 v137, v138, v139
    ds_write_b64 v1, v[136:137] offset:512
    v_mul_f32 v168, s58, v168
    v_mul_f32 v169, s58, v169
    v_mul_f32 v170, s58, v170
    v_mul_f32 v171, s58, v171
    v_cvt_pk_bf16_f32 v168, v168, v169
    v_cvt_pk_bf16_f32 v169, v170, v171
    ds_write_b64 v1, v[168:169] offset:4608
    v_add_u32 v1, s51, v2
    v_mul_f32 v140, s58, v140
    v_mul_f32 v141, s58, v141
    v_mul_f32 v142, s58, v142
    v_mul_f32 v143, s58, v143
    v_cvt_pk_bf16_f32 v140, v140, v141
    v_cvt_pk_bf16_f32 v141, v142, v143
    ds_write_b64 v1, v[140:141] offset:0
    v_mul_f32 v172, s58, v172
    v_mul_f32 v173, s58, v173
    v_mul_f32 v174, s58, v174
    v_mul_f32 v175, s58, v175
    v_cvt_pk_bf16_f32 v172, v172, v173
    v_cvt_pk_bf16_f32 v173, v174, v175
    ds_write_b64 v1, v[172:173] offset:4096
    v_mul_f32 v144, s58, v144
    v_mul_f32 v145, s58, v145
    v_mul_f32 v146, s58, v146
    v_mul_f32 v147, s58, v147
    v_cvt_pk_bf16_f32 v144, v144, v145
    v_cvt_pk_bf16_f32 v145, v146, v147
    ds_write_b64 v1, v[144:145] offset:512
    v_mul_f32 v176, s58, v176
    v_mul_f32 v177, s58, v177
    v_mul_f32 v178, s58, v178
    v_mul_f32 v179, s58, v179
    v_cvt_pk_bf16_f32 v176, v176, v177
    v_cvt_pk_bf16_f32 v177, v178, v179
    ds_write_b64 v1, v[176:177] offset:4608
    v_add_u32 v1, s52, v2
    v_mul_f32 v148, s58, v148
    v_mul_f32 v149, s58, v149
    v_mul_f32 v150, s58, v150
    v_mul_f32 v151, s58, v151
    v_cvt_pk_bf16_f32 v148, v148, v149
    v_cvt_pk_bf16_f32 v149, v150, v151
    ds_write_b64 v1, v[148:149] offset:0
    v_mul_f32 v180, s58, v180
    v_mul_f32 v181, s58, v181
    v_mul_f32 v182, s58, v182
    v_mul_f32 v183, s58, v183
    v_cvt_pk_bf16_f32 v180, v180, v181
    v_cvt_pk_bf16_f32 v181, v182, v183
    ds_write_b64 v1, v[180:181] offset:4096
    v_mul_f32 v152, s58, v152
    v_mul_f32 v153, s58, v153
    v_mul_f32 v154, s58, v154
    v_mul_f32 v155, s58, v155
    v_cvt_pk_bf16_f32 v152, v152, v153
    v_cvt_pk_bf16_f32 v153, v154, v155
    ds_write_b64 v1, v[152:153] offset:512
    v_mul_f32 v184, s58, v184
    v_mul_f32 v185, s58, v185
    v_mul_f32 v186, s58, v186
    v_mul_f32 v187, s58, v187
    v_cvt_pk_bf16_f32 v184, v184, v185
    v_cvt_pk_bf16_f32 v185, v186, v187
    ds_write_b64 v1, v[184:185] offset:4608
    v_add_u32 v1, s53, v2
    v_mul_f32 v156, s58, v156
    v_mul_f32 v157, s58, v157
    v_mul_f32 v158, s58, v158
    v_mul_f32 v159, s58, v159
    v_cvt_pk_bf16_f32 v156, v156, v157
    v_cvt_pk_bf16_f32 v157, v158, v159
    ds_write_b64 v1, v[156:157] offset:0
    v_mul_f32 v188, s58, v188
    v_mul_f32 v189, s58, v189
    v_mul_f32 v190, s58, v190
    v_mul_f32 v191, s58, v191
    v_cvt_pk_bf16_f32 v188, v188, v189
    v_cvt_pk_bf16_f32 v189, v190, v191
    ds_write_b64 v1, v[188:189] offset:4096
    v_mul_f32 v160, s58, v160
    v_mul_f32 v161, s58, v161
    v_mul_f32 v162, s58, v162
    v_mul_f32 v163, s58, v163
    v_cvt_pk_bf16_f32 v160, v160, v161
    v_cvt_pk_bf16_f32 v161, v162, v163
    ds_write_b64 v1, v[160:161] offset:512
    v_mul_f32 v192, s58, v192
    v_mul_f32 v193, s58, v193
    v_mul_f32 v194, s58, v194
    v_mul_f32 v195, s58, v195
    v_cvt_pk_bf16_f32 v192, v192, v193
    v_cvt_pk_bf16_f32 v193, v194, v195
    ds_write_b64 v1, v[192:193] offset:4608
    s_waitcnt vmcnt(4) lgkmcnt(0)
    s_barrier
    s_add_u32 m0, s45, 32768
    s_add_u32 s54, s54, 8192
    buffer_load_dwordx4 v252, s[4:7], s54 offen nt lds
    buffer_load_dwordx4 v252, s[4:7], s54 offen offset:2048 nt lds
    s_add_u32 m0, s45, 40960
    s_add_u32 s54, s54, 8192
    buffer_load_dwordx4 v252, s[4:7], s54 offen nt lds
    buffer_load_dwordx4 v252, s[4:7], s54 offen offset:2048 nt lds
    s_add_u32 s41, s47, 98304
    v_add_u32 v1, s41, v0
    ds_write_b128 v1, v[240:243]
    ds_write_b128 v1, v[4:7] offset:4096
    v_lshrrev_b32 v207, 4, v0
    v_lshrrev_b32 v204, 3, v207
    v_and_b32 v205, 6, v204
    v_and_b32 v248, 7, v207
    v_xor_b32 v248, v248, v205
    v_lshlrev_b32 v248, 4, v248
    v_lshl_add_u32 v248, v204, 10, v248
    s_lshl_b32 s43, s36, 15
    v_add_u32 v248, s43, v248
    v_bfe_u32 v204, v207, 3, 2
    v_xor_b32 v204, s36, v204
    v_lshlrev_b32 v204, 5, v204
    v_lshrrev_b32 v205, 2, v207
    v_lshl_add_u32 v204, v205, 7, v204
    v_and_b32 v205, 3, v207
    v_lshl_add_u32 v204, v205, 3, v204
    v_add_u32 v204, 65536, v204
    v_xor_b32 v244, 0, v204
    v_xor_b32 v245, 32, v204
    v_xor_b32 v246, 64, v204
    v_xor_b32 v247, 96, v204
    v_add_u32 v3, 98304, v0
    s_lshl_b32 s41, s36, 12
    v_add_u32 v249, s41, v0
    s_lshl_b32 s41, s36, 9
    s_add_u32 s41, s41, 16384
    v_and_b32 v204, 15, v207
    v_lshlrev_b32 v204, 5, v204
    v_lshrrev_b32 v205, 4, v207
    v_lshl_add_u32 v204, v205, 3, v204
    v_add_u32 v250, s41, v204
    v_min_u32 v207, 1, v207
    v_lshlrev_b32 v207, 30, v207
    s_lshl_b32 s41, s36, 5
    v_add_u32 v251, s41, v207
    v_mov_b32 v2, v252
    s_lshl_b32 s57, s40, 3
    s_waitcnt vmcnt(6) lgkmcnt(0)
    s_barrier
    s_add_u32 m0, s45, 49152
    s_add_u32 s63, s63, 8192
    buffer_load_dwordx4 v2, s[8:11], s63 offen nt lds
    buffer_load_dwordx4 v2, s[8:11], s63 offen offset:2048 nt lds
    s_add_u32 m0, s45, 57344
    s_add_u32 s63, s63, 8192
    buffer_load_dwordx4 v2, s[8:11], s63 offen nt lds
    buffer_load_dwordx4 v2, s[8:11], s63 offen offset:2048 nt lds
    v_mov_b32 v52, 0
    s_lshl_b32 s41, s40, 2
    buffer_load_dword v53, v52, s[32:35], s41 offen offset:128 sc1
    s_waitcnt vmcnt(5) lgkmcnt(0)
    s_barrier
    s_add_u32 m0, s45, 0
    s_add_u32 s54, s54, 8192
    buffer_load_dwordx4 v2, s[4:7], s54 offen nt lds
    buffer_load_dwordx4 v2, s[4:7], s54 offen offset:2048 nt lds
    s_add_u32 m0, s45, 8192
    s_add_u32 s54, s54, 8192
    buffer_load_dwordx4 v2, s[4:7], s54 offen nt lds
    buffer_load_dwordx4 v2, s[4:7], s54 offen offset:2048 nt lds
    s_add_u32 s41, s48, 114688
    v_add_u32 v1, s41, v0
    ds_read_b128 v[36:39], v1 offset:0
    ds_read_b128 v[40:43], v1 offset:1024
    ds_read_b128 v[44:47], v1 offset:2048
    ds_read_b128 v[48:51], v1 offset:3072
    ds_read_b128 v[100:103], v1 offset:4096
    ds_read_b128 v[104:107], v1 offset:5120
    ds_read_b128 v[108:111], v1 offset:6144
    ds_read_b128 v[112:115], v1 offset:7168
    s_waitcnt vmcnt(7) lgkmcnt(0)
    s_barrier
    s_add_u32 m0, s45, 16384
    s_add_u32 s63, s63, 8192
    buffer_load_dwordx4 v2, s[8:11], s63 offen nt lds
    buffer_load_dwordx4 v2, s[8:11], s63 offen offset:2048 nt lds
    s_add_u32 m0, s45, 24576
    s_add_u32 s63, s63, 8192
    buffer_load_dwordx4 v2, s[8:11], s63 offen nt lds
    buffer_load_dwordx4 v2, s[8:11], s63 offen offset:2048 nt lds
    s_waitcnt vmcnt(4) lgkmcnt(0)
    s_barrier
    s_add_u32 m0, s45, 32768
    s_add_u32 s54, s54, 8192
    buffer_load_dwordx4 v2, s[4:7], s54 offen nt lds
    buffer_load_dwordx4 v2, s[4:7], s54 offen offset:2048 nt lds
    s_add_u32 m0, s45, 40960
    s_add_u32 s54, s54, 8192
    buffer_load_dwordx4 v2, s[4:7], s54 offen nt lds
    buffer_load_dwordx4 v2, s[4:7], s54 offen offset:2048 nt lds
    s_waitcnt vmcnt(6) lgkmcnt(0)
    s_barrier
    s_add_u32 m0, s45, 49152
    s_add_u32 s63, s63, 8192
    buffer_load_dwordx4 v2, s[8:11], s63 offen nt lds
    buffer_load_dwordx4 v2, s[8:11], s63 offen offset:2048 nt lds
    s_add_u32 m0, s45, 57344
    s_add_u32 s63, s63, 8192
    buffer_load_dwordx4 v2, s[8:11], s63 offen nt lds
    buffer_load_dwordx4 v2, s[8:11], s63 offen offset:2048 nt lds
    s_lshl_b32 s41, s40, 2
    s_mov_b32 s44, 2097152
L_Bclr:
    v_readfirstlane_b32 s42, v53
    s_sub_u32 s44, s44, 1
    s_cbranch_scc1 L_Bclrd
    s_cmp_ge_u32 s42, 8
    s_cbranch_scc1 L_Bclrd
    buffer_load_dword v53, v52, s[32:35], s41 offen offset:128 sc1
    s_waitcnt vmcnt(0)
    s_branch L_Bclr
L_Bclrd:
    s_waitcnt vmcnt(4) lgkmcnt(0)
    s_barrier
    s_add_u32 m0, s45, 0
    s_add_u32 s54, s54, 8192
    buffer_load_dwordx4 v2, s[4:7], s54 offen nt lds
    buffer_load_dwordx4 v2, s[4:7], s54 offen offset:2048 nt lds
    s_add_u32 m0, s45, 8192
    s_add_u32 s54, s54, 8192
    buffer_load_dwordx4 v2, s[4:7], s54 offen nt lds
    buffer_load_dwordx4 v2, s[4:7], s54 offen offset:2048 nt lds
    s_waitcnt vmcnt(6) lgkmcnt(0)
    s_barrier
    s_add_u32 m0, s45, 16384
    s_add_u32 s63, s63, 8192
    buffer_load_dwordx4 v2, s[8:11], s63 offen nt lds
    buffer_load_dwordx4 v2, s[8:11], s63 offen offset:2048 nt lds
    s_add_u32 m0, s45, 24576
    s_add_u32 s63, s63, 8192
    buffer_load_dwordx4 v2, s[8:11], s63 offen nt lds
    buffer_load_dwordx4 v2, s[8:11], s63 offen offset:2048 nt lds
    s_waitcnt vmcnt(4) lgkmcnt(0)
    s_barrier
    s_add_u32 m0, s45, 32768
    s_add_u32 s54, s54, 8192
    buffer_load_dwordx4 v2, s[4:7], s54 offen nt lds
    buffer_load_dwordx4 v2, s[4:7], s54 offen offset:2048 nt lds
    s_add_u32 m0, s45, 40960
    s_add_u32 s54, s54, 8192
    buffer_load_dwordx4 v2, s[4:7], s54 offen nt lds
    buffer_load_dwordx4 v2, s[4:7], s54 offen offset:2048 nt lds
    s_waitcnt vmcnt(6) lgkmcnt(0)
    s_barrier
    s_add_u32 m0, s45, 49152
    s_add_u32 s63, s63, 8192
    buffer_load_dwordx4 v2, s[8:11], s63 offen nt lds
    buffer_load_dwordx4 v2, s[8:11], s63 offen offset:2048 nt lds
    s_add_u32 m0, s45, 57344
    s_add_u32 s63, s63, 8192
    buffer_load_dwordx4 v2, s[8:11], s63 offen nt lds
    buffer_load_dwordx4 v2, s[8:11], s63 offen offset:2048 nt lds
    s_getpc_b64 s[96:97]
L_pcb56:
    s_sub_u32 s96, s96, L_pcb56-concat_heads__mha_block_cached__gqa_block_cached__near_ridge_kernel
    s_subb_u32 s97, s97, 0
    s_lshr_b32 s41, s2, 3
    s_lshl_b32 s41, s41, 2
    s_add_u32 s41, s41, s36
    s_lshl_b32 s41, s41, 7
    v_lshlrev_b32 v56, 10, v0
    v_add_u32 v56, s41, v56
    v_min_u32 v56, L_end-concat_heads__mha_block_cached__gqa_block_cached__near_ridge_kernel, v56
    v_mov_b32 v57, s97
    v_add_co_u32 v56, vcc, s96, v56
    s_nop 1
    v_addc_co_u32 v57, vcc, 0, v57, vcc
    global_load_dword v58, v[56:57], off
    s_waitcnt vmcnt(5) lgkmcnt(0)
    s_barrier
    s_add_u32 m0, s45, 0
    s_add_u32 s54, s54, 8192
    buffer_load_dwordx4 v2, s[4:7], s54 offen nt lds
    buffer_load_dwordx4 v2, s[4:7], s54 offen offset:2048 nt lds
    s_add_u32 m0, s45, 8192
    s_add_u32 s54, s54, 8192
    buffer_load_dwordx4 v2, s[4:7], s54 offen nt lds
    buffer_load_dwordx4 v2, s[4:7], s54 offen offset:2048 nt lds
    s_waitcnt vmcnt(7) lgkmcnt(0)
    s_barrier
    s_add_u32 m0, s45, 16384
    s_add_u32 s63, s63, 8192
    buffer_load_dwordx4 v2, s[8:11], s63 offen nt lds
    buffer_load_dwordx4 v2, s[8:11], s63 offen offset:2048 nt lds
    s_add_u32 m0, s45, 24576
    s_add_u32 s63, s63, 8192
    buffer_load_dwordx4 v2, s[8:11], s63 offen nt lds
    buffer_load_dwordx4 v2, s[8:11], s63 offen offset:2048 nt lds
    s_waitcnt vmcnt(4) lgkmcnt(0)
    s_barrier
    s_add_u32 m0, s45, 32768
    s_add_u32 s54, s54, 8192
    buffer_load_dwordx4 v2, s[4:7], s54 offen nt lds
    buffer_load_dwordx4 v2, s[4:7], s54 offen offset:2048 nt lds
    s_add_u32 m0, s45, 40960
    s_add_u32 s54, s54, 8192
    buffer_load_dwordx4 v2, s[4:7], s54 offen nt lds
    buffer_load_dwordx4 v2, s[4:7], s54 offen offset:2048 nt lds
    s_waitcnt vmcnt(6) lgkmcnt(0)
    s_barrier
    s_add_u32 m0, s45, 49152
    s_add_u32 s63, s63, 8192
    buffer_load_dwordx4 v2, s[8:11], s63 offen nt lds
    buffer_load_dwordx4 v2, s[8:11], s63 offen offset:2048 nt lds
    s_add_u32 m0, s45, 57344
    s_add_u32 s63, s63, 8192
    buffer_load_dwordx4 v2, s[8:11], s63 offen nt lds
    buffer_load_dwordx4 v2, s[8:11], s63 offen offset:2048 nt lds
    s_lshl_b32 s42, s36, 12
    s_bfe_u32 s41, s100, 262144
    s_add_u32 s41, s41, s39
    s_and_b32 s41, s41, 7
    s_lshl_b32 s41, s41, 7
    s_add_u32 m0, s42, 65536
    s_add_u32 s41, s41, s88
    buffer_load_dwordx4 v248, s[20:23], s41 offen  lds
    s_add_u32 s41, s41, 7168
    buffer_load_dwordx4 v248, s[20:23], s41 offen offset:1024  lds
    s_add_u32 s41, s41, 7168
    buffer_load_dwordx4 v248, s[20:23], s41 offen offset:2048  lds
    s_add_u32 s41, s41, 7168
    buffer_load_dwordx4 v248, s[20:23], s41 offen offset:3072  lds
    s_lshl_b32 s42, s36, 12
    s_bfe_u32 s41, s100, 262144
    s_add_u32 s41, s41, s39
    s_and_b32 s41, s41, 7
    s_lshl_b32 s41, s41, 7
    s_add_u32 m0, s42, 81920
    s_add_u32 s41, s41, s88
    s_add_u32 s41, s41, 131072
    buffer_load_dwordx4 v248, s[20:23], s41 offen  lds
    s_add_u32 s41, s41, 7168
    buffer_load_dwordx4 v248, s[20:23], s41 offen offset:1024  lds
    s_add_u32 s41, s41, 7168
    buffer_load_dwordx4 v248, s[20:23], s41 offen offset:2048  lds
    s_add_u32 s41, s41, 7168
    buffer_load_dwordx4 v248, s[20:23], s41 offen offset:3072  lds
    s_waitcnt vmcnt(12) lgkmcnt(0)
    s_barrier
    s_lshl_b32 s42, s36, 12
    s_bfe_u32 s41, s100, 262144
    s_add_u32 s41, s41, s39
    s_and_b32 s41, s41, 7
    s_lshl_b32 s41, s41, 7
    s_add_u32 m0, s42, 0
    s_add_u32 s41, s41, s89
    buffer_load_dwordx4 v248, s[20:23], s41 offen  lds
    s_add_u32 s41, s41, 7168
    buffer_load_dwordx4 v248, s[20:23], s41 offen offset:1024  lds
    s_add_u32 s41, s41, 7168
    buffer_load_dwordx4 v248, s[20:23], s41 offen offset:2048  lds
    s_add_u32 s41, s41, 7168
    buffer_load_dwordx4 v248, s[20:23], s41 offen offset:3072  lds
    s_waitcnt vmcnt(14) lgkmcnt(0)
    s_barrier
    s_lshl_b32 s42, s36, 12
    s_bfe_u32 s41, s100, 262144
    s_add_u32 s41, s41, s39
    s_and_b32 s41, s41, 7
    s_lshl_b32 s41, s41, 7
    s_add_u32 m0, s42, 16384
    s_add_u32 s41, s41, s89
    s_add_u32 s41, s41, 131072
    buffer_load_dwordx4 v248, s[20:23], s41 offen  lds
    s_add_u32 s41, s41, 7168
    buffer_load_dwordx4 v248, s[20:23], s41 offen offset:1024  lds
    s_add_u32 s41, s41, 7168
    buffer_load_dwordx4 v248, s[20:23], s41 offen offset:2048  lds
    s_add_u32 s41, s41, 7168
    buffer_load_dwordx4 v248, s[20:23], s41 offen offset:3072  lds
    s_waitcnt vmcnt(8) lgkmcnt(0)
    s_barrier
L_Btail:
    ds_read_b64_tr_b16 v[204:205], v244 offset:0
    ds_read_b64_tr_b16 v[206:207], v244 offset:2048
    ds_read_b128 v[220:223], v3 offset:0
    ds_read_b64_tr_b16 v[208:209], v244 offset:4096
    ds_read_b64_tr_b16 v[210:211], v244 offset:6144
    ds_read_b128 v[240:243], v3 offset:1024
    ds_read_b64_tr_b16 v[212:213], v244 offset:8192
    ds_read_b64_tr_b16 v[214:215], v244 offset:10240
    ds_read_b128 v[252:255], v3 offset:2048
    ds_read_b64_tr_b16 v[216:217], v244 offset:12288
    ds_read_b64_tr_b16 v[218:219], v244 offset:14336
    ds_read_b64_tr_b16 v[4:5], v245 offset:0
    ds_read_b64_tr_b16 v[6:7], v245 offset:2048
    ds_read_b64_tr_b16 v[8:9], v245 offset:4096
    ds_read_b64_tr_b16 v[10:11], v245 offset:6144
    s_waitcnt lgkmcnt(12)
    v_mfma_f32_16x16x32_bf16 v[164:167], v[204:207], v[220:223], 0
    ds_read_b128 v[220:223], v3 offset:3072
    s_lshl_b32 s42, s36, 12
    s_bfe_u32 s41, s100, 262148
    s_add_u32 s41, s41, s39
    s_and_b32 s41, s41, 7
    s_lshl_b32 s41, s41, 7
    s_add_u32 m0, s42, 32768
    s_add_u32 s41, s41, s88
    buffer_load_dwordx4 v248, s[20:23], s41 offen  lds
    s_add_u32 s41, s41, 7168
    buffer_load_dwordx4 v248, s[20:23], s41 offen offset:1024  lds
    s_add_u32 s41, s41, 7168
    buffer_load_dwordx4 v248, s[20:23], s41 offen offset:2048  lds
    s_add_u32 s41, s41, 7168
    buffer_load_dwordx4 v248, s[20:23], s41 offen offset:3072  lds
    s_waitcnt lgkmcnt(2)
    v_mfma_f32_16x16x32_bf16 v[164:167], v[208:211], v[240:243], v[164:167]
    ds_read_b64_tr_b16 v[12:13], v245 offset:8192
    v_mfma_f32_16x16x32_bf16 v[164:167], v[212:215], v[252:255], v[164:167]
    ds_read_b64_tr_b16 v[14:15], v245 offset:10240
    v_mfma_f32_16x16x32_bf16 v[132:135], v[204:207], v[224:227], 0
    ds_read_b64_tr_b16 v[16:17], v245 offset:12288
    v_mfma_f32_16x16x32_bf16 v[132:135], v[208:211], v[228:231], v[132:135]
    ds_read_b64_tr_b16 v[18:19], v245 offset:14336
    v_mfma_f32_16x16x32_bf16 v[132:135], v[212:215], v[232:235], v[132:135]
    ds_read_b128 v[240:243], v3 offset:5120
    v_mfma_f32_16x16x32_bf16 v[132:135], v[216:219], v[236:239], v[132:135]
    ds_read_b128 v[252:255], v3 offset:6144
    v_mfma_f32_16x16x32_bf16 v[148:151], v[204:207], v[68:71], 0
    ds_read_b64_tr_b16 v[204:205], v246 offset:0
    v_mfma_f32_16x16x32_bf16 v[148:151], v[208:211], v[72:75], v[148:151]
    ds_read_b64_tr_b16 v[206:207], v246 offset:2048
    v_mfma_f32_16x16x32_bf16 v[148:151], v[212:215], v[76:79], v[148:151]
    ds_read_b64_tr_b16 v[208:209], v246 offset:4096
    v_mfma_f32_16x16x32_bf16 v[148:151], v[216:219], v[80:83], v[148:151]
    s_waitcnt lgkmcnt(8)
    ds_read_b64_tr_b16 v[210:211], v246 offset:6144
    v_mfma_f32_16x16x32_bf16 v[164:167], v[216:219], v[220:223], v[164:167]
    ds_read_b64_tr_b16 v[212:213], v246 offset:8192
    v_add_u32 v244, 16384, v244
    v_mfma_f32_16x16x32_bf16 v[136:139], v[4:7], v[224:227], 0
    ds_read_b64_tr_b16 v[214:215], v246 offset:10240
    v_mfma_f32_16x16x32_bf16 v[136:139], v[8:11], v[228:231], v[136:139]
    s_waitcnt lgkmcnt(7)
    ds_read_b64_tr_b16 v[216:217], v246 offset:12288
    v_mfma_f32_16x16x32_bf16 v[136:139], v[12:15], v[232:235], v[136:139]
    ds_read_b64_tr_b16 v[218:219], v246 offset:14336
    v_mfma_f32_16x16x32_bf16 v[136:139], v[16:19], v[236:239], v[136:139]
    ds_read_b128 v[220:223], v3 offset:4096
    v_add_u32 v245, 16384, v245
    v_mfma_f32_16x16x32_bf16 v[152:155], v[4:7], v[68:71], 0
    ds_read_b64_tr_b16 v[4:5], v247 offset:0
    v_mfma_f32_16x16x32_bf16 v[152:155], v[8:11], v[72:75], v[152:155]
    ds_read_b64_tr_b16 v[6:7], v247 offset:2048
    v_mfma_f32_16x16x32_bf16 v[152:155], v[12:15], v[76:79], v[152:155]
    ds_read_b64_tr_b16 v[8:9], v247 offset:4096
    v_mfma_f32_16x16x32_bf16 v[152:155], v[16:19], v[80:83], v[152:155]
    s_waitcnt lgkmcnt(7)
    ds_read_b64_tr_b16 v[10:11], v247 offset:6144
    v_add_u32 v246, 16384, v246
    v_mfma_f32_16x16x32_bf16 v[140:143], v[204:207], v[224:227], 0
    ds_read_b64_tr_b16 v[12:13], v247 offset:8192
    v_mfma_f32_16x16x32_bf16 v[140:143], v[208:211], v[228:231], v[140:143]
    s_waitcnt lgkmcnt(7)
    ds_read_b64_tr_b16 v[14:15], v247 offset:10240
    v_mfma_f32_16x16x32_bf16 v[140:143], v[212:215], v[232:235], v[140:143]
    s_waitcnt lgkmcnt(6)
    ds_read_b64_tr_b16 v[16:17], v247 offset:12288
    v_mfma_f32_16x16x32_bf16 v[140:143], v[216:219], v[236:239], v[140:143]
    ds_read_b64_tr_b16 v[18:19], v247 offset:14336
    v_mfma_f32_16x16x32_bf16 v[156:159], v[204:207], v[68:71], 0
    ds_read_b64_tr_b16 v[204:205], v244 offset:0
    v_mfma_f32_16x16x32_bf16 v[156:159], v[208:211], v[72:75], v[156:159]
    ds_read_b64_tr_b16 v[206:207], v244 offset:2048
    v_mfma_f32_16x16x32_bf16 v[156:159], v[212:215], v[76:79], v[156:159]
    ds_read_b64_tr_b16 v[208:209], v244 offset:4096
    v_mfma_f32_16x16x32_bf16 v[156:159], v[216:219], v[80:83], v[156:159]
    s_waitcnt lgkmcnt(7)
    ds_read_b64_tr_b16 v[210:211], v244 offset:6144
    v_add_u32 v247, 16384, v247
    v_mfma_f32_16x16x32_bf16 v[144:147], v[4:7], v[224:227], 0
    ds_read_b64_tr_b16 v[212:213], v244 offset:8192
    v_mfma_f32_16x16x32_bf16 v[144:147], v[8:11], v[228:231], v[144:147]
    s_waitcnt lgkmcnt(7)
    ds_read_b64_tr_b16 v[214:215], v244 offset:10240
    v_mfma_f32_16x16x32_bf16 v[144:147], v[12:15], v[232:235], v[144:147]
    s_waitcnt lgkmcnt(6)
    ds_read_b64_tr_b16 v[216:217], v244 offset:12288
    v_mfma_f32_16x16x32_bf16 v[144:147], v[16:19], v[236:239], v[144:147]
    ds_read_b64_tr_b16 v[218:219], v244 offset:14336
    v_mfma_f32_16x16x32_bf16 v[160:163], v[4:7], v[68:71], 0
    ds_read_b64_tr_b16 v[4:5], v245 offset:0
    v_mfma_f32_16x16x32_bf16 v[160:163], v[8:11], v[72:75], v[160:163]
    ds_read_b64_tr_b16 v[6:7], v245 offset:2048
    v_mfma_f32_16x16x32_bf16 v[160:163], v[12:15], v[76:79], v[160:163]
    ds_read_b64_tr_b16 v[8:9], v245 offset:4096
    v_mfma_f32_16x16x32_bf16 v[160:163], v[16:19], v[80:83], v[160:163]
    ds_read_b64_tr_b16 v[10:11], v245 offset:6144
    s_waitcnt vmcnt(8)
    s_barrier
    s_waitcnt lgkmcnt(7)
    v_mfma_f32_16x16x32_bf16 v[164:167], v[204:207], v[220:223], v[164:167]
    ds_read_b128 v[220:223], v3 offset:7168
    s_lshl_b32 s42, s36, 12
    s_bfe_u32 s41, s100, 262148
    s_add_u32 s41, s41, s39
    s_and_b32 s41, s41, 7
    s_lshl_b32 s41, s41, 7
    s_add_u32 m0, s42, 49152
    s_add_u32 s41, s41, s88
    s_add_u32 s41, s41, 131072
    buffer_load_dwordx4 v248, s[20:23], s41 offen  lds
    s_add_u32 s41, s41, 7168
    buffer_load_dwordx4 v248, s[20:23], s41 offen offset:1024  lds
    s_add_u32 s41, s41, 7168
    buffer_load_dwordx4 v248, s[20:23], s41 offen offset:2048  lds
    s_add_u32 s41, s41, 7168
    buffer_load_dwordx4 v248, s[20:23], s41 offen offset:3072  lds
    v_mfma_f32_16x16x32_bf16 v[164:167], v[208:211], v[240:243], v[164:167]
    s_waitcnt lgkmcnt(1)
    ds_read_b64_tr_b16 v[12:13], v245 offset:8192
    v_mfma_f32_16x16x32_bf16 v[164:167], v[212:215], v[252:255], v[164:167]
    ds_read_b64_tr_b16 v[14:15], v245 offset:10240
    v_mfma_f32_16x16x32_bf16 v[132:135], v[204:207], v[20:23], v[132:135]
    ds_read_b64_tr_b16 v[16:17], v245 offset:12288
    v_mfma_f32_16x16x32_bf16 v[132:135], v[208:211], v[24:27], v[132:135]
    ds_read_b64_tr_b16 v[18:19], v245 offset:14336
    v_mfma_f32_16x16x32_bf16 v[132:135], v[212:215], v[28:31], v[132:135]
    ds_read_b128 v[240:243], v3 offset:9216
    v_mfma_f32_16x16x32_bf16 v[132:135], v[216:219], v[32:35], v[132:135]
    ds_read_b128 v[252:255], v3 offset:10240
    v_mfma_f32_16x16x32_bf16 v[148:151], v[204:207], v[84:87], v[148:151]
    ds_read_b64_tr_b16 v[204:205], v246 offset:0
    v_mfma_f32_16x16x32_bf16 v[148:151], v[208:211], v[88:91], v[148:151]
    ds_read_b64_tr_b16 v[206:207], v246 offset:2048
    v_mfma_f32_16x16x32_bf16 v[148:151], v[212:215], v[92:95], v[148:151]
    ds_read_b64_tr_b16 v[208:209], v246 offset:4096
    v_mfma_f32_16x16x32_bf16 v[148:151], v[216:219], v[96:99], v[148:151]
    s_waitcnt lgkmcnt(8)
    ds_read_b64_tr_b16 v[210:211], v246 offset:6144
    v_mfma_f32_16x16x32_bf16 v[164:167], v[216:219], v[220:223], v[164:167]
    ds_read_b64_tr_b16 v[212:213], v246 offset:8192
    v_add_u32 v244, 4294885376, v244
    v_mfma_f32_16x16x32_bf16 v[136:139], v[4:7], v[20:23], v[136:139]
    ds_read_b64_tr_b16 v[214:215], v246 offset:10240
    v_mfma_f32_16x16x32_bf16 v[136:139], v[8:11], v[24:27], v[136:139]
    s_waitcnt lgkmcnt(7)
    ds_read_b64_tr_b16 v[216:217], v246 offset:12288
    v_mfma_f32_16x16x32_bf16 v[136:139], v[12:15], v[28:31], v[136:139]
    ds_read_b64_tr_b16 v[218:219], v246 offset:14336
    v_mfma_f32_16x16x32_bf16 v[136:139], v[16:19], v[32:35], v[136:139]
    ds_read_b128 v[220:223], v3 offset:8192
    v_add_u32 v245, 4294885376, v245
    v_mfma_f32_16x16x32_bf16 v[152:155], v[4:7], v[84:87], v[152:155]
    ds_read_b64_tr_b16 v[4:5], v247 offset:0
    s_lshl_b32 s42, s36, 12
    s_bfe_u32 s41, s100, 262148
    s_add_u32 s41, s41, s39
    s_and_b32 s41, s41, 7
    s_lshl_b32 s41, s41, 7
    s_add_u32 m0, s42, 65536
    s_add_u32 s41, s41, s89
    buffer_load_dwordx4 v248, s[20:23], s41 offen  lds
    s_add_u32 s41, s41, 7168
    buffer_load_dwordx4 v248, s[20:23], s41 offen offset:1024  lds
    s_add_u32 s41, s41, 7168
    buffer_load_dwordx4 v248, s[20:23], s41 offen offset:2048  lds
    s_add_u32 s41, s41, 7168
    buffer_load_dwordx4 v248, s[20:23], s41 offen offset:3072  lds
    v_mfma_f32_16x16x32_bf16 v[152:155], v[8:11], v[88:91], v[152:155]
    ds_read_b64_tr_b16 v[6:7], v247 offset:2048
    v_mfma_f32_16x16x32_bf16 v[152:155], v[12:15], v[92:95], v[152:155]
    ds_read_b64_tr_b16 v[8:9], v247 offset:4096
    v_mfma_f32_16x16x32_bf16 v[152:155], v[16:19], v[96:99], v[152:155]
    s_waitcnt lgkmcnt(2)
    ds_read_b64_tr_b16 v[10:11], v247 offset:6144
    v_add_u32 v246, 4294885376, v246
    v_mfma_f32_16x16x32_bf16 v[140:143], v[204:207], v[20:23], v[140:143]
    ds_read_b64_tr_b16 v[12:13], v247 offset:8192
    v_mfma_f32_16x16x32_bf16 v[140:143], v[208:211], v[24:27], v[140:143]
    ds_read_b64_tr_b16 v[14:15], v247 offset:10240
    v_mfma_f32_16x16x32_bf16 v[140:143], v[212:215], v[28:31], v[140:143]
    ds_read_b64_tr_b16 v[16:17], v247 offset:12288
    v_mfma_f32_16x16x32_bf16 v[140:143], v[216:219], v[32:35], v[140:143]
    ds_read_b64_tr_b16 v[18:19], v247 offset:14336
    v_mfma_f32_16x16x32_bf16 v[156:159], v[204:207], v[84:87], v[156:159]
    ds_read_b64_tr_b16 v[204:205], v244 offset:0
    v_mfma_f32_16x16x32_bf16 v[156:159], v[208:211], v[88:91], v[156:159]
    ds_read_b64_tr_b16 v[206:207], v244 offset:2048
    v_mfma_f32_16x16x32_bf16 v[156:159], v[212:215], v[92:95], v[156:159]
    ds_read_b64_tr_b16 v[208:209], v244 offset:4096
    v_mfma_f32_16x16x32_bf16 v[156:159], v[216:219], v[96:99], v[156:159]
    s_waitcnt lgkmcnt(7)
    ds_read_b64_tr_b16 v[210:211], v244 offset:6144
    v_add_u32 v247, 4294885376, v247
    v_mfma_f32_16x16x32_bf16 v[144:147], v[4:7], v[20:23], v[144:147]
    ds_read_b64_tr_b16 v[212:213], v244 offset:8192
    v_mfma_f32_16x16x32_bf16 v[144:147], v[8:11], v[24:27], v[144:147]
    s_waitcnt lgkmcnt(7)
    ds_read_b64_tr_b16 v[214:215], v244 offset:10240
    v_mfma_f32_16x16x32_bf16 v[144:147], v[12:15], v[28:31], v[144:147]
    s_waitcnt lgkmcnt(6)
    ds_read_b64_tr_b16 v[216:217], v244 offset:12288
    v_mfma_f32_16x16x32_bf16 v[144:147], v[16:19], v[32:35], v[144:147]
    ds_read_b64_tr_b16 v[218:219], v244 offset:14336
    v_mfma_f32_16x16x32_bf16 v[160:163], v[4:7], v[84:87], v[160:163]
    ds_read_b64_tr_b16 v[4:5], v245 offset:0
    v_mfma_f32_16x16x32_bf16 v[160:163], v[8:11], v[88:91], v[160:163]
    ds_read_b64_tr_b16 v[6:7], v245 offset:2048
    v_mfma_f32_16x16x32_bf16 v[160:163], v[12:15], v[92:95], v[160:163]
    ds_read_b64_tr_b16 v[8:9], v245 offset:4096
    v_mfma_f32_16x16x32_bf16 v[160:163], v[16:19], v[96:99], v[160:163]
    ds_read_b64_tr_b16 v[10:11], v245 offset:6144
    s_waitcnt vmcnt(12)
    s_barrier
    s_setprio 1
    s_waitcnt lgkmcnt(7)
    v_mfma_f32_16x16x32_bf16 v[164:167], v[204:207], v[220:223], v[164:167]
    ds_read_b128 v[220:223], v3 offset:11264
    s_add_u32 s41, s48, 114688
    v_mfma_f32_16x16x32_bf16 v[164:167], v[208:211], v[240:243], v[164:167]
    s_waitcnt lgkmcnt(6)
    ds_read_b64_tr_b16 v[12:13], v245 offset:8192
    v_mfma_f32_16x16x32_bf16 v[164:167], v[212:215], v[252:255], v[164:167]
    ds_read_b64_tr_b16 v[14:15], v245 offset:10240
    v_add_u32 v1, s41, v0
    v_mfma_f32_16x16x32_bf16 v[132:135], v[204:207], v[36:39], v[132:135]
    ds_read_b64_tr_b16 v[16:17], v245 offset:12288
    v_mfma_f32_16x16x32_bf16 v[132:135], v[208:211], v[40:43], v[132:135]
    ds_read_b64_tr_b16 v[18:19], v245 offset:14336
    ds_read_b128 v[52:55], v1 offset:0
    v_mfma_f32_16x16x32_bf16 v[132:135], v[212:215], v[44:47], v[132:135]
    s_waitcnt lgkmcnt(6)
    ds_read_b128 v[240:243], v3 offset:13312
    v_mfma_f32_16x16x32_bf16 v[132:135], v[216:219], v[48:51], v[132:135]
    ds_read_b128 v[252:255], v3 offset:14336
    ds_read_b128 v[56:59], v1 offset:1024
    v_mfma_f32_16x16x32_bf16 v[148:151], v[204:207], v[100:103], v[148:151]
    ds_read_b64_tr_b16 v[204:205], v246 offset:0
    v_mfma_f32_16x16x32_bf16 v[148:151], v[208:211], v[104:107], v[148:151]
    ds_read_b64_tr_b16 v[206:207], v246 offset:2048
    ds_read_b128 v[60:63], v1 offset:2048
    v_mfma_f32_16x16x32_bf16 v[148:151], v[212:215], v[108:111], v[148:151]
    ds_read_b64_tr_b16 v[208:209], v246 offset:4096
    v_mfma_f32_16x16x32_bf16 v[148:151], v[216:219], v[112:115], v[148:151]
    s_waitcnt lgkmcnt(9)
    ds_read_b64_tr_b16 v[210:211], v246 offset:6144
    ds_read_b128 v[64:67], v1 offset:3072
    v_mfma_f32_16x16x32_bf16 v[164:167], v[216:219], v[220:223], v[164:167]
    ds_read_b64_tr_b16 v[212:213], v246 offset:8192
    v_add_u32 v244, 16384, v244
    v_mfma_f32_16x16x32_bf16 v[136:139], v[4:7], v[36:39], v[136:139]
    ds_read_b64_tr_b16 v[214:215], v246 offset:10240
    ds_read_b128 v[116:119], v1 offset:4096
    v_mfma_f32_16x16x32_bf16 v[136:139], v[8:11], v[40:43], v[136:139]
    ds_read_b64_tr_b16 v[216:217], v246 offset:12288
    v_mfma_f32_16x16x32_bf16 v[136:139], v[12:15], v[44:47], v[136:139]
    s_waitcnt lgkmcnt(8)
    ds_read_b64_tr_b16 v[218:219], v246 offset:14336
    ds_read_b128 v[120:123], v1 offset:5120
    v_mfma_f32_16x16x32_bf16 v[136:139], v[16:19], v[48:51], v[136:139]
    ds_read_b128 v[220:223], v3 offset:12288
    v_add_u32 v245, 16384, v245
    v_mfma_f32_16x16x32_bf16 v[152:155], v[4:7], v[100:103], v[152:155]
    ds_read_b64_tr_b16 v[4:5], v247 offset:0
    ds_read_b128 v[124:127], v1 offset:6144
    v_mfma_f32_16x16x32_bf16 v[152:155], v[8:11], v[104:107], v[152:155]
    ds_read_b64_tr_b16 v[6:7], v247 offset:2048
    v_mfma_f32_16x16x32_bf16 v[152:155], v[12:15], v[108:111], v[152:155]
    ds_read_b64_tr_b16 v[8:9], v247 offset:4096
    ds_read_b128 v[128:131], v1 offset:7168
    v_mfma_f32_16x16x32_bf16 v[152:155], v[16:19], v[112:115], v[152:155]
    ds_read_b64_tr_b16 v[10:11], v247 offset:6144
    v_mov_b32 v2, 1
    v_add_u32 v246, 16384, v246
    v_mfma_f32_16x16x32_bf16 v[140:143], v[204:207], v[36:39], v[140:143]
    s_waitcnt lgkmcnt(7)
    ds_read_b64_tr_b16 v[12:13], v247 offset:8192
    v_bfe_u32 v1, v0, 4, 2
    v_mfma_f32_16x16x32_bf16 v[140:143], v[208:211], v[40:43], v[140:143]
    ds_read_b64_tr_b16 v[14:15], v247 offset:10240
    v_lshlrev_b32 v1, 2, v1
    v_mfma_f32_16x16x32_bf16 v[140:143], v[212:215], v[44:47], v[140:143]
    ds_read_b64_tr_b16 v[16:17], v247 offset:12288
    v_add_u32 v1, 162816, v1
    v_mfma_f32_16x16x32_bf16 v[140:143], v[216:219], v[48:51], v[140:143]
    ds_read_b64_tr_b16 v[18:19], v247 offset:14336
    ds_read_b32 v248, v1
    v_mfma_f32_16x16x32_bf16 v[156:159], v[204:207], v[100:103], v[156:159]
    ds_read_b64_tr_b16 v[204:205], v244 offset:0
    v_mfma_f32_16x16x32_bf16 v[156:159], v[208:211], v[104:107], v[156:159]
    ds_read_b64_tr_b16 v[206:207], v244 offset:2048
    v_mfma_f32_16x16x32_bf16 v[156:159], v[212:215], v[108:111], v[156:159]
    ds_read_b64_tr_b16 v[208:209], v244 offset:4096
    v_mfma_f32_16x16x32_bf16 v[156:159], v[216:219], v[112:115], v[156:159]
    s_waitcnt lgkmcnt(7)
    ds_read_b64_tr_b16 v[210:211], v244 offset:6144
    v_add_u32 v247, 16384, v247
    v_mfma_f32_16x16x32_bf16 v[144:147], v[4:7], v[36:39], v[144:147]
    ds_read_b64_tr_b16 v[212:213], v244 offset:8192
    v_mfma_f32_16x16x32_bf16 v[144:147], v[8:11], v[40:43], v[144:147]
    s_waitcnt lgkmcnt(7)
    ds_read_b64_tr_b16 v[214:215], v244 offset:10240
    v_mfma_f32_16x16x32_bf16 v[144:147], v[12:15], v[44:47], v[144:147]
    s_waitcnt lgkmcnt(7)
    ds_read_b64_tr_b16 v[216:217], v244 offset:12288
    v_mfma_f32_16x16x32_bf16 v[144:147], v[16:19], v[48:51], v[144:147]
    ds_read_b64_tr_b16 v[218:219], v244 offset:14336
    v_mfma_f32_16x16x32_bf16 v[160:163], v[4:7], v[100:103], v[160:163]
    ds_read_b64_tr_b16 v[4:5], v245 offset:0
    v_mfma_f32_16x16x32_bf16 v[160:163], v[8:11], v[104:107], v[160:163]
    ds_read_b64_tr_b16 v[6:7], v245 offset:2048
    s_waitcnt lgkmcnt(7)
    v_cmp_ne_u32 vcc, 0, v248
    s_nop 0
    s_cmp_lg_u64 vcc, 0
    s_cbranch_scc1 L_restart
    v_mfma_f32_16x16x32_bf16 v[160:163], v[12:15], v[108:111], v[160:163]
    ds_read_b64_tr_b16 v[8:9], v245 offset:4096
    v_mfma_f32_16x16x32_bf16 v[160:163], v[16:19], v[112:115], v[160:163]
    ds_read_b64_tr_b16 v[10:11], v245 offset:6144
    s_waitcnt vmcnt(8)
    s_barrier
    v_mfma_f32_16x16x32_bf16 v[164:167], v[204:207], v[220:223], v[164:167]
    s_waitcnt lgkmcnt(5)
    ds_read_b128 v[220:223], v3 offset:15360
    v_mfma_f32_16x16x32_bf16 v[164:167], v[208:211], v[240:243], v[164:167]
    ds_read_b64_tr_b16 v[12:13], v245 offset:8192
    v_mfma_f32_16x16x32_bf16 v[164:167], v[212:215], v[252:255], v[164:167]
    ds_read_b64_tr_b16 v[14:15], v245 offset:10240
    v_mfma_f32_16x16x32_bf16 v[132:135], v[204:207], v[52:55], v[132:135]
    ds_read_b64_tr_b16 v[16:17], v245 offset:12288
    v_mfma_f32_16x16x32_bf16 v[132:135], v[208:211], v[56:59], v[132:135]
    ds_read_b64_tr_b16 v[18:19], v245 offset:14336
    v_mfma_f32_16x16x32_bf16 v[132:135], v[212:215], v[60:63], v[132:135]
    s_waitcnt lgkmcnt(7)
    ds_read_b128 v[240:243], v3 offset:1024
    v_mfma_f32_16x16x32_bf16 v[132:135], v[216:219], v[64:67], v[132:135]
    ds_read_b128 v[252:255], v3 offset:2048
    v_mfma_f32_16x16x32_bf16 v[148:151], v[204:207], v[116:119], v[148:151]
    ds_read_b64_tr_b16 v[204:205], v246 offset:0
    v_mfma_f32_16x16x32_bf16 v[148:151], v[208:211], v[120:123], v[148:151]
    ds_read_b64_tr_b16 v[206:207], v246 offset:2048
    v_mfma_f32_16x16x32_bf16 v[148:151], v[212:215], v[124:127], v[148:151]
    ds_read_b64_tr_b16 v[208:209], v246 offset:4096
    v_mfma_f32_16x16x32_bf16 v[148:151], v[216:219], v[128:131], v[148:151]
    s_waitcnt lgkmcnt(8)
    ds_read_b64_tr_b16 v[210:211], v246 offset:6144
    v_mfma_f32_16x16x32_bf16 v[164:167], v[216:219], v[220:223], v[164:167]
    ds_read_b64_tr_b16 v[212:213], v246 offset:8192
    v_add_u32 v244, 16384, v244
    v_mfma_f32_16x16x32_bf16 v[136:139], v[4:7], v[52:55], v[136:139]
    ds_read_b64_tr_b16 v[214:215], v246 offset:10240
    v_mfma_f32_16x16x32_bf16 v[136:139], v[8:11], v[56:59], v[136:139]
    s_waitcnt lgkmcnt(7)
    ds_read_b64_tr_b16 v[216:217], v246 offset:12288
    v_mfma_f32_16x16x32_bf16 v[136:139], v[12:15], v[60:63], v[136:139]
    ds_read_b64_tr_b16 v[218:219], v246 offset:14336
    v_mfma_f32_16x16x32_bf16 v[136:139], v[16:19], v[64:67], v[136:139]
    ds_read_b128 v[220:223], v3 offset:0
    v_add_u32 v245, 16384, v245
    v_mfma_f32_16x16x32_bf16 v[152:155], v[4:7], v[116:119], v[152:155]
    ds_read_b64_tr_b16 v[4:5], v247 offset:0
    v_mfma_f32_16x16x32_bf16 v[152:155], v[8:11], v[120:123], v[152:155]
    ds_read_b64_tr_b16 v[6:7], v247 offset:2048
    v_mfma_f32_16x16x32_bf16 v[152:155], v[12:15], v[124:127], v[152:155]
    ds_read_b64_tr_b16 v[8:9], v247 offset:4096
    v_mfma_f32_16x16x32_bf16 v[152:155], v[16:19], v[128:131], v[152:155]
    s_waitcnt lgkmcnt(7)
    ds_read_b64_tr_b16 v[10:11], v247 offset:6144
    v_add_u32 v246, 16384, v246
    v_mfma_f32_16x16x32_bf16 v[140:143], v[204:207], v[52:55], v[140:143]
    ds_read_b64_tr_b16 v[12:13], v247 offset:8192
    v_mfma_f32_16x16x32_bf16 v[140:143], v[208:211], v[56:59], v[140:143]
    s_waitcnt lgkmcnt(7)
    ds_read_b64_tr_b16 v[14:15], v247 offset:10240
    v_mfma_f32_16x16x32_bf16 v[140:143], v[212:215], v[60:63], v[140:143]
    s_waitcnt lgkmcnt(6)
    ds_read_b64_tr_b16 v[16:17], v247 offset:12288
    v_mfma_f32_16x16x32_bf16 v[140:143], v[216:219], v[64:67], v[140:143]
    ds_read_b64_tr_b16 v[18:19], v247 offset:14336
    v_mfma_f32_16x16x32_bf16 v[156:159], v[204:207], v[116:119], v[156:159]
    ds_read_b64_tr_b16 v[204:205], v244 offset:0
    s_bfe_u32 s62, s100, 262144
    v_mfma_f32_16x16x32_bf16 v[156:159], v[208:211], v[120:123], v[156:159]
    ds_read_b64_tr_b16 v[206:207], v244 offset:2048
    s_add_u32 s62, s62, s101
    v_mfma_f32_16x16x32_bf16 v[156:159], v[212:215], v[124:127], v[156:159]
    ds_read_b64_tr_b16 v[208:209], v244 offset:4096
    s_and_b32 s62, s62, 7
    v_mfma_f32_16x16x32_bf16 v[156:159], v[216:219], v[128:131], v[156:159]
    s_waitcnt lgkmcnt(5)
    ds_read_b64_tr_b16 v[210:211], v244 offset:6144
    v_add_u32 v247, 16384, v247
    v_mfma_f32_16x16x32_bf16 v[144:147], v[4:7], v[52:55], v[144:147]
    ds_read_b64_tr_b16 v[212:213], v244 offset:8192
    s_add_u32 s62, s62, s57
    v_mfma_f32_16x16x32_bf16 v[144:147], v[8:11], v[56:59], v[144:147]
    ds_read_b64_tr_b16 v[214:215], v244 offset:10240
    s_mul_i32 s60, s62, 129024
    v_mfma_f32_16x16x32_bf16 v[144:147], v[12:15], v[60:63], v[144:147]
    s_waitcnt lgkmcnt(5)
    ds_read_b64_tr_b16 v[216:217], v244 offset:12288
    v_mfma_f32_16x16x32_bf16 v[144:147], v[16:19], v[64:67], v[144:147]
    ds_read_b64_tr_b16 v[218:219], v244 offset:14336
    s_add_u32 s60, s60, 8388608
    v_mfma_f32_16x16x32_bf16 v[160:163], v[4:7], v[116:119], v[160:163]
    ds_read_b64_tr_b16 v[4:5], v245 offset:0
    s_lshl_b32 s62, s62, 7
    v_mfma_f32_16x16x32_bf16 v[160:163], v[8:11], v[120:123], v[160:163]
    ds_read_b64_tr_b16 v[6:7], v245 offset:2048
    v_mfma_f32_16x16x32_bf16 v[160:163], v[12:15], v[124:127], v[160:163]
    ds_read_b64_tr_b16 v[8:9], v245 offset:4096
    v_mfma_f32_16x16x32_bf16 v[160:163], v[16:19], v[128:131], v[160:163]
    ds_read_b64_tr_b16 v[10:11], v245 offset:6144
    s_waitcnt vmcnt(4)
    s_barrier
    s_waitcnt lgkmcnt(6)
    v_mfma_f32_16x16x32_bf16 v[200:203], v[204:207], v[220:223], 0
    ds_read_b128 v[220:223], v3 offset:3072
    v_mfma_f32_16x16x32_bf16 v[200:203], v[208:211], v[240:243], v[200:203]
    ds_read_b64_tr_b16 v[12:13], v245 offset:8192
    v_mfma_f32_16x16x32_bf16 v[200:203], v[212:215], v[252:255], v[200:203]
    ds_read_b64_tr_b16 v[14:15], v245 offset:10240
    v_mfma_f32_16x16x32_bf16 v[168:171], v[204:207], v[224:227], 0
    ds_read_b64_tr_b16 v[16:17], v245 offset:12288
    v_cvt_pk_bf16_f32 v132, v132, v133
    v_mfma_f32_16x16x32_bf16 v[168:171], v[208:211], v[228:231], v[168:171]
    ds_read_b64_tr_b16 v[18:19], v245 offset:14336
    v_cvt_pk_bf16_f32 v133, v134, v135
    v_mfma_f32_16x16x32_bf16 v[168:171], v[212:215], v[232:235], v[168:171]
    s_waitcnt lgkmcnt(5)
    ds_read_b128 v[240:243], v3 offset:5120
    v_cvt_pk_bf16_f32 v134, v136, v137
    v_mfma_f32_16x16x32_bf16 v[168:171], v[216:219], v[236:239], v[168:171]
    ds_read_b128 v[252:255], v3 offset:6144
    v_cvt_pk_bf16_f32 v135, v138, v139
    v_mfma_f32_16x16x32_bf16 v[184:187], v[204:207], v[68:71], 0
    ds_read_b64_tr_b16 v[204:205], v246 offset:0
    v_cvt_pk_bf16_f32 v148, v148, v149
    v_mfma_f32_16x16x32_bf16 v[184:187], v[208:211], v[72:75], v[184:187]
    ds_read_b64_tr_b16 v[206:207], v246 offset:2048
    v_cvt_pk_bf16_f32 v149, v150, v151
    v_mfma_f32_16x16x32_bf16 v[184:187], v[212:215], v[76:79], v[184:187]
    ds_read_b64_tr_b16 v[208:209], v246 offset:4096
    v_cvt_pk_bf16_f32 v150, v152, v153
    v_mfma_f32_16x16x32_bf16 v[184:187], v[216:219], v[80:83], v[184:187]
    s_waitcnt lgkmcnt(5)
    ds_read_b64_tr_b16 v[210:211], v246 offset:6144
    v_cvt_pk_bf16_f32 v151, v154, v155
    v_mfma_f32_16x16x32_bf16 v[200:203], v[216:219], v[220:223], v[200:203]
    ds_read_b64_tr_b16 v[212:213], v246 offset:8192
    v_add_u32 v244, 16384, v244
    v_mfma_f32_16x16x32_bf16 v[172:175], v[4:7], v[224:227], 0
    ds_read_b64_tr_b16 v[214:215], v246 offset:10240
    v_cvt_pk_bf16_f32 v140, v140, v141
    v_mfma_f32_16x16x32_bf16 v[172:175], v[8:11], v[228:231], v[172:175]
    ds_read_b64_tr_b16 v[216:217], v246 offset:12288
    v_cvt_pk_bf16_f32 v141, v142, v143
    v_mfma_f32_16x16x32_bf16 v[172:175], v[12:15], v[232:235], v[172:175]
    ds_read_b64_tr_b16 v[218:219], v246 offset:14336
    v_cvt_pk_bf16_f32 v142, v144, v145
    v_mfma_f32_16x16x32_bf16 v[172:175], v[16:19], v[236:239], v[172:175]
    ds_read_b128 v[220:223], v3 offset:4096
    v_add_u32 v245, 16384, v245
    v_mfma_f32_16x16x32_bf16 v[188:191], v[4:7], v[68:71], 0
    ds_read_b64_tr_b16 v[4:5], v247 offset:0
    v_cvt_pk_bf16_f32 v143, v146, v147
    v_mfma_f32_16x16x32_bf16 v[188:191], v[8:11], v[72:75], v[188:191]
    ds_read_b64_tr_b16 v[6:7], v247 offset:2048
    v_cvt_pk_bf16_f32 v156, v156, v157
    v_mfma_f32_16x16x32_bf16 v[188:191], v[12:15], v[76:79], v[188:191]
    ds_read_b64_tr_b16 v[8:9], v247 offset:4096
    v_cvt_pk_bf16_f32 v157, v158, v159
    v_mfma_f32_16x16x32_bf16 v[188:191], v[16:19], v[80:83], v[188:191]
    s_waitcnt lgkmcnt(5)
    ds_read_b64_tr_b16 v[10:11], v247 offset:6144
    v_add_u32 v246, 16384, v246
    v_mfma_f32_16x16x32_bf16 v[176:179], v[204:207], v[224:227], 0
    ds_read_b64_tr_b16 v[12:13], v247 offset:8192
    v_cvt_pk_bf16_f32 v158, v160, v161
    v_mfma_f32_16x16x32_bf16 v[176:179], v[208:211], v[228:231], v[176:179]
    ds_read_b64_tr_b16 v[14:15], v247 offset:10240
    v_cvt_pk_bf16_f32 v159, v162, v163
    v_mfma_f32_16x16x32_bf16 v[176:179], v[212:215], v[232:235], v[176:179]
    ds_read_b64_tr_b16 v[16:17], v247 offset:12288
    v_cvt_pk_bf16_f32 v164, v164, v165
    buffer_store_dwordx4 v[132:135], v249, s[28:31], s60 offen offset:0 sc1
    s_waitcnt lgkmcnt(5)
    v_mfma_f32_16x16x32_bf16 v[176:179], v[216:219], v[236:239], v[176:179]
    ds_read_b64_tr_b16 v[18:19], v247 offset:14336
    v_cvt_pk_bf16_f32 v165, v166, v167
    v_mfma_f32_16x16x32_bf16 v[192:195], v[204:207], v[68:71], 0
    ds_read_b64_tr_b16 v[204:205], v244 offset:0
    v_mfma_f32_16x16x32_bf16 v[192:195], v[208:211], v[72:75], v[192:195]
    ds_read_b64_tr_b16 v[206:207], v244 offset:2048
    buffer_store_dwordx4 v[148:151], v249, s[28:31], s60 offen offset:2048 sc1
    v_mfma_f32_16x16x32_bf16 v[192:195], v[212:215], v[76:79], v[192:195]
    ds_read_b64_tr_b16 v[208:209], v244 offset:4096
    v_mfma_f32_16x16x32_bf16 v[192:195], v[216:219], v[80:83], v[192:195]
    ds_read_b64_tr_b16 v[210:211], v244 offset:6144
    v_add_u32 v247, 16384, v247
    v_mfma_f32_16x16x32_bf16 v[180:183], v[4:7], v[224:227], 0
    ds_read_b64_tr_b16 v[212:213], v244 offset:8192
    buffer_store_dwordx4 v[140:143], v249, s[28:31], s60 offen offset:1024 sc1
    s_waitcnt lgkmcnt(6)
    v_mfma_f32_16x16x32_bf16 v[180:183], v[8:11], v[228:231], v[180:183]
    ds_read_b64_tr_b16 v[214:215], v244 offset:10240
    v_mfma_f32_16x16x32_bf16 v[180:183], v[12:15], v[232:235], v[180:183]
    s_waitcnt lgkmcnt(6)
    ds_read_b64_tr_b16 v[216:217], v244 offset:12288
    v_mfma_f32_16x16x32_bf16 v[180:183], v[16:19], v[236:239], v[180:183]
    ds_read_b64_tr_b16 v[218:219], v244 offset:14336
    buffer_store_dwordx4 v[156:159], v249, s[28:31], s60 offen offset:3072 sc1
    v_mfma_f32_16x16x32_bf16 v[196:199], v[4:7], v[68:71], 0
    ds_read_b64_tr_b16 v[4:5], v245 offset:0
    v_mfma_f32_16x16x32_bf16 v[196:199], v[8:11], v[72:75], v[196:199]
    ds_read_b64_tr_b16 v[6:7], v245 offset:2048
    v_mfma_f32_16x16x32_bf16 v[196:199], v[12:15], v[76:79], v[196:199]
    ds_read_b64_tr_b16 v[8:9], v245 offset:4096
    buffer_store_dwordx2 v[164:165], v250, s[28:31], s60 offen sc1
    v_mfma_f32_16x16x32_bf16 v[196:199], v[16:19], v[80:83], v[196:199]
    ds_read_b64_tr_b16 v[10:11], v245 offset:6144
    s_waitcnt vmcnt(5)
    s_barrier
    s_waitcnt lgkmcnt(7)
    v_mfma_f32_16x16x32_bf16 v[200:203], v[204:207], v[220:223], v[200:203]
    ds_read_b128 v[220:223], v3 offset:7168
    v_mfma_f32_16x16x32_bf16 v[200:203], v[208:211], v[240:243], v[200:203]
    s_waitcnt lgkmcnt(6)
    ds_read_b64_tr_b16 v[12:13], v245 offset:8192
    v_mfma_f32_16x16x32_bf16 v[200:203], v[212:215], v[252:255], v[200:203]
    ds_read_b64_tr_b16 v[14:15], v245 offset:10240
    v_mfma_f32_16x16x32_bf16 v[168:171], v[204:207], v[20:23], v[168:171]
    ds_read_b64_tr_b16 v[16:17], v245 offset:12288
    v_mfma_f32_16x16x32_bf16 v[168:171], v[208:211], v[24:27], v[168:171]
    ds_read_b64_tr_b16 v[18:19], v245 offset:14336
    v_mfma_f32_16x16x32_bf16 v[168:171], v[212:215], v[28:31], v[168:171]
    s_waitcnt lgkmcnt(6)
    ds_read_b128 v[240:243], v3 offset:9216
    v_mfma_f32_16x16x32_bf16 v[168:171], v[216:219], v[32:35], v[168:171]
    ds_read_b128 v[252:255], v3 offset:10240
    v_mfma_f32_16x16x32_bf16 v[184:187], v[204:207], v[84:87], v[184:187]
    ds_read_b64_tr_b16 v[204:205], v246 offset:0
    v_mfma_f32_16x16x32_bf16 v[184:187], v[208:211], v[88:91], v[184:187]
    ds_read_b64_tr_b16 v[206:207], v246 offset:2048
    v_mfma_f32_16x16x32_bf16 v[184:187], v[212:215], v[92:95], v[184:187]
    ds_read_b64_tr_b16 v[208:209], v246 offset:4096
    v_mfma_f32_16x16x32_bf16 v[184:187], v[216:219], v[96:99], v[184:187]
    s_waitcnt lgkmcnt(8)
    ds_read_b64_tr_b16 v[210:211], v246 offset:6144
    v_mfma_f32_16x16x32_bf16 v[200:203], v[216:219], v[220:223], v[200:203]
    ds_read_b64_tr_b16 v[212:213], v246 offset:8192
    v_add_u32 v244, 16384, v244
    v_mfma_f32_16x16x32_bf16 v[172:175], v[4:7], v[20:23], v[172:175]
    ds_read_b64_tr_b16 v[214:215], v246 offset:10240
    v_mfma_f32_16x16x32_bf16 v[172:175], v[8:11], v[24:27], v[172:175]
    s_waitcnt lgkmcnt(7)
    ds_read_b64_tr_b16 v[216:217], v246 offset:12288
    v_mfma_f32_16x16x32_bf16 v[172:175], v[12:15], v[28:31], v[172:175]
    ds_read_b64_tr_b16 v[218:219], v246 offset:14336
    v_mfma_f32_16x16x32_bf16 v[172:175], v[16:19], v[32:35], v[172:175]
    ds_read_b128 v[220:223], v3 offset:8192
    v_add_u32 v245, 16384, v245
    v_mfma_f32_16x16x32_bf16 v[188:191], v[4:7], v[84:87], v[188:191]
    ds_read_b64_tr_b16 v[4:5], v247 offset:0
    v_mfma_f32_16x16x32_bf16 v[188:191], v[8:11], v[88:91], v[188:191]
    ds_read_b64_tr_b16 v[6:7], v247 offset:2048
    v_mfma_f32_16x16x32_bf16 v[188:191], v[12:15], v[92:95], v[188:191]
    ds_read_b64_tr_b16 v[8:9], v247 offset:4096
    v_mfma_f32_16x16x32_bf16 v[188:191], v[16:19], v[96:99], v[188:191]
    s_waitcnt lgkmcnt(7)
    ds_read_b64_tr_b16 v[10:11], v247 offset:6144
    v_add_u32 v246, 16384, v246
    v_mfma_f32_16x16x32_bf16 v[176:179], v[204:207], v[20:23], v[176:179]
    ds_read_b64_tr_b16 v[12:13], v247 offset:8192
    v_mfma_f32_16x16x32_bf16 v[176:179], v[208:211], v[24:27], v[176:179]
    s_waitcnt lgkmcnt(7)
    ds_read_b64_tr_b16 v[14:15], v247 offset:10240
    v_mfma_f32_16x16x32_bf16 v[176:179], v[212:215], v[28:31], v[176:179]
    s_waitcnt lgkmcnt(6)
    ds_read_b64_tr_b16 v[16:17], v247 offset:12288
    v_mfma_f32_16x16x32_bf16 v[176:179], v[216:219], v[32:35], v[176:179]
    ds_read_b64_tr_b16 v[18:19], v247 offset:14336
    v_mfma_f32_16x16x32_bf16 v[192:195], v[204:207], v[84:87], v[192:195]
    ds_read_b64_tr_b16 v[204:205], v244 offset:0
    v_mfma_f32_16x16x32_bf16 v[192:195], v[208:211], v[88:91], v[192:195]
    ds_read_b64_tr_b16 v[206:207], v244 offset:2048
    v_mfma_f32_16x16x32_bf16 v[192:195], v[212:215], v[92:95], v[192:195]
    ds_read_b64_tr_b16 v[208:209], v244 offset:4096
    v_mfma_f32_16x16x32_bf16 v[192:195], v[216:219], v[96:99], v[192:195]
    s_waitcnt lgkmcnt(7)
    ds_read_b64_tr_b16 v[210:211], v244 offset:6144
    v_add_u32 v247, 16384, v247
    v_mfma_f32_16x16x32_bf16 v[180:183], v[4:7], v[20:23], v[180:183]
    ds_read_b64_tr_b16 v[212:213], v244 offset:8192
    v_mfma_f32_16x16x32_bf16 v[180:183], v[8:11], v[24:27], v[180:183]
    s_waitcnt lgkmcnt(7)
    ds_read_b64_tr_b16 v[214:215], v244 offset:10240
    v_mfma_f32_16x16x32_bf16 v[180:183], v[12:15], v[28:31], v[180:183]
    s_waitcnt lgkmcnt(6)
    ds_read_b64_tr_b16 v[216:217], v244 offset:12288
    v_mfma_f32_16x16x32_bf16 v[180:183], v[16:19], v[32:35], v[180:183]
    ds_read_b64_tr_b16 v[218:219], v244 offset:14336
    v_mfma_f32_16x16x32_bf16 v[196:199], v[4:7], v[84:87], v[196:199]
    ds_read_b64_tr_b16 v[4:5], v245 offset:0
    v_mfma_f32_16x16x32_bf16 v[196:199], v[8:11], v[88:91], v[196:199]
    ds_read_b64_tr_b16 v[6:7], v245 offset:2048
    v_mfma_f32_16x16x32_bf16 v[196:199], v[12:15], v[92:95], v[196:199]
    ds_read_b64_tr_b16 v[8:9], v245 offset:4096
    v_mfma_f32_16x16x32_bf16 v[196:199], v[16:19], v[96:99], v[196:199]
    ds_read_b64_tr_b16 v[10:11], v245 offset:6144
    s_barrier
    s_waitcnt lgkmcnt(8)
    v_mfma_f32_16x16x32_bf16 v[200:203], v[204:207], v[220:223], v[200:203]
    ds_read_b128 v[220:223], v3 offset:11264
    v_mfma_f32_16x16x32_bf16 v[200:203], v[208:211], v[240:243], v[200:203]
    s_waitcnt lgkmcnt(7)
    ds_read_b64_tr_b16 v[12:13], v245 offset:8192
    v_mfma_f32_16x16x32_bf16 v[200:203], v[212:215], v[252:255], v[200:203]
    ds_read_b64_tr_b16 v[14:15], v245 offset:10240
    v_mfma_f32_16x16x32_bf16 v[168:171], v[204:207], v[36:39], v[168:171]
    ds_read_b64_tr_b16 v[16:17], v245 offset:12288
    v_mfma_f32_16x16x32_bf16 v[168:171], v[208:211], v[40:43], v[168:171]
    ds_read_b64_tr_b16 v[18:19], v245 offset:14336
    v_mfma_f32_16x16x32_bf16 v[168:171], v[212:215], v[44:47], v[168:171]
    s_waitcnt lgkmcnt(7)
    ds_read_b128 v[240:243], v3 offset:13312
    v_mfma_f32_16x16x32_bf16 v[168:171], v[216:219], v[48:51], v[168:171]
    ds_read_b128 v[252:255], v3 offset:14336
    v_mfma_f32_16x16x32_bf16 v[184:187], v[204:207], v[100:103], v[184:187]
    ds_read_b64_tr_b16 v[204:205], v246 offset:0
    v_mfma_f32_16x16x32_bf16 v[184:187], v[208:211], v[104:107], v[184:187]
    ds_read_b64_tr_b16 v[206:207], v246 offset:2048
    v_mfma_f32_16x16x32_bf16 v[184:187], v[212:215], v[108:111], v[184:187]
    ds_read_b64_tr_b16 v[208:209], v246 offset:4096
    v_mfma_f32_16x16x32_bf16 v[184:187], v[216:219], v[112:115], v[184:187]
    s_waitcnt lgkmcnt(8)
    ds_read_b64_tr_b16 v[210:211], v246 offset:6144
    v_mfma_f32_16x16x32_bf16 v[200:203], v[216:219], v[220:223], v[200:203]
    ds_read_b64_tr_b16 v[212:213], v246 offset:8192
    v_add_u32 v244, 16384, v244
    v_mfma_f32_16x16x32_bf16 v[172:175], v[4:7], v[36:39], v[172:175]
    ds_read_b64_tr_b16 v[214:215], v246 offset:10240
    v_mfma_f32_16x16x32_bf16 v[172:175], v[8:11], v[40:43], v[172:175]
    s_waitcnt lgkmcnt(7)
    ds_read_b64_tr_b16 v[216:217], v246 offset:12288
    v_mfma_f32_16x16x32_bf16 v[172:175], v[12:15], v[44:47], v[172:175]
    ds_read_b64_tr_b16 v[218:219], v246 offset:14336
    v_mfma_f32_16x16x32_bf16 v[172:175], v[16:19], v[48:51], v[172:175]
    ds_read_b128 v[220:223], v3 offset:12288
    v_add_u32 v245, 16384, v245
    v_mfma_f32_16x16x32_bf16 v[188:191], v[4:7], v[100:103], v[188:191]
    ds_read_b64_tr_b16 v[4:5], v247 offset:0
    v_mfma_f32_16x16x32_bf16 v[188:191], v[8:11], v[104:107], v[188:191]
    ds_read_b64_tr_b16 v[6:7], v247 offset:2048
    v_mfma_f32_16x16x32_bf16 v[188:191], v[12:15], v[108:111], v[188:191]
    ds_read_b64_tr_b16 v[8:9], v247 offset:4096
    s_waitcnt vmcnt(0)
    buffer_store_dword v2, v251, s[28:31], s62 offen offset:0 sc1
    v_mfma_f32_16x16x32_bf16 v[188:191], v[16:19], v[112:115], v[188:191]
    s_waitcnt lgkmcnt(6)
    ds_read_b64_tr_b16 v[10:11], v247 offset:6144
    v_add_u32 v246, 16384, v246
    v_mfma_f32_16x16x32_bf16 v[176:179], v[204:207], v[36:39], v[176:179]
    ds_read_b64_tr_b16 v[12:13], v247 offset:8192
    v_mfma_f32_16x16x32_bf16 v[176:179], v[208:211], v[40:43], v[176:179]
    ds_read_b64_tr_b16 v[14:15], v247 offset:10240
    v_mfma_f32_16x16x32_bf16 v[176:179], v[212:215], v[44:47], v[176:179]
    s_waitcnt lgkmcnt(6)
    ds_read_b64_tr_b16 v[16:17], v247 offset:12288
    v_mfma_f32_16x16x32_bf16 v[176:179], v[216:219], v[48:51], v[176:179]
    ds_read_b64_tr_b16 v[18:19], v247 offset:14336
    v_mfma_f32_16x16x32_bf16 v[192:195], v[204:207], v[100:103], v[192:195]
    ds_read_b64_tr_b16 v[204:205], v244 offset:0
    v_mfma_f32_16x16x32_bf16 v[192:195], v[208:211], v[104:107], v[192:195]
    ds_read_b64_tr_b16 v[206:207], v244 offset:2048
    v_mfma_f32_16x16x32_bf16 v[192:195], v[212:215], v[108:111], v[192:195]
    ds_read_b64_tr_b16 v[208:209], v244 offset:4096
    v_mfma_f32_16x16x32_bf16 v[192:195], v[216:219], v[112:115], v[192:195]
    s_waitcnt lgkmcnt(7)
    ds_read_b64_tr_b16 v[210:211], v244 offset:6144
    v_add_u32 v247, 16384, v247
    v_mfma_f32_16x16x32_bf16 v[180:183], v[4:7], v[36:39], v[180:183]
    ds_read_b64_tr_b16 v[212:213], v244 offset:8192
    v_mfma_f32_16x16x32_bf16 v[180:183], v[8:11], v[40:43], v[180:183]
    s_waitcnt lgkmcnt(7)
    ds_read_b64_tr_b16 v[214:215], v244 offset:10240
    v_mfma_f32_16x16x32_bf16 v[180:183], v[12:15], v[44:47], v[180:183]
    s_waitcnt lgkmcnt(6)
    ds_read_b64_tr_b16 v[216:217], v244 offset:12288
    v_mfma_f32_16x16x32_bf16 v[180:183], v[16:19], v[48:51], v[180:183]
    ds_read_b64_tr_b16 v[218:219], v244 offset:14336
    v_mfma_f32_16x16x32_bf16 v[196:199], v[4:7], v[100:103], v[196:199]
    ds_read_b64_tr_b16 v[4:5], v245 offset:0
    v_mfma_f32_16x16x32_bf16 v[196:199], v[8:11], v[104:107], v[196:199]
    ds_read_b64_tr_b16 v[6:7], v245 offset:2048
    v_mfma_f32_16x16x32_bf16 v[196:199], v[12:15], v[108:111], v[196:199]
    ds_read_b64_tr_b16 v[8:9], v245 offset:4096
    v_mfma_f32_16x16x32_bf16 v[196:199], v[16:19], v[112:115], v[196:199]
    ds_read_b64_tr_b16 v[10:11], v245 offset:6144
    s_barrier
    s_waitcnt lgkmcnt(8)
    v_mfma_f32_16x16x32_bf16 v[200:203], v[204:207], v[220:223], v[200:203]
    ds_read_b128 v[220:223], v3 offset:15360
    v_mfma_f32_16x16x32_bf16 v[200:203], v[208:211], v[240:243], v[200:203]
    s_waitcnt lgkmcnt(7)
    ds_read_b64_tr_b16 v[12:13], v245 offset:8192
    v_mfma_f32_16x16x32_bf16 v[200:203], v[212:215], v[252:255], v[200:203]
    ds_read_b64_tr_b16 v[14:15], v245 offset:10240
    v_mfma_f32_16x16x32_bf16 v[168:171], v[204:207], v[52:55], v[168:171]
    ds_read_b64_tr_b16 v[16:17], v245 offset:12288
    v_mfma_f32_16x16x32_bf16 v[168:171], v[208:211], v[56:59], v[168:171]
    ds_read_b64_tr_b16 v[18:19], v245 offset:14336
    v_mfma_f32_16x16x32_bf16 v[168:171], v[212:215], v[60:63], v[168:171]
    s_waitcnt lgkmcnt(7)
    ds_read_b128 v[240:243], v3 offset:1024
    v_mfma_f32_16x16x32_bf16 v[168:171], v[216:219], v[64:67], v[168:171]
    ds_read_b128 v[252:255], v3 offset:2048
    v_mfma_f32_16x16x32_bf16 v[184:187], v[204:207], v[116:119], v[184:187]
    ds_read_b64_tr_b16 v[204:205], v246 offset:0
    v_mfma_f32_16x16x32_bf16 v[184:187], v[208:211], v[120:123], v[184:187]
    ds_read_b64_tr_b16 v[206:207], v246 offset:2048
    v_mfma_f32_16x16x32_bf16 v[184:187], v[212:215], v[124:127], v[184:187]
    ds_read_b64_tr_b16 v[208:209], v246 offset:4096
    v_mfma_f32_16x16x32_bf16 v[184:187], v[216:219], v[128:131], v[184:187]
    s_waitcnt lgkmcnt(8)
    ds_read_b64_tr_b16 v[210:211], v246 offset:6144
    v_mfma_f32_16x16x32_bf16 v[200:203], v[216:219], v[220:223], v[200:203]
    ds_read_b64_tr_b16 v[212:213], v246 offset:8192
    v_add_u32 v244, 4294885376, v244
    v_mfma_f32_16x16x32_bf16 v[172:175], v[4:7], v[52:55], v[172:175]
    ds_read_b64_tr_b16 v[214:215], v246 offset:10240
    v_mfma_f32_16x16x32_bf16 v[172:175], v[8:11], v[56:59], v[172:175]
    s_waitcnt lgkmcnt(7)
    ds_read_b64_tr_b16 v[216:217], v246 offset:12288
    v_mfma_f32_16x16x32_bf16 v[172:175], v[12:15], v[60:63], v[172:175]
    ds_read_b64_tr_b16 v[218:219], v246 offset:14336
    v_mfma_f32_16x16x32_bf16 v[172:175], v[16:19], v[64:67], v[172:175]
    ds_read_b128 v[220:223], v3 offset:0
    v_add_u32 v245, 4294885376, v245
    v_mfma_f32_16x16x32_bf16 v[188:191], v[4:7], v[116:119], v[188:191]
    ds_read_b64_tr_b16 v[4:5], v247 offset:0
    v_mfma_f32_16x16x32_bf16 v[188:191], v[8:11], v[120:123], v[188:191]
    ds_read_b64_tr_b16 v[6:7], v247 offset:2048
    v_mfma_f32_16x16x32_bf16 v[188:191], v[12:15], v[124:127], v[188:191]
    ds_read_b64_tr_b16 v[8:9], v247 offset:4096
    v_mfma_f32_16x16x32_bf16 v[188:191], v[16:19], v[128:131], v[188:191]
    s_waitcnt lgkmcnt(7)
    ds_read_b64_tr_b16 v[10:11], v247 offset:6144
    v_add_u32 v246, 4294885376, v246
    v_mfma_f32_16x16x32_bf16 v[176:179], v[204:207], v[52:55], v[176:179]
    ds_read_b64_tr_b16 v[12:13], v247 offset:8192
    v_mfma_f32_16x16x32_bf16 v[176:179], v[208:211], v[56:59], v[176:179]
    s_waitcnt lgkmcnt(7)
    ds_read_b64_tr_b16 v[14:15], v247 offset:10240
    v_mfma_f32_16x16x32_bf16 v[176:179], v[212:215], v[60:63], v[176:179]
    s_waitcnt lgkmcnt(6)
    ds_read_b64_tr_b16 v[16:17], v247 offset:12288
    v_mfma_f32_16x16x32_bf16 v[176:179], v[216:219], v[64:67], v[176:179]
    ds_read_b64_tr_b16 v[18:19], v247 offset:14336
    v_mfma_f32_16x16x32_bf16 v[192:195], v[204:207], v[116:119], v[192:195]
    ds_read_b64_tr_b16 v[204:205], v244 offset:0
    s_bfe_u32 s56, s100, 262148
    v_mfma_f32_16x16x32_bf16 v[192:195], v[208:211], v[120:123], v[192:195]
    ds_read_b64_tr_b16 v[206:207], v244 offset:2048
    s_add_u32 s56, s56, s101
    v_mfma_f32_16x16x32_bf16 v[192:195], v[212:215], v[124:127], v[192:195]
    ds_read_b64_tr_b16 v[208:209], v244 offset:4096
    s_and_b32 s56, s56, 7
    v_mfma_f32_16x16x32_bf16 v[192:195], v[216:219], v[128:131], v[192:195]
    s_waitcnt lgkmcnt(5)
    ds_read_b64_tr_b16 v[210:211], v244 offset:6144
    v_add_u32 v247, 4294885376, v247
    v_mfma_f32_16x16x32_bf16 v[180:183], v[4:7], v[52:55], v[180:183]
    ds_read_b64_tr_b16 v[212:213], v244 offset:8192
    s_add_u32 s56, s56, s57
    v_mfma_f32_16x16x32_bf16 v[180:183], v[8:11], v[56:59], v[180:183]
    ds_read_b64_tr_b16 v[214:215], v244 offset:10240
    s_mul_i32 s61, s56, 129024
    v_mfma_f32_16x16x32_bf16 v[180:183], v[12:15], v[60:63], v[180:183]
    s_waitcnt lgkmcnt(5)
    ds_read_b64_tr_b16 v[216:217], v244 offset:12288
    v_mfma_f32_16x16x32_bf16 v[180:183], v[16:19], v[64:67], v[180:183]
    ds_read_b64_tr_b16 v[218:219], v244 offset:14336
    s_add_u32 s61, s61, 8407040
    v_mfma_f32_16x16x32_bf16 v[196:199], v[4:7], v[116:119], v[196:199]
    ds_read_b64_tr_b16 v[4:5], v245 offset:0
    s_lshl_b32 s56, s56, 7
    v_mfma_f32_16x16x32_bf16 v[196:199], v[8:11], v[120:123], v[196:199]
    ds_read_b64_tr_b16 v[6:7], v245 offset:2048
    v_mfma_f32_16x16x32_bf16 v[196:199], v[12:15], v[124:127], v[196:199]
    ds_read_b64_tr_b16 v[8:9], v245 offset:4096
    v_mfma_f32_16x16x32_bf16 v[196:199], v[16:19], v[128:131], v[196:199]
    ds_read_b64_tr_b16 v[10:11], v245 offset:6144
    s_barrier
    s_waitcnt lgkmcnt(7)
    v_mfma_f32_16x16x32_bf16 v[164:167], v[204:207], v[220:223], 0
    ds_read_b128 v[220:223], v3 offset:3072
    v_mfma_f32_16x16x32_bf16 v[164:167], v[208:211], v[240:243], v[164:167]
    s_waitcnt lgkmcnt(6)
    ds_read_b64_tr_b16 v[12:13], v245 offset:8192
    v_mfma_f32_16x16x32_bf16 v[164:167], v[212:215], v[252:255], v[164:167]
    ds_read_b64_tr_b16 v[14:15], v245 offset:10240
    v_mfma_f32_16x16x32_bf16 v[132:135], v[204:207], v[224:227], 0
    ds_read_b64_tr_b16 v[16:17], v245 offset:12288
    v_cvt_pk_bf16_f32 v168, v168, v169
    v_mfma_f32_16x16x32_bf16 v[132:135], v[208:211], v[228:231], v[132:135]
    ds_read_b64_tr_b16 v[18:19], v245 offset:14336
    v_cvt_pk_bf16_f32 v169, v170, v171
    v_mfma_f32_16x16x32_bf16 v[132:135], v[212:215], v[232:235], v[132:135]
    s_waitcnt lgkmcnt(5)
    ds_read_b128 v[240:243], v3 offset:5120
    v_cvt_pk_bf16_f32 v170, v172, v173
    v_mfma_f32_16x16x32_bf16 v[132:135], v[216:219], v[236:239], v[132:135]
    ds_read_b128 v[252:255], v3 offset:6144
    v_cvt_pk_bf16_f32 v171, v174, v175
    v_mfma_f32_16x16x32_bf16 v[148:151], v[204:207], v[68:71], 0
    ds_read_b64_tr_b16 v[204:205], v246 offset:0
    v_cvt_pk_bf16_f32 v184, v184, v185
    v_mfma_f32_16x16x32_bf16 v[148:151], v[208:211], v[72:75], v[148:151]
    ds_read_b64_tr_b16 v[206:207], v246 offset:2048
    v_cvt_pk_bf16_f32 v185, v186, v187
    v_mfma_f32_16x16x32_bf16 v[148:151], v[212:215], v[76:79], v[148:151]
    ds_read_b64_tr_b16 v[208:209], v246 offset:4096
    v_cvt_pk_bf16_f32 v186, v188, v189
    v_mfma_f32_16x16x32_bf16 v[148:151], v[216:219], v[80:83], v[148:151]
    s_waitcnt lgkmcnt(5)
    ds_read_b64_tr_b16 v[210:211], v246 offset:6144
    v_cvt_pk_bf16_f32 v187, v190, v191
    v_mfma_f32_16x16x32_bf16 v[164:167], v[216:219], v[220:223], v[164:167]
    ds_read_b64_tr_b16 v[212:213], v246 offset:8192
    v_add_u32 v244, 16384, v244
    v_mfma_f32_16x16x32_bf16 v[136:139], v[4:7], v[224:227], 0
    ds_read_b64_tr_b16 v[214:215], v246 offset:10240
    v_cvt_pk_bf16_f32 v176, v176, v177
    v_mfma_f32_16x16x32_bf16 v[136:139], v[8:11], v[228:231], v[136:139]
    ds_read_b64_tr_b16 v[216:217], v246 offset:12288
    v_cvt_pk_bf16_f32 v177, v178, v179
    v_mfma_f32_16x16x32_bf16 v[136:139], v[12:15], v[232:235], v[136:139]
    ds_read_b64_tr_b16 v[218:219], v246 offset:14336
    v_cvt_pk_bf16_f32 v178, v180, v181
    v_mfma_f32_16x16x32_bf16 v[136:139], v[16:19], v[236:239], v[136:139]
    ds_read_b128 v[220:223], v3 offset:4096
    v_add_u32 v245, 16384, v245
    v_mfma_f32_16x16x32_bf16 v[152:155], v[4:7], v[68:71], 0
    ds_read_b64_tr_b16 v[4:5], v247 offset:0
    v_cvt_pk_bf16_f32 v179, v182, v183
    v_mfma_f32_16x16x32_bf16 v[152:155], v[8:11], v[72:75], v[152:155]
    ds_read_b64_tr_b16 v[6:7], v247 offset:2048
    v_cvt_pk_bf16_f32 v192, v192, v193
    v_mfma_f32_16x16x32_bf16 v[152:155], v[12:15], v[76:79], v[152:155]
    ds_read_b64_tr_b16 v[8:9], v247 offset:4096
    v_cvt_pk_bf16_f32 v193, v194, v195
    v_mfma_f32_16x16x32_bf16 v[152:155], v[16:19], v[80:83], v[152:155]
    s_waitcnt lgkmcnt(5)
    ds_read_b64_tr_b16 v[10:11], v247 offset:6144
    v_add_u32 v246, 16384, v246
    v_mfma_f32_16x16x32_bf16 v[140:143], v[204:207], v[224:227], 0
    ds_read_b64_tr_b16 v[12:13], v247 offset:8192
    v_cvt_pk_bf16_f32 v194, v196, v197
    v_mfma_f32_16x16x32_bf16 v[140:143], v[208:211], v[228:231], v[140:143]
    ds_read_b64_tr_b16 v[14:15], v247 offset:10240
    v_cvt_pk_bf16_f32 v195, v198, v199
    v_mfma_f32_16x16x32_bf16 v[140:143], v[212:215], v[232:235], v[140:143]
    ds_read_b64_tr_b16 v[16:17], v247 offset:12288
    v_cvt_pk_bf16_f32 v200, v200, v201
    buffer_store_dwordx4 v[168:171], v249, s[28:31], s61 offen offset:0 sc1
    s_waitcnt lgkmcnt(5)
    v_mfma_f32_16x16x32_bf16 v[140:143], v[216:219], v[236:239], v[140:143]
    ds_read_b64_tr_b16 v[18:19], v247 offset:14336
    v_cvt_pk_bf16_f32 v201, v202, v203
    v_mfma_f32_16x16x32_bf16 v[156:159], v[204:207], v[68:71], 0
    ds_read_b64_tr_b16 v[204:205], v244 offset:0
    v_mfma_f32_16x16x32_bf16 v[156:159], v[208:211], v[72:75], v[156:159]
    ds_read_b64_tr_b16 v[206:207], v244 offset:2048
    buffer_store_dwordx4 v[184:187], v249, s[28:31], s61 offen offset:2048 sc1
    v_mfma_f32_16x16x32_bf16 v[156:159], v[212:215], v[76:79], v[156:159]
    ds_read_b64_tr_b16 v[208:209], v244 offset:4096
    v_mfma_f32_16x16x32_bf16 v[156:159], v[216:219], v[80:83], v[156:159]
    ds_read_b64_tr_b16 v[210:211], v244 offset:6144
    v_add_u32 v247, 16384, v247
    v_mfma_f32_16x16x32_bf16 v[144:147], v[4:7], v[224:227], 0
    ds_read_b64_tr_b16 v[212:213], v244 offset:8192
    buffer_store_dwordx4 v[176:179], v249, s[28:31], s61 offen offset:1024 sc1
    s_waitcnt lgkmcnt(6)
    v_mfma_f32_16x16x32_bf16 v[144:147], v[8:11], v[228:231], v[144:147]
    ds_read_b64_tr_b16 v[214:215], v244 offset:10240
    v_mfma_f32_16x16x32_bf16 v[144:147], v[12:15], v[232:235], v[144:147]
    s_waitcnt lgkmcnt(6)
    ds_read_b64_tr_b16 v[216:217], v244 offset:12288
    v_mfma_f32_16x16x32_bf16 v[144:147], v[16:19], v[236:239], v[144:147]
    ds_read_b64_tr_b16 v[218:219], v244 offset:14336
    buffer_store_dwordx4 v[192:195], v249, s[28:31], s61 offen offset:3072 sc1
    v_mfma_f32_16x16x32_bf16 v[160:163], v[4:7], v[68:71], 0
    ds_read_b64_tr_b16 v[4:5], v245 offset:0
    v_mfma_f32_16x16x32_bf16 v[160:163], v[8:11], v[72:75], v[160:163]
    ds_read_b64_tr_b16 v[6:7], v245 offset:2048
    v_mfma_f32_16x16x32_bf16 v[160:163], v[12:15], v[76:79], v[160:163]
    ds_read_b64_tr_b16 v[8:9], v245 offset:4096
    buffer_store_dwordx2 v[200:201], v250, s[28:31], s61 offen sc1
    v_mfma_f32_16x16x32_bf16 v[160:163], v[16:19], v[80:83], v[160:163]
    ds_read_b64_tr_b16 v[10:11], v245 offset:6144
    s_barrier
    s_waitcnt lgkmcnt(7)
    v_mfma_f32_16x16x32_bf16 v[164:167], v[204:207], v[220:223], v[164:167]
    ds_read_b128 v[220:223], v3 offset:7168
    v_mfma_f32_16x16x32_bf16 v[164:167], v[208:211], v[240:243], v[164:167]
    s_waitcnt lgkmcnt(6)
    ds_read_b64_tr_b16 v[12:13], v245 offset:8192
    v_mfma_f32_16x16x32_bf16 v[164:167], v[212:215], v[252:255], v[164:167]
    ds_read_b64_tr_b16 v[14:15], v245 offset:10240
    v_mfma_f32_16x16x32_bf16 v[132:135], v[204:207], v[20:23], v[132:135]
    ds_read_b64_tr_b16 v[16:17], v245 offset:12288
    v_mfma_f32_16x16x32_bf16 v[132:135], v[208:211], v[24:27], v[132:135]
    ds_read_b64_tr_b16 v[18:19], v245 offset:14336
    v_mfma_f32_16x16x32_bf16 v[132:135], v[212:215], v[28:31], v[132:135]
    s_waitcnt lgkmcnt(6)
    ds_read_b128 v[240:243], v3 offset:9216
    v_mfma_f32_16x16x32_bf16 v[132:135], v[216:219], v[32:35], v[132:135]
    ds_read_b128 v[252:255], v3 offset:10240
    v_mfma_f32_16x16x32_bf16 v[148:151], v[204:207], v[84:87], v[148:151]
    ds_read_b64_tr_b16 v[204:205], v246 offset:0
    v_mfma_f32_16x16x32_bf16 v[148:151], v[208:211], v[88:91], v[148:151]
    ds_read_b64_tr_b16 v[206:207], v246 offset:2048
    v_mfma_f32_16x16x32_bf16 v[148:151], v[212:215], v[92:95], v[148:151]
    ds_read_b64_tr_b16 v[208:209], v246 offset:4096
    v_mfma_f32_16x16x32_bf16 v[148:151], v[216:219], v[96:99], v[148:151]
    s_waitcnt lgkmcnt(8)
    ds_read_b64_tr_b16 v[210:211], v246 offset:6144
    v_mfma_f32_16x16x32_bf16 v[164:167], v[216:219], v[220:223], v[164:167]
    ds_read_b64_tr_b16 v[212:213], v246 offset:8192
    v_add_u32 v244, 16384, v244
    v_mfma_f32_16x16x32_bf16 v[136:139], v[4:7], v[20:23], v[136:139]
    ds_read_b64_tr_b16 v[214:215], v246 offset:10240
    v_mfma_f32_16x16x32_bf16 v[136:139], v[8:11], v[24:27], v[136:139]
    s_waitcnt lgkmcnt(7)
    ds_read_b64_tr_b16 v[216:217], v246 offset:12288
    v_mfma_f32_16x16x32_bf16 v[136:139], v[12:15], v[28:31], v[136:139]
    ds_read_b64_tr_b16 v[218:219], v246 offset:14336
    v_mfma_f32_16x16x32_bf16 v[136:139], v[16:19], v[32:35], v[136:139]
    ds_read_b128 v[220:223], v3 offset:8192
    v_add_u32 v245, 16384, v245
    v_mfma_f32_16x16x32_bf16 v[152:155], v[4:7], v[84:87], v[152:155]
    ds_read_b64_tr_b16 v[4:5], v247 offset:0
    v_mfma_f32_16x16x32_bf16 v[152:155], v[8:11], v[88:91], v[152:155]
    ds_read_b64_tr_b16 v[6:7], v247 offset:2048
    v_mfma_f32_16x16x32_bf16 v[152:155], v[12:15], v[92:95], v[152:155]
    ds_read_b64_tr_b16 v[8:9], v247 offset:4096
    v_mfma_f32_16x16x32_bf16 v[152:155], v[16:19], v[96:99], v[152:155]
    s_waitcnt lgkmcnt(7)
    ds_read_b64_tr_b16 v[10:11], v247 offset:6144
    v_add_u32 v246, 16384, v246
    v_mfma_f32_16x16x32_bf16 v[140:143], v[204:207], v[20:23], v[140:143]
    ds_read_b64_tr_b16 v[12:13], v247 offset:8192
    v_mfma_f32_16x16x32_bf16 v[140:143], v[208:211], v[24:27], v[140:143]
    s_waitcnt lgkmcnt(7)
    ds_read_b64_tr_b16 v[14:15], v247 offset:10240
    v_mfma_f32_16x16x32_bf16 v[140:143], v[212:215], v[28:31], v[140:143]
    s_waitcnt lgkmcnt(6)
    ds_read_b64_tr_b16 v[16:17], v247 offset:12288
    v_mfma_f32_16x16x32_bf16 v[140:143], v[216:219], v[32:35], v[140:143]
    ds_read_b64_tr_b16 v[18:19], v247 offset:14336
    v_mfma_f32_16x16x32_bf16 v[156:159], v[204:207], v[84:87], v[156:159]
    ds_read_b64_tr_b16 v[204:205], v244 offset:0
    v_mfma_f32_16x16x32_bf16 v[156:159], v[208:211], v[88:91], v[156:159]
    ds_read_b64_tr_b16 v[206:207], v244 offset:2048
    v_mfma_f32_16x16x32_bf16 v[156:159], v[212:215], v[92:95], v[156:159]
    ds_read_b64_tr_b16 v[208:209], v244 offset:4096
    v_mfma_f32_16x16x32_bf16 v[156:159], v[216:219], v[96:99], v[156:159]
    s_waitcnt lgkmcnt(7)
    ds_read_b64_tr_b16 v[210:211], v244 offset:6144
    v_add_u32 v247, 16384, v247
    v_mfma_f32_16x16x32_bf16 v[144:147], v[4:7], v[20:23], v[144:147]
    ds_read_b64_tr_b16 v[212:213], v244 offset:8192
    v_mfma_f32_16x16x32_bf16 v[144:147], v[8:11], v[24:27], v[144:147]
    s_waitcnt lgkmcnt(7)
    ds_read_b64_tr_b16 v[214:215], v244 offset:10240
    v_mfma_f32_16x16x32_bf16 v[144:147], v[12:15], v[28:31], v[144:147]
    s_waitcnt lgkmcnt(6)
    ds_read_b64_tr_b16 v[216:217], v244 offset:12288
    v_mfma_f32_16x16x32_bf16 v[144:147], v[16:19], v[32:35], v[144:147]
    ds_read_b64_tr_b16 v[218:219], v244 offset:14336
    v_mfma_f32_16x16x32_bf16 v[160:163], v[4:7], v[84:87], v[160:163]
    ds_read_b64_tr_b16 v[4:5], v245 offset:0
    v_mfma_f32_16x16x32_bf16 v[160:163], v[8:11], v[88:91], v[160:163]
    ds_read_b64_tr_b16 v[6:7], v245 offset:2048
    v_mfma_f32_16x16x32_bf16 v[160:163], v[12:15], v[92:95], v[160:163]
    ds_read_b64_tr_b16 v[8:9], v245 offset:4096
    v_mfma_f32_16x16x32_bf16 v[160:163], v[16:19], v[96:99], v[160:163]
    ds_read_b64_tr_b16 v[10:11], v245 offset:6144
    s_barrier
    s_waitcnt lgkmcnt(8)
    v_mfma_f32_16x16x32_bf16 v[164:167], v[204:207], v[220:223], v[164:167]
    ds_read_b128 v[220:223], v3 offset:11264
    v_mfma_f32_16x16x32_bf16 v[164:167], v[208:211], v[240:243], v[164:167]
    s_waitcnt lgkmcnt(7)
    ds_read_b64_tr_b16 v[12:13], v245 offset:8192
    v_mfma_f32_16x16x32_bf16 v[164:167], v[212:215], v[252:255], v[164:167]
    ds_read_b64_tr_b16 v[14:15], v245 offset:10240
    v_mfma_f32_16x16x32_bf16 v[132:135], v[204:207], v[36:39], v[132:135]
    ds_read_b64_tr_b16 v[16:17], v245 offset:12288
    v_mfma_f32_16x16x32_bf16 v[132:135], v[208:211], v[40:43], v[132:135]
    ds_read_b64_tr_b16 v[18:19], v245 offset:14336
    v_mfma_f32_16x16x32_bf16 v[132:135], v[212:215], v[44:47], v[132:135]
    s_waitcnt lgkmcnt(7)
    ds_read_b128 v[240:243], v3 offset:13312
    v_mfma_f32_16x16x32_bf16 v[132:135], v[216:219], v[48:51], v[132:135]
    ds_read_b128 v[252:255], v3 offset:14336
    v_mfma_f32_16x16x32_bf16 v[148:151], v[204:207], v[100:103], v[148:151]
    ds_read_b64_tr_b16 v[204:205], v246 offset:0
    v_mfma_f32_16x16x32_bf16 v[148:151], v[208:211], v[104:107], v[148:151]
    ds_read_b64_tr_b16 v[206:207], v246 offset:2048
    v_mfma_f32_16x16x32_bf16 v[148:151], v[212:215], v[108:111], v[148:151]
    ds_read_b64_tr_b16 v[208:209], v246 offset:4096
    v_mfma_f32_16x16x32_bf16 v[148:151], v[216:219], v[112:115], v[148:151]
    s_waitcnt lgkmcnt(8)
    ds_read_b64_tr_b16 v[210:211], v246 offset:6144
    v_mfma_f32_16x16x32_bf16 v[164:167], v[216:219], v[220:223], v[164:167]
    ds_read_b64_tr_b16 v[212:213], v246 offset:8192
    v_add_u32 v244, 16384, v244
    v_mfma_f32_16x16x32_bf16 v[136:139], v[4:7], v[36:39], v[136:139]
    ds_read_b64_tr_b16 v[214:215], v246 offset:10240
    v_mfma_f32_16x16x32_bf16 v[136:139], v[8:11], v[40:43], v[136:139]
    s_waitcnt lgkmcnt(7)
    ds_read_b64_tr_b16 v[216:217], v246 offset:12288
    v_mfma_f32_16x16x32_bf16 v[136:139], v[12:15], v[44:47], v[136:139]
    ds_read_b64_tr_b16 v[218:219], v246 offset:14336
    v_mfma_f32_16x16x32_bf16 v[136:139], v[16:19], v[48:51], v[136:139]
    ds_read_b128 v[220:223], v3 offset:12288
    v_add_u32 v245, 16384, v245
    v_mfma_f32_16x16x32_bf16 v[152:155], v[4:7], v[100:103], v[152:155]
    ds_read_b64_tr_b16 v[4:5], v247 offset:0
    v_mfma_f32_16x16x32_bf16 v[152:155], v[8:11], v[104:107], v[152:155]
    ds_read_b64_tr_b16 v[6:7], v247 offset:2048
    v_mfma_f32_16x16x32_bf16 v[152:155], v[12:15], v[108:111], v[152:155]
    ds_read_b64_tr_b16 v[8:9], v247 offset:4096
    s_waitcnt vmcnt(0)
    buffer_store_dword v2, v251, s[28:31], s56 offen offset:4 sc1
    v_mfma_f32_16x16x32_bf16 v[152:155], v[16:19], v[112:115], v[152:155]
    s_waitcnt lgkmcnt(6)
    ds_read_b64_tr_b16 v[10:11], v247 offset:6144
    v_add_u32 v246, 16384, v246
    v_mfma_f32_16x16x32_bf16 v[140:143], v[204:207], v[36:39], v[140:143]
    ds_read_b64_tr_b16 v[12:13], v247 offset:8192
    v_mfma_f32_16x16x32_bf16 v[140:143], v[208:211], v[40:43], v[140:143]
    ds_read_b64_tr_b16 v[14:15], v247 offset:10240
    v_mfma_f32_16x16x32_bf16 v[140:143], v[212:215], v[44:47], v[140:143]
    s_waitcnt lgkmcnt(6)
    ds_read_b64_tr_b16 v[16:17], v247 offset:12288
    v_mfma_f32_16x16x32_bf16 v[140:143], v[216:219], v[48:51], v[140:143]
    ds_read_b64_tr_b16 v[18:19], v247 offset:14336
    v_mfma_f32_16x16x32_bf16 v[156:159], v[204:207], v[100:103], v[156:159]
    ds_read_b64_tr_b16 v[204:205], v244 offset:0
    v_mfma_f32_16x16x32_bf16 v[156:159], v[208:211], v[104:107], v[156:159]
    ds_read_b64_tr_b16 v[206:207], v244 offset:2048
    v_mfma_f32_16x16x32_bf16 v[156:159], v[212:215], v[108:111], v[156:159]
    ds_read_b64_tr_b16 v[208:209], v244 offset:4096
    v_mfma_f32_16x16x32_bf16 v[156:159], v[216:219], v[112:115], v[156:159]
    s_waitcnt lgkmcnt(7)
    ds_read_b64_tr_b16 v[210:211], v244 offset:6144
    v_add_u32 v247, 16384, v247
    v_mfma_f32_16x16x32_bf16 v[144:147], v[4:7], v[36:39], v[144:147]
    ds_read_b64_tr_b16 v[212:213], v244 offset:8192
    v_mfma_f32_16x16x32_bf16 v[144:147], v[8:11], v[40:43], v[144:147]
    s_waitcnt lgkmcnt(7)
    ds_read_b64_tr_b16 v[214:215], v244 offset:10240
    v_mfma_f32_16x16x32_bf16 v[144:147], v[12:15], v[44:47], v[144:147]
    s_waitcnt lgkmcnt(6)
    ds_read_b64_tr_b16 v[216:217], v244 offset:12288
    v_mfma_f32_16x16x32_bf16 v[144:147], v[16:19], v[48:51], v[144:147]
    ds_read_b64_tr_b16 v[218:219], v244 offset:14336
    v_mfma_f32_16x16x32_bf16 v[160:163], v[4:7], v[100:103], v[160:163]
    ds_read_b64_tr_b16 v[4:5], v245 offset:0
    v_mfma_f32_16x16x32_bf16 v[160:163], v[8:11], v[104:107], v[160:163]
    ds_read_b64_tr_b16 v[6:7], v245 offset:2048
    v_mfma_f32_16x16x32_bf16 v[160:163], v[12:15], v[108:111], v[160:163]
    ds_read_b64_tr_b16 v[8:9], v245 offset:4096
    v_mfma_f32_16x16x32_bf16 v[160:163], v[16:19], v[112:115], v[160:163]
    ds_read_b64_tr_b16 v[10:11], v245 offset:6144
    s_barrier
    s_waitcnt lgkmcnt(8)
    v_mfma_f32_16x16x32_bf16 v[164:167], v[204:207], v[220:223], v[164:167]
    ds_read_b128 v[220:223], v3 offset:15360
    v_mfma_f32_16x16x32_bf16 v[164:167], v[208:211], v[240:243], v[164:167]
    s_waitcnt lgkmcnt(7)
    ds_read_b64_tr_b16 v[12:13], v245 offset:8192
    v_mfma_f32_16x16x32_bf16 v[164:167], v[212:215], v[252:255], v[164:167]
    ds_read_b64_tr_b16 v[14:15], v245 offset:10240
    v_mfma_f32_16x16x32_bf16 v[132:135], v[204:207], v[52:55], v[132:135]
    ds_read_b64_tr_b16 v[16:17], v245 offset:12288
    v_mfma_f32_16x16x32_bf16 v[132:135], v[208:211], v[56:59], v[132:135]
    ds_read_b64_tr_b16 v[18:19], v245 offset:14336
    v_mfma_f32_16x16x32_bf16 v[132:135], v[212:215], v[60:63], v[132:135]
    s_waitcnt lgkmcnt(7)
    ds_read_b128 v[240:243], v3 offset:1024
    v_mfma_f32_16x16x32_bf16 v[132:135], v[216:219], v[64:67], v[132:135]
    ds_read_b128 v[252:255], v3 offset:2048
    v_mfma_f32_16x16x32_bf16 v[148:151], v[204:207], v[116:119], v[148:151]
    ds_read_b64_tr_b16 v[204:205], v246 offset:0
    v_mfma_f32_16x16x32_bf16 v[148:151], v[208:211], v[120:123], v[148:151]
    ds_read_b64_tr_b16 v[206:207], v246 offset:2048
    v_mfma_f32_16x16x32_bf16 v[148:151], v[212:215], v[124:127], v[148:151]
    ds_read_b64_tr_b16 v[208:209], v246 offset:4096
    v_mfma_f32_16x16x32_bf16 v[148:151], v[216:219], v[128:131], v[148:151]
    s_waitcnt lgkmcnt(8)
    ds_read_b64_tr_b16 v[210:211], v246 offset:6144
    v_mfma_f32_16x16x32_bf16 v[164:167], v[216:219], v[220:223], v[164:167]
    ds_read_b64_tr_b16 v[212:213], v246 offset:8192
    v_add_u32 v244, 16384, v244
    v_mfma_f32_16x16x32_bf16 v[136:139], v[4:7], v[52:55], v[136:139]
    ds_read_b64_tr_b16 v[214:215], v246 offset:10240
    v_mfma_f32_16x16x32_bf16 v[136:139], v[8:11], v[56:59], v[136:139]
    s_waitcnt lgkmcnt(7)
    ds_read_b64_tr_b16 v[216:217], v246 offset:12288
    v_mfma_f32_16x16x32_bf16 v[136:139], v[12:15], v[60:63], v[136:139]
    ds_read_b64_tr_b16 v[218:219], v246 offset:14336
    v_mfma_f32_16x16x32_bf16 v[136:139], v[16:19], v[64:67], v[136:139]
    ds_read_b128 v[220:223], v3 offset:0
    v_add_u32 v245, 16384, v245
    v_mfma_f32_16x16x32_bf16 v[152:155], v[4:7], v[116:119], v[152:155]
    ds_read_b64_tr_b16 v[4:5], v247 offset:0
    v_mfma_f32_16x16x32_bf16 v[152:155], v[8:11], v[120:123], v[152:155]
    ds_read_b64_tr_b16 v[6:7], v247 offset:2048
    v_mfma_f32_16x16x32_bf16 v[152:155], v[12:15], v[124:127], v[152:155]
    ds_read_b64_tr_b16 v[8:9], v247 offset:4096
    v_mfma_f32_16x16x32_bf16 v[152:155], v[16:19], v[128:131], v[152:155]
    s_waitcnt lgkmcnt(7)
    ds_read_b64_tr_b16 v[10:11], v247 offset:6144
    v_add_u32 v246, 16384, v246
    v_mfma_f32_16x16x32_bf16 v[140:143], v[204:207], v[52:55], v[140:143]
    ds_read_b64_tr_b16 v[12:13], v247 offset:8192
    v_mfma_f32_16x16x32_bf16 v[140:143], v[208:211], v[56:59], v[140:143]
    s_waitcnt lgkmcnt(7)
    ds_read_b64_tr_b16 v[14:15], v247 offset:10240
    v_mfma_f32_16x16x32_bf16 v[140:143], v[212:215], v[60:63], v[140:143]
    s_waitcnt lgkmcnt(6)
    ds_read_b64_tr_b16 v[16:17], v247 offset:12288
    v_mfma_f32_16x16x32_bf16 v[140:143], v[216:219], v[64:67], v[140:143]
    ds_read_b64_tr_b16 v[18:19], v247 offset:14336
    v_mfma_f32_16x16x32_bf16 v[156:159], v[204:207], v[116:119], v[156:159]
    ds_read_b64_tr_b16 v[204:205], v244 offset:0
    s_bfe_u32 s62, s100, 262152
    v_mfma_f32_16x16x32_bf16 v[156:159], v[208:211], v[120:123], v[156:159]
    ds_read_b64_tr_b16 v[206:207], v244 offset:2048
    s_add_u32 s62, s62, s101
    v_mfma_f32_16x16x32_bf16 v[156:159], v[212:215], v[124:127], v[156:159]
    ds_read_b64_tr_b16 v[208:209], v244 offset:4096
    s_and_b32 s62, s62, 7
    v_mfma_f32_16x16x32_bf16 v[156:159], v[216:219], v[128:131], v[156:159]
    s_waitcnt lgkmcnt(5)
    ds_read_b64_tr_b16 v[210:211], v244 offset:6144
    v_add_u32 v247, 16384, v247
    v_mfma_f32_16x16x32_bf16 v[144:147], v[4:7], v[52:55], v[144:147]
    ds_read_b64_tr_b16 v[212:213], v244 offset:8192
    s_add_u32 s62, s62, s57
    v_mfma_f32_16x16x32_bf16 v[144:147], v[8:11], v[56:59], v[144:147]
    ds_read_b64_tr_b16 v[214:215], v244 offset:10240
    s_mul_i32 s60, s62, 129024
    v_mfma_f32_16x16x32_bf16 v[144:147], v[12:15], v[60:63], v[144:147]
    s_waitcnt lgkmcnt(5)
    ds_read_b64_tr_b16 v[216:217], v244 offset:12288
    v_mfma_f32_16x16x32_bf16 v[144:147], v[16:19], v[64:67], v[144:147]
    ds_read_b64_tr_b16 v[218:219], v244 offset:14336
    s_add_u32 s60, s60, 8425472
    v_mfma_f32_16x16x32_bf16 v[160:163], v[4:7], v[116:119], v[160:163]
    ds_read_b64_tr_b16 v[4:5], v245 offset:0
    s_lshl_b32 s62, s62, 7
    v_mfma_f32_16x16x32_bf16 v[160:163], v[8:11], v[120:123], v[160:163]
    ds_read_b64_tr_b16 v[6:7], v245 offset:2048
    v_mfma_f32_16x16x32_bf16 v[160:163], v[12:15], v[124:127], v[160:163]
    ds_read_b64_tr_b16 v[8:9], v245 offset:4096
    v_mfma_f32_16x16x32_bf16 v[160:163], v[16:19], v[128:131], v[160:163]
    ds_read_b64_tr_b16 v[10:11], v245 offset:6144
    s_barrier
    s_waitcnt lgkmcnt(7)
    v_mfma_f32_16x16x32_bf16 v[200:203], v[204:207], v[220:223], 0
    ds_read_b128 v[220:223], v3 offset:3072
    v_mfma_f32_16x16x32_bf16 v[200:203], v[208:211], v[240:243], v[200:203]
    s_waitcnt lgkmcnt(6)
    ds_read_b64_tr_b16 v[12:13], v245 offset:8192
    v_mfma_f32_16x16x32_bf16 v[200:203], v[212:215], v[252:255], v[200:203]
    ds_read_b64_tr_b16 v[14:15], v245 offset:10240
    v_mfma_f32_16x16x32_bf16 v[168:171], v[204:207], v[224:227], 0
    ds_read_b64_tr_b16 v[16:17], v245 offset:12288
    v_cvt_pk_bf16_f32 v132, v132, v133
    v_mfma_f32_16x16x32_bf16 v[168:171], v[208:211], v[228:231], v[168:171]
    ds_read_b64_tr_b16 v[18:19], v245 offset:14336
    v_cvt_pk_bf16_f32 v133, v134, v135
    v_mfma_f32_16x16x32_bf16 v[168:171], v[212:215], v[232:235], v[168:171]
    s_waitcnt lgkmcnt(5)
    ds_read_b128 v[240:243], v3 offset:5120
    v_cvt_pk_bf16_f32 v134, v136, v137
    v_mfma_f32_16x16x32_bf16 v[168:171], v[216:219], v[236:239], v[168:171]
    ds_read_b128 v[252:255], v3 offset:6144
    v_cvt_pk_bf16_f32 v135, v138, v139
    v_mfma_f32_16x16x32_bf16 v[184:187], v[204:207], v[68:71], 0
    ds_read_b64_tr_b16 v[204:205], v246 offset:0
    v_cvt_pk_bf16_f32 v148, v148, v149
    v_mfma_f32_16x16x32_bf16 v[184:187], v[208:211], v[72:75], v[184:187]
    ds_read_b64_tr_b16 v[206:207], v246 offset:2048
    v_cvt_pk_bf16_f32 v149, v150, v151
    v_mfma_f32_16x16x32_bf16 v[184:187], v[212:215], v[76:79], v[184:187]
    ds_read_b64_tr_b16 v[208:209], v246 offset:4096
    v_cvt_pk_bf16_f32 v150, v152, v153
    v_mfma_f32_16x16x32_bf16 v[184:187], v[216:219], v[80:83], v[184:187]
    s_waitcnt lgkmcnt(5)
    ds_read_b64_tr_b16 v[210:211], v246 offset:6144
    v_cvt_pk_bf16_f32 v151, v154, v155
    v_mfma_f32_16x16x32_bf16 v[200:203], v[216:219], v[220:223], v[200:203]
    ds_read_b64_tr_b16 v[212:213], v246 offset:8192
    v_add_u32 v244, 16384, v244
    v_mfma_f32_16x16x32_bf16 v[172:175], v[4:7], v[224:227], 0
    ds_read_b64_tr_b16 v[214:215], v246 offset:10240
    v_cvt_pk_bf16_f32 v140, v140, v141
    v_mfma_f32_16x16x32_bf16 v[172:175], v[8:11], v[228:231], v[172:175]
    ds_read_b64_tr_b16 v[216:217], v246 offset:12288
    v_cvt_pk_bf16_f32 v141, v142, v143
    v_mfma_f32_16x16x32_bf16 v[172:175], v[12:15], v[232:235], v[172:175]
    ds_read_b64_tr_b16 v[218:219], v246 offset:14336
    v_cvt_pk_bf16_f32 v142, v144, v145
    v_mfma_f32_16x16x32_bf16 v[172:175], v[16:19], v[236:239], v[172:175]
    ds_read_b128 v[220:223], v3 offset:4096
    v_add_u32 v245, 16384, v245
    v_mfma_f32_16x16x32_bf16 v[188:191], v[4:7], v[68:71], 0
    ds_read_b64_tr_b16 v[4:5], v247 offset:0
    v_cvt_pk_bf16_f32 v143, v146, v147
    v_mfma_f32_16x16x32_bf16 v[188:191], v[8:11], v[72:75], v[188:191]
    ds_read_b64_tr_b16 v[6:7], v247 offset:2048
    v_cvt_pk_bf16_f32 v156, v156, v157
    v_mfma_f32_16x16x32_bf16 v[188:191], v[12:15], v[76:79], v[188:191]
    ds_read_b64_tr_b16 v[8:9], v247 offset:4096
    v_cvt_pk_bf16_f32 v157, v158, v159
    v_mfma_f32_16x16x32_bf16 v[188:191], v[16:19], v[80:83], v[188:191]
    s_waitcnt lgkmcnt(5)
    ds_read_b64_tr_b16 v[10:11], v247 offset:6144
    v_add_u32 v246, 16384, v246
    v_mfma_f32_16x16x32_bf16 v[176:179], v[204:207], v[224:227], 0
    ds_read_b64_tr_b16 v[12:13], v247 offset:8192
    v_cvt_pk_bf16_f32 v158, v160, v161
    v_mfma_f32_16x16x32_bf16 v[176:179], v[208:211], v[228:231], v[176:179]
    ds_read_b64_tr_b16 v[14:15], v247 offset:10240
    v_cvt_pk_bf16_f32 v159, v162, v163
    v_mfma_f32_16x16x32_bf16 v[176:179], v[212:215], v[232:235], v[176:179]
    ds_read_b64_tr_b16 v[16:17], v247 offset:12288
    v_cvt_pk_bf16_f32 v164, v164, v165
    buffer_store_dwordx4 v[132:135], v249, s[28:31], s60 offen offset:0 sc1
    s_waitcnt lgkmcnt(5)
    v_mfma_f32_16x16x32_bf16 v[176:179], v[216:219], v[236:239], v[176:179]
    ds_read_b64_tr_b16 v[18:19], v247 offset:14336
    v_cvt_pk_bf16_f32 v165, v166, v167
    v_mfma_f32_16x16x32_bf16 v[192:195], v[204:207], v[68:71], 0
    ds_read_b64_tr_b16 v[204:205], v244 offset:0
    v_mfma_f32_16x16x32_bf16 v[192:195], v[208:211], v[72:75], v[192:195]
    ds_read_b64_tr_b16 v[206:207], v244 offset:2048
    buffer_store_dwordx4 v[148:151], v249, s[28:31], s60 offen offset:2048 sc1
    v_mfma_f32_16x16x32_bf16 v[192:195], v[212:215], v[76:79], v[192:195]
    ds_read_b64_tr_b16 v[208:209], v244 offset:4096
    v_mfma_f32_16x16x32_bf16 v[192:195], v[216:219], v[80:83], v[192:195]
    ds_read_b64_tr_b16 v[210:211], v244 offset:6144
    v_add_u32 v247, 16384, v247
    v_mfma_f32_16x16x32_bf16 v[180:183], v[4:7], v[224:227], 0
    ds_read_b64_tr_b16 v[212:213], v244 offset:8192
    buffer_store_dwordx4 v[140:143], v249, s[28:31], s60 offen offset:1024 sc1
    s_waitcnt lgkmcnt(6)
    v_mfma_f32_16x16x32_bf16 v[180:183], v[8:11], v[228:231], v[180:183]
    ds_read_b64_tr_b16 v[214:215], v244 offset:10240
    v_mfma_f32_16x16x32_bf16 v[180:183], v[12:15], v[232:235], v[180:183]
    s_waitcnt lgkmcnt(6)
    ds_read_b64_tr_b16 v[216:217], v244 offset:12288
    v_mfma_f32_16x16x32_bf16 v[180:183], v[16:19], v[236:239], v[180:183]
    ds_read_b64_tr_b16 v[218:219], v244 offset:14336
    buffer_store_dwordx4 v[156:159], v249, s[28:31], s60 offen offset:3072 sc1
    v_mfma_f32_16x16x32_bf16 v[196:199], v[4:7], v[68:71], 0
    ds_read_b64_tr_b16 v[4:5], v245 offset:0
    v_mfma_f32_16x16x32_bf16 v[196:199], v[8:11], v[72:75], v[196:199]
    ds_read_b64_tr_b16 v[6:7], v245 offset:2048
    v_mfma_f32_16x16x32_bf16 v[196:199], v[12:15], v[76:79], v[196:199]
    ds_read_b64_tr_b16 v[8:9], v245 offset:4096
    buffer_store_dwordx2 v[164:165], v250, s[28:31], s60 offen sc1
    v_mfma_f32_16x16x32_bf16 v[196:199], v[16:19], v[80:83], v[196:199]
    ds_read_b64_tr_b16 v[10:11], v245 offset:6144
    s_barrier
    s_waitcnt lgkmcnt(7)
    v_mfma_f32_16x16x32_bf16 v[200:203], v[204:207], v[220:223], v[200:203]
    ds_read_b128 v[220:223], v3 offset:7168
    v_mfma_f32_16x16x32_bf16 v[200:203], v[208:211], v[240:243], v[200:203]
    s_waitcnt lgkmcnt(6)
    ds_read_b64_tr_b16 v[12:13], v245 offset:8192
    v_mfma_f32_16x16x32_bf16 v[200:203], v[212:215], v[252:255], v[200:203]
    ds_read_b64_tr_b16 v[14:15], v245 offset:10240
    v_mfma_f32_16x16x32_bf16 v[168:171], v[204:207], v[20:23], v[168:171]
    ds_read_b64_tr_b16 v[16:17], v245 offset:12288
    v_mfma_f32_16x16x32_bf16 v[168:171], v[208:211], v[24:27], v[168:171]
    ds_read_b64_tr_b16 v[18:19], v245 offset:14336
    v_mfma_f32_16x16x32_bf16 v[168:171], v[212:215], v[28:31], v[168:171]
    s_waitcnt lgkmcnt(6)
    ds_read_b128 v[240:243], v3 offset:9216
    v_mfma_f32_16x16x32_bf16 v[168:171], v[216:219], v[32:35], v[168:171]
    ds_read_b128 v[252:255], v3 offset:10240
    v_mfma_f32_16x16x32_bf16 v[184:187], v[204:207], v[84:87], v[184:187]
    ds_read_b64_tr_b16 v[204:205], v246 offset:0
    v_mfma_f32_16x16x32_bf16 v[184:187], v[208:211], v[88:91], v[184:187]
    ds_read_b64_tr_b16 v[206:207], v246 offset:2048
    v_mfma_f32_16x16x32_bf16 v[184:187], v[212:215], v[92:95], v[184:187]
    ds_read_b64_tr_b16 v[208:209], v246 offset:4096
    v_mfma_f32_16x16x32_bf16 v[184:187], v[216:219], v[96:99], v[184:187]
    s_waitcnt lgkmcnt(8)
    ds_read_b64_tr_b16 v[210:211], v246 offset:6144
    v_mfma_f32_16x16x32_bf16 v[200:203], v[216:219], v[220:223], v[200:203]
    ds_read_b64_tr_b16 v[212:213], v246 offset:8192
    v_add_u32 v244, 4294885376, v244
    v_mfma_f32_16x16x32_bf16 v[172:175], v[4:7], v[20:23], v[172:175]
    ds_read_b64_tr_b16 v[214:215], v246 offset:10240
    v_mfma_f32_16x16x32_bf16 v[172:175], v[8:11], v[24:27], v[172:175]
    s_waitcnt lgkmcnt(7)
    ds_read_b64_tr_b16 v[216:217], v246 offset:12288
    v_mfma_f32_16x16x32_bf16 v[172:175], v[12:15], v[28:31], v[172:175]
    ds_read_b64_tr_b16 v[218:219], v246 offset:14336
    v_mfma_f32_16x16x32_bf16 v[172:175], v[16:19], v[32:35], v[172:175]
    ds_read_b128 v[220:223], v3 offset:8192
    v_add_u32 v245, 4294885376, v245
    v_mfma_f32_16x16x32_bf16 v[188:191], v[4:7], v[84:87], v[188:191]
    ds_read_b64_tr_b16 v[4:5], v247 offset:0
    v_mfma_f32_16x16x32_bf16 v[188:191], v[8:11], v[88:91], v[188:191]
    ds_read_b64_tr_b16 v[6:7], v247 offset:2048
    v_mfma_f32_16x16x32_bf16 v[188:191], v[12:15], v[92:95], v[188:191]
    ds_read_b64_tr_b16 v[8:9], v247 offset:4096
    v_mfma_f32_16x16x32_bf16 v[188:191], v[16:19], v[96:99], v[188:191]
    s_waitcnt lgkmcnt(7)
    ds_read_b64_tr_b16 v[10:11], v247 offset:6144
    v_add_u32 v246, 4294885376, v246
    v_mfma_f32_16x16x32_bf16 v[176:179], v[204:207], v[20:23], v[176:179]
    ds_read_b64_tr_b16 v[12:13], v247 offset:8192
    v_mfma_f32_16x16x32_bf16 v[176:179], v[208:211], v[24:27], v[176:179]
    s_waitcnt lgkmcnt(7)
    ds_read_b64_tr_b16 v[14:15], v247 offset:10240
    v_mfma_f32_16x16x32_bf16 v[176:179], v[212:215], v[28:31], v[176:179]
    s_waitcnt lgkmcnt(6)
    ds_read_b64_tr_b16 v[16:17], v247 offset:12288
    v_mfma_f32_16x16x32_bf16 v[176:179], v[216:219], v[32:35], v[176:179]
    ds_read_b64_tr_b16 v[18:19], v247 offset:14336
    v_mfma_f32_16x16x32_bf16 v[192:195], v[204:207], v[84:87], v[192:195]
    ds_read_b64_tr_b16 v[204:205], v244 offset:0
    v_mfma_f32_16x16x32_bf16 v[192:195], v[208:211], v[88:91], v[192:195]
    ds_read_b64_tr_b16 v[206:207], v244 offset:2048
    v_mfma_f32_16x16x32_bf16 v[192:195], v[212:215], v[92:95], v[192:195]
    ds_read_b64_tr_b16 v[208:209], v244 offset:4096
    v_mfma_f32_16x16x32_bf16 v[192:195], v[216:219], v[96:99], v[192:195]
    s_waitcnt lgkmcnt(7)
    ds_read_b64_tr_b16 v[210:211], v244 offset:6144
    v_add_u32 v247, 4294885376, v247
    v_mfma_f32_16x16x32_bf16 v[180:183], v[4:7], v[20:23], v[180:183]
    ds_read_b64_tr_b16 v[212:213], v244 offset:8192
    v_mfma_f32_16x16x32_bf16 v[180:183], v[8:11], v[24:27], v[180:183]
    s_waitcnt lgkmcnt(7)
    ds_read_b64_tr_b16 v[214:215], v244 offset:10240
    v_mfma_f32_16x16x32_bf16 v[180:183], v[12:15], v[28:31], v[180:183]
    s_waitcnt lgkmcnt(6)
    ds_read_b64_tr_b16 v[216:217], v244 offset:12288
    v_mfma_f32_16x16x32_bf16 v[180:183], v[16:19], v[32:35], v[180:183]
    ds_read_b64_tr_b16 v[218:219], v244 offset:14336
    v_mfma_f32_16x16x32_bf16 v[196:199], v[4:7], v[84:87], v[196:199]
    ds_read_b64_tr_b16 v[4:5], v245 offset:0
    v_mfma_f32_16x16x32_bf16 v[196:199], v[8:11], v[88:91], v[196:199]
    ds_read_b64_tr_b16 v[6:7], v245 offset:2048
    v_mfma_f32_16x16x32_bf16 v[196:199], v[12:15], v[92:95], v[196:199]
    ds_read_b64_tr_b16 v[8:9], v245 offset:4096
    v_mfma_f32_16x16x32_bf16 v[196:199], v[16:19], v[96:99], v[196:199]
    ds_read_b64_tr_b16 v[10:11], v245 offset:6144
    s_barrier
    s_waitcnt lgkmcnt(8)
    v_mfma_f32_16x16x32_bf16 v[200:203], v[204:207], v[220:223], v[200:203]
    ds_read_b128 v[220:223], v3 offset:11264
    v_mfma_f32_16x16x32_bf16 v[200:203], v[208:211], v[240:243], v[200:203]
    s_waitcnt lgkmcnt(7)
    ds_read_b64_tr_b16 v[12:13], v245 offset:8192
    v_mfma_f32_16x16x32_bf16 v[200:203], v[212:215], v[252:255], v[200:203]
    ds_read_b64_tr_b16 v[14:15], v245 offset:10240
    v_mfma_f32_16x16x32_bf16 v[168:171], v[204:207], v[36:39], v[168:171]
    ds_read_b64_tr_b16 v[16:17], v245 offset:12288
    v_mfma_f32_16x16x32_bf16 v[168:171], v[208:211], v[40:43], v[168:171]
    ds_read_b64_tr_b16 v[18:19], v245 offset:14336
    v_mfma_f32_16x16x32_bf16 v[168:171], v[212:215], v[44:47], v[168:171]
    s_waitcnt lgkmcnt(7)
    ds_read_b128 v[240:243], v3 offset:13312
    v_mfma_f32_16x16x32_bf16 v[168:171], v[216:219], v[48:51], v[168:171]
    ds_read_b128 v[252:255], v3 offset:14336
    v_mfma_f32_16x16x32_bf16 v[184:187], v[204:207], v[100:103], v[184:187]
    ds_read_b64_tr_b16 v[204:205], v246 offset:0
    v_mfma_f32_16x16x32_bf16 v[184:187], v[208:211], v[104:107], v[184:187]
    ds_read_b64_tr_b16 v[206:207], v246 offset:2048
    v_mfma_f32_16x16x32_bf16 v[184:187], v[212:215], v[108:111], v[184:187]
    ds_read_b64_tr_b16 v[208:209], v246 offset:4096
    v_mfma_f32_16x16x32_bf16 v[184:187], v[216:219], v[112:115], v[184:187]
    s_waitcnt lgkmcnt(8)
    ds_read_b64_tr_b16 v[210:211], v246 offset:6144
    v_mfma_f32_16x16x32_bf16 v[200:203], v[216:219], v[220:223], v[200:203]
    ds_read_b64_tr_b16 v[212:213], v246 offset:8192
    v_add_u32 v244, 16384, v244
    v_mfma_f32_16x16x32_bf16 v[172:175], v[4:7], v[36:39], v[172:175]
    ds_read_b64_tr_b16 v[214:215], v246 offset:10240
    v_mfma_f32_16x16x32_bf16 v[172:175], v[8:11], v[40:43], v[172:175]
    s_waitcnt lgkmcnt(7)
    ds_read_b64_tr_b16 v[216:217], v246 offset:12288
    v_mfma_f32_16x16x32_bf16 v[172:175], v[12:15], v[44:47], v[172:175]
    ds_read_b64_tr_b16 v[218:219], v246 offset:14336
    v_mfma_f32_16x16x32_bf16 v[172:175], v[16:19], v[48:51], v[172:175]
    ds_read_b128 v[220:223], v3 offset:12288
    v_add_u32 v245, 16384, v245
    v_mfma_f32_16x16x32_bf16 v[188:191], v[4:7], v[100:103], v[188:191]
    ds_read_b64_tr_b16 v[4:5], v247 offset:0
    v_mfma_f32_16x16x32_bf16 v[188:191], v[8:11], v[104:107], v[188:191]
    ds_read_b64_tr_b16 v[6:7], v247 offset:2048
    v_mfma_f32_16x16x32_bf16 v[188:191], v[12:15], v[108:111], v[188:191]
    ds_read_b64_tr_b16 v[8:9], v247 offset:4096
    s_waitcnt vmcnt(0)
    buffer_store_dword v2, v251, s[28:31], s62 offen offset:8 sc1
    v_mfma_f32_16x16x32_bf16 v[188:191], v[16:19], v[112:115], v[188:191]
    s_waitcnt lgkmcnt(6)
    ds_read_b64_tr_b16 v[10:11], v247 offset:6144
    v_add_u32 v246, 16384, v246
    v_mfma_f32_16x16x32_bf16 v[176:179], v[204:207], v[36:39], v[176:179]
    ds_read_b64_tr_b16 v[12:13], v247 offset:8192
    v_mfma_f32_16x16x32_bf16 v[176:179], v[208:211], v[40:43], v[176:179]
    ds_read_b64_tr_b16 v[14:15], v247 offset:10240
    v_mfma_f32_16x16x32_bf16 v[176:179], v[212:215], v[44:47], v[176:179]
    s_waitcnt lgkmcnt(6)
    ds_read_b64_tr_b16 v[16:17], v247 offset:12288
    v_mfma_f32_16x16x32_bf16 v[176:179], v[216:219], v[48:51], v[176:179]
    ds_read_b64_tr_b16 v[18:19], v247 offset:14336
    v_mfma_f32_16x16x32_bf16 v[192:195], v[204:207], v[100:103], v[192:195]
    ds_read_b64_tr_b16 v[204:205], v244 offset:0
    v_mfma_f32_16x16x32_bf16 v[192:195], v[208:211], v[104:107], v[192:195]
    ds_read_b64_tr_b16 v[206:207], v244 offset:2048
    v_mfma_f32_16x16x32_bf16 v[192:195], v[212:215], v[108:111], v[192:195]
    ds_read_b64_tr_b16 v[208:209], v244 offset:4096
    v_mfma_f32_16x16x32_bf16 v[192:195], v[216:219], v[112:115], v[192:195]
    s_waitcnt lgkmcnt(7)
    ds_read_b64_tr_b16 v[210:211], v244 offset:6144
    v_add_u32 v247, 16384, v247
    v_mfma_f32_16x16x32_bf16 v[180:183], v[4:7], v[36:39], v[180:183]
    ds_read_b64_tr_b16 v[212:213], v244 offset:8192
    v_mfma_f32_16x16x32_bf16 v[180:183], v[8:11], v[40:43], v[180:183]
    s_waitcnt lgkmcnt(7)
    ds_read_b64_tr_b16 v[214:215], v244 offset:10240
    v_mfma_f32_16x16x32_bf16 v[180:183], v[12:15], v[44:47], v[180:183]
    s_waitcnt lgkmcnt(6)
    ds_read_b64_tr_b16 v[216:217], v244 offset:12288
    v_mfma_f32_16x16x32_bf16 v[180:183], v[16:19], v[48:51], v[180:183]
    ds_read_b64_tr_b16 v[218:219], v244 offset:14336
    v_mfma_f32_16x16x32_bf16 v[196:199], v[4:7], v[100:103], v[196:199]
    ds_read_b64_tr_b16 v[4:5], v245 offset:0
    v_mfma_f32_16x16x32_bf16 v[196:199], v[8:11], v[104:107], v[196:199]
    ds_read_b64_tr_b16 v[6:7], v245 offset:2048
    v_mfma_f32_16x16x32_bf16 v[196:199], v[12:15], v[108:111], v[196:199]
    ds_read_b64_tr_b16 v[8:9], v245 offset:4096
    v_mfma_f32_16x16x32_bf16 v[196:199], v[16:19], v[112:115], v[196:199]
    ds_read_b64_tr_b16 v[10:11], v245 offset:6144
    s_barrier
    s_waitcnt lgkmcnt(8)
    v_mfma_f32_16x16x32_bf16 v[200:203], v[204:207], v[220:223], v[200:203]
    ds_read_b128 v[220:223], v3 offset:15360
    v_mfma_f32_16x16x32_bf16 v[200:203], v[208:211], v[240:243], v[200:203]
    s_waitcnt lgkmcnt(7)
    ds_read_b64_tr_b16 v[12:13], v245 offset:8192
    v_mfma_f32_16x16x32_bf16 v[200:203], v[212:215], v[252:255], v[200:203]
    ds_read_b64_tr_b16 v[14:15], v245 offset:10240
    v_mfma_f32_16x16x32_bf16 v[168:171], v[204:207], v[52:55], v[168:171]
    ds_read_b64_tr_b16 v[16:17], v245 offset:12288
    v_mfma_f32_16x16x32_bf16 v[168:171], v[208:211], v[56:59], v[168:171]
    ds_read_b64_tr_b16 v[18:19], v245 offset:14336
    v_mfma_f32_16x16x32_bf16 v[168:171], v[212:215], v[60:63], v[168:171]
    s_waitcnt lgkmcnt(7)
    ds_read_b128 v[240:243], v3 offset:1024
    v_mfma_f32_16x16x32_bf16 v[168:171], v[216:219], v[64:67], v[168:171]
    ds_read_b128 v[252:255], v3 offset:2048
    v_mfma_f32_16x16x32_bf16 v[184:187], v[204:207], v[116:119], v[184:187]
    ds_read_b64_tr_b16 v[204:205], v246 offset:0
    v_mfma_f32_16x16x32_bf16 v[184:187], v[208:211], v[120:123], v[184:187]
    ds_read_b64_tr_b16 v[206:207], v246 offset:2048
    v_mfma_f32_16x16x32_bf16 v[184:187], v[212:215], v[124:127], v[184:187]
    ds_read_b64_tr_b16 v[208:209], v246 offset:4096
    v_mfma_f32_16x16x32_bf16 v[184:187], v[216:219], v[128:131], v[184:187]
    s_waitcnt lgkmcnt(8)
    ds_read_b64_tr_b16 v[210:211], v246 offset:6144
    v_mfma_f32_16x16x32_bf16 v[200:203], v[216:219], v[220:223], v[200:203]
    ds_read_b64_tr_b16 v[212:213], v246 offset:8192
    v_add_u32 v244, 16384, v244
    v_mfma_f32_16x16x32_bf16 v[172:175], v[4:7], v[52:55], v[172:175]
    ds_read_b64_tr_b16 v[214:215], v246 offset:10240
    v_mfma_f32_16x16x32_bf16 v[172:175], v[8:11], v[56:59], v[172:175]
    s_waitcnt lgkmcnt(7)
    ds_read_b64_tr_b16 v[216:217], v246 offset:12288
    v_mfma_f32_16x16x32_bf16 v[172:175], v[12:15], v[60:63], v[172:175]
    ds_read_b64_tr_b16 v[218:219], v246 offset:14336
    v_mfma_f32_16x16x32_bf16 v[172:175], v[16:19], v[64:67], v[172:175]
    ds_read_b128 v[220:223], v3 offset:0
    v_add_u32 v245, 16384, v245
    v_mfma_f32_16x16x32_bf16 v[188:191], v[4:7], v[116:119], v[188:191]
    ds_read_b64_tr_b16 v[4:5], v247 offset:0
    v_mfma_f32_16x16x32_bf16 v[188:191], v[8:11], v[120:123], v[188:191]
    ds_read_b64_tr_b16 v[6:7], v247 offset:2048
    v_mfma_f32_16x16x32_bf16 v[188:191], v[12:15], v[124:127], v[188:191]
    ds_read_b64_tr_b16 v[8:9], v247 offset:4096
    v_mfma_f32_16x16x32_bf16 v[188:191], v[16:19], v[128:131], v[188:191]
    s_waitcnt lgkmcnt(7)
    ds_read_b64_tr_b16 v[10:11], v247 offset:6144
    v_add_u32 v246, 16384, v246
    v_mfma_f32_16x16x32_bf16 v[176:179], v[204:207], v[52:55], v[176:179]
    ds_read_b64_tr_b16 v[12:13], v247 offset:8192
    v_mfma_f32_16x16x32_bf16 v[176:179], v[208:211], v[56:59], v[176:179]
    s_waitcnt lgkmcnt(7)
    ds_read_b64_tr_b16 v[14:15], v247 offset:10240
    v_mfma_f32_16x16x32_bf16 v[176:179], v[212:215], v[60:63], v[176:179]
    s_waitcnt lgkmcnt(6)
    ds_read_b64_tr_b16 v[16:17], v247 offset:12288
    v_mfma_f32_16x16x32_bf16 v[176:179], v[216:219], v[64:67], v[176:179]
    ds_read_b64_tr_b16 v[18:19], v247 offset:14336
    v_mfma_f32_16x16x32_bf16 v[192:195], v[204:207], v[116:119], v[192:195]
    ds_read_b64_tr_b16 v[204:205], v244 offset:0
    s_bfe_u32 s56, s100, 262156
    v_mfma_f32_16x16x32_bf16 v[192:195], v[208:211], v[120:123], v[192:195]
    ds_read_b64_tr_b16 v[206:207], v244 offset:2048
    s_add_u32 s56, s56, s101
    v_mfma_f32_16x16x32_bf16 v[192:195], v[212:215], v[124:127], v[192:195]
    ds_read_b64_tr_b16 v[208:209], v244 offset:4096
    s_and_b32 s56, s56, 7
    v_mfma_f32_16x16x32_bf16 v[192:195], v[216:219], v[128:131], v[192:195]
    s_waitcnt lgkmcnt(5)
    ds_read_b64_tr_b16 v[210:211], v244 offset:6144
    v_add_u32 v247, 16384, v247
    v_mfma_f32_16x16x32_bf16 v[180:183], v[4:7], v[52:55], v[180:183]
    ds_read_b64_tr_b16 v[212:213], v244 offset:8192
    s_add_u32 s56, s56, s57
    v_mfma_f32_16x16x32_bf16 v[180:183], v[8:11], v[56:59], v[180:183]
    ds_read_b64_tr_b16 v[214:215], v244 offset:10240
    s_mul_i32 s61, s56, 129024
    v_mfma_f32_16x16x32_bf16 v[180:183], v[12:15], v[60:63], v[180:183]
    s_waitcnt lgkmcnt(5)
    ds_read_b64_tr_b16 v[216:217], v244 offset:12288
    v_mfma_f32_16x16x32_bf16 v[180:183], v[16:19], v[64:67], v[180:183]
    ds_read_b64_tr_b16 v[218:219], v244 offset:14336
    s_add_u32 s61, s61, 8443904
    v_mfma_f32_16x16x32_bf16 v[196:199], v[4:7], v[116:119], v[196:199]
    ds_read_b64_tr_b16 v[4:5], v245 offset:0
    s_lshl_b32 s56, s56, 7
    v_mfma_f32_16x16x32_bf16 v[196:199], v[8:11], v[120:123], v[196:199]
    ds_read_b64_tr_b16 v[6:7], v245 offset:2048
    v_mfma_f32_16x16x32_bf16 v[196:199], v[12:15], v[124:127], v[196:199]
    ds_read_b64_tr_b16 v[8:9], v245 offset:4096
    v_mfma_f32_16x16x32_bf16 v[196:199], v[16:19], v[128:131], v[196:199]
    ds_read_b64_tr_b16 v[10:11], v245 offset:6144
    s_barrier
    s_waitcnt lgkmcnt(7)
    v_mfma_f32_16x16x32_bf16 v[164:167], v[204:207], v[220:223], 0
    ds_read_b128 v[220:223], v3 offset:3072
    v_mfma_f32_16x16x32_bf16 v[164:167], v[208:211], v[240:243], v[164:167]
    s_waitcnt lgkmcnt(6)
    ds_read_b64_tr_b16 v[12:13], v245 offset:8192
    v_mfma_f32_16x16x32_bf16 v[164:167], v[212:215], v[252:255], v[164:167]
    ds_read_b64_tr_b16 v[14:15], v245 offset:10240
    v_mfma_f32_16x16x32_bf16 v[132:135], v[204:207], v[224:227], 0
    ds_read_b64_tr_b16 v[16:17], v245 offset:12288
    v_cvt_pk_bf16_f32 v168, v168, v169
    v_mfma_f32_16x16x32_bf16 v[132:135], v[208:211], v[228:231], v[132:135]
    ds_read_b64_tr_b16 v[18:19], v245 offset:14336
    v_cvt_pk_bf16_f32 v169, v170, v171
    v_mfma_f32_16x16x32_bf16 v[132:135], v[212:215], v[232:235], v[132:135]
    s_waitcnt lgkmcnt(5)
    ds_read_b128 v[240:243], v3 offset:5120
    v_cvt_pk_bf16_f32 v170, v172, v173
    v_mfma_f32_16x16x32_bf16 v[132:135], v[216:219], v[236:239], v[132:135]
    ds_read_b128 v[252:255], v3 offset:6144
    v_cvt_pk_bf16_f32 v171, v174, v175
    v_mfma_f32_16x16x32_bf16 v[148:151], v[204:207], v[68:71], 0
    ds_read_b64_tr_b16 v[204:205], v246 offset:0
    v_cvt_pk_bf16_f32 v184, v184, v185
    v_mfma_f32_16x16x32_bf16 v[148:151], v[208:211], v[72:75], v[148:151]
    ds_read_b64_tr_b16 v[206:207], v246 offset:2048
    v_cvt_pk_bf16_f32 v185, v186, v187
    v_mfma_f32_16x16x32_bf16 v[148:151], v[212:215], v[76:79], v[148:151]
    ds_read_b64_tr_b16 v[208:209], v246 offset:4096
    v_cvt_pk_bf16_f32 v186, v188, v189
    v_mfma_f32_16x16x32_bf16 v[148:151], v[216:219], v[80:83], v[148:151]
    s_waitcnt lgkmcnt(5)
    ds_read_b64_tr_b16 v[210:211], v246 offset:6144
    v_cvt_pk_bf16_f32 v187, v190, v191
    v_mfma_f32_16x16x32_bf16 v[164:167], v[216:219], v[220:223], v[164:167]
    ds_read_b64_tr_b16 v[212:213], v246 offset:8192
    v_add_u32 v244, 16384, v244
    v_mfma_f32_16x16x32_bf16 v[136:139], v[4:7], v[224:227], 0
    ds_read_b64_tr_b16 v[214:215], v246 offset:10240
    v_cvt_pk_bf16_f32 v176, v176, v177
    v_mfma_f32_16x16x32_bf16 v[136:139], v[8:11], v[228:231], v[136:139]
    ds_read_b64_tr_b16 v[216:217], v246 offset:12288
    v_cvt_pk_bf16_f32 v177, v178, v179
    v_mfma_f32_16x16x32_bf16 v[136:139], v[12:15], v[232:235], v[136:139]
    ds_read_b64_tr_b16 v[218:219], v246 offset:14336
    v_cvt_pk_bf16_f32 v178, v180, v181
    v_mfma_f32_16x16x32_bf16 v[136:139], v[16:19], v[236:239], v[136:139]
    ds_read_b128 v[220:223], v3 offset:4096
    v_add_u32 v245, 16384, v245
    v_mfma_f32_16x16x32_bf16 v[152:155], v[4:7], v[68:71], 0
    ds_read_b64_tr_b16 v[4:5], v247 offset:0
    v_cvt_pk_bf16_f32 v179, v182, v183
    v_mfma_f32_16x16x32_bf16 v[152:155], v[8:11], v[72:75], v[152:155]
    ds_read_b64_tr_b16 v[6:7], v247 offset:2048
    v_cvt_pk_bf16_f32 v192, v192, v193
    v_mfma_f32_16x16x32_bf16 v[152:155], v[12:15], v[76:79], v[152:155]
    ds_read_b64_tr_b16 v[8:9], v247 offset:4096
    v_cvt_pk_bf16_f32 v193, v194, v195
    v_mfma_f32_16x16x32_bf16 v[152:155], v[16:19], v[80:83], v[152:155]
    s_waitcnt lgkmcnt(5)
    ds_read_b64_tr_b16 v[10:11], v247 offset:6144
    v_add_u32 v246, 16384, v246
    v_mfma_f32_16x16x32_bf16 v[140:143], v[204:207], v[224:227], 0
    ds_read_b64_tr_b16 v[12:13], v247 offset:8192
    v_cvt_pk_bf16_f32 v194, v196, v197
    v_mfma_f32_16x16x32_bf16 v[140:143], v[208:211], v[228:231], v[140:143]
    ds_read_b64_tr_b16 v[14:15], v247 offset:10240
    v_cvt_pk_bf16_f32 v195, v198, v199
    v_mfma_f32_16x16x32_bf16 v[140:143], v[212:215], v[232:235], v[140:143]
    ds_read_b64_tr_b16 v[16:17], v247 offset:12288
    v_cvt_pk_bf16_f32 v200, v200, v201
    buffer_store_dwordx4 v[168:171], v249, s[28:31], s61 offen offset:0 sc1
    s_waitcnt lgkmcnt(5)
    v_mfma_f32_16x16x32_bf16 v[140:143], v[216:219], v[236:239], v[140:143]
    ds_read_b64_tr_b16 v[18:19], v247 offset:14336
    v_cvt_pk_bf16_f32 v201, v202, v203
    v_mfma_f32_16x16x32_bf16 v[156:159], v[204:207], v[68:71], 0
    ds_read_b64_tr_b16 v[204:205], v244 offset:0
    v_mfma_f32_16x16x32_bf16 v[156:159], v[208:211], v[72:75], v[156:159]
    ds_read_b64_tr_b16 v[206:207], v244 offset:2048
    buffer_store_dwordx4 v[184:187], v249, s[28:31], s61 offen offset:2048 sc1
    v_mfma_f32_16x16x32_bf16 v[156:159], v[212:215], v[76:79], v[156:159]
    ds_read_b64_tr_b16 v[208:209], v244 offset:4096
    v_mfma_f32_16x16x32_bf16 v[156:159], v[216:219], v[80:83], v[156:159]
    ds_read_b64_tr_b16 v[210:211], v244 offset:6144
    v_add_u32 v247, 16384, v247
    v_mfma_f32_16x16x32_bf16 v[144:147], v[4:7], v[224:227], 0
    ds_read_b64_tr_b16 v[212:213], v244 offset:8192
    buffer_store_dwordx4 v[176:179], v249, s[28:31], s61 offen offset:1024 sc1
    s_waitcnt lgkmcnt(6)
    v_mfma_f32_16x16x32_bf16 v[144:147], v[8:11], v[228:231], v[144:147]
    ds_read_b64_tr_b16 v[214:215], v244 offset:10240
    v_mfma_f32_16x16x32_bf16 v[144:147], v[12:15], v[232:235], v[144:147]
    s_waitcnt lgkmcnt(6)
    ds_read_b64_tr_b16 v[216:217], v244 offset:12288
    v_mfma_f32_16x16x32_bf16 v[144:147], v[16:19], v[236:239], v[144:147]
    ds_read_b64_tr_b16 v[218:219], v244 offset:14336
    buffer_store_dwordx4 v[192:195], v249, s[28:31], s61 offen offset:3072 sc1
    v_mfma_f32_16x16x32_bf16 v[160:163], v[4:7], v[68:71], 0
    ds_read_b64_tr_b16 v[4:5], v245 offset:0
    v_mfma_f32_16x16x32_bf16 v[160:163], v[8:11], v[72:75], v[160:163]
    ds_read_b64_tr_b16 v[6:7], v245 offset:2048
    v_mfma_f32_16x16x32_bf16 v[160:163], v[12:15], v[76:79], v[160:163]
    ds_read_b64_tr_b16 v[8:9], v245 offset:4096
    buffer_store_dwordx2 v[200:201], v250, s[28:31], s61 offen sc1
    v_mfma_f32_16x16x32_bf16 v[160:163], v[16:19], v[80:83], v[160:163]
    ds_read_b64_tr_b16 v[10:11], v245 offset:6144
    s_barrier
    s_waitcnt lgkmcnt(7)
    v_mfma_f32_16x16x32_bf16 v[164:167], v[204:207], v[220:223], v[164:167]
    ds_read_b128 v[220:223], v3 offset:7168
    v_mfma_f32_16x16x32_bf16 v[164:167], v[208:211], v[240:243], v[164:167]
    s_waitcnt lgkmcnt(6)
    ds_read_b64_tr_b16 v[12:13], v245 offset:8192
    v_mfma_f32_16x16x32_bf16 v[164:167], v[212:215], v[252:255], v[164:167]
    ds_read_b64_tr_b16 v[14:15], v245 offset:10240
    v_mfma_f32_16x16x32_bf16 v[132:135], v[204:207], v[20:23], v[132:135]
    ds_read_b64_tr_b16 v[16:17], v245 offset:12288
    v_mfma_f32_16x16x32_bf16 v[132:135], v[208:211], v[24:27], v[132:135]
    ds_read_b64_tr_b16 v[18:19], v245 offset:14336
    v_mfma_f32_16x16x32_bf16 v[132:135], v[212:215], v[28:31], v[132:135]
    s_waitcnt lgkmcnt(6)
    ds_read_b128 v[240:243], v3 offset:9216
    v_mfma_f32_16x16x32_bf16 v[132:135], v[216:219], v[32:35], v[132:135]
    ds_read_b128 v[252:255], v3 offset:10240
    v_mfma_f32_16x16x32_bf16 v[148:151], v[204:207], v[84:87], v[148:151]
    ds_read_b64_tr_b16 v[204:205], v246 offset:0
    v_mfma_f32_16x16x32_bf16 v[148:151], v[208:211], v[88:91], v[148:151]
    ds_read_b64_tr_b16 v[206:207], v246 offset:2048
    v_mfma_f32_16x16x32_bf16 v[148:151], v[212:215], v[92:95], v[148:151]
    ds_read_b64_tr_b16 v[208:209], v246 offset:4096
    v_mfma_f32_16x16x32_bf16 v[148:151], v[216:219], v[96:99], v[148:151]
    s_waitcnt lgkmcnt(8)
    ds_read_b64_tr_b16 v[210:211], v246 offset:6144
    v_mfma_f32_16x16x32_bf16 v[164:167], v[216:219], v[220:223], v[164:167]
    ds_read_b64_tr_b16 v[212:213], v246 offset:8192
    v_add_u32 v244, 16384, v244
    v_mfma_f32_16x16x32_bf16 v[136:139], v[4:7], v[20:23], v[136:139]
    ds_read_b64_tr_b16 v[214:215], v246 offset:10240
    v_mfma_f32_16x16x32_bf16 v[136:139], v[8:11], v[24:27], v[136:139]
    s_waitcnt lgkmcnt(7)
    ds_read_b64_tr_b16 v[216:217], v246 offset:12288
    v_mfma_f32_16x16x32_bf16 v[136:139], v[12:15], v[28:31], v[136:139]
    ds_read_b64_tr_b16 v[218:219], v246 offset:14336
    v_mfma_f32_16x16x32_bf16 v[136:139], v[16:19], v[32:35], v[136:139]
    ds_read_b128 v[220:223], v3 offset:8192
    v_add_u32 v245, 16384, v245
    v_mfma_f32_16x16x32_bf16 v[152:155], v[4:7], v[84:87], v[152:155]
    ds_read_b64_tr_b16 v[4:5], v247 offset:0
    v_mfma_f32_16x16x32_bf16 v[152:155], v[8:11], v[88:91], v[152:155]
    ds_read_b64_tr_b16 v[6:7], v247 offset:2048
    v_mfma_f32_16x16x32_bf16 v[152:155], v[12:15], v[92:95], v[152:155]
    ds_read_b64_tr_b16 v[8:9], v247 offset:4096
    v_mfma_f32_16x16x32_bf16 v[152:155], v[16:19], v[96:99], v[152:155]
    s_waitcnt lgkmcnt(7)
    ds_read_b64_tr_b16 v[10:11], v247 offset:6144
    v_add_u32 v246, 16384, v246
    v_mfma_f32_16x16x32_bf16 v[140:143], v[204:207], v[20:23], v[140:143]
    ds_read_b64_tr_b16 v[12:13], v247 offset:8192
    v_mfma_f32_16x16x32_bf16 v[140:143], v[208:211], v[24:27], v[140:143]
    s_waitcnt lgkmcnt(7)
    ds_read_b64_tr_b16 v[14:15], v247 offset:10240
    v_mfma_f32_16x16x32_bf16 v[140:143], v[212:215], v[28:31], v[140:143]
    s_waitcnt lgkmcnt(6)
    ds_read_b64_tr_b16 v[16:17], v247 offset:12288
    v_mfma_f32_16x16x32_bf16 v[140:143], v[216:219], v[32:35], v[140:143]
    ds_read_b64_tr_b16 v[18:19], v247 offset:14336
    v_mfma_f32_16x16x32_bf16 v[156:159], v[204:207], v[84:87], v[156:159]
    ds_read_b64_tr_b16 v[204:205], v244 offset:0
    v_mfma_f32_16x16x32_bf16 v[156:159], v[208:211], v[88:91], v[156:159]
    ds_read_b64_tr_b16 v[206:207], v244 offset:2048
    v_mfma_f32_16x16x32_bf16 v[156:159], v[212:215], v[92:95], v[156:159]
    ds_read_b64_tr_b16 v[208:209], v244 offset:4096
    v_mfma_f32_16x16x32_bf16 v[156:159], v[216:219], v[96:99], v[156:159]
    s_waitcnt lgkmcnt(7)
    ds_read_b64_tr_b16 v[210:211], v244 offset:6144
    v_add_u32 v247, 16384, v247
    v_mfma_f32_16x16x32_bf16 v[144:147], v[4:7], v[20:23], v[144:147]
    ds_read_b64_tr_b16 v[212:213], v244 offset:8192
    v_mfma_f32_16x16x32_bf16 v[144:147], v[8:11], v[24:27], v[144:147]
    s_waitcnt lgkmcnt(7)
    ds_read_b64_tr_b16 v[214:215], v244 offset:10240
    v_mfma_f32_16x16x32_bf16 v[144:147], v[12:15], v[28:31], v[144:147]
    s_waitcnt lgkmcnt(6)
    ds_read_b64_tr_b16 v[216:217], v244 offset:12288
    v_mfma_f32_16x16x32_bf16 v[144:147], v[16:19], v[32:35], v[144:147]
    ds_read_b64_tr_b16 v[218:219], v244 offset:14336
    v_mfma_f32_16x16x32_bf16 v[160:163], v[4:7], v[84:87], v[160:163]
    ds_read_b64_tr_b16 v[4:5], v245 offset:0
    v_mfma_f32_16x16x32_bf16 v[160:163], v[8:11], v[88:91], v[160:163]
    ds_read_b64_tr_b16 v[6:7], v245 offset:2048
    v_mfma_f32_16x16x32_bf16 v[160:163], v[12:15], v[92:95], v[160:163]
    ds_read_b64_tr_b16 v[8:9], v245 offset:4096
    v_mfma_f32_16x16x32_bf16 v[160:163], v[16:19], v[96:99], v[160:163]
    ds_read_b64_tr_b16 v[10:11], v245 offset:6144
    s_barrier
    s_waitcnt lgkmcnt(8)
    v_mfma_f32_16x16x32_bf16 v[164:167], v[204:207], v[220:223], v[164:167]
    ds_read_b128 v[220:223], v3 offset:11264
    v_mfma_f32_16x16x32_bf16 v[164:167], v[208:211], v[240:243], v[164:167]
    s_waitcnt lgkmcnt(7)
    ds_read_b64_tr_b16 v[12:13], v245 offset:8192
    v_mfma_f32_16x16x32_bf16 v[164:167], v[212:215], v[252:255], v[164:167]
    ds_read_b64_tr_b16 v[14:15], v245 offset:10240
    v_mfma_f32_16x16x32_bf16 v[132:135], v[204:207], v[36:39], v[132:135]
    ds_read_b64_tr_b16 v[16:17], v245 offset:12288
    v_mfma_f32_16x16x32_bf16 v[132:135], v[208:211], v[40:43], v[132:135]
    ds_read_b64_tr_b16 v[18:19], v245 offset:14336
    v_mfma_f32_16x16x32_bf16 v[132:135], v[212:215], v[44:47], v[132:135]
    s_waitcnt lgkmcnt(7)
    ds_read_b128 v[240:243], v3 offset:13312
    v_mfma_f32_16x16x32_bf16 v[132:135], v[216:219], v[48:51], v[132:135]
    ds_read_b128 v[252:255], v3 offset:14336
    v_mfma_f32_16x16x32_bf16 v[148:151], v[204:207], v[100:103], v[148:151]
    ds_read_b64_tr_b16 v[204:205], v246 offset:0
    v_mfma_f32_16x16x32_bf16 v[148:151], v[208:211], v[104:107], v[148:151]
    ds_read_b64_tr_b16 v[206:207], v246 offset:2048
    v_mfma_f32_16x16x32_bf16 v[148:151], v[212:215], v[108:111], v[148:151]
    ds_read_b64_tr_b16 v[208:209], v246 offset:4096
    v_mfma_f32_16x16x32_bf16 v[148:151], v[216:219], v[112:115], v[148:151]
    s_waitcnt lgkmcnt(8)
    ds_read_b64_tr_b16 v[210:211], v246 offset:6144
    v_mfma_f32_16x16x32_bf16 v[164:167], v[216:219], v[220:223], v[164:167]
    ds_read_b64_tr_b16 v[212:213], v246 offset:8192
    v_add_u32 v244, 16384, v244
    v_mfma_f32_16x16x32_bf16 v[136:139], v[4:7], v[36:39], v[136:139]
    ds_read_b64_tr_b16 v[214:215], v246 offset:10240
    v_mfma_f32_16x16x32_bf16 v[136:139], v[8:11], v[40:43], v[136:139]
    s_waitcnt lgkmcnt(7)
    ds_read_b64_tr_b16 v[216:217], v246 offset:12288
    v_mfma_f32_16x16x32_bf16 v[136:139], v[12:15], v[44:47], v[136:139]
    ds_read_b64_tr_b16 v[218:219], v246 offset:14336
    v_mfma_f32_16x16x32_bf16 v[136:139], v[16:19], v[48:51], v[136:139]
    ds_read_b128 v[220:223], v3 offset:12288
    v_add_u32 v245, 16384, v245
    v_mfma_f32_16x16x32_bf16 v[152:155], v[4:7], v[100:103], v[152:155]
    ds_read_b64_tr_b16 v[4:5], v247 offset:0
    v_mfma_f32_16x16x32_bf16 v[152:155], v[8:11], v[104:107], v[152:155]
    ds_read_b64_tr_b16 v[6:7], v247 offset:2048
    v_mfma_f32_16x16x32_bf16 v[152:155], v[12:15], v[108:111], v[152:155]
    ds_read_b64_tr_b16 v[8:9], v247 offset:4096
    s_waitcnt vmcnt(0)
    buffer_store_dword v2, v251, s[28:31], s56 offen offset:12 sc1
    v_mfma_f32_16x16x32_bf16 v[152:155], v[16:19], v[112:115], v[152:155]
    s_waitcnt lgkmcnt(6)
    ds_read_b64_tr_b16 v[10:11], v247 offset:6144
    v_add_u32 v246, 16384, v246
    v_mfma_f32_16x16x32_bf16 v[140:143], v[204:207], v[36:39], v[140:143]
    ds_read_b64_tr_b16 v[12:13], v247 offset:8192
    v_mfma_f32_16x16x32_bf16 v[140:143], v[208:211], v[40:43], v[140:143]
    ds_read_b64_tr_b16 v[14:15], v247 offset:10240
    v_mfma_f32_16x16x32_bf16 v[140:143], v[212:215], v[44:47], v[140:143]
    s_waitcnt lgkmcnt(6)
    ds_read_b64_tr_b16 v[16:17], v247 offset:12288
    v_mfma_f32_16x16x32_bf16 v[140:143], v[216:219], v[48:51], v[140:143]
    ds_read_b64_tr_b16 v[18:19], v247 offset:14336
    v_mfma_f32_16x16x32_bf16 v[156:159], v[204:207], v[100:103], v[156:159]
    ds_read_b64_tr_b16 v[204:205], v244 offset:0
    v_mfma_f32_16x16x32_bf16 v[156:159], v[208:211], v[104:107], v[156:159]
    ds_read_b64_tr_b16 v[206:207], v244 offset:2048
    v_mfma_f32_16x16x32_bf16 v[156:159], v[212:215], v[108:111], v[156:159]
    ds_read_b64_tr_b16 v[208:209], v244 offset:4096
    v_mfma_f32_16x16x32_bf16 v[156:159], v[216:219], v[112:115], v[156:159]
    s_waitcnt lgkmcnt(7)
    ds_read_b64_tr_b16 v[210:211], v244 offset:6144
    v_add_u32 v247, 16384, v247
    v_mfma_f32_16x16x32_bf16 v[144:147], v[4:7], v[36:39], v[144:147]
    ds_read_b64_tr_b16 v[212:213], v244 offset:8192
    v_mfma_f32_16x16x32_bf16 v[144:147], v[8:11], v[40:43], v[144:147]
    s_waitcnt lgkmcnt(7)
    ds_read_b64_tr_b16 v[214:215], v244 offset:10240
    v_mfma_f32_16x16x32_bf16 v[144:147], v[12:15], v[44:47], v[144:147]
    s_waitcnt lgkmcnt(6)
    ds_read_b64_tr_b16 v[216:217], v244 offset:12288
    v_mfma_f32_16x16x32_bf16 v[144:147], v[16:19], v[48:51], v[144:147]
    ds_read_b64_tr_b16 v[218:219], v244 offset:14336
    v_mfma_f32_16x16x32_bf16 v[160:163], v[4:7], v[100:103], v[160:163]
    ds_read_b64_tr_b16 v[4:5], v245 offset:0
    v_mfma_f32_16x16x32_bf16 v[160:163], v[8:11], v[104:107], v[160:163]
    ds_read_b64_tr_b16 v[6:7], v245 offset:2048
    v_mfma_f32_16x16x32_bf16 v[160:163], v[12:15], v[108:111], v[160:163]
    ds_read_b64_tr_b16 v[8:9], v245 offset:4096
    v_mfma_f32_16x16x32_bf16 v[160:163], v[16:19], v[112:115], v[160:163]
    ds_read_b64_tr_b16 v[10:11], v245 offset:6144
    s_barrier
    s_waitcnt lgkmcnt(8)
    v_mfma_f32_16x16x32_bf16 v[164:167], v[204:207], v[220:223], v[164:167]
    ds_read_b128 v[220:223], v3 offset:15360
    v_mfma_f32_16x16x32_bf16 v[164:167], v[208:211], v[240:243], v[164:167]
    s_waitcnt lgkmcnt(7)
    ds_read_b64_tr_b16 v[12:13], v245 offset:8192
    v_mfma_f32_16x16x32_bf16 v[164:167], v[212:215], v[252:255], v[164:167]
    ds_read_b64_tr_b16 v[14:15], v245 offset:10240
    v_mfma_f32_16x16x32_bf16 v[132:135], v[204:207], v[52:55], v[132:135]
    ds_read_b64_tr_b16 v[16:17], v245 offset:12288
    v_mfma_f32_16x16x32_bf16 v[132:135], v[208:211], v[56:59], v[132:135]
    ds_read_b64_tr_b16 v[18:19], v245 offset:14336
    v_mfma_f32_16x16x32_bf16 v[132:135], v[212:215], v[60:63], v[132:135]
    s_waitcnt lgkmcnt(7)
    ds_read_b128 v[240:243], v3 offset:1024
    v_mfma_f32_16x16x32_bf16 v[132:135], v[216:219], v[64:67], v[132:135]
    ds_read_b128 v[252:255], v3 offset:2048
    v_mfma_f32_16x16x32_bf16 v[148:151], v[204:207], v[116:119], v[148:151]
    ds_read_b64_tr_b16 v[204:205], v246 offset:0
    v_mfma_f32_16x16x32_bf16 v[148:151], v[208:211], v[120:123], v[148:151]
    ds_read_b64_tr_b16 v[206:207], v246 offset:2048
    v_mfma_f32_16x16x32_bf16 v[148:151], v[212:215], v[124:127], v[148:151]
    ds_read_b64_tr_b16 v[208:209], v246 offset:4096
    v_mfma_f32_16x16x32_bf16 v[148:151], v[216:219], v[128:131], v[148:151]
    s_waitcnt lgkmcnt(8)
    ds_read_b64_tr_b16 v[210:211], v246 offset:6144
    v_mfma_f32_16x16x32_bf16 v[164:167], v[216:219], v[220:223], v[164:167]
    ds_read_b64_tr_b16 v[212:213], v246 offset:8192
    v_add_u32 v244, 4294885376, v244
    v_mfma_f32_16x16x32_bf16 v[136:139], v[4:7], v[52:55], v[136:139]
    ds_read_b64_tr_b16 v[214:215], v246 offset:10240
    v_mfma_f32_16x16x32_bf16 v[136:139], v[8:11], v[56:59], v[136:139]
    s_waitcnt lgkmcnt(7)
    ds_read_b64_tr_b16 v[216:217], v246 offset:12288
    v_mfma_f32_16x16x32_bf16 v[136:139], v[12:15], v[60:63], v[136:139]
    ds_read_b64_tr_b16 v[218:219], v246 offset:14336
    v_mfma_f32_16x16x32_bf16 v[136:139], v[16:19], v[64:67], v[136:139]
    ds_read_b128 v[220:223], v3 offset:0
    v_add_u32 v245, 4294885376, v245
    v_mfma_f32_16x16x32_bf16 v[152:155], v[4:7], v[116:119], v[152:155]
    ds_read_b64_tr_b16 v[4:5], v247 offset:0
    v_mfma_f32_16x16x32_bf16 v[152:155], v[8:11], v[120:123], v[152:155]
    ds_read_b64_tr_b16 v[6:7], v247 offset:2048
    v_mfma_f32_16x16x32_bf16 v[152:155], v[12:15], v[124:127], v[152:155]
    ds_read_b64_tr_b16 v[8:9], v247 offset:4096
    v_mfma_f32_16x16x32_bf16 v[152:155], v[16:19], v[128:131], v[152:155]
    s_waitcnt lgkmcnt(7)
    ds_read_b64_tr_b16 v[10:11], v247 offset:6144
    v_add_u32 v246, 4294885376, v246
    v_mfma_f32_16x16x32_bf16 v[140:143], v[204:207], v[52:55], v[140:143]
    ds_read_b64_tr_b16 v[12:13], v247 offset:8192
    v_mfma_f32_16x16x32_bf16 v[140:143], v[208:211], v[56:59], v[140:143]
    s_waitcnt lgkmcnt(7)
    ds_read_b64_tr_b16 v[14:15], v247 offset:10240
    v_mfma_f32_16x16x32_bf16 v[140:143], v[212:215], v[60:63], v[140:143]
    s_waitcnt lgkmcnt(6)
    ds_read_b64_tr_b16 v[16:17], v247 offset:12288
    v_mfma_f32_16x16x32_bf16 v[140:143], v[216:219], v[64:67], v[140:143]
    ds_read_b64_tr_b16 v[18:19], v247 offset:14336
    v_mfma_f32_16x16x32_bf16 v[156:159], v[204:207], v[116:119], v[156:159]
    ds_read_b64_tr_b16 v[204:205], v244 offset:0
    s_bfe_u32 s62, s100, 262160
    v_mfma_f32_16x16x32_bf16 v[156:159], v[208:211], v[120:123], v[156:159]
    ds_read_b64_tr_b16 v[206:207], v244 offset:2048
    s_add_u32 s62, s62, s101
    v_mfma_f32_16x16x32_bf16 v[156:159], v[212:215], v[124:127], v[156:159]
    ds_read_b64_tr_b16 v[208:209], v244 offset:4096
    s_and_b32 s62, s62, 7
    v_mfma_f32_16x16x32_bf16 v[156:159], v[216:219], v[128:131], v[156:159]
    s_waitcnt lgkmcnt(5)
    ds_read_b64_tr_b16 v[210:211], v244 offset:6144
    v_add_u32 v247, 4294885376, v247
    v_mfma_f32_16x16x32_bf16 v[144:147], v[4:7], v[52:55], v[144:147]
    ds_read_b64_tr_b16 v[212:213], v244 offset:8192
    s_add_u32 s62, s62, s57
    v_mfma_f32_16x16x32_bf16 v[144:147], v[8:11], v[56:59], v[144:147]
    ds_read_b64_tr_b16 v[214:215], v244 offset:10240
    s_mul_i32 s60, s62, 129024
    v_mfma_f32_16x16x32_bf16 v[144:147], v[12:15], v[60:63], v[144:147]
    s_waitcnt lgkmcnt(5)
    ds_read_b64_tr_b16 v[216:217], v244 offset:12288
    v_mfma_f32_16x16x32_bf16 v[144:147], v[16:19], v[64:67], v[144:147]
    ds_read_b64_tr_b16 v[218:219], v244 offset:14336
    s_add_u32 s60, s60, 8462336
    v_mfma_f32_16x16x32_bf16 v[160:163], v[4:7], v[116:119], v[160:163]
    ds_read_b64_tr_b16 v[4:5], v245 offset:0
    s_lshl_b32 s62, s62, 7
    v_mfma_f32_16x16x32_bf16 v[160:163], v[8:11], v[120:123], v[160:163]
    ds_read_b64_tr_b16 v[6:7], v245 offset:2048
    v_mfma_f32_16x16x32_bf16 v[160:163], v[12:15], v[124:127], v[160:163]
    ds_read_b64_tr_b16 v[8:9], v245 offset:4096
    v_mfma_f32_16x16x32_bf16 v[160:163], v[16:19], v[128:131], v[160:163]
    ds_read_b64_tr_b16 v[10:11], v245 offset:6144
    s_barrier
    s_waitcnt lgkmcnt(7)
    v_mfma_f32_16x16x32_bf16 v[200:203], v[204:207], v[220:223], 0
    ds_read_b128 v[220:223], v3 offset:3072
    v_mfma_f32_16x16x32_bf16 v[200:203], v[208:211], v[240:243], v[200:203]
    s_waitcnt lgkmcnt(6)
    ds_read_b64_tr_b16 v[12:13], v245 offset:8192
    v_mfma_f32_16x16x32_bf16 v[200:203], v[212:215], v[252:255], v[200:203]
    ds_read_b64_tr_b16 v[14:15], v245 offset:10240
    v_mfma_f32_16x16x32_bf16 v[168:171], v[204:207], v[224:227], 0
    ds_read_b64_tr_b16 v[16:17], v245 offset:12288
    v_cvt_pk_bf16_f32 v132, v132, v133
    v_mfma_f32_16x16x32_bf16 v[168:171], v[208:211], v[228:231], v[168:171]
    ds_read_b64_tr_b16 v[18:19], v245 offset:14336
    v_cvt_pk_bf16_f32 v133, v134, v135
    v_mfma_f32_16x16x32_bf16 v[168:171], v[212:215], v[232:235], v[168:171]
    s_waitcnt lgkmcnt(5)
    ds_read_b128 v[240:243], v3 offset:5120
    v_cvt_pk_bf16_f32 v134, v136, v137
    v_mfma_f32_16x16x32_bf16 v[168:171], v[216:219], v[236:239], v[168:171]
    ds_read_b128 v[252:255], v3 offset:6144
    v_cvt_pk_bf16_f32 v135, v138, v139
    v_mfma_f32_16x16x32_bf16 v[184:187], v[204:207], v[68:71], 0
    ds_read_b64_tr_b16 v[204:205], v246 offset:0
    v_cvt_pk_bf16_f32 v148, v148, v149
    v_mfma_f32_16x16x32_bf16 v[184:187], v[208:211], v[72:75], v[184:187]
    ds_read_b64_tr_b16 v[206:207], v246 offset:2048
    v_cvt_pk_bf16_f32 v149, v150, v151
    v_mfma_f32_16x16x32_bf16 v[184:187], v[212:215], v[76:79], v[184:187]
    ds_read_b64_tr_b16 v[208:209], v246 offset:4096
    v_cvt_pk_bf16_f32 v150, v152, v153
    v_mfma_f32_16x16x32_bf16 v[184:187], v[216:219], v[80:83], v[184:187]
    s_waitcnt lgkmcnt(5)
    ds_read_b64_tr_b16 v[210:211], v246 offset:6144
    v_cvt_pk_bf16_f32 v151, v154, v155
    v_mfma_f32_16x16x32_bf16 v[200:203], v[216:219], v[220:223], v[200:203]
    ds_read_b64_tr_b16 v[212:213], v246 offset:8192
    v_add_u32 v244, 16384, v244
    v_mfma_f32_16x16x32_bf16 v[172:175], v[4:7], v[224:227], 0
    ds_read_b64_tr_b16 v[214:215], v246 offset:10240
    v_cvt_pk_bf16_f32 v140, v140, v141
    v_mfma_f32_16x16x32_bf16 v[172:175], v[8:11], v[228:231], v[172:175]
    ds_read_b64_tr_b16 v[216:217], v246 offset:12288
    v_cvt_pk_bf16_f32 v141, v142, v143
    v_mfma_f32_16x16x32_bf16 v[172:175], v[12:15], v[232:235], v[172:175]
    ds_read_b64_tr_b16 v[218:219], v246 offset:14336
    v_cvt_pk_bf16_f32 v142, v144, v145
    v_mfma_f32_16x16x32_bf16 v[172:175], v[16:19], v[236:239], v[172:175]
    ds_read_b128 v[220:223], v3 offset:4096
    v_add_u32 v245, 16384, v245
    v_mfma_f32_16x16x32_bf16 v[188:191], v[4:7], v[68:71], 0
    ds_read_b64_tr_b16 v[4:5], v247 offset:0
    v_cvt_pk_bf16_f32 v143, v146, v147
    v_mfma_f32_16x16x32_bf16 v[188:191], v[8:11], v[72:75], v[188:191]
    ds_read_b64_tr_b16 v[6:7], v247 offset:2048
    v_cvt_pk_bf16_f32 v156, v156, v157
    v_mfma_f32_16x16x32_bf16 v[188:191], v[12:15], v[76:79], v[188:191]
    ds_read_b64_tr_b16 v[8:9], v247 offset:4096
    v_cvt_pk_bf16_f32 v157, v158, v159
    v_mfma_f32_16x16x32_bf16 v[188:191], v[16:19], v[80:83], v[188:191]
    s_waitcnt lgkmcnt(5)
    ds_read_b64_tr_b16 v[10:11], v247 offset:6144
    v_add_u32 v246, 16384, v246
    v_mfma_f32_16x16x32_bf16 v[176:179], v[204:207], v[224:227], 0
    ds_read_b64_tr_b16 v[12:13], v247 offset:8192
    v_cvt_pk_bf16_f32 v158, v160, v161
    v_mfma_f32_16x16x32_bf16 v[176:179], v[208:211], v[228:231], v[176:179]
    ds_read_b64_tr_b16 v[14:15], v247 offset:10240
    v_cvt_pk_bf16_f32 v159, v162, v163
    v_mfma_f32_16x16x32_bf16 v[176:179], v[212:215], v[232:235], v[176:179]
    ds_read_b64_tr_b16 v[16:17], v247 offset:12288
    v_cvt_pk_bf16_f32 v164, v164, v165
    buffer_store_dwordx4 v[132:135], v249, s[28:31], s60 offen offset:0 sc1
    s_waitcnt lgkmcnt(5)
    v_mfma_f32_16x16x32_bf16 v[176:179], v[216:219], v[236:239], v[176:179]
    ds_read_b64_tr_b16 v[18:19], v247 offset:14336
    v_cvt_pk_bf16_f32 v165, v166, v167
    v_mfma_f32_16x16x32_bf16 v[192:195], v[204:207], v[68:71], 0
    ds_read_b64_tr_b16 v[204:205], v244 offset:0
    v_mfma_f32_16x16x32_bf16 v[192:195], v[208:211], v[72:75], v[192:195]
    ds_read_b64_tr_b16 v[206:207], v244 offset:2048
    buffer_store_dwordx4 v[148:151], v249, s[28:31], s60 offen offset:2048 sc1
    v_mfma_f32_16x16x32_bf16 v[192:195], v[212:215], v[76:79], v[192:195]
    ds_read_b64_tr_b16 v[208:209], v244 offset:4096
    v_mfma_f32_16x16x32_bf16 v[192:195], v[216:219], v[80:83], v[192:195]
    ds_read_b64_tr_b16 v[210:211], v244 offset:6144
    v_add_u32 v247, 16384, v247
    v_mfma_f32_16x16x32_bf16 v[180:183], v[4:7], v[224:227], 0
    ds_read_b64_tr_b16 v[212:213], v244 offset:8192
    buffer_store_dwordx4 v[140:143], v249, s[28:31], s60 offen offset:1024 sc1
    s_waitcnt lgkmcnt(6)
    v_mfma_f32_16x16x32_bf16 v[180:183], v[8:11], v[228:231], v[180:183]
    ds_read_b64_tr_b16 v[214:215], v244 offset:10240
    v_mfma_f32_16x16x32_bf16 v[180:183], v[12:15], v[232:235], v[180:183]
    s_waitcnt lgkmcnt(6)
    ds_read_b64_tr_b16 v[216:217], v244 offset:12288
    v_mfma_f32_16x16x32_bf16 v[180:183], v[16:19], v[236:239], v[180:183]
    ds_read_b64_tr_b16 v[218:219], v244 offset:14336
    buffer_store_dwordx4 v[156:159], v249, s[28:31], s60 offen offset:3072 sc1
    v_mfma_f32_16x16x32_bf16 v[196:199], v[4:7], v[68:71], 0
    ds_read_b64_tr_b16 v[4:5], v245 offset:0
    v_mfma_f32_16x16x32_bf16 v[196:199], v[8:11], v[72:75], v[196:199]
    ds_read_b64_tr_b16 v[6:7], v245 offset:2048
    v_mfma_f32_16x16x32_bf16 v[196:199], v[12:15], v[76:79], v[196:199]
    ds_read_b64_tr_b16 v[8:9], v245 offset:4096
    buffer_store_dwordx2 v[164:165], v250, s[28:31], s60 offen sc1
    v_mfma_f32_16x16x32_bf16 v[196:199], v[16:19], v[80:83], v[196:199]
    ds_read_b64_tr_b16 v[10:11], v245 offset:6144
    s_barrier
    s_waitcnt lgkmcnt(7)
    v_mfma_f32_16x16x32_bf16 v[200:203], v[204:207], v[220:223], v[200:203]
    ds_read_b128 v[220:223], v3 offset:7168
    v_mfma_f32_16x16x32_bf16 v[200:203], v[208:211], v[240:243], v[200:203]
    s_waitcnt lgkmcnt(6)
    ds_read_b64_tr_b16 v[12:13], v245 offset:8192
    v_mfma_f32_16x16x32_bf16 v[200:203], v[212:215], v[252:255], v[200:203]
    ds_read_b64_tr_b16 v[14:15], v245 offset:10240
    v_mfma_f32_16x16x32_bf16 v[168:171], v[204:207], v[20:23], v[168:171]
    ds_read_b64_tr_b16 v[16:17], v245 offset:12288
    v_mfma_f32_16x16x32_bf16 v[168:171], v[208:211], v[24:27], v[168:171]
    ds_read_b64_tr_b16 v[18:19], v245 offset:14336
    v_mfma_f32_16x16x32_bf16 v[168:171], v[212:215], v[28:31], v[168:171]
    s_waitcnt lgkmcnt(6)
    ds_read_b128 v[240:243], v3 offset:9216
    v_mfma_f32_16x16x32_bf16 v[168:171], v[216:219], v[32:35], v[168:171]
    ds_read_b128 v[252:255], v3 offset:10240
    v_mfma_f32_16x16x32_bf16 v[184:187], v[204:207], v[84:87], v[184:187]
    ds_read_b64_tr_b16 v[204:205], v246 offset:0
    v_mfma_f32_16x16x32_bf16 v[184:187], v[208:211], v[88:91], v[184:187]
    ds_read_b64_tr_b16 v[206:207], v246 offset:2048
    v_mfma_f32_16x16x32_bf16 v[184:187], v[212:215], v[92:95], v[184:187]
    ds_read_b64_tr_b16 v[208:209], v246 offset:4096
    v_mfma_f32_16x16x32_bf16 v[184:187], v[216:219], v[96:99], v[184:187]
    s_waitcnt lgkmcnt(8)
    ds_read_b64_tr_b16 v[210:211], v246 offset:6144
    v_mfma_f32_16x16x32_bf16 v[200:203], v[216:219], v[220:223], v[200:203]
    ds_read_b64_tr_b16 v[212:213], v246 offset:8192
    v_add_u32 v244, 16384, v244
    v_mfma_f32_16x16x32_bf16 v[172:175], v[4:7], v[20:23], v[172:175]
    ds_read_b64_tr_b16 v[214:215], v246 offset:10240
    v_mfma_f32_16x16x32_bf16 v[172:175], v[8:11], v[24:27], v[172:175]
    s_waitcnt lgkmcnt(7)
    ds_read_b64_tr_b16 v[216:217], v246 offset:12288
    v_mfma_f32_16x16x32_bf16 v[172:175], v[12:15], v[28:31], v[172:175]
    ds_read_b64_tr_b16 v[218:219], v246 offset:14336
    v_mfma_f32_16x16x32_bf16 v[172:175], v[16:19], v[32:35], v[172:175]
    ds_read_b128 v[220:223], v3 offset:8192
    v_add_u32 v245, 16384, v245
    v_mfma_f32_16x16x32_bf16 v[188:191], v[4:7], v[84:87], v[188:191]
    ds_read_b64_tr_b16 v[4:5], v247 offset:0
    v_mfma_f32_16x16x32_bf16 v[188:191], v[8:11], v[88:91], v[188:191]
    ds_read_b64_tr_b16 v[6:7], v247 offset:2048
    v_mfma_f32_16x16x32_bf16 v[188:191], v[12:15], v[92:95], v[188:191]
    ds_read_b64_tr_b16 v[8:9], v247 offset:4096
    v_mfma_f32_16x16x32_bf16 v[188:191], v[16:19], v[96:99], v[188:191]
    s_waitcnt lgkmcnt(7)
    ds_read_b64_tr_b16 v[10:11], v247 offset:6144
    v_add_u32 v246, 16384, v246
    v_mfma_f32_16x16x32_bf16 v[176:179], v[204:207], v[20:23], v[176:179]
    ds_read_b64_tr_b16 v[12:13], v247 offset:8192
    v_mfma_f32_16x16x32_bf16 v[176:179], v[208:211], v[24:27], v[176:179]
    s_waitcnt lgkmcnt(7)
    ds_read_b64_tr_b16 v[14:15], v247 offset:10240
    v_mfma_f32_16x16x32_bf16 v[176:179], v[212:215], v[28:31], v[176:179]
    s_waitcnt lgkmcnt(6)
    ds_read_b64_tr_b16 v[16:17], v247 offset:12288
    v_mfma_f32_16x16x32_bf16 v[176:179], v[216:219], v[32:35], v[176:179]
    ds_read_b64_tr_b16 v[18:19], v247 offset:14336
    v_mfma_f32_16x16x32_bf16 v[192:195], v[204:207], v[84:87], v[192:195]
    ds_read_b64_tr_b16 v[204:205], v244 offset:0
    v_mfma_f32_16x16x32_bf16 v[192:195], v[208:211], v[88:91], v[192:195]
    ds_read_b64_tr_b16 v[206:207], v244 offset:2048
    v_mfma_f32_16x16x32_bf16 v[192:195], v[212:215], v[92:95], v[192:195]
    ds_read_b64_tr_b16 v[208:209], v244 offset:4096
    v_mfma_f32_16x16x32_bf16 v[192:195], v[216:219], v[96:99], v[192:195]
    s_waitcnt lgkmcnt(7)
    ds_read_b64_tr_b16 v[210:211], v244 offset:6144
    v_add_u32 v247, 16384, v247
    v_mfma_f32_16x16x32_bf16 v[180:183], v[4:7], v[20:23], v[180:183]
    ds_read_b64_tr_b16 v[212:213], v244 offset:8192
    v_mfma_f32_16x16x32_bf16 v[180:183], v[8:11], v[24:27], v[180:183]
    s_waitcnt lgkmcnt(7)
    ds_read_b64_tr_b16 v[214:215], v244 offset:10240
    v_mfma_f32_16x16x32_bf16 v[180:183], v[12:15], v[28:31], v[180:183]
    s_waitcnt lgkmcnt(6)
    ds_read_b64_tr_b16 v[216:217], v244 offset:12288
    v_mfma_f32_16x16x32_bf16 v[180:183], v[16:19], v[32:35], v[180:183]
    ds_read_b64_tr_b16 v[218:219], v244 offset:14336
    v_mfma_f32_16x16x32_bf16 v[196:199], v[4:7], v[84:87], v[196:199]
    ds_read_b64_tr_b16 v[4:5], v245 offset:0
    v_mfma_f32_16x16x32_bf16 v[196:199], v[8:11], v[88:91], v[196:199]
    ds_read_b64_tr_b16 v[6:7], v245 offset:2048
    v_mfma_f32_16x16x32_bf16 v[196:199], v[12:15], v[92:95], v[196:199]
    ds_read_b64_tr_b16 v[8:9], v245 offset:4096
    v_mfma_f32_16x16x32_bf16 v[196:199], v[16:19], v[96:99], v[196:199]
    ds_read_b64_tr_b16 v[10:11], v245 offset:6144
    s_barrier
    s_waitcnt lgkmcnt(8)
    v_mfma_f32_16x16x32_bf16 v[200:203], v[204:207], v[220:223], v[200:203]
    ds_read_b128 v[220:223], v3 offset:11264
    v_mfma_f32_16x16x32_bf16 v[200:203], v[208:211], v[240:243], v[200:203]
    s_waitcnt lgkmcnt(7)
    ds_read_b64_tr_b16 v[12:13], v245 offset:8192
    v_mfma_f32_16x16x32_bf16 v[200:203], v[212:215], v[252:255], v[200:203]
    ds_read_b64_tr_b16 v[14:15], v245 offset:10240
    v_mfma_f32_16x16x32_bf16 v[168:171], v[204:207], v[36:39], v[168:171]
    ds_read_b64_tr_b16 v[16:17], v245 offset:12288
    v_mfma_f32_16x16x32_bf16 v[168:171], v[208:211], v[40:43], v[168:171]
    ds_read_b64_tr_b16 v[18:19], v245 offset:14336
    v_mfma_f32_16x16x32_bf16 v[168:171], v[212:215], v[44:47], v[168:171]
    s_waitcnt lgkmcnt(7)
    ds_read_b128 v[240:243], v3 offset:13312
    v_mfma_f32_16x16x32_bf16 v[168:171], v[216:219], v[48:51], v[168:171]
    ds_read_b128 v[252:255], v3 offset:14336
    v_mfma_f32_16x16x32_bf16 v[184:187], v[204:207], v[100:103], v[184:187]
    ds_read_b64_tr_b16 v[204:205], v246 offset:0
    v_mfma_f32_16x16x32_bf16 v[184:187], v[208:211], v[104:107], v[184:187]
    ds_read_b64_tr_b16 v[206:207], v246 offset:2048
    v_mfma_f32_16x16x32_bf16 v[184:187], v[212:215], v[108:111], v[184:187]
    ds_read_b64_tr_b16 v[208:209], v246 offset:4096
    v_mfma_f32_16x16x32_bf16 v[184:187], v[216:219], v[112:115], v[184:187]
    s_waitcnt lgkmcnt(8)
    ds_read_b64_tr_b16 v[210:211], v246 offset:6144
    v_mfma_f32_16x16x32_bf16 v[200:203], v[216:219], v[220:223], v[200:203]
    ds_read_b64_tr_b16 v[212:213], v246 offset:8192
    v_add_u32 v244, 16384, v244
    v_mfma_f32_16x16x32_bf16 v[172:175], v[4:7], v[36:39], v[172:175]
    ds_read_b64_tr_b16 v[214:215], v246 offset:10240
    v_mfma_f32_16x16x32_bf16 v[172:175], v[8:11], v[40:43], v[172:175]
    s_waitcnt lgkmcnt(7)
    ds_read_b64_tr_b16 v[216:217], v246 offset:12288
    v_mfma_f32_16x16x32_bf16 v[172:175], v[12:15], v[44:47], v[172:175]
    ds_read_b64_tr_b16 v[218:219], v246 offset:14336
    v_mfma_f32_16x16x32_bf16 v[172:175], v[16:19], v[48:51], v[172:175]
    ds_read_b128 v[220:223], v3 offset:12288
    v_add_u32 v245, 16384, v245
    v_mfma_f32_16x16x32_bf16 v[188:191], v[4:7], v[100:103], v[188:191]
    ds_read_b64_tr_b16 v[4:5], v247 offset:0
    v_mfma_f32_16x16x32_bf16 v[188:191], v[8:11], v[104:107], v[188:191]
    ds_read_b64_tr_b16 v[6:7], v247 offset:2048
    v_mfma_f32_16x16x32_bf16 v[188:191], v[12:15], v[108:111], v[188:191]
    ds_read_b64_tr_b16 v[8:9], v247 offset:4096
    s_waitcnt vmcnt(0)
    buffer_store_dword v2, v251, s[28:31], s62 offen offset:16 sc1
    v_mfma_f32_16x16x32_bf16 v[188:191], v[16:19], v[112:115], v[188:191]
    s_waitcnt lgkmcnt(6)
    ds_read_b64_tr_b16 v[10:11], v247 offset:6144
    v_add_u32 v246, 16384, v246
    v_mfma_f32_16x16x32_bf16 v[176:179], v[204:207], v[36:39], v[176:179]
    ds_read_b64_tr_b16 v[12:13], v247 offset:8192
    v_mfma_f32_16x16x32_bf16 v[176:179], v[208:211], v[40:43], v[176:179]
    ds_read_b64_tr_b16 v[14:15], v247 offset:10240
    v_mfma_f32_16x16x32_bf16 v[176:179], v[212:215], v[44:47], v[176:179]
    s_waitcnt lgkmcnt(6)
    ds_read_b64_tr_b16 v[16:17], v247 offset:12288
    v_mfma_f32_16x16x32_bf16 v[176:179], v[216:219], v[48:51], v[176:179]
    ds_read_b64_tr_b16 v[18:19], v247 offset:14336
    v_mfma_f32_16x16x32_bf16 v[192:195], v[204:207], v[100:103], v[192:195]
    ds_read_b64_tr_b16 v[204:205], v244 offset:0
    v_mfma_f32_16x16x32_bf16 v[192:195], v[208:211], v[104:107], v[192:195]
    ds_read_b64_tr_b16 v[206:207], v244 offset:2048
    v_mfma_f32_16x16x32_bf16 v[192:195], v[212:215], v[108:111], v[192:195]
    ds_read_b64_tr_b16 v[208:209], v244 offset:4096
    v_mfma_f32_16x16x32_bf16 v[192:195], v[216:219], v[112:115], v[192:195]
    s_waitcnt lgkmcnt(7)
    ds_read_b64_tr_b16 v[210:211], v244 offset:6144
    v_add_u32 v247, 16384, v247
    v_mfma_f32_16x16x32_bf16 v[180:183], v[4:7], v[36:39], v[180:183]
    ds_read_b64_tr_b16 v[212:213], v244 offset:8192
    v_mfma_f32_16x16x32_bf16 v[180:183], v[8:11], v[40:43], v[180:183]
    s_waitcnt lgkmcnt(7)
    ds_read_b64_tr_b16 v[214:215], v244 offset:10240
    v_mfma_f32_16x16x32_bf16 v[180:183], v[12:15], v[44:47], v[180:183]
    s_waitcnt lgkmcnt(6)
    ds_read_b64_tr_b16 v[216:217], v244 offset:12288
    v_mfma_f32_16x16x32_bf16 v[180:183], v[16:19], v[48:51], v[180:183]
    ds_read_b64_tr_b16 v[218:219], v244 offset:14336
    v_mfma_f32_16x16x32_bf16 v[196:199], v[4:7], v[100:103], v[196:199]
    ds_read_b64_tr_b16 v[4:5], v245 offset:0
    v_mfma_f32_16x16x32_bf16 v[196:199], v[8:11], v[104:107], v[196:199]
    ds_read_b64_tr_b16 v[6:7], v245 offset:2048
    v_mfma_f32_16x16x32_bf16 v[196:199], v[12:15], v[108:111], v[196:199]
    ds_read_b64_tr_b16 v[8:9], v245 offset:4096
    v_mfma_f32_16x16x32_bf16 v[196:199], v[16:19], v[112:115], v[196:199]
    ds_read_b64_tr_b16 v[10:11], v245 offset:6144
    s_barrier
    s_waitcnt lgkmcnt(8)
    v_mfma_f32_16x16x32_bf16 v[200:203], v[204:207], v[220:223], v[200:203]
    ds_read_b128 v[220:223], v3 offset:15360
    v_mfma_f32_16x16x32_bf16 v[200:203], v[208:211], v[240:243], v[200:203]
    s_waitcnt lgkmcnt(7)
    ds_read_b64_tr_b16 v[12:13], v245 offset:8192
    v_mfma_f32_16x16x32_bf16 v[200:203], v[212:215], v[252:255], v[200:203]
    ds_read_b64_tr_b16 v[14:15], v245 offset:10240
    v_mfma_f32_16x16x32_bf16 v[168:171], v[204:207], v[52:55], v[168:171]
    ds_read_b64_tr_b16 v[16:17], v245 offset:12288
    v_mfma_f32_16x16x32_bf16 v[168:171], v[208:211], v[56:59], v[168:171]
    ds_read_b64_tr_b16 v[18:19], v245 offset:14336
    v_mfma_f32_16x16x32_bf16 v[168:171], v[212:215], v[60:63], v[168:171]
    s_waitcnt lgkmcnt(7)
    ds_read_b128 v[240:243], v3 offset:1024
    v_mfma_f32_16x16x32_bf16 v[168:171], v[216:219], v[64:67], v[168:171]
    ds_read_b128 v[252:255], v3 offset:2048
    v_mfma_f32_16x16x32_bf16 v[184:187], v[204:207], v[116:119], v[184:187]
    ds_read_b64_tr_b16 v[204:205], v246 offset:0
    v_mfma_f32_16x16x32_bf16 v[184:187], v[208:211], v[120:123], v[184:187]
    ds_read_b64_tr_b16 v[206:207], v246 offset:2048
    v_mfma_f32_16x16x32_bf16 v[184:187], v[212:215], v[124:127], v[184:187]
    ds_read_b64_tr_b16 v[208:209], v246 offset:4096
    v_mfma_f32_16x16x32_bf16 v[184:187], v[216:219], v[128:131], v[184:187]
    s_waitcnt lgkmcnt(8)
    ds_read_b64_tr_b16 v[210:211], v246 offset:6144
    v_mfma_f32_16x16x32_bf16 v[200:203], v[216:219], v[220:223], v[200:203]
    ds_read_b64_tr_b16 v[212:213], v246 offset:8192
    v_add_u32 v244, 16384, v244
    v_mfma_f32_16x16x32_bf16 v[172:175], v[4:7], v[52:55], v[172:175]
    ds_read_b64_tr_b16 v[214:215], v246 offset:10240
    v_mfma_f32_16x16x32_bf16 v[172:175], v[8:11], v[56:59], v[172:175]
    s_waitcnt lgkmcnt(7)
    ds_read_b64_tr_b16 v[216:217], v246 offset:12288
    v_mfma_f32_16x16x32_bf16 v[172:175], v[12:15], v[60:63], v[172:175]
    ds_read_b64_tr_b16 v[218:219], v246 offset:14336
    v_mfma_f32_16x16x32_bf16 v[172:175], v[16:19], v[64:67], v[172:175]
    ds_read_b128 v[220:223], v3 offset:0
    v_add_u32 v245, 16384, v245
    v_mfma_f32_16x16x32_bf16 v[188:191], v[4:7], v[116:119], v[188:191]
    ds_read_b64_tr_b16 v[4:5], v247 offset:0
    v_mfma_f32_16x16x32_bf16 v[188:191], v[8:11], v[120:123], v[188:191]
    ds_read_b64_tr_b16 v[6:7], v247 offset:2048
    v_mfma_f32_16x16x32_bf16 v[188:191], v[12:15], v[124:127], v[188:191]
    ds_read_b64_tr_b16 v[8:9], v247 offset:4096
    v_mfma_f32_16x16x32_bf16 v[188:191], v[16:19], v[128:131], v[188:191]
    s_waitcnt lgkmcnt(7)
    ds_read_b64_tr_b16 v[10:11], v247 offset:6144
    v_add_u32 v246, 16384, v246
    v_mfma_f32_16x16x32_bf16 v[176:179], v[204:207], v[52:55], v[176:179]
    ds_read_b64_tr_b16 v[12:13], v247 offset:8192
    v_mfma_f32_16x16x32_bf16 v[176:179], v[208:211], v[56:59], v[176:179]
    s_waitcnt lgkmcnt(7)
    ds_read_b64_tr_b16 v[14:15], v247 offset:10240
    v_mfma_f32_16x16x32_bf16 v[176:179], v[212:215], v[60:63], v[176:179]
    s_waitcnt lgkmcnt(6)
    ds_read_b64_tr_b16 v[16:17], v247 offset:12288
    v_mfma_f32_16x16x32_bf16 v[176:179], v[216:219], v[64:67], v[176:179]
    ds_read_b64_tr_b16 v[18:19], v247 offset:14336
    v_mfma_f32_16x16x32_bf16 v[192:195], v[204:207], v[116:119], v[192:195]
    ds_read_b64_tr_b16 v[204:205], v244 offset:0
    s_bfe_u32 s56, s100, 262164
    v_mfma_f32_16x16x32_bf16 v[192:195], v[208:211], v[120:123], v[192:195]
    ds_read_b64_tr_b16 v[206:207], v244 offset:2048
    s_add_u32 s56, s56, s101
    v_mfma_f32_16x16x32_bf16 v[192:195], v[212:215], v[124:127], v[192:195]
    ds_read_b64_tr_b16 v[208:209], v244 offset:4096
    s_and_b32 s56, s56, 7
    v_mfma_f32_16x16x32_bf16 v[192:195], v[216:219], v[128:131], v[192:195]
    s_waitcnt lgkmcnt(5)
    ds_read_b64_tr_b16 v[210:211], v244 offset:6144
    v_add_u32 v247, 16384, v247
    v_mfma_f32_16x16x32_bf16 v[180:183], v[4:7], v[52:55], v[180:183]
    ds_read_b64_tr_b16 v[212:213], v244 offset:8192
    s_add_u32 s56, s56, s57
    v_mfma_f32_16x16x32_bf16 v[180:183], v[8:11], v[56:59], v[180:183]
    ds_read_b64_tr_b16 v[214:215], v244 offset:10240
    s_mul_i32 s61, s56, 129024
    v_mfma_f32_16x16x32_bf16 v[180:183], v[12:15], v[60:63], v[180:183]
    s_waitcnt lgkmcnt(5)
    ds_read_b64_tr_b16 v[216:217], v244 offset:12288
    v_mfma_f32_16x16x32_bf16 v[180:183], v[16:19], v[64:67], v[180:183]
    ds_read_b64_tr_b16 v[218:219], v244 offset:14336
    s_add_u32 s61, s61, 8480768
    v_mfma_f32_16x16x32_bf16 v[196:199], v[4:7], v[116:119], v[196:199]
    ds_read_b64_tr_b16 v[4:5], v245 offset:0
    s_lshl_b32 s56, s56, 7
    v_mfma_f32_16x16x32_bf16 v[196:199], v[8:11], v[120:123], v[196:199]
    ds_read_b64_tr_b16 v[6:7], v245 offset:2048
    v_mfma_f32_16x16x32_bf16 v[196:199], v[12:15], v[124:127], v[196:199]
    ds_read_b64_tr_b16 v[8:9], v245 offset:4096
    v_mfma_f32_16x16x32_bf16 v[196:199], v[16:19], v[128:131], v[196:199]
    ds_read_b64_tr_b16 v[10:11], v245 offset:6144
    s_barrier
    s_waitcnt lgkmcnt(7)
    v_mfma_f32_16x16x32_bf16 v[164:167], v[204:207], v[220:223], 0
    ds_read_b128 v[220:223], v3 offset:3072
    v_mfma_f32_16x16x32_bf16 v[164:167], v[208:211], v[240:243], v[164:167]
    s_waitcnt lgkmcnt(6)
    ds_read_b64_tr_b16 v[12:13], v245 offset:8192
    v_mfma_f32_16x16x32_bf16 v[164:167], v[212:215], v[252:255], v[164:167]
    ds_read_b64_tr_b16 v[14:15], v245 offset:10240
    v_mfma_f32_16x16x32_bf16 v[132:135], v[204:207], v[224:227], 0
    ds_read_b64_tr_b16 v[16:17], v245 offset:12288
    v_cvt_pk_bf16_f32 v168, v168, v169
    v_mfma_f32_16x16x32_bf16 v[132:135], v[208:211], v[228:231], v[132:135]
    ds_read_b64_tr_b16 v[18:19], v245 offset:14336
    v_cvt_pk_bf16_f32 v169, v170, v171
    v_mfma_f32_16x16x32_bf16 v[132:135], v[212:215], v[232:235], v[132:135]
    s_waitcnt lgkmcnt(5)
    ds_read_b128 v[240:243], v3 offset:5120
    v_cvt_pk_bf16_f32 v170, v172, v173
    v_mfma_f32_16x16x32_bf16 v[132:135], v[216:219], v[236:239], v[132:135]
    ds_read_b128 v[252:255], v3 offset:6144
    v_cvt_pk_bf16_f32 v171, v174, v175
    v_mfma_f32_16x16x32_bf16 v[148:151], v[204:207], v[68:71], 0
    ds_read_b64_tr_b16 v[204:205], v246 offset:0
    v_cvt_pk_bf16_f32 v184, v184, v185
    v_mfma_f32_16x16x32_bf16 v[148:151], v[208:211], v[72:75], v[148:151]
    ds_read_b64_tr_b16 v[206:207], v246 offset:2048
    v_cvt_pk_bf16_f32 v185, v186, v187
    v_mfma_f32_16x16x32_bf16 v[148:151], v[212:215], v[76:79], v[148:151]
    ds_read_b64_tr_b16 v[208:209], v246 offset:4096
    v_cvt_pk_bf16_f32 v186, v188, v189
    v_mfma_f32_16x16x32_bf16 v[148:151], v[216:219], v[80:83], v[148:151]
    s_waitcnt lgkmcnt(5)
    ds_read_b64_tr_b16 v[210:211], v246 offset:6144
    v_cvt_pk_bf16_f32 v187, v190, v191
    v_mfma_f32_16x16x32_bf16 v[164:167], v[216:219], v[220:223], v[164:167]
    ds_read_b64_tr_b16 v[212:213], v246 offset:8192
    v_add_u32 v244, 16384, v244
    v_mfma_f32_16x16x32_bf16 v[136:139], v[4:7], v[224:227], 0
    ds_read_b64_tr_b16 v[214:215], v246 offset:10240
    v_cvt_pk_bf16_f32 v176, v176, v177
    v_mfma_f32_16x16x32_bf16 v[136:139], v[8:11], v[228:231], v[136:139]
    ds_read_b64_tr_b16 v[216:217], v246 offset:12288
    v_cvt_pk_bf16_f32 v177, v178, v179
    v_mfma_f32_16x16x32_bf16 v[136:139], v[12:15], v[232:235], v[136:139]
    ds_read_b64_tr_b16 v[218:219], v246 offset:14336
    v_cvt_pk_bf16_f32 v178, v180, v181
    v_mfma_f32_16x16x32_bf16 v[136:139], v[16:19], v[236:239], v[136:139]
    ds_read_b128 v[220:223], v3 offset:4096
    v_add_u32 v245, 16384, v245
    v_mfma_f32_16x16x32_bf16 v[152:155], v[4:7], v[68:71], 0
    ds_read_b64_tr_b16 v[4:5], v247 offset:0
    v_cvt_pk_bf16_f32 v179, v182, v183
    v_mfma_f32_16x16x32_bf16 v[152:155], v[8:11], v[72:75], v[152:155]
    ds_read_b64_tr_b16 v[6:7], v247 offset:2048
    v_cvt_pk_bf16_f32 v192, v192, v193
    v_mfma_f32_16x16x32_bf16 v[152:155], v[12:15], v[76:79], v[152:155]
    ds_read_b64_tr_b16 v[8:9], v247 offset:4096
    v_cvt_pk_bf16_f32 v193, v194, v195
    v_mfma_f32_16x16x32_bf16 v[152:155], v[16:19], v[80:83], v[152:155]
    s_waitcnt lgkmcnt(5)
    ds_read_b64_tr_b16 v[10:11], v247 offset:6144
    v_add_u32 v246, 16384, v246
    v_mfma_f32_16x16x32_bf16 v[140:143], v[204:207], v[224:227], 0
    ds_read_b64_tr_b16 v[12:13], v247 offset:8192
    v_cvt_pk_bf16_f32 v194, v196, v197
    v_mfma_f32_16x16x32_bf16 v[140:143], v[208:211], v[228:231], v[140:143]
    ds_read_b64_tr_b16 v[14:15], v247 offset:10240
    v_cvt_pk_bf16_f32 v195, v198, v199
    v_mfma_f32_16x16x32_bf16 v[140:143], v[212:215], v[232:235], v[140:143]
    ds_read_b64_tr_b16 v[16:17], v247 offset:12288
    v_cvt_pk_bf16_f32 v200, v200, v201
    buffer_store_dwordx4 v[168:171], v249, s[28:31], s61 offen offset:0 sc1
    s_waitcnt lgkmcnt(5)
    v_mfma_f32_16x16x32_bf16 v[140:143], v[216:219], v[236:239], v[140:143]
    ds_read_b64_tr_b16 v[18:19], v247 offset:14336
    v_cvt_pk_bf16_f32 v201, v202, v203
    v_mfma_f32_16x16x32_bf16 v[156:159], v[204:207], v[68:71], 0
    ds_read_b64_tr_b16 v[204:205], v244 offset:0
    v_mfma_f32_16x16x32_bf16 v[156:159], v[208:211], v[72:75], v[156:159]
    ds_read_b64_tr_b16 v[206:207], v244 offset:2048
    buffer_store_dwordx4 v[184:187], v249, s[28:31], s61 offen offset:2048 sc1
    v_mfma_f32_16x16x32_bf16 v[156:159], v[212:215], v[76:79], v[156:159]
    ds_read_b64_tr_b16 v[208:209], v244 offset:4096
    v_mfma_f32_16x16x32_bf16 v[156:159], v[216:219], v[80:83], v[156:159]
    ds_read_b64_tr_b16 v[210:211], v244 offset:6144
    v_add_u32 v247, 16384, v247
    v_mfma_f32_16x16x32_bf16 v[144:147], v[4:7], v[224:227], 0
    ds_read_b64_tr_b16 v[212:213], v244 offset:8192
    buffer_store_dwordx4 v[176:179], v249, s[28:31], s61 offen offset:1024 sc1
    s_waitcnt lgkmcnt(6)
    v_mfma_f32_16x16x32_bf16 v[144:147], v[8:11], v[228:231], v[144:147]
    ds_read_b64_tr_b16 v[214:215], v244 offset:10240
    v_mfma_f32_16x16x32_bf16 v[144:147], v[12:15], v[232:235], v[144:147]
    s_waitcnt lgkmcnt(6)
    ds_read_b64_tr_b16 v[216:217], v244 offset:12288
    v_mfma_f32_16x16x32_bf16 v[144:147], v[16:19], v[236:239], v[144:147]
    ds_read_b64_tr_b16 v[218:219], v244 offset:14336
    buffer_store_dwordx4 v[192:195], v249, s[28:31], s61 offen offset:3072 sc1
    v_mfma_f32_16x16x32_bf16 v[160:163], v[4:7], v[68:71], 0
    ds_read_b64_tr_b16 v[4:5], v245 offset:0
    v_mfma_f32_16x16x32_bf16 v[160:163], v[8:11], v[72:75], v[160:163]
    ds_read_b64_tr_b16 v[6:7], v245 offset:2048
    v_mfma_f32_16x16x32_bf16 v[160:163], v[12:15], v[76:79], v[160:163]
    ds_read_b64_tr_b16 v[8:9], v245 offset:4096
    buffer_store_dwordx2 v[200:201], v250, s[28:31], s61 offen sc1
    v_mfma_f32_16x16x32_bf16 v[160:163], v[16:19], v[80:83], v[160:163]
    ds_read_b64_tr_b16 v[10:11], v245 offset:6144
    s_barrier
    s_waitcnt lgkmcnt(7)
    v_mfma_f32_16x16x32_bf16 v[164:167], v[204:207], v[220:223], v[164:167]
    ds_read_b128 v[220:223], v3 offset:7168
    v_mfma_f32_16x16x32_bf16 v[164:167], v[208:211], v[240:243], v[164:167]
    s_waitcnt lgkmcnt(6)
    ds_read_b64_tr_b16 v[12:13], v245 offset:8192
    v_mfma_f32_16x16x32_bf16 v[164:167], v[212:215], v[252:255], v[164:167]
    ds_read_b64_tr_b16 v[14:15], v245 offset:10240
    v_mfma_f32_16x16x32_bf16 v[132:135], v[204:207], v[20:23], v[132:135]
    ds_read_b64_tr_b16 v[16:17], v245 offset:12288
    v_mfma_f32_16x16x32_bf16 v[132:135], v[208:211], v[24:27], v[132:135]
    ds_read_b64_tr_b16 v[18:19], v245 offset:14336
    v_mfma_f32_16x16x32_bf16 v[132:135], v[212:215], v[28:31], v[132:135]
    s_waitcnt lgkmcnt(6)
    ds_read_b128 v[240:243], v3 offset:9216
    v_mfma_f32_16x16x32_bf16 v[132:135], v[216:219], v[32:35], v[132:135]
    ds_read_b128 v[252:255], v3 offset:10240
    v_mfma_f32_16x16x32_bf16 v[148:151], v[204:207], v[84:87], v[148:151]
    ds_read_b64_tr_b16 v[204:205], v246 offset:0
    v_mfma_f32_16x16x32_bf16 v[148:151], v[208:211], v[88:91], v[148:151]
    ds_read_b64_tr_b16 v[206:207], v246 offset:2048
    v_mfma_f32_16x16x32_bf16 v[148:151], v[212:215], v[92:95], v[148:151]
    ds_read_b64_tr_b16 v[208:209], v246 offset:4096
    v_mfma_f32_16x16x32_bf16 v[148:151], v[216:219], v[96:99], v[148:151]
    s_waitcnt lgkmcnt(8)
    ds_read_b64_tr_b16 v[210:211], v246 offset:6144
    v_mfma_f32_16x16x32_bf16 v[164:167], v[216:219], v[220:223], v[164:167]
    ds_read_b64_tr_b16 v[212:213], v246 offset:8192
    v_add_u32 v244, 4294885376, v244
    v_mfma_f32_16x16x32_bf16 v[136:139], v[4:7], v[20:23], v[136:139]
    ds_read_b64_tr_b16 v[214:215], v246 offset:10240
    v_mfma_f32_16x16x32_bf16 v[136:139], v[8:11], v[24:27], v[136:139]
    s_waitcnt lgkmcnt(7)
    ds_read_b64_tr_b16 v[216:217], v246 offset:12288
    v_mfma_f32_16x16x32_bf16 v[136:139], v[12:15], v[28:31], v[136:139]
    ds_read_b64_tr_b16 v[218:219], v246 offset:14336
    v_mfma_f32_16x16x32_bf16 v[136:139], v[16:19], v[32:35], v[136:139]
    ds_read_b128 v[220:223], v3 offset:8192
    v_add_u32 v245, 4294885376, v245
    v_mfma_f32_16x16x32_bf16 v[152:155], v[4:7], v[84:87], v[152:155]
    ds_read_b64_tr_b16 v[4:5], v247 offset:0
    v_mfma_f32_16x16x32_bf16 v[152:155], v[8:11], v[88:91], v[152:155]
    ds_read_b64_tr_b16 v[6:7], v247 offset:2048
    v_mfma_f32_16x16x32_bf16 v[152:155], v[12:15], v[92:95], v[152:155]
    ds_read_b64_tr_b16 v[8:9], v247 offset:4096
    v_mfma_f32_16x16x32_bf16 v[152:155], v[16:19], v[96:99], v[152:155]
    s_waitcnt lgkmcnt(7)
    ds_read_b64_tr_b16 v[10:11], v247 offset:6144
    v_add_u32 v246, 4294885376, v246
    v_mfma_f32_16x16x32_bf16 v[140:143], v[204:207], v[20:23], v[140:143]
    ds_read_b64_tr_b16 v[12:13], v247 offset:8192
    v_mfma_f32_16x16x32_bf16 v[140:143], v[208:211], v[24:27], v[140:143]
    s_waitcnt lgkmcnt(7)
    ds_read_b64_tr_b16 v[14:15], v247 offset:10240
    v_mfma_f32_16x16x32_bf16 v[140:143], v[212:215], v[28:31], v[140:143]
    s_waitcnt lgkmcnt(6)
    ds_read_b64_tr_b16 v[16:17], v247 offset:12288
    v_mfma_f32_16x16x32_bf16 v[140:143], v[216:219], v[32:35], v[140:143]
    ds_read_b64_tr_b16 v[18:19], v247 offset:14336
    v_mfma_f32_16x16x32_bf16 v[156:159], v[204:207], v[84:87], v[156:159]
    ds_read_b64_tr_b16 v[204:205], v244 offset:0
    v_mfma_f32_16x16x32_bf16 v[156:159], v[208:211], v[88:91], v[156:159]
    ds_read_b64_tr_b16 v[206:207], v244 offset:2048
    v_mfma_f32_16x16x32_bf16 v[156:159], v[212:215], v[92:95], v[156:159]
    ds_read_b64_tr_b16 v[208:209], v244 offset:4096
    v_mfma_f32_16x16x32_bf16 v[156:159], v[216:219], v[96:99], v[156:159]
    s_waitcnt lgkmcnt(7)
    ds_read_b64_tr_b16 v[210:211], v244 offset:6144
    v_add_u32 v247, 4294885376, v247
    v_mfma_f32_16x16x32_bf16 v[144:147], v[4:7], v[20:23], v[144:147]
    ds_read_b64_tr_b16 v[212:213], v244 offset:8192
    v_mfma_f32_16x16x32_bf16 v[144:147], v[8:11], v[24:27], v[144:147]
    s_waitcnt lgkmcnt(7)
    ds_read_b64_tr_b16 v[214:215], v244 offset:10240
    v_mfma_f32_16x16x32_bf16 v[144:147], v[12:15], v[28:31], v[144:147]
    s_waitcnt lgkmcnt(6)
    ds_read_b64_tr_b16 v[216:217], v244 offset:12288
    v_mfma_f32_16x16x32_bf16 v[144:147], v[16:19], v[32:35], v[144:147]
    ds_read_b64_tr_b16 v[218:219], v244 offset:14336
    v_mfma_f32_16x16x32_bf16 v[160:163], v[4:7], v[84:87], v[160:163]
    ds_read_b64_tr_b16 v[4:5], v245 offset:0
    v_mfma_f32_16x16x32_bf16 v[160:163], v[8:11], v[88:91], v[160:163]
    ds_read_b64_tr_b16 v[6:7], v245 offset:2048
    v_mfma_f32_16x16x32_bf16 v[160:163], v[12:15], v[92:95], v[160:163]
    ds_read_b64_tr_b16 v[8:9], v245 offset:4096
    v_mfma_f32_16x16x32_bf16 v[160:163], v[16:19], v[96:99], v[160:163]
    ds_read_b64_tr_b16 v[10:11], v245 offset:6144
    s_barrier
    s_waitcnt lgkmcnt(8)
    v_mfma_f32_16x16x32_bf16 v[164:167], v[204:207], v[220:223], v[164:167]
    ds_read_b128 v[220:223], v3 offset:11264
    v_mfma_f32_16x16x32_bf16 v[164:167], v[208:211], v[240:243], v[164:167]
    s_waitcnt lgkmcnt(7)
    ds_read_b64_tr_b16 v[12:13], v245 offset:8192
    v_mfma_f32_16x16x32_bf16 v[164:167], v[212:215], v[252:255], v[164:167]
    ds_read_b64_tr_b16 v[14:15], v245 offset:10240
    v_mfma_f32_16x16x32_bf16 v[132:135], v[204:207], v[36:39], v[132:135]
    ds_read_b64_tr_b16 v[16:17], v245 offset:12288
    v_mfma_f32_16x16x32_bf16 v[132:135], v[208:211], v[40:43], v[132:135]
    ds_read_b64_tr_b16 v[18:19], v245 offset:14336
    v_mfma_f32_16x16x32_bf16 v[132:135], v[212:215], v[44:47], v[132:135]
    s_waitcnt lgkmcnt(7)
    ds_read_b128 v[240:243], v3 offset:13312
    v_mfma_f32_16x16x32_bf16 v[132:135], v[216:219], v[48:51], v[132:135]
    ds_read_b128 v[252:255], v3 offset:14336
    v_mfma_f32_16x16x32_bf16 v[148:151], v[204:207], v[100:103], v[148:151]
    ds_read_b64_tr_b16 v[204:205], v246 offset:0
    v_mfma_f32_16x16x32_bf16 v[148:151], v[208:211], v[104:107], v[148:151]
    ds_read_b64_tr_b16 v[206:207], v246 offset:2048
    v_mfma_f32_16x16x32_bf16 v[148:151], v[212:215], v[108:111], v[148:151]
    ds_read_b64_tr_b16 v[208:209], v246 offset:4096
    v_mfma_f32_16x16x32_bf16 v[148:151], v[216:219], v[112:115], v[148:151]
    s_waitcnt lgkmcnt(8)
    ds_read_b64_tr_b16 v[210:211], v246 offset:6144
    v_mfma_f32_16x16x32_bf16 v[164:167], v[216:219], v[220:223], v[164:167]
    ds_read_b64_tr_b16 v[212:213], v246 offset:8192
    v_add_u32 v244, 16384, v244
    v_mfma_f32_16x16x32_bf16 v[136:139], v[4:7], v[36:39], v[136:139]
    ds_read_b64_tr_b16 v[214:215], v246 offset:10240
    v_mfma_f32_16x16x32_bf16 v[136:139], v[8:11], v[40:43], v[136:139]
    s_waitcnt lgkmcnt(7)
    ds_read_b64_tr_b16 v[216:217], v246 offset:12288
    v_mfma_f32_16x16x32_bf16 v[136:139], v[12:15], v[44:47], v[136:139]
    ds_read_b64_tr_b16 v[218:219], v246 offset:14336
    v_mfma_f32_16x16x32_bf16 v[136:139], v[16:19], v[48:51], v[136:139]
    ds_read_b128 v[220:223], v3 offset:12288
    v_add_u32 v245, 16384, v245
    v_mfma_f32_16x16x32_bf16 v[152:155], v[4:7], v[100:103], v[152:155]
    ds_read_b64_tr_b16 v[4:5], v247 offset:0
    v_mfma_f32_16x16x32_bf16 v[152:155], v[8:11], v[104:107], v[152:155]
    ds_read_b64_tr_b16 v[6:7], v247 offset:2048
    v_mfma_f32_16x16x32_bf16 v[152:155], v[12:15], v[108:111], v[152:155]
    ds_read_b64_tr_b16 v[8:9], v247 offset:4096
    s_waitcnt vmcnt(0)
    buffer_store_dword v2, v251, s[28:31], s56 offen offset:20 sc1
    v_mfma_f32_16x16x32_bf16 v[152:155], v[16:19], v[112:115], v[152:155]
    s_waitcnt lgkmcnt(6)
    ds_read_b64_tr_b16 v[10:11], v247 offset:6144
    v_add_u32 v246, 16384, v246
    v_mfma_f32_16x16x32_bf16 v[140:143], v[204:207], v[36:39], v[140:143]
    ds_read_b64_tr_b16 v[12:13], v247 offset:8192
    v_mfma_f32_16x16x32_bf16 v[140:143], v[208:211], v[40:43], v[140:143]
    ds_read_b64_tr_b16 v[14:15], v247 offset:10240
    v_mfma_f32_16x16x32_bf16 v[140:143], v[212:215], v[44:47], v[140:143]
    s_waitcnt lgkmcnt(6)
    ds_read_b64_tr_b16 v[16:17], v247 offset:12288
    v_mfma_f32_16x16x32_bf16 v[140:143], v[216:219], v[48:51], v[140:143]
    ds_read_b64_tr_b16 v[18:19], v247 offset:14336
    v_mfma_f32_16x16x32_bf16 v[156:159], v[204:207], v[100:103], v[156:159]
    ds_read_b64_tr_b16 v[204:205], v244 offset:0
    v_mfma_f32_16x16x32_bf16 v[156:159], v[208:211], v[104:107], v[156:159]
    ds_read_b64_tr_b16 v[206:207], v244 offset:2048
    v_mfma_f32_16x16x32_bf16 v[156:159], v[212:215], v[108:111], v[156:159]
    ds_read_b64_tr_b16 v[208:209], v244 offset:4096
    v_mfma_f32_16x16x32_bf16 v[156:159], v[216:219], v[112:115], v[156:159]
    s_waitcnt lgkmcnt(7)
    ds_read_b64_tr_b16 v[210:211], v244 offset:6144
    v_add_u32 v247, 16384, v247
    v_mfma_f32_16x16x32_bf16 v[144:147], v[4:7], v[36:39], v[144:147]
    ds_read_b64_tr_b16 v[212:213], v244 offset:8192
    v_mfma_f32_16x16x32_bf16 v[144:147], v[8:11], v[40:43], v[144:147]
    s_waitcnt lgkmcnt(7)
    ds_read_b64_tr_b16 v[214:215], v244 offset:10240
    v_mfma_f32_16x16x32_bf16 v[144:147], v[12:15], v[44:47], v[144:147]
    s_waitcnt lgkmcnt(6)
    ds_read_b64_tr_b16 v[216:217], v244 offset:12288
    v_mfma_f32_16x16x32_bf16 v[144:147], v[16:19], v[48:51], v[144:147]
    ds_read_b64_tr_b16 v[218:219], v244 offset:14336
    v_mfma_f32_16x16x32_bf16 v[160:163], v[4:7], v[100:103], v[160:163]
    ds_read_b64_tr_b16 v[4:5], v245 offset:0
    v_mfma_f32_16x16x32_bf16 v[160:163], v[8:11], v[104:107], v[160:163]
    ds_read_b64_tr_b16 v[6:7], v245 offset:2048
    v_mfma_f32_16x16x32_bf16 v[160:163], v[12:15], v[108:111], v[160:163]
    ds_read_b64_tr_b16 v[8:9], v245 offset:4096
    v_mfma_f32_16x16x32_bf16 v[160:163], v[16:19], v[112:115], v[160:163]
    ds_read_b64_tr_b16 v[10:11], v245 offset:6144
    s_barrier
    s_waitcnt lgkmcnt(8)
    v_mfma_f32_16x16x32_bf16 v[164:167], v[204:207], v[220:223], v[164:167]
    ds_read_b128 v[220:223], v3 offset:15360
    v_mfma_f32_16x16x32_bf16 v[164:167], v[208:211], v[240:243], v[164:167]
    s_waitcnt lgkmcnt(7)
    ds_read_b64_tr_b16 v[12:13], v245 offset:8192
    v_mfma_f32_16x16x32_bf16 v[164:167], v[212:215], v[252:255], v[164:167]
    ds_read_b64_tr_b16 v[14:15], v245 offset:10240
    s_bfe_u32 s62, s100, 262168
    v_mfma_f32_16x16x32_bf16 v[132:135], v[204:207], v[52:55], v[132:135]
    ds_read_b64_tr_b16 v[16:17], v245 offset:12288
    s_add_u32 s62, s62, s101
    v_mfma_f32_16x16x32_bf16 v[132:135], v[208:211], v[56:59], v[132:135]
    ds_read_b64_tr_b16 v[18:19], v245 offset:14336
    s_and_b32 s62, s62, 7
    v_mfma_f32_16x16x32_bf16 v[132:135], v[212:215], v[60:63], v[132:135]
    ds_read_b128 v[240:243], v3 offset:1024
    s_add_u32 s62, s62, s57
    s_waitcnt lgkmcnt(6)
    v_mfma_f32_16x16x32_bf16 v[132:135], v[216:219], v[64:67], v[132:135]
    ds_read_b128 v[252:255], v3 offset:2048
    v_mfma_f32_16x16x32_bf16 v[148:151], v[204:207], v[116:119], v[148:151]
    ds_read_b64_tr_b16 v[204:205], v246 offset:0
    s_mul_i32 s60, s62, 129024
    v_mfma_f32_16x16x32_bf16 v[148:151], v[208:211], v[120:123], v[148:151]
    ds_read_b64_tr_b16 v[206:207], v246 offset:2048
    s_add_u32 s60, s60, 8499200
    v_mfma_f32_16x16x32_bf16 v[148:151], v[212:215], v[124:127], v[148:151]
    ds_read_b64_tr_b16 v[208:209], v246 offset:4096
    s_lshl_b32 s62, s62, 7
    v_mfma_f32_16x16x32_bf16 v[148:151], v[216:219], v[128:131], v[148:151]
    s_waitcnt lgkmcnt(5)
    ds_read_b64_tr_b16 v[210:211], v246 offset:6144
    v_mfma_f32_16x16x32_bf16 v[164:167], v[216:219], v[220:223], v[164:167]
    ds_read_b64_tr_b16 v[212:213], v246 offset:8192
    v_add_u32 v244, 16384, v244
    v_mfma_f32_16x16x32_bf16 v[136:139], v[4:7], v[52:55], v[136:139]
    ds_read_b64_tr_b16 v[214:215], v246 offset:10240
    v_mfma_f32_16x16x32_bf16 v[136:139], v[8:11], v[56:59], v[136:139]
    ds_read_b64_tr_b16 v[216:217], v246 offset:12288
    v_mfma_f32_16x16x32_bf16 v[136:139], v[12:15], v[60:63], v[136:139]
    ds_read_b64_tr_b16 v[218:219], v246 offset:14336
    v_mfma_f32_16x16x32_bf16 v[136:139], v[16:19], v[64:67], v[136:139]
    ds_read_b128 v[220:223], v3 offset:0
    v_add_u32 v245, 16384, v245
    v_mfma_f32_16x16x32_bf16 v[152:155], v[4:7], v[116:119], v[152:155]
    ds_read_b64_tr_b16 v[4:5], v247 offset:0
    v_mfma_f32_16x16x32_bf16 v[152:155], v[8:11], v[120:123], v[152:155]
    ds_read_b64_tr_b16 v[6:7], v247 offset:2048
    v_cvt_pk_bf16_f32 v164, v164, v165
    v_mfma_f32_16x16x32_bf16 v[152:155], v[12:15], v[124:127], v[152:155]
    ds_read_b64_tr_b16 v[8:9], v247 offset:4096
    v_cvt_pk_bf16_f32 v165, v166, v167
    v_mfma_f32_16x16x32_bf16 v[152:155], v[16:19], v[128:131], v[152:155]
    ds_read_b64_tr_b16 v[10:11], v247 offset:6144
    v_add_u32 v246, 16384, v246
    buffer_store_dwordx2 v[164:165], v250, s[28:31], s60 offen sc1
    s_waitcnt lgkmcnt(7)
    v_mfma_f32_16x16x32_bf16 v[140:143], v[204:207], v[52:55], v[140:143]
    ds_read_b64_tr_b16 v[12:13], v247 offset:8192
    v_mfma_f32_16x16x32_bf16 v[140:143], v[208:211], v[56:59], v[140:143]
    ds_read_b64_tr_b16 v[14:15], v247 offset:10240
    v_cvt_pk_bf16_f32 v132, v132, v133
    v_mfma_f32_16x16x32_bf16 v[140:143], v[212:215], v[60:63], v[140:143]
    s_waitcnt lgkmcnt(5)
    ds_read_b64_tr_b16 v[16:17], v247 offset:12288
    v_cvt_pk_bf16_f32 v133, v134, v135
    v_mfma_f32_16x16x32_bf16 v[140:143], v[216:219], v[64:67], v[140:143]
    ds_read_b64_tr_b16 v[18:19], v247 offset:14336
    v_cvt_pk_bf16_f32 v134, v136, v137
    v_mfma_f32_16x16x32_bf16 v[156:159], v[204:207], v[116:119], v[156:159]
    ds_read_b64_tr_b16 v[204:205], v244 offset:0
    v_cvt_pk_bf16_f32 v135, v138, v139
    v_mfma_f32_16x16x32_bf16 v[156:159], v[208:211], v[120:123], v[156:159]
    ds_read_b64_tr_b16 v[206:207], v244 offset:2048
    buffer_store_dwordx4 v[132:135], v249, s[28:31], s60 offen offset:0 sc1
    v_mfma_f32_16x16x32_bf16 v[156:159], v[212:215], v[124:127], v[156:159]
    ds_read_b64_tr_b16 v[208:209], v244 offset:4096
    v_mfma_f32_16x16x32_bf16 v[156:159], v[216:219], v[128:131], v[156:159]
    s_waitcnt lgkmcnt(5)
    ds_read_b64_tr_b16 v[210:211], v244 offset:6144
    v_add_u32 v247, 16384, v247
    v_mfma_f32_16x16x32_bf16 v[144:147], v[4:7], v[52:55], v[144:147]
    ds_read_b64_tr_b16 v[212:213], v244 offset:8192
    v_cvt_pk_bf16_f32 v148, v148, v149
    v_mfma_f32_16x16x32_bf16 v[144:147], v[8:11], v[56:59], v[144:147]
    ds_read_b64_tr_b16 v[214:215], v244 offset:10240
    v_cvt_pk_bf16_f32 v149, v150, v151
    v_mfma_f32_16x16x32_bf16 v[144:147], v[12:15], v[60:63], v[144:147]
    s_waitcnt lgkmcnt(5)
    ds_read_b64_tr_b16 v[216:217], v244 offset:12288
    v_cvt_pk_bf16_f32 v150, v152, v153
    v_mfma_f32_16x16x32_bf16 v[144:147], v[16:19], v[64:67], v[144:147]
    ds_read_b64_tr_b16 v[218:219], v244 offset:14336
    v_cvt_pk_bf16_f32 v151, v154, v155
    v_mfma_f32_16x16x32_bf16 v[160:163], v[4:7], v[116:119], v[160:163]
    ds_read_b64_tr_b16 v[4:5], v245 offset:0
    buffer_store_dwordx4 v[148:151], v249, s[28:31], s60 offen offset:2048 sc1
    v_mfma_f32_16x16x32_bf16 v[160:163], v[8:11], v[120:123], v[160:163]
    ds_read_b64_tr_b16 v[6:7], v245 offset:2048
    v_mfma_f32_16x16x32_bf16 v[160:163], v[12:15], v[124:127], v[160:163]
    ds_read_b64_tr_b16 v[8:9], v245 offset:4096
    v_mfma_f32_16x16x32_bf16 v[160:163], v[16:19], v[128:131], v[160:163]
    ds_read_b64_tr_b16 v[10:11], v245 offset:6144
    s_barrier
    s_waitcnt lgkmcnt(6)
    v_mfma_f32_16x16x32_bf16 v[200:203], v[204:207], v[220:223], 0
    ds_read_b128 v[220:223], v3 offset:3072
    v_cvt_pk_bf16_f32 v140, v140, v141
    v_cvt_pk_bf16_f32 v141, v142, v143
    v_mfma_f32_16x16x32_bf16 v[200:203], v[208:211], v[240:243], v[200:203]
    ds_read_b64_tr_b16 v[12:13], v245 offset:8192
    v_cvt_pk_bf16_f32 v142, v144, v145
    v_cvt_pk_bf16_f32 v143, v146, v147
    v_mfma_f32_16x16x32_bf16 v[200:203], v[212:215], v[252:255], v[200:203]
    ds_read_b64_tr_b16 v[14:15], v245 offset:10240
    buffer_store_dwordx4 v[140:143], v249, s[28:31], s60 offen offset:1024 sc1
    v_mfma_f32_16x16x32_bf16 v[168:171], v[204:207], v[224:227], 0
    ds_read_b64_tr_b16 v[16:17], v245 offset:12288
    v_cvt_pk_bf16_f32 v156, v156, v157
    v_cvt_pk_bf16_f32 v157, v158, v159
    v_mfma_f32_16x16x32_bf16 v[168:171], v[208:211], v[228:231], v[168:171]
    ds_read_b64_tr_b16 v[18:19], v245 offset:14336
    v_cvt_pk_bf16_f32 v158, v160, v161
    v_cvt_pk_bf16_f32 v159, v162, v163
    v_mfma_f32_16x16x32_bf16 v[168:171], v[212:215], v[232:235], v[168:171]
    ds_read_b128 v[240:243], v3 offset:5120
    buffer_store_dwordx4 v[156:159], v249, s[28:31], s60 offen offset:3072 sc1
    s_waitcnt lgkmcnt(5)
    v_mfma_f32_16x16x32_bf16 v[168:171], v[216:219], v[236:239], v[168:171]
    ds_read_b128 v[252:255], v3 offset:6144
    v_mfma_f32_16x16x32_bf16 v[184:187], v[204:207], v[68:71], 0
    ds_read_b64_tr_b16 v[204:205], v246 offset:0
    v_mfma_f32_16x16x32_bf16 v[184:187], v[208:211], v[72:75], v[184:187]
    ds_read_b64_tr_b16 v[206:207], v246 offset:2048
    v_mfma_f32_16x16x32_bf16 v[184:187], v[212:215], v[76:79], v[184:187]
    ds_read_b64_tr_b16 v[208:209], v246 offset:4096
    v_mfma_f32_16x16x32_bf16 v[184:187], v[216:219], v[80:83], v[184:187]
    ds_read_b64_tr_b16 v[210:211], v246 offset:6144
    v_mfma_f32_16x16x32_bf16 v[200:203], v[216:219], v[220:223], v[200:203]
    ds_read_b64_tr_b16 v[212:213], v246 offset:8192
    v_add_u32 v244, 16384, v244
    v_mfma_f32_16x16x32_bf16 v[172:175], v[4:7], v[224:227], 0
    ds_read_b64_tr_b16 v[214:215], v246 offset:10240
    v_mfma_f32_16x16x32_bf16 v[172:175], v[8:11], v[228:231], v[172:175]
    s_waitcnt lgkmcnt(7)
    ds_read_b64_tr_b16 v[216:217], v246 offset:12288
    v_mfma_f32_16x16x32_bf16 v[172:175], v[12:15], v[232:235], v[172:175]
    ds_read_b64_tr_b16 v[218:219], v246 offset:14336
    v_mfma_f32_16x16x32_bf16 v[172:175], v[16:19], v[236:239], v[172:175]
    ds_read_b128 v[220:223], v3 offset:4096
    v_add_u32 v245, 16384, v245
    v_mfma_f32_16x16x32_bf16 v[188:191], v[4:7], v[68:71], 0
    ds_read_b64_tr_b16 v[4:5], v247 offset:0
    v_mfma_f32_16x16x32_bf16 v[188:191], v[8:11], v[72:75], v[188:191]
    ds_read_b64_tr_b16 v[6:7], v247 offset:2048
    v_mfma_f32_16x16x32_bf16 v[188:191], v[12:15], v[76:79], v[188:191]
    ds_read_b64_tr_b16 v[8:9], v247 offset:4096
    v_mfma_f32_16x16x32_bf16 v[188:191], v[16:19], v[80:83], v[188:191]
    s_waitcnt lgkmcnt(7)
    ds_read_b64_tr_b16 v[10:11], v247 offset:6144
    v_add_u32 v246, 16384, v246
    v_mfma_f32_16x16x32_bf16 v[176:179], v[204:207], v[224:227], 0
    ds_read_b64_tr_b16 v[12:13], v247 offset:8192
    v_mfma_f32_16x16x32_bf16 v[176:179], v[208:211], v[228:231], v[176:179]
    s_waitcnt lgkmcnt(7)
    ds_read_b64_tr_b16 v[14:15], v247 offset:10240
    v_mfma_f32_16x16x32_bf16 v[176:179], v[212:215], v[232:235], v[176:179]
    s_waitcnt lgkmcnt(6)
    ds_read_b64_tr_b16 v[16:17], v247 offset:12288
    v_mfma_f32_16x16x32_bf16 v[176:179], v[216:219], v[236:239], v[176:179]
    ds_read_b64_tr_b16 v[18:19], v247 offset:14336
    v_mfma_f32_16x16x32_bf16 v[192:195], v[204:207], v[68:71], 0
    ds_read_b64_tr_b16 v[204:205], v244 offset:0
    v_mfma_f32_16x16x32_bf16 v[192:195], v[208:211], v[72:75], v[192:195]
    ds_read_b64_tr_b16 v[206:207], v244 offset:2048
    v_mfma_f32_16x16x32_bf16 v[192:195], v[212:215], v[76:79], v[192:195]
    ds_read_b64_tr_b16 v[208:209], v244 offset:4096
    v_mfma_f32_16x16x32_bf16 v[192:195], v[216:219], v[80:83], v[192:195]
    s_waitcnt lgkmcnt(7)
    ds_read_b64_tr_b16 v[210:211], v244 offset:6144
    v_add_u32 v247, 16384, v247
    v_mfma_f32_16x16x32_bf16 v[180:183], v[4:7], v[224:227], 0
    ds_read_b64_tr_b16 v[212:213], v244 offset:8192
    v_mfma_f32_16x16x32_bf16 v[180:183], v[8:11], v[228:231], v[180:183]
    s_waitcnt lgkmcnt(7)
    ds_read_b64_tr_b16 v[214:215], v244 offset:10240
    v_mfma_f32_16x16x32_bf16 v[180:183], v[12:15], v[232:235], v[180:183]
    s_waitcnt lgkmcnt(6)
    ds_read_b64_tr_b16 v[216:217], v244 offset:12288
    v_mfma_f32_16x16x32_bf16 v[180:183], v[16:19], v[236:239], v[180:183]
    ds_read_b64_tr_b16 v[218:219], v244 offset:14336
    v_mfma_f32_16x16x32_bf16 v[196:199], v[4:7], v[68:71], 0
    ds_read_b64_tr_b16 v[4:5], v245 offset:0
    v_mfma_f32_16x16x32_bf16 v[196:199], v[8:11], v[72:75], v[196:199]
    ds_read_b64_tr_b16 v[6:7], v245 offset:2048
    v_mfma_f32_16x16x32_bf16 v[196:199], v[12:15], v[76:79], v[196:199]
    ds_read_b64_tr_b16 v[8:9], v245 offset:4096
    v_mfma_f32_16x16x32_bf16 v[196:199], v[16:19], v[80:83], v[196:199]
    ds_read_b64_tr_b16 v[10:11], v245 offset:6144
    s_barrier
    s_waitcnt lgkmcnt(8)
    v_mfma_f32_16x16x32_bf16 v[200:203], v[204:207], v[220:223], v[200:203]
    ds_read_b128 v[220:223], v3 offset:7168
    v_mfma_f32_16x16x32_bf16 v[200:203], v[208:211], v[240:243], v[200:203]
    s_waitcnt lgkmcnt(7)
    ds_read_b64_tr_b16 v[12:13], v245 offset:8192
    v_mfma_f32_16x16x32_bf16 v[200:203], v[212:215], v[252:255], v[200:203]
    ds_read_b64_tr_b16 v[14:15], v245 offset:10240
    v_mfma_f32_16x16x32_bf16 v[168:171], v[204:207], v[20:23], v[168:171]
    ds_read_b64_tr_b16 v[16:17], v245 offset:12288
    v_mfma_f32_16x16x32_bf16 v[168:171], v[208:211], v[24:27], v[168:171]
    ds_read_b64_tr_b16 v[18:19], v245 offset:14336
    v_mfma_f32_16x16x32_bf16 v[168:171], v[212:215], v[28:31], v[168:171]
    s_waitcnt lgkmcnt(7)
    ds_read_b128 v[240:243], v3 offset:9216
    v_mfma_f32_16x16x32_bf16 v[168:171], v[216:219], v[32:35], v[168:171]
    ds_read_b128 v[252:255], v3 offset:10240
    v_mfma_f32_16x16x32_bf16 v[184:187], v[204:207], v[84:87], v[184:187]
    ds_read_b64_tr_b16 v[204:205], v246 offset:0
    v_mfma_f32_16x16x32_bf16 v[184:187], v[208:211], v[88:91], v[184:187]
    ds_read_b64_tr_b16 v[206:207], v246 offset:2048
    v_mfma_f32_16x16x32_bf16 v[184:187], v[212:215], v[92:95], v[184:187]
    ds_read_b64_tr_b16 v[208:209], v246 offset:4096
    v_mfma_f32_16x16x32_bf16 v[184:187], v[216:219], v[96:99], v[184:187]
    s_waitcnt lgkmcnt(8)
    ds_read_b64_tr_b16 v[210:211], v246 offset:6144
    v_mfma_f32_16x16x32_bf16 v[200:203], v[216:219], v[220:223], v[200:203]
    ds_read_b64_tr_b16 v[212:213], v246 offset:8192
    v_add_u32 v244, 16384, v244
    v_mfma_f32_16x16x32_bf16 v[172:175], v[4:7], v[20:23], v[172:175]
    ds_read_b64_tr_b16 v[214:215], v246 offset:10240
    v_mfma_f32_16x16x32_bf16 v[172:175], v[8:11], v[24:27], v[172:175]
    s_waitcnt lgkmcnt(7)
    ds_read_b64_tr_b16 v[216:217], v246 offset:12288
    v_mfma_f32_16x16x32_bf16 v[172:175], v[12:15], v[28:31], v[172:175]
    ds_read_b64_tr_b16 v[218:219], v246 offset:14336
    v_mfma_f32_16x16x32_bf16 v[172:175], v[16:19], v[32:35], v[172:175]
    ds_read_b128 v[220:223], v3 offset:8192
    v_add_u32 v245, 16384, v245
    v_mfma_f32_16x16x32_bf16 v[188:191], v[4:7], v[84:87], v[188:191]
    ds_read_b64_tr_b16 v[4:5], v247 offset:0
    v_mfma_f32_16x16x32_bf16 v[188:191], v[8:11], v[88:91], v[188:191]
    ds_read_b64_tr_b16 v[6:7], v247 offset:2048
    v_mfma_f32_16x16x32_bf16 v[188:191], v[12:15], v[92:95], v[188:191]
    ds_read_b64_tr_b16 v[8:9], v247 offset:4096
    v_mfma_f32_16x16x32_bf16 v[188:191], v[16:19], v[96:99], v[188:191]
    s_waitcnt lgkmcnt(7)
    ds_read_b64_tr_b16 v[10:11], v247 offset:6144
    v_add_u32 v246, 16384, v246
    v_mfma_f32_16x16x32_bf16 v[176:179], v[204:207], v[20:23], v[176:179]
    ds_read_b64_tr_b16 v[12:13], v247 offset:8192
    v_mfma_f32_16x16x32_bf16 v[176:179], v[208:211], v[24:27], v[176:179]
    s_waitcnt lgkmcnt(7)
    ds_read_b64_tr_b16 v[14:15], v247 offset:10240
    v_mfma_f32_16x16x32_bf16 v[176:179], v[212:215], v[28:31], v[176:179]
    s_waitcnt lgkmcnt(6)
    ds_read_b64_tr_b16 v[16:17], v247 offset:12288
    v_mfma_f32_16x16x32_bf16 v[176:179], v[216:219], v[32:35], v[176:179]
    ds_read_b64_tr_b16 v[18:19], v247 offset:14336
    v_mfma_f32_16x16x32_bf16 v[192:195], v[204:207], v[84:87], v[192:195]
    ds_read_b64_tr_b16 v[204:205], v244 offset:0
    s_waitcnt vmcnt(0)
    buffer_store_dword v2, v251, s[28:31], s62 offen offset:24 sc1
    v_mfma_f32_16x16x32_bf16 v[192:195], v[208:211], v[88:91], v[192:195]
    ds_read_b64_tr_b16 v[206:207], v244 offset:2048
    v_mfma_f32_16x16x32_bf16 v[192:195], v[212:215], v[92:95], v[192:195]
    ds_read_b64_tr_b16 v[208:209], v244 offset:4096
    v_mfma_f32_16x16x32_bf16 v[192:195], v[216:219], v[96:99], v[192:195]
    s_waitcnt lgkmcnt(6)
    ds_read_b64_tr_b16 v[210:211], v244 offset:6144
    v_add_u32 v247, 16384, v247
    v_mfma_f32_16x16x32_bf16 v[180:183], v[4:7], v[20:23], v[180:183]
    ds_read_b64_tr_b16 v[212:213], v244 offset:8192
    v_mfma_f32_16x16x32_bf16 v[180:183], v[8:11], v[24:27], v[180:183]
    s_waitcnt lgkmcnt(6)
    ds_read_b64_tr_b16 v[214:215], v244 offset:10240
    v_mfma_f32_16x16x32_bf16 v[180:183], v[12:15], v[28:31], v[180:183]
    s_waitcnt lgkmcnt(6)
    ds_read_b64_tr_b16 v[216:217], v244 offset:12288
    v_mfma_f32_16x16x32_bf16 v[180:183], v[16:19], v[32:35], v[180:183]
    ds_read_b64_tr_b16 v[218:219], v244 offset:14336
    v_mfma_f32_16x16x32_bf16 v[196:199], v[4:7], v[84:87], v[196:199]
    ds_read_b64_tr_b16 v[4:5], v245 offset:0
    v_mfma_f32_16x16x32_bf16 v[196:199], v[8:11], v[88:91], v[196:199]
    ds_read_b64_tr_b16 v[6:7], v245 offset:2048
    v_mfma_f32_16x16x32_bf16 v[196:199], v[12:15], v[92:95], v[196:199]
    ds_read_b64_tr_b16 v[8:9], v245 offset:4096
    v_mfma_f32_16x16x32_bf16 v[196:199], v[16:19], v[96:99], v[196:199]
    s_waitcnt lgkmcnt(7)
    ds_read_b64_tr_b16 v[10:11], v245 offset:6144
    v_mfma_f32_16x16x32_bf16 v[200:203], v[204:207], v[220:223], v[200:203]
    ds_read_b128 v[220:223], v3 offset:11264
    v_mfma_f32_16x16x32_bf16 v[200:203], v[208:211], v[240:243], v[200:203]
    s_waitcnt lgkmcnt(7)
    ds_read_b64_tr_b16 v[12:13], v245 offset:8192
    v_mfma_f32_16x16x32_bf16 v[200:203], v[212:215], v[252:255], v[200:203]
    ds_read_b64_tr_b16 v[14:15], v245 offset:10240
    v_mfma_f32_16x16x32_bf16 v[168:171], v[204:207], v[36:39], v[168:171]
    ds_read_b64_tr_b16 v[16:17], v245 offset:12288
    v_mfma_f32_16x16x32_bf16 v[168:171], v[208:211], v[40:43], v[168:171]
    ds_read_b64_tr_b16 v[18:19], v245 offset:14336
    v_mfma_f32_16x16x32_bf16 v[168:171], v[212:215], v[44:47], v[168:171]
    s_waitcnt lgkmcnt(7)
    ds_read_b128 v[240:243], v3 offset:13312
    v_mfma_f32_16x16x32_bf16 v[168:171], v[216:219], v[48:51], v[168:171]
    ds_read_b128 v[252:255], v3 offset:14336
    v_mfma_f32_16x16x32_bf16 v[184:187], v[204:207], v[100:103], v[184:187]
    ds_read_b64_tr_b16 v[204:205], v246 offset:0
    v_mfma_f32_16x16x32_bf16 v[184:187], v[208:211], v[104:107], v[184:187]
    ds_read_b64_tr_b16 v[206:207], v246 offset:2048
    v_mfma_f32_16x16x32_bf16 v[184:187], v[212:215], v[108:111], v[184:187]
    ds_read_b64_tr_b16 v[208:209], v246 offset:4096
    v_mfma_f32_16x16x32_bf16 v[184:187], v[216:219], v[112:115], v[184:187]
    s_waitcnt lgkmcnt(8)
    ds_read_b64_tr_b16 v[210:211], v246 offset:6144
    v_mfma_f32_16x16x32_bf16 v[200:203], v[216:219], v[220:223], v[200:203]
    ds_read_b64_tr_b16 v[212:213], v246 offset:8192
    v_add_u32 v244, 16384, v244
    v_mfma_f32_16x16x32_bf16 v[172:175], v[4:7], v[36:39], v[172:175]
    ds_read_b64_tr_b16 v[214:215], v246 offset:10240
    v_mfma_f32_16x16x32_bf16 v[172:175], v[8:11], v[40:43], v[172:175]
    s_waitcnt lgkmcnt(7)
    ds_read_b64_tr_b16 v[216:217], v246 offset:12288
    v_mfma_f32_16x16x32_bf16 v[172:175], v[12:15], v[44:47], v[172:175]
    ds_read_b64_tr_b16 v[218:219], v246 offset:14336
    v_mfma_f32_16x16x32_bf16 v[172:175], v[16:19], v[48:51], v[172:175]
    ds_read_b128 v[220:223], v3 offset:12288
    v_add_u32 v245, 16384, v245
    v_mfma_f32_16x16x32_bf16 v[188:191], v[4:7], v[100:103], v[188:191]
    ds_read_b64_tr_b16 v[4:5], v247 offset:0
    v_mfma_f32_16x16x32_bf16 v[188:191], v[8:11], v[104:107], v[188:191]
    ds_read_b64_tr_b16 v[6:7], v247 offset:2048
    v_mfma_f32_16x16x32_bf16 v[188:191], v[12:15], v[108:111], v[188:191]
    ds_read_b64_tr_b16 v[8:9], v247 offset:4096
    v_mfma_f32_16x16x32_bf16 v[188:191], v[16:19], v[112:115], v[188:191]
    s_waitcnt lgkmcnt(7)
    ds_read_b64_tr_b16 v[10:11], v247 offset:6144
    v_add_u32 v246, 16384, v246
    v_mfma_f32_16x16x32_bf16 v[176:179], v[204:207], v[36:39], v[176:179]
    ds_read_b64_tr_b16 v[12:13], v247 offset:8192
    v_mfma_f32_16x16x32_bf16 v[176:179], v[208:211], v[40:43], v[176:179]
    ds_read_b64_tr_b16 v[14:15], v247 offset:10240
    s_mul_i32 s41, s36, 9216
    s_waitcnt lgkmcnt(7)
    v_mfma_f32_16x16x32_bf16 v[176:179], v[212:215], v[44:47], v[176:179]
    ds_read_b64_tr_b16 v[16:17], v247 offset:12288
    s_add_u32 s41, s41, 114688
    v_mfma_f32_16x16x32_bf16 v[176:179], v[216:219], v[48:51], v[176:179]
    ds_read_b64_tr_b16 v[18:19], v247 offset:14336
    v_add_u32 v1, s41, v0
    v_mfma_f32_16x16x32_bf16 v[192:195], v[204:207], v[100:103], v[192:195]
    ds_read_b64_tr_b16 v[204:205], v244 offset:0
    v_mfma_f32_16x16x32_bf16 v[192:195], v[208:211], v[104:107], v[192:195]
    ds_read_b64_tr_b16 v[206:207], v244 offset:2048
    v_mfma_f32_16x16x32_bf16 v[192:195], v[212:215], v[108:111], v[192:195]
    ds_read_b64_tr_b16 v[208:209], v244 offset:4096
    v_mfma_f32_16x16x32_bf16 v[192:195], v[216:219], v[112:115], v[192:195]
    s_waitcnt lgkmcnt(6)
    ds_read_b64_tr_b16 v[210:211], v244 offset:6144
    v_add_u32 v247, 16384, v247
    v_mfma_f32_16x16x32_bf16 v[180:183], v[4:7], v[36:39], v[180:183]
    ds_read_b64_tr_b16 v[212:213], v244 offset:8192
    v_mfma_f32_16x16x32_bf16 v[180:183], v[8:11], v[40:43], v[180:183]
    s_waitcnt lgkmcnt(6)
    ds_read_b64_tr_b16 v[214:215], v244 offset:10240
    v_mfma_f32_16x16x32_bf16 v[180:183], v[12:15], v[44:47], v[180:183]
    s_waitcnt lgkmcnt(6)
    ds_read_b64_tr_b16 v[216:217], v244 offset:12288
    v_mfma_f32_16x16x32_bf16 v[180:183], v[16:19], v[48:51], v[180:183]
    ds_read_b64_tr_b16 v[218:219], v244 offset:14336
    v_mfma_f32_16x16x32_bf16 v[196:199], v[4:7], v[100:103], v[196:199]
    ds_read_b64_tr_b16 v[4:5], v245 offset:0
    v_mfma_f32_16x16x32_bf16 v[196:199], v[8:11], v[104:107], v[196:199]
    ds_read_b64_tr_b16 v[6:7], v245 offset:2048
    v_mfma_f32_16x16x32_bf16 v[196:199], v[12:15], v[108:111], v[196:199]
    ds_read_b64_tr_b16 v[8:9], v245 offset:4096
    v_mfma_f32_16x16x32_bf16 v[196:199], v[16:19], v[112:115], v[196:199]
    s_waitcnt lgkmcnt(7)
    ds_read_b64_tr_b16 v[10:11], v245 offset:6144
    v_mfma_f32_16x16x32_bf16 v[200:203], v[204:207], v[220:223], v[200:203]
    ds_read_b128 v[220:223], v3 offset:15360
    v_mfma_f32_16x16x32_bf16 v[200:203], v[208:211], v[240:243], v[200:203]
    s_waitcnt lgkmcnt(7)
    ds_read_b64_tr_b16 v[12:13], v245 offset:8192
    v_mfma_f32_16x16x32_bf16 v[200:203], v[212:215], v[252:255], v[200:203]
    ds_read_b64_tr_b16 v[14:15], v245 offset:10240
    v_mfma_f32_16x16x32_bf16 v[168:171], v[204:207], v[52:55], v[168:171]
    ds_read_b64_tr_b16 v[16:17], v245 offset:12288
    v_mfma_f32_16x16x32_bf16 v[168:171], v[208:211], v[56:59], v[168:171]
    ds_read_b64_tr_b16 v[18:19], v245 offset:14336
    v_mfma_f32_16x16x32_bf16 v[168:171], v[212:215], v[60:63], v[168:171]
    s_waitcnt lgkmcnt(8)
    v_mfma_f32_16x16x32_bf16 v[168:171], v[216:219], v[64:67], v[168:171]
    v_mfma_f32_16x16x32_bf16 v[184:187], v[204:207], v[116:119], v[184:187]
    ds_read_b64_tr_b16 v[204:205], v246 offset:0
    v_mfma_f32_16x16x32_bf16 v[184:187], v[208:211], v[120:123], v[184:187]
    ds_read_b64_tr_b16 v[206:207], v246 offset:2048
    v_mfma_f32_16x16x32_bf16 v[184:187], v[212:215], v[124:127], v[184:187]
    ds_read_b64_tr_b16 v[208:209], v246 offset:4096
    v_mfma_f32_16x16x32_bf16 v[184:187], v[216:219], v[128:131], v[184:187]
    s_waitcnt lgkmcnt(6)
    ds_read_b64_tr_b16 v[210:211], v246 offset:6144
    v_mfma_f32_16x16x32_bf16 v[200:203], v[216:219], v[220:223], v[200:203]
    ds_read_b64_tr_b16 v[212:213], v246 offset:8192
    v_mfma_f32_16x16x32_bf16 v[172:175], v[4:7], v[52:55], v[172:175]
    ds_read_b64_tr_b16 v[214:215], v246 offset:10240
    v_mfma_f32_16x16x32_bf16 v[172:175], v[8:11], v[56:59], v[172:175]
    s_waitcnt lgkmcnt(6)
    ds_read_b64_tr_b16 v[216:217], v246 offset:12288
    v_mfma_f32_16x16x32_bf16 v[172:175], v[12:15], v[60:63], v[172:175]
    ds_read_b64_tr_b16 v[218:219], v246 offset:14336
    v_mfma_f32_16x16x32_bf16 v[172:175], v[16:19], v[64:67], v[172:175]
    ds_write_b128 v1, v[168:171] offset:0
    v_mfma_f32_16x16x32_bf16 v[188:191], v[4:7], v[116:119], v[188:191]
    ds_read_b64_tr_b16 v[4:5], v247 offset:0
    v_mfma_f32_16x16x32_bf16 v[188:191], v[8:11], v[120:123], v[188:191]
    ds_read_b64_tr_b16 v[6:7], v247 offset:2048
    v_mfma_f32_16x16x32_bf16 v[188:191], v[12:15], v[124:127], v[188:191]
    ds_read_b64_tr_b16 v[8:9], v247 offset:4096
    v_mfma_f32_16x16x32_bf16 v[188:191], v[16:19], v[128:131], v[188:191]
    s_waitcnt lgkmcnt(8)
    ds_read_b64_tr_b16 v[10:11], v247 offset:6144
    v_mfma_f32_16x16x32_bf16 v[176:179], v[204:207], v[52:55], v[176:179]
    ds_read_b64_tr_b16 v[12:13], v247 offset:8192
    v_mfma_f32_16x16x32_bf16 v[176:179], v[208:211], v[56:59], v[176:179]
    s_waitcnt lgkmcnt(7)
    ds_read_b64_tr_b16 v[14:15], v247 offset:10240
    v_mfma_f32_16x16x32_bf16 v[176:179], v[212:215], v[60:63], v[176:179]
    s_waitcnt lgkmcnt(7)
    ds_read_b64_tr_b16 v[16:17], v247 offset:12288
    v_mfma_f32_16x16x32_bf16 v[176:179], v[216:219], v[64:67], v[176:179]
    ds_read_b64_tr_b16 v[18:19], v247 offset:14336
    v_mfma_f32_16x16x32_bf16 v[192:195], v[204:207], v[116:119], v[192:195]
    ds_write_b128 v1, v[184:187] offset:4096
    v_mfma_f32_16x16x32_bf16 v[192:195], v[208:211], v[120:123], v[192:195]
    v_mfma_f32_16x16x32_bf16 v[192:195], v[212:215], v[124:127], v[192:195]
    ds_write_b128 v1, v[200:203] offset:8192
    v_mfma_f32_16x16x32_bf16 v[192:195], v[216:219], v[128:131], v[192:195]
    s_waitcnt lgkmcnt(7)
    v_mfma_f32_16x16x32_bf16 v[180:183], v[4:7], v[52:55], v[180:183]
    s_waitcnt lgkmcnt(6)
    ds_write_b128 v1, v[172:175] offset:1024
    v_mfma_f32_16x16x32_bf16 v[180:183], v[8:11], v[56:59], v[180:183]
    s_waitcnt lgkmcnt(5)
    v_mfma_f32_16x16x32_bf16 v[180:183], v[12:15], v[60:63], v[180:183]
    s_waitcnt lgkmcnt(3)
    ds_write_b128 v1, v[188:191] offset:5120
    v_mfma_f32_16x16x32_bf16 v[180:183], v[16:19], v[64:67], v[180:183]
    v_mfma_f32_16x16x32_bf16 v[196:199], v[4:7], v[116:119], v[196:199]
    ds_write_b128 v1, v[176:179] offset:2048
    v_mfma_f32_16x16x32_bf16 v[196:199], v[8:11], v[120:123], v[196:199]
    v_mfma_f32_16x16x32_bf16 v[196:199], v[12:15], v[124:127], v[196:199]
    v_mfma_f32_16x16x32_bf16 v[196:199], v[16:19], v[128:131], v[196:199]
    ds_write_b128 v1, v[192:195] offset:6144
    s_nop 1
    ds_write_b128 v1, v[180:183] offset:3072
    s_nop 3
    ds_write_b128 v1, v[196:199] offset:7168
    s_waitcnt lgkmcnt(0)
    s_barrier
L_end:
    s_endpgm
L_restart:
    s_waitcnt vmcnt(0) lgkmcnt(0)
    s_barrier
    s_add_u32 s49, s49, 1
    s_setprio 0
    s_mov_b64 s[50:51], 0
    s_mov_b64 s[52:53], 0
    v_mbcnt_lo_u32_b32 v0, -1, 0
    v_mbcnt_hi_u32_b32 v0, -1, v0
    s_branch L_role
L_hkm15pre:
    s_nop 7
    s_cmp_eq_u32 s49, 2
    s_cbranch_scc1 L_hsm15pre
    v_mov_b32 v241, 0xff800000
    v_mov_b32 v242, 0xff800000
    v_max3_f32 v241, v241, v124, v125
    v_max3_f32 v241, v241, v126, v127
    v_max3_f32 v241, v241, v132, v133
    v_max3_f32 v241, v241, v134, v135
    v_max3_f32 v242, v242, v128, v129
    v_max3_f32 v242, v242, v130, v131
    v_max3_f32 v242, v242, v136, v137
    v_max3_f32 v242, v242, v138, v139
    s_branch L_hrm15pre
L_hsm15pre:
    s_mul_i32 s96, s2, 12288
    s_mul_i32 s97, s38, 3072
    s_add_u32 s96, s96, s97
    s_mul_i32 s97, s36, 768
    v_and_b32 v248, 15, v0
    v_lshlrev_b32 v248, 4, v248
    s_add_u32 s96, s96, 65536
    s_add_u32 s97, s97, s96
    v_mov_b32 v241, 0xff800000
    buffer_load_dwordx4 v[244:247], v248, s[28:31], s97 offen offset:0 sc1
    s_waitcnt vmcnt(0)
    v_max3_f32 v241, v241, v244, v245
    v_max3_f32 v241, v241, v246, v247
    v_mov_b32 v242, 0xff800000
    buffer_load_dwordx4 v[244:247], v248, s[28:31], s97 offen offset:256 sc1
    s_waitcnt vmcnt(0)
    v_max3_f32 v242, v242, v244, v245
    v_max3_f32 v242, v242, v246, v247
    v_sub_f32 v124, v124, v241
    v_sub_f32 v125, v125, v241
    v_sub_f32 v126, v126, v241
    v_sub_f32 v127, v127, v241
    v_sub_f32 v132, v132, v241
    v_sub_f32 v133, v133, v241
    v_sub_f32 v134, v134, v241
    v_sub_f32 v135, v135, v241
    v_sub_f32 v128, v128, v242
    v_sub_f32 v129, v129, v242
    v_sub_f32 v130, v130, v242
    v_sub_f32 v131, v131, v242
    v_sub_f32 v136, v136, v242
    v_sub_f32 v137, v137, v242
    v_sub_f32 v138, v138, v242
    v_sub_f32 v139, v139, v242
    s_branch L_hrm15pre
L_hkx15pre:
    s_nop 7
    s_cmp_eq_u32 s49, 2
    s_cbranch_scc1 L_hsx15pre
    v_mov_b32 v243, 0xff800000
    v_max3_f32 v243, v243, v156, v157
    v_max3_f32 v243, v243, v158, v159
    s_branch L_hrx15pre
L_hsx15pre:
    s_mul_i32 s96, s2, 12288
    s_mul_i32 s97, s38, 3072
    s_add_u32 s96, s96, s97
    s_mul_i32 s97, s36, 768
    v_and_b32 v248, 15, v0
    v_lshlrev_b32 v248, 4, v248
    s_add_u32 s96, s96, 65536
    s_add_u32 s97, s97, s96
    v_mov_b32 v243, 0xff800000
    buffer_load_dwordx4 v[244:247], v248, s[28:31], s96 offen offset:512 sc1
    s_waitcnt vmcnt(0)
    v_max3_f32 v243, v243, v244, v245
    v_max3_f32 v243, v243, v246, v247
    buffer_load_dwordx4 v[244:247], v248, s[28:31], s96 offen offset:1280 sc1
    s_waitcnt vmcnt(0)
    v_max3_f32 v243, v243, v244, v245
    v_max3_f32 v243, v243, v246, v247
    buffer_load_dwordx4 v[244:247], v248, s[28:31], s96 offen offset:2048 sc1
    s_waitcnt vmcnt(0)
    v_max3_f32 v243, v243, v244, v245
    v_max3_f32 v243, v243, v246, v247
    buffer_load_dwordx4 v[244:247], v248, s[28:31], s96 offen offset:2816 sc1
    s_waitcnt vmcnt(0)
    v_max3_f32 v243, v243, v244, v245
    v_max3_f32 v243, v243, v246, v247
    v_sub_f32 v156, v156, v243
    v_sub_f32 v157, v157, v243
    v_sub_f32 v158, v158, v243
    v_sub_f32 v159, v159, v243
    s_branch L_hrx15pre
L_hkm0first:
    s_nop 7
    s_cmp_eq_u32 s49, 2
    s_cbranch_scc1 L_hsm0first
    v_max3_f32 v241, v241, v140, v141
    v_max3_f32 v241, v241, v142, v143
    v_max3_f32 v241, v241, v148, v149
    v_max3_f32 v241, v241, v150, v151
    v_max3_f32 v242, v242, v144, v145
    v_max3_f32 v242, v242, v146, v147
    v_max3_f32 v242, v242, v152, v153
    v_max3_f32 v242, v242, v154, v155
    s_branch L_hrm0first
L_hsm0first:
    v_sub_f32 v140, v140, v241
    v_sub_f32 v141, v141, v241
    v_sub_f32 v142, v142, v241
    v_sub_f32 v143, v143, v241
    v_sub_f32 v148, v148, v241
    v_sub_f32 v149, v149, v241
    v_sub_f32 v150, v150, v241
    v_sub_f32 v151, v151, v241
    v_sub_f32 v144, v144, v242
    v_sub_f32 v145, v145, v242
    v_sub_f32 v146, v146, v242
    v_sub_f32 v147, v147, v242
    v_sub_f32 v152, v152, v242
    v_sub_f32 v153, v153, v242
    v_sub_f32 v154, v154, v242
    v_sub_f32 v155, v155, v242
    s_branch L_hrm0first
L_hkm15:
    s_nop 7
    s_cmp_eq_u32 s49, 2
    s_cbranch_scc1 L_hsm15
    s_mul_i32 s96, s2, 12288
    s_mul_i32 s97, s38, 3072
    s_add_u32 s96, s96, s97
    s_mul_i32 s97, s36, 768
    v_and_b32 v248, 15, v0
    v_lshlrev_b32 v248, 4, v248
    s_add_u32 s96, s96, s97
    s_add_u32 s96, s96, 62464
    v_lshrrev_b32 v244, 4, v0
    v_lshl_add_u32 v248, v244, 2, v248
    buffer_store_dword v241, v248, s[28:31], s96 offen offset:0 sc1
    buffer_store_dword v242, v248, s[28:31], s96 offen offset:256 sc1
    s_waitcnt vmcnt(0)
    v_mov_b32 v241, 0xff800000
    v_mov_b32 v242, 0xff800000
    v_max3_f32 v241, v241, v124, v125
    v_max3_f32 v241, v241, v126, v127
    v_max3_f32 v241, v241, v132, v133
    v_max3_f32 v241, v241, v134, v135
    v_max3_f32 v242, v242, v128, v129
    v_max3_f32 v242, v242, v130, v131
    v_max3_f32 v242, v242, v136, v137
    v_max3_f32 v242, v242, v138, v139
    s_branch L_hrm15
L_hsm15:
    s_mul_i32 s96, s2, 12288
    s_mul_i32 s97, s38, 3072
    s_add_u32 s96, s96, s97
    s_mul_i32 s97, s36, 768
    v_and_b32 v248, 15, v0
    v_lshlrev_b32 v248, 4, v248
    s_add_u32 s96, s96, 65536
    s_add_u32 s97, s97, s96
    v_mov_b32 v241, 0xff800000
    buffer_load_dwordx4 v[244:247], v248, s[28:31], s97 offen offset:0 sc1
    s_waitcnt vmcnt(0)
    v_max3_f32 v241, v241, v244, v245
    v_max3_f32 v241, v241, v246, v247
    v_mov_b32 v242, 0xff800000
    buffer_load_dwordx4 v[244:247], v248, s[28:31], s97 offen offset:256 sc1
    s_waitcnt vmcnt(0)
    v_max3_f32 v242, v242, v244, v245
    v_max3_f32 v242, v242, v246, v247
    v_sub_f32 v124, v124, v241
    v_sub_f32 v125, v125, v241
    v_sub_f32 v126, v126, v241
    v_sub_f32 v127, v127, v241
    v_sub_f32 v132, v132, v241
    v_sub_f32 v133, v133, v241
    v_sub_f32 v134, v134, v241
    v_sub_f32 v135, v135, v241
    v_sub_f32 v128, v128, v242
    v_sub_f32 v129, v129, v242
    v_sub_f32 v130, v130, v242
    v_sub_f32 v131, v131, v242
    v_sub_f32 v136, v136, v242
    v_sub_f32 v137, v137, v242
    v_sub_f32 v138, v138, v242
    v_sub_f32 v139, v139, v242
    s_branch L_hrm15
L_hkx15:
    s_nop 7
    s_cmp_eq_u32 s49, 2
    s_cbranch_scc1 L_hsx15
    s_mul_i32 s96, s2, 12288
    s_mul_i32 s97, s38, 3072
    s_add_u32 s96, s96, s97
    s_mul_i32 s97, s36, 768
    v_and_b32 v248, 15, v0
    v_lshlrev_b32 v248, 4, v248
    s_add_u32 s96, s96, s97
    s_add_u32 s96, s96, 62464
    v_lshrrev_b32 v244, 4, v0
    v_lshl_add_u32 v248, v244, 2, v248
    buffer_store_dword v243, v248, s[28:31], s96 offen offset:512 sc1
    s_waitcnt vmcnt(0)
    v_mov_b32 v243, 0xff800000
    v_max3_f32 v243, v243, v156, v157
    v_max3_f32 v243, v243, v158, v159
    s_branch L_hrx15
L_hsx15:
    s_mul_i32 s96, s2, 12288
    s_mul_i32 s97, s38, 3072
    s_add_u32 s96, s96, s97
    s_mul_i32 s97, s36, 768
    v_and_b32 v248, 15, v0
    v_lshlrev_b32 v248, 4, v248
    s_add_u32 s96, s96, 65536
    s_add_u32 s97, s97, s96
    v_mov_b32 v243, 0xff800000
    buffer_load_dwordx4 v[244:247], v248, s[28:31], s96 offen offset:512 sc1
    s_waitcnt vmcnt(0)
    v_max3_f32 v243, v243, v244, v245
    v_max3_f32 v243, v243, v246, v247
    buffer_load_dwordx4 v[244:247], v248, s[28:31], s96 offen offset:1280 sc1
    s_waitcnt vmcnt(0)
    v_max3_f32 v243, v243, v244, v245
    v_max3_f32 v243, v243, v246, v247
    buffer_load_dwordx4 v[244:247], v248, s[28:31], s96 offen offset:2048 sc1
    s_waitcnt vmcnt(0)
    v_max3_f32 v243, v243, v244, v245
    v_max3_f32 v243, v243, v246, v247
    buffer_load_dwordx4 v[244:247], v248, s[28:31], s96 offen offset:2816 sc1
    s_waitcnt vmcnt(0)
    v_max3_f32 v243, v243, v244, v245
    v_max3_f32 v243, v243, v246, v247
    v_sub_f32 v156, v156, v243
    v_sub_f32 v157, v157, v243
    v_sub_f32 v158, v158, v243
    v_sub_f32 v159, v159, v243
    s_branch L_hrx15
L_hkm0:
    s_nop 7
    s_cmp_eq_u32 s49, 2
    s_cbranch_scc1 L_hsm0
    v_max3_f32 v241, v241, v140, v141
    v_max3_f32 v241, v241, v142, v143
    v_max3_f32 v241, v241, v148, v149
    v_max3_f32 v241, v241, v150, v151
    v_max3_f32 v242, v242, v144, v145
    v_max3_f32 v242, v242, v146, v147
    v_max3_f32 v242, v242, v152, v153
    v_max3_f32 v242, v242, v154, v155
    s_branch L_hrm0
L_hsm0:
    v_sub_f32 v140, v140, v241
    v_sub_f32 v141, v141, v241
    v_sub_f32 v142, v142, v241
    v_sub_f32 v143, v143, v241
    v_sub_f32 v148, v148, v241
    v_sub_f32 v149, v149, v241
    v_sub_f32 v150, v150, v241
    v_sub_f32 v151, v151, v241
    v_sub_f32 v144, v144, v242
    v_sub_f32 v145, v145, v242
    v_sub_f32 v146, v146, v242
    v_sub_f32 v147, v147, v242
    v_sub_f32 v152, v152, v242
    v_sub_f32 v153, v153, v242
    v_sub_f32 v154, v154, v242
    v_sub_f32 v155, v155, v242
    s_branch L_hrm0
L_hkm1:
    s_nop 7
    s_cmp_eq_u32 s49, 2
    s_cbranch_scc1 L_hsm1
    v_max3_f32 v241, v241, v124, v125
    v_max3_f32 v241, v241, v126, v127
    v_max3_f32 v241, v241, v132, v133
    v_max3_f32 v241, v241, v134, v135
    v_max3_f32 v242, v242, v128, v129
    v_max3_f32 v242, v242, v130, v131
    v_max3_f32 v242, v242, v136, v137
    v_max3_f32 v242, v242, v138, v139
    s_branch L_hrm1
L_hsm1:
    v_sub_f32 v124, v124, v241
    v_sub_f32 v125, v125, v241
    v_sub_f32 v126, v126, v241
    v_sub_f32 v127, v127, v241
    v_sub_f32 v132, v132, v241
    v_sub_f32 v133, v133, v241
    v_sub_f32 v134, v134, v241
    v_sub_f32 v135, v135, v241
    v_sub_f32 v128, v128, v242
    v_sub_f32 v129, v129, v242
    v_sub_f32 v130, v130, v242
    v_sub_f32 v131, v131, v242
    v_sub_f32 v136, v136, v242
    v_sub_f32 v137, v137, v242
    v_sub_f32 v138, v138, v242
    v_sub_f32 v139, v139, v242
    s_branch L_hrm1
L_hkx1:
    s_nop 7
    s_cmp_eq_u32 s49, 2
    s_cbranch_scc1 L_hsx1
    v_max3_f32 v243, v243, v156, v157
    v_max3_f32 v243, v243, v158, v159
    s_branch L_hrx1
L_hsx1:
    v_sub_f32 v156, v156, v243
    v_sub_f32 v157, v157, v243
    v_sub_f32 v158, v158, v243
    v_sub_f32 v159, v159, v243
    s_branch L_hrx1
L_hkm2:
    s_nop 7
    s_cmp_eq_u32 s49, 2
    s_cbranch_scc1 L_hsm2
    v_max3_f32 v241, v241, v140, v141
    v_max3_f32 v241, v241, v142, v143
    v_max3_f32 v241, v241, v148, v149
    v_max3_f32 v241, v241, v150, v151
    v_max3_f32 v242, v242, v144, v145
    v_max3_f32 v242, v242, v146, v147
    v_max3_f32 v242, v242, v152, v153
    v_max3_f32 v242, v242, v154, v155
    s_branch L_hrm2
L_hsm2:
    v_sub_f32 v140, v140, v241
    v_sub_f32 v141, v141, v241
    v_sub_f32 v142, v142, v241
    v_sub_f32 v143, v143, v241
    v_sub_f32 v148, v148, v241
    v_sub_f32 v149, v149, v241
    v_sub_f32 v150, v150, v241
    v_sub_f32 v151, v151, v241
    v_sub_f32 v144, v144, v242
    v_sub_f32 v145, v145, v242
    v_sub_f32 v146, v146, v242
    v_sub_f32 v147, v147, v242
    v_sub_f32 v152, v152, v242
    v_sub_f32 v153, v153, v242
    v_sub_f32 v154, v154, v242
    v_sub_f32 v155, v155, v242
    s_branch L_hrm2
L_hkm3:
    s_nop 7
    s_cmp_eq_u32 s49, 2
    s_cbranch_scc1 L_hsm3
    v_max3_f32 v241, v241, v124, v125
    v_max3_f32 v241, v241, v126, v127
    v_max3_f32 v241, v241, v132, v133
    v_max3_f32 v241, v241, v134, v135
    v_max3_f32 v242, v242, v128, v129
    v_max3_f32 v242, v242, v130, v131
    v_max3_f32 v242, v242, v136, v137
    v_max3_f32 v242, v242, v138, v139
    s_branch L_hrm3
L_hsm3:
    v_sub_f32 v124, v124, v241
    v_sub_f32 v125, v125, v241
    v_sub_f32 v126, v126, v241
    v_sub_f32 v127, v127, v241
    v_sub_f32 v132, v132, v241
    v_sub_f32 v133, v133, v241
    v_sub_f32 v134, v134, v241
    v_sub_f32 v135, v135, v241
    v_sub_f32 v128, v128, v242
    v_sub_f32 v129, v129, v242
    v_sub_f32 v130, v130, v242
    v_sub_f32 v131, v131, v242
    v_sub_f32 v136, v136, v242
    v_sub_f32 v137, v137, v242
    v_sub_f32 v138, v138, v242
    v_sub_f32 v139, v139, v242
    s_branch L_hrm3
L_hkx3:
    s_nop 7
    s_cmp_eq_u32 s49, 2
    s_cbranch_scc1 L_hsx3
    v_max3_f32 v243, v243, v156, v157
    v_max3_f32 v243, v243, v158, v159
    s_branch L_hrx3
L_hsx3:
    v_sub_f32 v156, v156, v243
    v_sub_f32 v157, v157, v243
    v_sub_f32 v158, v158, v243
    v_sub_f32 v159, v159, v243
    s_branch L_hrx3
L_hkm4:
    s_nop 7
    s_cmp_eq_u32 s49, 2
    s_cbranch_scc1 L_hsm4
    v_max3_f32 v241, v241, v140, v141
    v_max3_f32 v241, v241, v142, v143
    v_max3_f32 v241, v241, v148, v149
    v_max3_f32 v241, v241, v150, v151
    v_max3_f32 v242, v242, v144, v145
    v_max3_f32 v242, v242, v146, v147
    v_max3_f32 v242, v242, v152, v153
    v_max3_f32 v242, v242, v154, v155
    s_branch L_hrm4
L_hsm4:
    v_sub_f32 v140, v140, v241
    v_sub_f32 v141, v141, v241
    v_sub_f32 v142, v142, v241
    v_sub_f32 v143, v143, v241
    v_sub_f32 v148, v148, v241
    v_sub_f32 v149, v149, v241
    v_sub_f32 v150, v150, v241
    v_sub_f32 v151, v151, v241
    v_sub_f32 v144, v144, v242
    v_sub_f32 v145, v145, v242
    v_sub_f32 v146, v146, v242
    v_sub_f32 v147, v147, v242
    v_sub_f32 v152, v152, v242
    v_sub_f32 v153, v153, v242
    v_sub_f32 v154, v154, v242
    v_sub_f32 v155, v155, v242
    s_branch L_hrm4
L_hkm5:
    s_nop 7
    s_cmp_eq_u32 s49, 2
    s_cbranch_scc1 L_hsm5
    v_max3_f32 v241, v241, v124, v125
    v_max3_f32 v241, v241, v126, v127
    v_max3_f32 v241, v241, v132, v133
    v_max3_f32 v241, v241, v134, v135
    v_max3_f32 v242, v242, v128, v129
    v_max3_f32 v242, v242, v130, v131
    v_max3_f32 v242, v242, v136, v137
    v_max3_f32 v242, v242, v138, v139
    s_branch L_hrm5
L_hsm5:
    v_sub_f32 v124, v124, v241
    v_sub_f32 v125, v125, v241
    v_sub_f32 v126, v126, v241
    v_sub_f32 v127, v127, v241
    v_sub_f32 v132, v132, v241
    v_sub_f32 v133, v133, v241
    v_sub_f32 v134, v134, v241
    v_sub_f32 v135, v135, v241
    v_sub_f32 v128, v128, v242
    v_sub_f32 v129, v129, v242
    v_sub_f32 v130, v130, v242
    v_sub_f32 v131, v131, v242
    v_sub_f32 v136, v136, v242
    v_sub_f32 v137, v137, v242
    v_sub_f32 v138, v138, v242
    v_sub_f32 v139, v139, v242
    s_branch L_hrm5
L_hkx5:
    s_nop 7
    s_cmp_eq_u32 s49, 2
    s_cbranch_scc1 L_hsx5
    v_max3_f32 v243, v243, v156, v157
    v_max3_f32 v243, v243, v158, v159
    s_branch L_hrx5
L_hsx5:
    v_sub_f32 v156, v156, v243
    v_sub_f32 v157, v157, v243
    v_sub_f32 v158, v158, v243
    v_sub_f32 v159, v159, v243
    s_branch L_hrx5
L_hkm6:
    s_nop 7
    s_cmp_eq_u32 s49, 2
    s_cbranch_scc1 L_hsm6
    v_max3_f32 v241, v241, v140, v141
    v_max3_f32 v241, v241, v142, v143
    v_max3_f32 v241, v241, v148, v149
    v_max3_f32 v241, v241, v150, v151
    v_max3_f32 v242, v242, v144, v145
    v_max3_f32 v242, v242, v146, v147
    v_max3_f32 v242, v242, v152, v153
    v_max3_f32 v242, v242, v154, v155
    s_branch L_hrm6
L_hsm6:
    v_sub_f32 v140, v140, v241
    v_sub_f32 v141, v141, v241
    v_sub_f32 v142, v142, v241
    v_sub_f32 v143, v143, v241
    v_sub_f32 v148, v148, v241
    v_sub_f32 v149, v149, v241
    v_sub_f32 v150, v150, v241
    v_sub_f32 v151, v151, v241
    v_sub_f32 v144, v144, v242
    v_sub_f32 v145, v145, v242
    v_sub_f32 v146, v146, v242
    v_sub_f32 v147, v147, v242
    v_sub_f32 v152, v152, v242
    v_sub_f32 v153, v153, v242
    v_sub_f32 v154, v154, v242
    v_sub_f32 v155, v155, v242
    s_branch L_hrm6
L_hkm7:
    s_nop 7
    s_cmp_eq_u32 s49, 2
    s_cbranch_scc1 L_hsm7
    v_max3_f32 v241, v241, v124, v125
    v_max3_f32 v241, v241, v126, v127
    v_max3_f32 v241, v241, v132, v133
    v_max3_f32 v241, v241, v134, v135
    v_max3_f32 v242, v242, v128, v129
    v_max3_f32 v242, v242, v130, v131
    v_max3_f32 v242, v242, v136, v137
    v_max3_f32 v242, v242, v138, v139
    s_branch L_hrm7
L_hsm7:
    v_sub_f32 v124, v124, v241
    v_sub_f32 v125, v125, v241
    v_sub_f32 v126, v126, v241
    v_sub_f32 v127, v127, v241
    v_sub_f32 v132, v132, v241
    v_sub_f32 v133, v133, v241
    v_sub_f32 v134, v134, v241
    v_sub_f32 v135, v135, v241
    v_sub_f32 v128, v128, v242
    v_sub_f32 v129, v129, v242
    v_sub_f32 v130, v130, v242
    v_sub_f32 v131, v131, v242
    v_sub_f32 v136, v136, v242
    v_sub_f32 v137, v137, v242
    v_sub_f32 v138, v138, v242
    v_sub_f32 v139, v139, v242
    s_branch L_hrm7
L_hkx7:
    s_nop 7
    s_cmp_eq_u32 s49, 2
    s_cbranch_scc1 L_hsx7
    v_max3_f32 v243, v243, v156, v157
    v_max3_f32 v243, v243, v158, v159
    s_branch L_hrx7
L_hsx7:
    v_sub_f32 v156, v156, v243
    v_sub_f32 v157, v157, v243
    v_sub_f32 v158, v158, v243
    v_sub_f32 v159, v159, v243
    s_branch L_hrx7
L_hkm8:
    s_nop 7
    s_cmp_eq_u32 s49, 2
    s_cbranch_scc1 L_hsm8
    v_max3_f32 v241, v241, v140, v141
    v_max3_f32 v241, v241, v142, v143
    v_max3_f32 v241, v241, v148, v149
    v_max3_f32 v241, v241, v150, v151
    v_max3_f32 v242, v242, v144, v145
    v_max3_f32 v242, v242, v146, v147
    v_max3_f32 v242, v242, v152, v153
    v_max3_f32 v242, v242, v154, v155
    s_branch L_hrm8
L_hsm8:
    v_sub_f32 v140, v140, v241
    v_sub_f32 v141, v141, v241
    v_sub_f32 v142, v142, v241
    v_sub_f32 v143, v143, v241
    v_sub_f32 v148, v148, v241
    v_sub_f32 v149, v149, v241
    v_sub_f32 v150, v150, v241
    v_sub_f32 v151, v151, v241
    v_sub_f32 v144, v144, v242
    v_sub_f32 v145, v145, v242
    v_sub_f32 v146, v146, v242
    v_sub_f32 v147, v147, v242
    v_sub_f32 v152, v152, v242
    v_sub_f32 v153, v153, v242
    v_sub_f32 v154, v154, v242
    v_sub_f32 v155, v155, v242
    s_branch L_hrm8
L_hkm9:
    s_nop 7
    s_cmp_eq_u32 s49, 2
    s_cbranch_scc1 L_hsm9
    v_max3_f32 v241, v241, v124, v125
    v_max3_f32 v241, v241, v126, v127
    v_max3_f32 v241, v241, v132, v133
    v_max3_f32 v241, v241, v134, v135
    v_max3_f32 v242, v242, v128, v129
    v_max3_f32 v242, v242, v130, v131
    v_max3_f32 v242, v242, v136, v137
    v_max3_f32 v242, v242, v138, v139
    s_branch L_hrm9
L_hsm9:
    v_sub_f32 v124, v124, v241
    v_sub_f32 v125, v125, v241
    v_sub_f32 v126, v126, v241
    v_sub_f32 v127, v127, v241
    v_sub_f32 v132, v132, v241
    v_sub_f32 v133, v133, v241
    v_sub_f32 v134, v134, v241
    v_sub_f32 v135, v135, v241
    v_sub_f32 v128, v128, v242
    v_sub_f32 v129, v129, v242
    v_sub_f32 v130, v130, v242
    v_sub_f32 v131, v131, v242
    v_sub_f32 v136, v136, v242
    v_sub_f32 v137, v137, v242
    v_sub_f32 v138, v138, v242
    v_sub_f32 v139, v139, v242
    s_branch L_hrm9
L_hkx9:
    s_nop 7
    s_cmp_eq_u32 s49, 2
    s_cbranch_scc1 L_hsx9
    v_max3_f32 v243, v243, v156, v157
    v_max3_f32 v243, v243, v158, v159
    s_branch L_hrx9
L_hsx9:
    v_sub_f32 v156, v156, v243
    v_sub_f32 v157, v157, v243
    v_sub_f32 v158, v158, v243
    v_sub_f32 v159, v159, v243
    s_branch L_hrx9
L_hkm10:
    s_nop 7
    s_cmp_eq_u32 s49, 2
    s_cbranch_scc1 L_hsm10
    v_max3_f32 v241, v241, v140, v141
    v_max3_f32 v241, v241, v142, v143
    v_max3_f32 v241, v241, v148, v149
    v_max3_f32 v241, v241, v150, v151
    v_max3_f32 v242, v242, v144, v145
    v_max3_f32 v242, v242, v146, v147
    v_max3_f32 v242, v242, v152, v153
    v_max3_f32 v242, v242, v154, v155
    s_branch L_hrm10
L_hsm10:
    v_sub_f32 v140, v140, v241
    v_sub_f32 v141, v141, v241
    v_sub_f32 v142, v142, v241
    v_sub_f32 v143, v143, v241
    v_sub_f32 v148, v148, v241
    v_sub_f32 v149, v149, v241
    v_sub_f32 v150, v150, v241
    v_sub_f32 v151, v151, v241
    v_sub_f32 v144, v144, v242
    v_sub_f32 v145, v145, v242
    v_sub_f32 v146, v146, v242
    v_sub_f32 v147, v147, v242
    v_sub_f32 v152, v152, v242
    v_sub_f32 v153, v153, v242
    v_sub_f32 v154, v154, v242
    v_sub_f32 v155, v155, v242
    s_branch L_hrm10
L_hkm11:
    s_nop 7
    s_cmp_eq_u32 s49, 2
    s_cbranch_scc1 L_hsm11
    v_max3_f32 v241, v241, v124, v125
    v_max3_f32 v241, v241, v126, v127
    v_max3_f32 v241, v241, v132, v133
    v_max3_f32 v241, v241, v134, v135
    v_max3_f32 v242, v242, v128, v129
    v_max3_f32 v242, v242, v130, v131
    v_max3_f32 v242, v242, v136, v137
    v_max3_f32 v242, v242, v138, v139
    s_branch L_hrm11
L_hsm11:
    v_sub_f32 v124, v124, v241
    v_sub_f32 v125, v125, v241
    v_sub_f32 v126, v126, v241
    v_sub_f32 v127, v127, v241
    v_sub_f32 v132, v132, v241
    v_sub_f32 v133, v133, v241
    v_sub_f32 v134, v134, v241
    v_sub_f32 v135, v135, v241
    v_sub_f32 v128, v128, v242
    v_sub_f32 v129, v129, v242
    v_sub_f32 v130, v130, v242
    v_sub_f32 v131, v131, v242
    v_sub_f32 v136, v136, v242
    v_sub_f32 v137, v137, v242
    v_sub_f32 v138, v138, v242
    v_sub_f32 v139, v139, v242
    s_branch L_hrm11
L_hkx11:
    s_nop 7
    s_cmp_eq_u32 s49, 2
    s_cbranch_scc1 L_hsx11
    v_max3_f32 v243, v243, v156, v157
    v_max3_f32 v243, v243, v158, v159
    s_branch L_hrx11
L_hsx11:
    v_sub_f32 v156, v156, v243
    v_sub_f32 v157, v157, v243
    v_sub_f32 v158, v158, v243
    v_sub_f32 v159, v159, v243
    s_branch L_hrx11
L_hkm12:
    s_nop 7
    s_cmp_eq_u32 s49, 2
    s_cbranch_scc1 L_hsm12
    v_max3_f32 v241, v241, v140, v141
    v_max3_f32 v241, v241, v142, v143
    v_max3_f32 v241, v241, v148, v149
    v_max3_f32 v241, v241, v150, v151
    v_max3_f32 v242, v242, v144, v145
    v_max3_f32 v242, v242, v146, v147
    v_max3_f32 v242, v242, v152, v153
    v_max3_f32 v242, v242, v154, v155
    s_branch L_hrm12
L_hsm12:
    v_sub_f32 v140, v140, v241
    v_sub_f32 v141, v141, v241
    v_sub_f32 v142, v142, v241
    v_sub_f32 v143, v143, v241
    v_sub_f32 v148, v148, v241
    v_sub_f32 v149, v149, v241
    v_sub_f32 v150, v150, v241
    v_sub_f32 v151, v151, v241
    v_sub_f32 v144, v144, v242
    v_sub_f32 v145, v145, v242
    v_sub_f32 v146, v146, v242
    v_sub_f32 v147, v147, v242
    v_sub_f32 v152, v152, v242
    v_sub_f32 v153, v153, v242
    v_sub_f32 v154, v154, v242
    v_sub_f32 v155, v155, v242
    s_branch L_hrm12
L_hkm13:
    s_nop 7
    s_cmp_eq_u32 s49, 2
    s_cbranch_scc1 L_hsm13
    v_max3_f32 v241, v241, v124, v125
    v_max3_f32 v241, v241, v126, v127
    v_max3_f32 v241, v241, v132, v133
    v_max3_f32 v241, v241, v134, v135
    v_max3_f32 v242, v242, v128, v129
    v_max3_f32 v242, v242, v130, v131
    v_max3_f32 v242, v242, v136, v137
    v_max3_f32 v242, v242, v138, v139
    s_branch L_hrm13
L_hsm13:
    v_sub_f32 v124, v124, v241
    v_sub_f32 v125, v125, v241
    v_sub_f32 v126, v126, v241
    v_sub_f32 v127, v127, v241
    v_sub_f32 v132, v132, v241
    v_sub_f32 v133, v133, v241
    v_sub_f32 v134, v134, v241
    v_sub_f32 v135, v135, v241
    v_sub_f32 v128, v128, v242
    v_sub_f32 v129, v129, v242
    v_sub_f32 v130, v130, v242
    v_sub_f32 v131, v131, v242
    v_sub_f32 v136, v136, v242
    v_sub_f32 v137, v137, v242
    v_sub_f32 v138, v138, v242
    v_sub_f32 v139, v139, v242
    s_branch L_hrm13
L_hkx13:
    s_nop 7
    s_cmp_eq_u32 s49, 2
    s_cbranch_scc1 L_hsx13
    v_max3_f32 v243, v243, v156, v157
    v_max3_f32 v243, v243, v158, v159
    s_branch L_hrx13
L_hsx13:
    v_sub_f32 v156, v156, v243
    v_sub_f32 v157, v157, v243
    v_sub_f32 v158, v158, v243
    v_sub_f32 v159, v159, v243
    s_branch L_hrx13
L_hkm14:
    s_nop 7
    s_cmp_eq_u32 s49, 2
    s_cbranch_scc1 L_hsm14
    v_max3_f32 v241, v241, v140, v141
    v_max3_f32 v241, v241, v142, v143
    v_max3_f32 v241, v241, v148, v149
    v_max3_f32 v241, v241, v150, v151
    v_max3_f32 v242, v242, v144, v145
    v_max3_f32 v242, v242, v146, v147
    v_max3_f32 v242, v242, v152, v153
    v_max3_f32 v242, v242, v154, v155
    s_branch L_hrm14
L_hsm14:
    v_sub_f32 v140, v140, v241
    v_sub_f32 v141, v141, v241
    v_sub_f32 v142, v142, v241
    v_sub_f32 v143, v143, v241
    v_sub_f32 v148, v148, v241
    v_sub_f32 v149, v149, v241
    v_sub_f32 v150, v150, v241
    v_sub_f32 v151, v151, v241
    v_sub_f32 v144, v144, v242
    v_sub_f32 v145, v145, v242
    v_sub_f32 v146, v146, v242
    v_sub_f32 v147, v147, v242
    v_sub_f32 v152, v152, v242
    v_sub_f32 v153, v153, v242
    v_sub_f32 v154, v154, v242
    v_sub_f32 v155, v155, v242
    s_branch L_hrm14
L_hkfl:
    s_nop 7
    s_cmp_eq_u32 s49, 2
    s_cbranch_scc1 L_hsfl
    s_mul_i32 s96, s2, 12288
    s_mul_i32 s97, s38, 3072
    s_add_u32 s96, s96, s97
    s_mul_i32 s97, s36, 768
    v_and_b32 v248, 15, v0
    v_lshlrev_b32 v248, 4, v248
    s_add_u32 s96, s96, s97
    s_add_u32 s96, s96, 62464
    v_lshrrev_b32 v244, 4, v0
    v_lshl_add_u32 v248, v244, 2, v248
    buffer_store_dword v241, v248, s[28:31], s96 offen offset:0 sc1
    buffer_store_dword v242, v248, s[28:31], s96 offen offset:256 sc1
    buffer_store_dword v243, v248, s[28:31], s96 offen offset:512 sc1
    s_waitcnt vmcnt(0)
    s_branch L_hrfl
L_hsfl:
    s_branch L_hrfl
.section .rodata,"a"
.p2align 6
.amdhsa_kernel concat_heads__mha_block_cached__gqa_block_cached__near_ridge_kernel
  .amdhsa_next_free_vgpr 256
  .amdhsa_next_free_sgpr 102
  .amdhsa_accum_offset 256
  .amdhsa_group_segment_fixed_size 0
  .amdhsa_kernarg_size 104
  .amdhsa_user_sgpr_count 2
  .amdhsa_user_sgpr_kernarg_segment_ptr 1
  .amdhsa_system_sgpr_workgroup_id_x 1
.end_amdhsa_kernel
```
